```python
import torch

def _softmax(x, axis=-1):
    return torch.softmax(x, dim=axis)
def _gelu(x):
    return torch.nn.functional.gelu(x, approximate="tanh")
def _silu(x):
    return torch.nn.functional.silu(x)
def _sigmoid(x):
    return torch.sigmoid(x)
def _layernorm(x, axis=-1, eps=1e-5):
    m = x.mean(dim=axis, keepdim=True)
    v = x.var(dim=axis, keepdim=True, unbiased=False)
    return (x - m) / torch.sqrt(v + eps)
def _scatter_add(tgt, idx, src, axis=0):
    return tgt.clone().index_add_(axis, idx, src)
def _segment_sum(src, seg, n):
    out = torch.zeros((n,) + src.shape[1:], dtype=src.dtype)
    return out.index_add_(0, seg, src)
def _pad(x, pw):
    flat = tuple(v for pair in reversed(pw) for v in pair)
    return torch.nn.functional.pad(x, flat)

kernel_name = 'gated_mix__ssm_conv_s4__dense_activation_gelu__prompt'

def setup_inputs():

    _w = (lambda a: (lambda t: t.to(torch.bfloat16) if t.is_floating_point() else t)(torch.as_tensor(a)))
    def _A_setup():
        B, L, D, N = 1, 2048, 640, 128
        A_re = -(lambda _x: torch.exp(torch.as_tensor(_x)))((lambda *s: torch.randn(*s, dtype=torch.bfloat16) * 3.2)(D, N))
        A_im = torch.pi * (lambda *s: torch.randn(*s, dtype=torch.bfloat16) * 0.05)(D, N)
        B_re = (lambda *s: torch.randn(*s, dtype=torch.bfloat16) * 0.1)(D, N)
        B_im = (lambda *s: torch.randn(*s, dtype=torch.bfloat16) * 0.1)(D, N)
        C_re = (lambda *s: torch.randn(*s, dtype=torch.bfloat16) * 0.1)(D, N)
        C_im = (lambda *s: torch.randn(*s, dtype=torch.bfloat16) * 0.1)(D, N)
        log_dt = (lambda *s: torch.randn(*s, dtype=torch.bfloat16) * 0.05)(D) * 0.5 - 4.0
        Dskip = (lambda *s: torch.randn(*s, dtype=torch.bfloat16) * 0.05)(D)
        return {
            "u": _w((lambda *s: torch.randn(*s, dtype=torch.bfloat16) * 0.05)(B, L, D)),
            "A_re": _w(A_re),
            "A_im": _w(A_im),
            "B_re": _w(B_re),
            "B_im": _w(B_im),
            "C_re": _w(C_re),
            "C_im": _w(C_im),
            "log_dt": _w(log_dt),
            "Dskip": _w(Dskip),
        }
    _A_in = _A_setup()

    def _B_setup():
        B, S, D, F = 1, 2048, 640, 1728
        return {
            "x": _w((lambda *s: torch.randn(*s, dtype=torch.bfloat16) * 0.05)(B, S, D)),
            "w1": _w((lambda *s: torch.randn(*s, dtype=torch.bfloat16) * 3.2)(D, F) * (D ** -0.5)),
            "b1": _w((lambda *s: torch.randn(*s, dtype=torch.bfloat16) * 3.2)(F) * 0.01),
            "w2": _w((lambda *s: torch.randn(*s, dtype=torch.bfloat16) * 0.1)(F, D) * (F ** -0.5)),
            "b2": _w((lambda *s: torch.randn(*s, dtype=torch.bfloat16) * 0.2)(D) * 0.01),
        }
    _B_in = _B_setup()

    return {
        "A_u": _A_in["u"],
        "A_A_re": _A_in["A_re"],
        "A_A_im": _A_in["A_im"],
        "A_B_re": _A_in["B_re"],
        "A_B_im": _A_in["B_im"],
        "A_C_re": _A_in["C_re"],
        "A_C_im": _A_in["C_im"],
        "A_log_dt": _A_in["log_dt"],
        "A_Dskip": _A_in["Dskip"],
        "B_x": _B_in["x"],
        "B_w1": _B_in["w1"],
        "B_b1": _B_in["b1"],
        "B_w2": _B_in["w2"],
        "B_b2": _B_in["b2"],
        "gate_w": _w((lambda *s: torch.randn(*s, dtype=torch.bfloat16) * 0.05)(640) * 16.0),
    }

def reference(A_u, A_A_re, A_A_im, A_B_re, A_B_im, A_C_re, A_C_im, A_log_dt, A_Dskip, B_x, B_w1, B_b1, B_w2, B_b2, gate_w):
    def _A_ref(u, A_re, A_im, B_re, B_im, C_re, C_im, log_dt, Dskip):
        Bsz, L, D = u.shape
        dt = torch.exp(log_dt)[:, None]
        A = A_re + 1j * A_im
        Bc = B_re + 1j * B_im
        Cc = C_re + 1j * C_im
        logdA = dt * A
        dB = dt * Bc
        l = (lambda x, dt: x.to(dt))(torch.arange(L), A_re.dtype)
        P = torch.exp(logdA[:, :, None] * l[None, None, :])
        K = torch.einsum("dn,dnl,dn->dl", Cc, P, dB).real
        L2 = 2 * L
        Kp = _pad(K, ((0, 0), (0, L)))
        up = (lambda x, *d: x.permute(*d))(u, 0, 2, 1)
        up = _pad(up, ((0, 0), (0, 0), (0, L)))
        Kf = (lambda x, axes=(-2,-1): torch.fft.rfft2(x.float(), dim=axes))(Kp[:, None, :], axes=(-2, -1))
        Uf = (lambda x, axes=(-2,-1): torch.fft.rfft2(x.float(), dim=axes))(up[:, :, None, :], axes=(-2, -1))
        Yf = Uf * Kf[None, :, :, :]
        y = (lambda x, s, axes=(-2,-1): torch.fft.irfft2(x, s=s, dim=axes).to(torch.bfloat16))(Yf, (1, L2), axes=(-2, -1))[:, :, 0, :L]
        y = (lambda x, *d: x.permute(*d))(y, 0, 2, 1) + u * Dskip[None, None, :]
        return y

    def _B_ref(x, w1, b1, w2, b2):
        h = torch.einsum("bsd,df->bsf", x, w1) + b1
        h = _gelu(h)
        return torch.einsum("bsf,fd->bsd", h, w2) + b2

    x = A_u
    g = _sigmoid((x * gate_w).sum(-1, keepdims=True))
    a = _A_ref(x, A_A_re, A_A_im, A_B_re, A_B_im, A_C_re, A_C_im, A_log_dt, A_Dskip)
    b = _B_ref(x, B_w1, B_b1, B_w2, B_b2)
    return g * a + (1 - g) * b
```

```asm
; @launch grid=(256,1,1) block=(256,1,1) lds=163840
.amdgcn_target "amdgcn-amd-amdhsa--gfx950"
.text
.globl gated_mix__ssm_conv_s4__dense_activation_gelu__prompt_kernel
.p2align 8
.type gated_mix__ssm_conv_s4__dense_activation_gelu__prompt_kernel,@function
gated_mix__ssm_conv_s4__dense_activation_gelu__prompt_kernel:
s_cmp_ge_u32 s2, 256
s_cbranch_scc1 L_end
s_load_dwordx16 s[36:51], s[0:1], 0
s_load_dwordx16 s[52:67], s[0:1], 64
s_load_dwordx4 s[68:71], s[0:1], 128
s_memrealtime s[32:33]
v_lshrrev_b32 v4, 6, v0
v_and_b32 v1, 63, v0
v_readfirstlane_b32 s3, v4
v_and_b32 v2, 15, v0
v_bfe_u32 v3, v0, 4, 2
s_and_b32 s30, s2, 7
s_lshr_b32 s31, s2, 3
s_lshr_b32 s28, s30, 1
s_and_b32 s29, s30, 1
s_lshl_b32 s25, s28, 3
s_lshr_b32 s101, s31, 2
s_add_u32 s25, s25, s101
s_lshl_b32 s26, s29, 2
s_and_b32 s101, s31, 3
s_add_u32 s26, s26, s101
s_cmp_ge_u32 s31, 30
s_cbranch_scc1 L_C
s_cmp_ge_u32 s31, 24
s_cbranch_scc1 L_B
s_getpc_b64 s[20:21]
pc1:
v_lshlrev_b32 v4, 7, v0
v_min_u32 v4, L_A_end-pc1-4, v4
global_load_dword v229, v4, s[20:21]
s_mul_i32 s23, s29, 6
s_lshr_b32 s101, s31, 2
s_add_u32 s23, s23, s101
s_and_b32 s101, s31, 3
s_lshl_b32 s22, s28, 2
s_add_u32 s22, s22, s101
s_mul_i32 s24, s30, 24
s_add_u32 s24, s24, s31
s_mul_i32 s101, s22, 3
s_add_u32 s101, s101, s23
s_mul_i32 s100, s101, 6554
s_lshr_b32 s100, s100, 16
s_mul_i32 s100, s100, 10
s_sub_u32 s27, s101, s100
s_lshl_b32 s101, s24, 9
v_lshlrev_b32 v5, 1, v0
v_add_u32 v12, s101, v5
s_lshl_b32 s101, s24, 2
s_waitcnt lgkmcnt(0)
s_or_b32 s100, s2, s3
s_cmp_lg_u32 s100, 0
s_cbranch_scc1 np2
v_mov_b32 v13, 0
s_or_b32 s33, s33, 0x40000000
v_mov_b32 v14, s32
v_mov_b32 v15, s33
s_mov_b64 exec, 1
global_store_dwordx2 v13, v[14:15], s[68:69] sc1
s_mov_b64 exec, -1
np2:
global_load_ushort v36, v12, s[38:39]
global_load_ushort v37, v12, s[40:41]
global_load_ushort v38, v12, s[42:43]
global_load_ushort v39, v12, s[44:45]
global_load_ushort v40, v12, s[46:47]
global_load_ushort v41, v12, s[48:49]
s_add_u32 s50, s50, s101
s_addc_u32 s51, s51, 0
s_add_u32 s52, s52, s101
s_addc_u32 s53, s53, 0
s_load_dword s0, s[50:51], 0
s_load_dword s54, s[52:53], 0
s_mov_b32 s12, s70
s_mov_b32 s13, s71
s_mov_b32 s14, 33554432
s_mov_b32 s15, 0x20000
s_mov_b32 s4, s36
s_mov_b32 s5, s37
s_mov_b32 s6, 2621440
s_mov_b32 s7, 0x20000
s_mov_b32 s8, s56
s_mov_b32 s9, s57
s_mov_b32 s10, 2211840
s_mov_b32 s11, 0x20000
s_lshl_b32 s28, s27, 7
s_mul_i32 s29, s27, 221184
s_lshl_b32 s47, s3, 12
s_add_u32 s47, s47, 32768
s_lshl_b32 s48, s3, 12
s_add_u32 s48, s48, 49152
s_lshl_b32 s101, s22, 2
s_add_u32 s101, s101, s3
s_mul_i32 s101, s101, 40960
v_lshrrev_b32 v64, 3, v1
v_and_b32 v65, 7, v1
v_xor_b32 v66, v64, v65
v_mul_u32_u24 v67, 1280, v64
v_lshl_add_u32 v67, v66, 4, v67
v_add_u32 v16, s101, v67
v_add_u32 v17, 9216, v16
v_add_u32 v18, 18432, v16
v_add_u32 v19, 27648, v16
s_mul_i32 s101, s3, 55296
s_lshl_b32 s100, s23, 8
s_add_u32 s101, s101, s100
v_mul_u32_u24 v67, 3456, v3
v_and_b32 v64, 1, v1
v_lshl_add_u32 v67, v64, 4, v67
v_add_u32 v67, s101, v67
v_lshrrev_b32 v65, 1, v2
v_xor_b32 v65, v65, v3
v_xor_b32 v66, 4, v65
v_lshl_add_u32 v20, v65, 5, v67
v_lshl_add_u32 v22, v66, 5, v67
v_add_u32 v21, 12800, v20
v_add_u32 v23, 38400, v22
v_add_u32 v22, 25600, v22
s_mov_b32 s36, s27
s_mov_b32 s37, s31
s_add_u32 m0, s47, 0
s_nop 0
buffer_load_dwordx4 v16, s[4:7], s28 offen offset:0 lds
buffer_load_dwordx4 v17, s[4:7], s28 offen offset:1024 lds
buffer_load_dwordx4 v18, s[4:7], s28 offen offset:2048 lds
buffer_load_dwordx4 v19, s[4:7], s28 offen offset:3072 lds
s_mov_b32 s16, s60
s_mov_b32 s17, s61
s_mov_b32 s18, 2211840
s_mov_b32 s19, 0x20000
s_and_b32 s101, s2, 7
s_mul_i32 s101, s101, 14
s_add_u32 s101, s101, s37
s_cmp_lt_u32 s37, 14
s_cselect_b32 s41, s101, 200
s_lshr_b32 s100, s41, 1
s_and_b32 s101, s41, 1
s_lshl_b32 s40, s101, 2
s_add_u32 s40, s40, s3
s_lshl_b32 s40, s40, 6
s_add_u32 s40, s40, s100
s_lshl_b32 s40, s40, 7
s_add_u32 s40, s40, 16908288
s_lshl_b32 s101, s101, 2
s_add_u32 s101, s101, s3
s_mul_i32 s38, s100, 40960
s_mul_i32 s39, s100, 5120
s_mul_i32 s100, s101, 160
s_add_u32 s38, s38, s100
s_mul_i32 s100, s101, 276480
s_add_u32 s39, s39, s100
s_add_u32 s39, s39, 7340032
s_cmp_lt_u32 s41, 108
s_cselect_b32 s38, s38, 2146435072
s_cselect_b32 s39, s39, 2146435072
s_cselect_b32 s40, s40, 2146435072
v_add_u32 v64, 0, v1
v_mul_u32_u24 v65, 6554, v64
v_lshrrev_b32 v65, 16, v65
v_mul_u32_u24 v66, 1120, v65
v_lshl_add_u32 v44, v64, 4, v66
v_add_u32 v64, 64, v1
v_mul_u32_u24 v65, 6554, v64
v_lshrrev_b32 v65, 16, v65
v_mul_u32_u24 v66, 1120, v65
v_lshl_add_u32 v45, v64, 4, v66
v_add_u32 v45, -1024, v45
v_add_u32 v64, 128, v1
v_mul_u32_u24 v65, 6554, v64
v_lshrrev_b32 v65, 16, v65
v_mul_u32_u24 v66, 1120, v65
v_lshl_add_u32 v46, v64, 4, v66
v_add_u32 v46, -2048, v46
v_cmp_gt_u32 vcc, 32, v1
v_mov_b32 v64, 2146435072
v_bfe_u32 v66, v1, 2, 4
v_cndmask_b32 v46, v64, v46, vcc
v_mul_u32_u24 v66, 160, v66
v_and_b32 v67, 3, v1
s_add_u32 s101, s47, 98304
v_lshl_add_u32 v66, v67, 3, v66
v_add_u32 v47, s101, v66
s_lshl_b32 s101, s3, 12
s_add_u32 s101, s101, 32768
v_bfe_u32 v66, v1, 2, 2
v_and_b32 v67, 3, v1
v_lshl_add_u32 v69, v3, 3, v66
v_lshl_add_u32 v69, v69, 7, s101
v_and_b32 v71, 1, v1
v_lshl_add_u32 v69, v71, 3, v69
v_lshrrev_b32 v71, 1, v67
v_xor_b32 v71, v71, v66
v_xor_b32 v72, 0, v71
v_lshl_add_u32 v52, v72, 4, v69
v_xor_b32 v72, 2, v71
v_lshl_add_u32 v53, v72, 4, v69
v_xor_b32 v72, 4, v71
v_lshl_add_u32 v54, v72, 4, v69
v_xor_b32 v72, 6, v71
v_lshl_add_u32 v55, v72, 4, v69
v_lshlrev_b32 v69, 14, v66
v_lshl_add_u32 v69, v67, 4, v69
v_lshl_add_u32 v69, v3, 6, v69
s_lshl_b32 s101, s3, 8
v_add_u32 v8, s101, v69
v_mov_b32 v13, 0
global_load_dwordx2 v[10:11], v13, s[68:69] sc1
s_lshl_b32 s101, s23, 8
s_and_b32 s100, s3, 1
s_lshl_b32 s100, s100, 7
s_add_u32 s101, s101, s100
v_lshl_add_u32 v42, v3, 3, s101
v_cmp_eq_u32 vcc, 0, v0
v_mov_b32 v63, 2146435072
v_lshlrev_b32 v56, 4, v1
v_cndmask_b32 v63, v63, 0, vcc
v_add_u32 v57, 4096, v56
s_xor_b32 s101, s3, 0
s_lshl_b32 s101, s101, 10
v_add_u32 v58, s101, v56
s_xor_b32 s101, s3, 1
s_lshl_b32 s101, s101, 10
v_add_u32 v59, s101, v56
s_xor_b32 s101, s3, 2
s_lshl_b32 s101, s101, 10
v_add_u32 v60, s101, v56
s_xor_b32 s101, s3, 3
s_lshl_b32 s101, s101, 10
v_add_u32 v61, s101, v56
s_and_b32 s42, s37, 3
s_mul_i32 s42, s42, 3
s_lshr_b32 s43, s37, 2
s_mul_i32 s43, s43, 5
s_add_u32 s42, s42, s43
s_mul_i32 s43, s42, 5042
s_lshr_b32 s43, s43, 16
s_mul_i32 s43, s43, 13
s_sub_u32 s42, s42, s43
s_mul_i32 s43, s3, 14
s_cmp_eq_u32 s3, 3
s_cselect_b32 s44, 1, 0
s_sub_u32 s43, s43, s44
s_cmp_lt_u32 s3, 2
s_cselect_b32 s44, 14, 13
s_add_u32 s44, s44, s43
s_add_u32 s42, s42, s43
s_mul_i32 s45, s26, 276480
s_add_u32 s45, s45, 7340032
s_mul_i32 s46, s25, 221184
s_mul_i32 s72, s42, 5120
s_add_u32 s72, s72, s45
s_lshl_b32 s86, s42, 12
s_add_u32 s86, s86, s46
s_add_u32 s42, s42, 1
s_cmp_eq_u32 s42, s44
s_cselect_b32 s42, s43, s42
s_mul_i32 s73, s42, 5120
s_add_u32 s73, s73, s45
s_lshl_b32 s87, s42, 12
s_add_u32 s87, s87, s46
s_add_u32 s42, s42, 1
s_cmp_eq_u32 s42, s44
s_cselect_b32 s42, s43, s42
s_mul_i32 s74, s42, 5120
s_add_u32 s74, s74, s45
s_lshl_b32 s88, s42, 12
s_add_u32 s88, s88, s46
s_add_u32 s42, s42, 1
s_cmp_eq_u32 s42, s44
s_cselect_b32 s42, s43, s42
s_mul_i32 s75, s42, 5120
s_add_u32 s75, s75, s45
s_lshl_b32 s89, s42, 12
s_add_u32 s89, s89, s46
s_add_u32 s42, s42, 1
s_cmp_eq_u32 s42, s44
s_cselect_b32 s42, s43, s42
s_mul_i32 s76, s42, 5120
s_add_u32 s76, s76, s45
s_lshl_b32 s90, s42, 12
s_add_u32 s90, s90, s46
s_add_u32 s42, s42, 1
s_cmp_eq_u32 s42, s44
s_cselect_b32 s42, s43, s42
s_mul_i32 s77, s42, 5120
s_add_u32 s77, s77, s45
s_lshl_b32 s91, s42, 12
s_add_u32 s91, s91, s46
s_add_u32 s42, s42, 1
s_cmp_eq_u32 s42, s44
s_cselect_b32 s42, s43, s42
s_mul_i32 s78, s42, 5120
s_add_u32 s78, s78, s45
s_lshl_b32 s92, s42, 12
s_add_u32 s92, s92, s46
s_add_u32 s42, s42, 1
s_cmp_eq_u32 s42, s44
s_cselect_b32 s42, s43, s42
s_mul_i32 s79, s42, 5120
s_add_u32 s79, s79, s45
s_lshl_b32 s93, s42, 12
s_add_u32 s93, s93, s46
s_add_u32 s42, s42, 1
s_cmp_eq_u32 s42, s44
s_cselect_b32 s42, s43, s42
s_mul_i32 s80, s42, 5120
s_add_u32 s80, s80, s45
s_lshl_b32 s94, s42, 12
s_add_u32 s94, s94, s46
s_add_u32 s42, s42, 1
s_cmp_eq_u32 s42, s44
s_cselect_b32 s42, s43, s42
s_mul_i32 s81, s42, 5120
s_add_u32 s81, s81, s45
s_lshl_b32 s95, s42, 12
s_add_u32 s95, s95, s46
s_add_u32 s42, s42, 1
s_cmp_eq_u32 s42, s44
s_cselect_b32 s42, s43, s42
s_mul_i32 s82, s42, 5120
s_add_u32 s82, s82, s45
s_lshl_b32 s96, s42, 12
s_add_u32 s96, s96, s46
s_add_u32 s42, s42, 1
s_cmp_eq_u32 s42, s44
s_cselect_b32 s42, s43, s42
s_mul_i32 s83, s42, 5120
s_add_u32 s83, s83, s45
s_lshl_b32 s97, s42, 12
s_add_u32 s97, s97, s46
s_add_u32 s42, s42, 1
s_cmp_eq_u32 s42, s44
s_cselect_b32 s42, s43, s42
s_mul_i32 s84, s42, 5120
s_add_u32 s84, s84, s45
s_lshl_b32 s98, s42, 12
s_add_u32 s98, s98, s46
s_add_u32 s42, s42, 1
s_cmp_eq_u32 s42, s44
s_cselect_b32 s42, s43, s42
s_mul_i32 s85, s42, 5120
s_add_u32 s85, s85, s45
s_lshl_b32 s99, s42, 12
s_add_u32 s99, s99, s46
s_cmp_lt_u32 s3, 2
s_cselect_b32 s85, s85, 2146435072
s_cselect_b32 s99, s99, 2146435072
s_waitcnt lgkmcnt(0)
s_lshl_b32 s49, s36, 11
s_lshl_b32 s50, s36, 18
s_lshl_b32 s101, s22, 10
s_add_u32 s50, s50, s101
s_add_u32 s50, s50, 10485760
s_lshl_b32 s101, s22, 7
s_add_u32 s52, s49, s101
s_add_u32 s52, s52, 16875520
s_cmp_lt_u32 s23, 10
s_cselect_b32 s50, s50, 2146435072
s_cselect_b32 s52, s52, 2146435072
s_lshr_b32 s101, s3, 1
s_lshl_b32 s101, s101, 4
s_lshr_b32 s0, s0, s101
s_lshl_b32 s0, s0, 16
s_lshr_b32 s54, s54, s101
s_lshl_b32 s54, s54, 16
v_mov_b32 v122, 0x3fb8aa3b
v_mul_f32 v122, s0, v122
s_mul_i32 s101, s3, 4608
v_exp_f32 v122, v122
s_add_u32 s101, s101, 12288
v_lshl_add_u32 v188, v1, 2, s101
v_cvt_pk_bf16_f32 v122, v122, v122
v_mul_u32_u24 v189, 288, v2
v_lshlrev_b32 v122, 16, v122
v_lshl_add_u32 v189, v3, 4, v189
v_add_u32 v189, s101, v189
s_waitcnt vmcnt(5)
v_lshlrev_b32 v36, 16, v36
v_lshlrev_b32 v37, 16, v37
v_lshlrev_b32 v38, 16, v38
v_lshlrev_b32 v39, 16, v39
v_lshlrev_b32 v40, 16, v40
v_lshlrev_b32 v41, 16, v41
v_mul_f32 v120, v122, v36
s_add_u32 m0, s48, 0
s_nop 0
buffer_load_dwordx4 v20, s[8:11], s29 offen offset:0 lds
v_mul_f32 v121, v122, v37
v_mul_f32 v120, 0x3fb8aa3b, v120
v_mul_f32 v121, 0x3e22f983, v121
v_mul_f32 v123, 0x41000000, v120
v_mul_f32 v124, 0xc1000000, v121
v_exp_f32 v123, v123
v_fract_f32 v124, v124
v_mul_f32 v38, v122, v38
buffer_load_dwordx4 v21, s[8:11], s29 offen offset:1024 lds
v_cos_f32 v116, v124
v_sin_f32 v117, v124
v_mul_f32 v39, v122, v39
v_pk_mul_f32 v[116:117], v[116:117], v[122:123] op_sel:[0,1] op_sel_hi:[1,1]
v_mul_f32 v112, v40, v38
v_mul_f32 v113, v40, v39
v_fma_f32 v112, -v41, v39, v112
buffer_load_dwordx4 v22, s[8:11], s29 offen offset:2048 lds
v_fma_f32 v113, -v41, v38, -v113
v_cvt_pk_bf16_f32 v128, v112, v113
v_pk_mul_f32 v[114:115], v[112:113], v[116:117] op_sel:[0,0] op_sel_hi:[0,1]
v_pk_fma_f32 v[114:115], v[112:113], v[116:117], v[114:115] op_sel:[1,1,0] op_sel_hi:[1,0,1] neg_lo:[1,0,0]
v_cvt_pk_bf16_f32 v129, v114, v115
ds_write_b32 v188, v128 offset:0
v_pk_mul_f32 v[112:113], v[114:115], v[116:117] op_sel:[0,0] op_sel_hi:[0,1]
v_pk_fma_f32 v[112:113], v[114:115], v[116:117], v[112:113] op_sel:[1,1,0] op_sel_hi:[1,0,1] neg_lo:[1,0,0]
v_cvt_pk_bf16_f32 v130, v112, v113
ds_write_b32 v188, v129 offset:288
buffer_load_dwordx4 v23, s[8:11], s29 offen offset:3072 lds
s_add_u32 s27, s27, 1
s_cmp_eq_u32 s27, 10
s_cselect_b32 s27, 0, s27
s_lshl_b32 s28, s27, 7
s_mul_i32 s29, s27, 221184
v_pk_mul_f32 v[114:115], v[112:113], v[116:117] op_sel:[0,0] op_sel_hi:[0,1]
v_pk_fma_f32 v[114:115], v[112:113], v[116:117], v[114:115] op_sel:[1,1,0] op_sel_hi:[1,0,1] neg_lo:[1,0,0]
v_cvt_pk_bf16_f32 v131, v114, v115
ds_write_b32 v188, v130 offset:576
s_add_u32 m0, s47, 98304
s_nop 0
buffer_load_dwordx4 v44, s[16:19], s38 offen offset:0 lds
v_pk_mul_f32 v[112:113], v[114:115], v[116:117] op_sel:[0,0] op_sel_hi:[0,1]
v_pk_fma_f32 v[112:113], v[114:115], v[116:117], v[112:113] op_sel:[1,1,0] op_sel_hi:[1,0,1] neg_lo:[1,0,0]
v_cvt_pk_bf16_f32 v132, v112, v113
ds_write_b32 v188, v131 offset:864
v_pk_mul_f32 v[114:115], v[112:113], v[116:117] op_sel:[0,0] op_sel_hi:[0,1]
v_pk_fma_f32 v[114:115], v[112:113], v[116:117], v[114:115] op_sel:[1,1,0] op_sel_hi:[1,0,1] neg_lo:[1,0,0]
v_cvt_pk_bf16_f32 v133, v114, v115
ds_write_b32 v188, v132 offset:1152
v_pk_mul_f32 v[112:113], v[114:115], v[116:117] op_sel:[0,0] op_sel_hi:[0,1]
buffer_load_dwordx4 v45, s[16:19], s38 offen offset:1024 lds
v_pk_fma_f32 v[112:113], v[114:115], v[116:117], v[112:113] op_sel:[1,1,0] op_sel_hi:[1,0,1] neg_lo:[1,0,0]
v_cvt_pk_bf16_f32 v134, v112, v113
ds_write_b32 v188, v133 offset:1440
v_pk_mul_f32 v[114:115], v[112:113], v[116:117] op_sel:[0,0] op_sel_hi:[0,1]
v_pk_fma_f32 v[114:115], v[112:113], v[116:117], v[114:115] op_sel:[1,1,0] op_sel_hi:[1,0,1] neg_lo:[1,0,0]
v_cvt_pk_bf16_f32 v135, v114, v115
ds_write_b32 v188, v134 offset:1728
v_pk_mul_f32 v[112:113], v[114:115], v[116:117] op_sel:[0,0] op_sel_hi:[0,1]
v_pk_fma_f32 v[112:113], v[114:115], v[116:117], v[112:113] op_sel:[1,1,0] op_sel_hi:[1,0,1] neg_lo:[1,0,0]
buffer_load_dwordx4 v46, s[16:19], s38 offen offset:2048 lds
v_cvt_pk_bf16_f32 v128, v112, v113
ds_write_b32 v188, v135 offset:2016
v_pk_mul_f32 v[114:115], v[112:113], v[116:117] op_sel:[0,0] op_sel_hi:[0,1]
v_pk_fma_f32 v[114:115], v[112:113], v[116:117], v[114:115] op_sel:[1,1,0] op_sel_hi:[1,0,1] neg_lo:[1,0,0]
v_cvt_pk_bf16_f32 v129, v114, v115
ds_write_b32 v188, v128 offset:2304
v_pk_mul_f32 v[112:113], v[114:115], v[116:117] op_sel:[0,0] op_sel_hi:[0,1]
v_pk_fma_f32 v[112:113], v[114:115], v[116:117], v[112:113] op_sel:[1,1,0] op_sel_hi:[1,0,1] neg_lo:[1,0,0]
v_cvt_pk_bf16_f32 v130, v112, v113
ds_write_b32 v188, v129 offset:2592
s_add_u32 s38, s38, 20480
s_add_u32 m0, s47, 114688
s_nop 0
buffer_load_dwordx4 v44, s[16:19], s38 offen offset:0 lds
v_pk_mul_f32 v[114:115], v[112:113], v[116:117] op_sel:[0,0] op_sel_hi:[0,1]
v_pk_fma_f32 v[114:115], v[112:113], v[116:117], v[114:115] op_sel:[1,1,0] op_sel_hi:[1,0,1] neg_lo:[1,0,0]
v_cvt_pk_bf16_f32 v131, v114, v115
ds_write_b32 v188, v130 offset:2880
v_pk_mul_f32 v[112:113], v[114:115], v[116:117] op_sel:[0,0] op_sel_hi:[0,1]
v_pk_fma_f32 v[112:113], v[114:115], v[116:117], v[112:113] op_sel:[1,1,0] op_sel_hi:[1,0,1] neg_lo:[1,0,0]
v_cvt_pk_bf16_f32 v132, v112, v113
buffer_load_dwordx4 v45, s[16:19], s38 offen offset:1024 lds
ds_write_b32 v188, v131 offset:3168
v_pk_mul_f32 v[114:115], v[112:113], v[116:117] op_sel:[0,0] op_sel_hi:[0,1]
v_pk_fma_f32 v[114:115], v[112:113], v[116:117], v[114:115] op_sel:[1,1,0] op_sel_hi:[1,0,1] neg_lo:[1,0,0]
v_cvt_pk_bf16_f32 v133, v114, v115
ds_write_b32 v188, v132 offset:3456
v_pk_mul_f32 v[112:113], v[114:115], v[116:117] op_sel:[0,0] op_sel_hi:[0,1]
v_pk_fma_f32 v[112:113], v[114:115], v[116:117], v[112:113] op_sel:[1,1,0] op_sel_hi:[1,0,1] neg_lo:[1,0,0]
v_cvt_pk_bf16_f32 v134, v112, v113
ds_write_b32 v188, v133 offset:3744
v_pk_mul_f32 v[114:115], v[112:113], v[116:117] op_sel:[0,0] op_sel_hi:[0,1]
buffer_load_dwordx4 v46, s[16:19], s38 offen offset:2048 lds
v_pk_fma_f32 v[114:115], v[112:113], v[116:117], v[114:115] op_sel:[1,1,0] op_sel_hi:[1,0,1] neg_lo:[1,0,0]
v_cvt_pk_bf16_f32 v135, v114, v115
ds_write_b32 v188, v134 offset:4032
ds_write_b32 v188, v135 offset:4320
ds_read_b128 v[144:147], v189 offset:0
ds_read_b128 v[148:151], v189 offset:64
ds_read_b128 v[152:155], v189 offset:128
ds_read_b128 v[156:159], v189 offset:192
v_mul_f32 v125, 1.0, v120
global_load_dwordx2 v[200:201], v42, s[58:59] offset:0
global_load_dwordx2 v[202:203], v42, s[58:59] offset:32
global_load_dwordx2 v[204:205], v42, s[58:59] offset:64
global_load_dwordx2 v[206:207], v42, s[58:59] offset:96
v_mul_f32 v126, 1.0, v121
v_exp_f32 v125, v125
v_fract_f32 v126, v126
v_cos_f32 v64, v126
v_sin_f32 v65, v126
s_waitcnt vmcnt(15)
ds_read_b64_tr_b16 a[20:21], v52 offset:0
ds_read_b64_tr_b16 a[22:23], v54 offset:512
ds_read_b64_tr_b16 a[24:25], v53 offset:0
ds_read_b64_tr_b16 a[26:27], v55 offset:512
ds_read_b64_tr_b16 a[28:29], v54 offset:0
ds_read_b64_tr_b16 a[30:31], v52 offset:512
ds_read_b64_tr_b16 a[32:33], v55 offset:0
ds_read_b64_tr_b16 a[34:35], v53 offset:512
s_nop 0
s_waitcnt lgkmcnt(6)
s_add_u32 s51, s50, 0
buffer_store_dwordx4 a[20:23], v8, s[12:15], s51 offen sc1
v_pk_mul_f32 v[64:65], v[64:65], v[124:125] op_sel:[0,1] op_sel_hi:[1,1]
v_mul_f32 v125, 0x43000000, v120
v_mul_f32 v126, 0x43000000, v121
v_exp_f32 v125, v125
v_fract_f32 v126, v126
v_cos_f32 v80, v126
v_sin_f32 v81, v126
s_waitcnt lgkmcnt(4)
s_add_u32 s51, s50, 65536
buffer_store_dwordx4 a[24:27], v8, s[12:15], s51 offen sc1
s_nop 0
v_pk_mul_f32 v[80:81], v[80:81], v[124:125] op_sel:[0,1] op_sel_hi:[1,1]
v_mov_b32 v135, 0x3f80
v_cvt_pk_bf16_f32 v128, v64, v65
v_cvt_pk_bf16_f32 v129, v80, v81
v_pk_mul_f32 v[66:67], v[64:65], v[64:65] op_sel:[0,0] op_sel_hi:[0,1]
ds_write_b32 v188, v135
s_waitcnt lgkmcnt(3)
s_add_u32 s51, s50, 131072
buffer_store_dwordx4 a[28:31], v8, s[12:15], s51 offen sc1
v_pk_fma_f32 v[66:67], v[64:65], v[64:65], v[66:67] op_sel:[1,1,0] op_sel_hi:[1,0,1] neg_lo:[1,0,0]
ds_write_b32 v188, v128 offset:288
v_cvt_pk_bf16_f32 v130, v66, v67
ds_write_b32 v188, v129 offset:2304
v_pk_mul_f32 v[68:69], v[66:67], v[64:65] op_sel:[0,0] op_sel_hi:[0,1]
v_pk_fma_f32 v[68:69], v[66:67], v[64:65], v[68:69] op_sel:[1,1,0] op_sel_hi:[1,0,1] neg_lo:[1,0,0]
v_cvt_pk_bf16_f32 v131, v68, v69
ds_write_b32 v188, v130 offset:576
v_pk_mul_f32 v[70:71], v[66:67], v[66:67] op_sel:[0,0] op_sel_hi:[0,1]
s_waitcnt lgkmcnt(4)
s_add_u32 s51, s50, 196608
buffer_store_dwordx4 a[32:35], v8, s[12:15], s51 offen sc1
v_pk_fma_f32 v[70:71], v[66:67], v[66:67], v[70:71] op_sel:[1,1,0] op_sel_hi:[1,0,1] neg_lo:[1,0,0]
v_cvt_pk_bf16_f32 v132, v70, v71
ds_write_b32 v188, v131 offset:864
v_pk_mul_f32 v[72:73], v[70:71], v[64:65] op_sel:[0,0] op_sel_hi:[0,1]
v_pk_fma_f32 v[72:73], v[70:71], v[64:65], v[72:73] op_sel:[1,1,0] op_sel_hi:[1,0,1] neg_lo:[1,0,0]
v_cvt_pk_bf16_f32 v133, v72, v73
ds_write_b32 v188, v132 offset:1152
v_pk_mul_f32 v[74:75], v[70:71], v[66:67] op_sel:[0,0] op_sel_hi:[0,1]
s_add_u32 m0, s47, 32768
s_nop 0
buffer_load_dwordx4 v16, s[4:7], s28 offen offset:0 lds
v_pk_fma_f32 v[74:75], v[70:71], v[66:67], v[74:75] op_sel:[1,1,0] op_sel_hi:[1,0,1] neg_lo:[1,0,0]
v_cvt_pk_bf16_f32 v134, v74, v75
ds_write_b32 v188, v133 offset:1440
v_pk_mul_f32 v[76:77], v[70:71], v[68:69] op_sel:[0,0] op_sel_hi:[0,1]
v_pk_fma_f32 v[76:77], v[70:71], v[68:69], v[76:77] op_sel:[1,1,0] op_sel_hi:[1,0,1] neg_lo:[1,0,0]
v_cvt_pk_bf16_f32 v135, v76, v77
ds_write_b32 v188, v134 offset:1728
v_pk_mul_f32 v[136:137], v[80:81], v[64:65] op_sel:[0,0] op_sel_hi:[0,1]
v_pk_fma_f32 v[136:137], v[80:81], v[64:65], v[136:137] op_sel:[1,1,0] op_sel_hi:[1,0,1] neg_lo:[1,0,0]
buffer_load_dwordx4 v17, s[4:7], s28 offen offset:1024 lds
v_cvt_pk_bf16_f32 v128, v136, v137
ds_write_b32 v188, v135 offset:2016
v_pk_mul_f32 v[138:139], v[80:81], v[66:67] op_sel:[0,0] op_sel_hi:[0,1]
v_pk_fma_f32 v[138:139], v[80:81], v[66:67], v[138:139] op_sel:[1,1,0] op_sel_hi:[1,0,1] neg_lo:[1,0,0]
v_cvt_pk_bf16_f32 v129, v138, v139
ds_write_b32 v188, v128 offset:2592
v_pk_mul_f32 v[140:141], v[80:81], v[68:69] op_sel:[0,0] op_sel_hi:[0,1]
v_pk_fma_f32 v[140:141], v[80:81], v[68:69], v[140:141] op_sel:[1,1,0] op_sel_hi:[1,0,1] neg_lo:[1,0,0]
v_cvt_pk_bf16_f32 v130, v140, v141
buffer_load_dwordx4 v18, s[4:7], s28 offen offset:2048 lds
ds_write_b32 v188, v129 offset:2880
v_pk_mul_f32 v[142:143], v[80:81], v[70:71] op_sel:[0,0] op_sel_hi:[0,1]
v_pk_fma_f32 v[142:143], v[80:81], v[70:71], v[142:143] op_sel:[1,1,0] op_sel_hi:[1,0,1] neg_lo:[1,0,0]
v_cvt_pk_bf16_f32 v131, v142, v143
ds_write_b32 v188, v130 offset:3168
v_pk_mul_f32 v[136:137], v[80:81], v[72:73] op_sel:[0,0] op_sel_hi:[0,1]
v_pk_fma_f32 v[136:137], v[80:81], v[72:73], v[136:137] op_sel:[1,1,0] op_sel_hi:[1,0,1] neg_lo:[1,0,0]
v_cvt_pk_bf16_f32 v132, v136, v137
ds_write_b32 v188, v131 offset:3456
v_pk_mul_f32 v[138:139], v[80:81], v[74:75] op_sel:[0,0] op_sel_hi:[0,1]
buffer_load_dwordx4 v19, s[4:7], s28 offen offset:3072 lds
v_pk_fma_f32 v[138:139], v[80:81], v[74:75], v[138:139] op_sel:[1,1,0] op_sel_hi:[1,0,1] neg_lo:[1,0,0]
v_cvt_pk_bf16_f32 v133, v138, v139
ds_write_b32 v188, v132 offset:3744
v_pk_mul_f32 v[140:141], v[80:81], v[76:77] op_sel:[0,0] op_sel_hi:[0,1]
v_pk_fma_f32 v[140:141], v[80:81], v[76:77], v[140:141] op_sel:[1,1,0] op_sel_hi:[1,0,1] neg_lo:[1,0,0]
v_cvt_pk_bf16_f32 v134, v140, v141
ds_write_b32 v188, v133 offset:4032
ds_write_b32 v188, v134 offset:4320
ds_read_b128 v[160:163], v189 offset:0
s_add_u32 m0, s48, 32768
s_nop 0
buffer_load_dwordx4 v20, s[8:11], s29 offen offset:0 lds
ds_read_b128 v[164:167], v189 offset:64
ds_read_b128 v[168:171], v189 offset:128
ds_read_b128 v[172:175], v189 offset:192
v_pk_mul_f32 v[82:83], v[80:81], v[80:81] op_sel:[0,0] op_sel_hi:[0,1]
v_pk_fma_f32 v[82:83], v[80:81], v[80:81], v[82:83] op_sel:[1,1,0] op_sel_hi:[1,0,1] neg_lo:[1,0,0]
v_pk_mul_f32 v[84:85], v[82:83], v[80:81] op_sel:[0,0] op_sel_hi:[0,1]
v_pk_fma_f32 v[84:85], v[82:83], v[80:81], v[84:85] op_sel:[1,1,0] op_sel_hi:[1,0,1] neg_lo:[1,0,0]
v_pk_mul_f32 v[86:87], v[82:83], v[82:83] op_sel:[0,0] op_sel_hi:[0,1]
v_pk_fma_f32 v[86:87], v[82:83], v[82:83], v[86:87] op_sel:[1,1,0] op_sel_hi:[1,0,1] neg_lo:[1,0,0]
buffer_load_dwordx4 v21, s[8:11], s29 offen offset:1024 lds
v_pk_mul_f32 v[88:89], v[86:87], v[80:81] op_sel:[0,0] op_sel_hi:[0,1]
v_pk_fma_f32 v[88:89], v[86:87], v[80:81], v[88:89] op_sel:[1,1,0] op_sel_hi:[1,0,1] neg_lo:[1,0,0]
v_pk_mul_f32 v[90:91], v[86:87], v[82:83] op_sel:[0,0] op_sel_hi:[0,1]
v_pk_fma_f32 v[90:91], v[86:87], v[82:83], v[90:91] op_sel:[1,1,0] op_sel_hi:[1,0,1] neg_lo:[1,0,0]
v_pk_mul_f32 v[92:93], v[86:87], v[84:85] op_sel:[0,0] op_sel_hi:[0,1]
v_pk_fma_f32 v[92:93], v[86:87], v[84:85], v[92:93] op_sel:[1,1,0] op_sel_hi:[1,0,1] neg_lo:[1,0,0]
v_pk_mul_f32 v[94:95], v[86:87], v[86:87] op_sel:[0,0] op_sel_hi:[0,1]
v_pk_fma_f32 v[94:95], v[86:87], v[86:87], v[94:95] op_sel:[1,1,0] op_sel_hi:[1,0,1] neg_lo:[1,0,0]
s_waitcnt lgkmcnt(0)
v_mfma_f32_16x16x32_bf16 v[176:179], v[160:163], v[144:147], 0
buffer_load_dwordx4 v22, s[8:11], s29 offen offset:2048 lds
v_mfma_f32_16x16x32_bf16 v[176:179], v[164:167], v[148:151], v[176:179]
v_mfma_f32_16x16x32_bf16 v[176:179], v[168:171], v[152:155], v[176:179]
v_mfma_f32_16x16x32_bf16 v[176:179], v[172:175], v[156:159], v[176:179]
buffer_load_dwordx4 v23, s[8:11], s29 offen offset:3072 lds
s_add_u32 s27, s27, 1
s_cmp_eq_u32 s27, 10
s_cselect_b32 s27, 0, s27
s_lshl_b32 s28, s27, 7
s_mul_i32 s29, s27, 221184
v_cvt_pk_bf16_f32 v135, v82, v83
v_pk_mul_f32 v[142:143], v[82:83], v[66:67] op_sel:[0,0] op_sel_hi:[0,1]
v_pk_fma_f32 v[142:143], v[82:83], v[66:67], v[142:143] op_sel:[1,1,0] op_sel_hi:[1,0,1] neg_lo:[1,0,0]
s_waitcnt vmcnt(16)
ds_read_b64_tr_b16 a[0:1], v47 offset:0
ds_read_b64_tr_b16 a[2:3], v47 offset:16384
ds_read_b64_tr_b16 a[4:5], v47 offset:32
ds_read_b64_tr_b16 a[6:7], v47 offset:16416
ds_read_b64_tr_b16 a[8:9], v47 offset:64
ds_read_b64_tr_b16 a[10:11], v47 offset:16448
ds_read_b64_tr_b16 a[12:13], v47 offset:96
ds_read_b64_tr_b16 a[14:15], v47 offset:16480
ds_read_b64_tr_b16 a[16:17], v47 offset:128
ds_read_b64_tr_b16 a[18:19], v47 offset:16512
v_cvt_pk_bf16_f32 v128, v142, v143
s_waitcnt lgkmcnt(8)
buffer_store_dwordx4 a[0:3], v56, s[12:15], s39 offen offset:0 sc1
ds_write_b32 v188, v135 offset:0
v_pk_mul_f32 v[136:137], v[82:83], v[70:71] op_sel:[0,0] op_sel_hi:[0,1]
v_pk_fma_f32 v[136:137], v[82:83], v[70:71], v[136:137] op_sel:[1,1,0] op_sel_hi:[1,0,1] neg_lo:[1,0,0]
v_cvt_pk_bf16_f32 v129, v136, v137
ds_write_b32 v188, v128 offset:288
v_pk_mul_f32 v[138:139], v[82:83], v[74:75] op_sel:[0,0] op_sel_hi:[0,1]
v_pk_fma_f32 v[138:139], v[82:83], v[74:75], v[138:139] op_sel:[1,1,0] op_sel_hi:[1,0,1] neg_lo:[1,0,0]
v_cvt_pk_bf16_f32 v130, v138, v139
ds_write_b32 v188, v129 offset:576
s_waitcnt lgkmcnt(9)
buffer_store_dwordx4 a[4:7], v56, s[12:15], s39 offen offset:1024 sc1
v_cvt_pk_bf16_f32 v131, v84, v85
v_pk_mul_f32 v[140:141], v[84:85], v[66:67] op_sel:[0,0] op_sel_hi:[0,1]
v_pk_fma_f32 v[140:141], v[84:85], v[66:67], v[140:141] op_sel:[1,1,0] op_sel_hi:[1,0,1] neg_lo:[1,0,0]
ds_write_b32 v188, v130 offset:864
v_cvt_pk_bf16_f32 v132, v140, v141
ds_write_b32 v188, v131 offset:1152
v_pk_mul_f32 v[142:143], v[84:85], v[70:71] op_sel:[0,0] op_sel_hi:[0,1]
v_pk_fma_f32 v[142:143], v[84:85], v[70:71], v[142:143] op_sel:[1,1,0] op_sel_hi:[1,0,1] neg_lo:[1,0,0]
v_cvt_pk_bf16_f32 v133, v142, v143
ds_write_b32 v188, v132 offset:1440
s_waitcnt lgkmcnt(10)
buffer_store_dwordx4 a[8:11], v56, s[12:15], s39 offen offset:2048 sc1
v_pk_mul_f32 v[136:137], v[84:85], v[74:75] op_sel:[0,0] op_sel_hi:[0,1]
v_pk_fma_f32 v[136:137], v[84:85], v[74:75], v[136:137] op_sel:[1,1,0] op_sel_hi:[1,0,1] neg_lo:[1,0,0]
v_cvt_pk_bf16_f32 v134, v136, v137
ds_write_b32 v188, v133 offset:1728
v_cvt_pk_bf16_f32 v135, v86, v87
v_pk_mul_f32 v[138:139], v[86:87], v[70:71] op_sel:[0,0] op_sel_hi:[0,1]
v_pk_fma_f32 v[138:139], v[86:87], v[70:71], v[138:139] op_sel:[1,1,0] op_sel_hi:[1,0,1] neg_lo:[1,0,0]
ds_write_b32 v188, v134 offset:2016
v_cvt_pk_bf16_f32 v128, v138, v139
s_waitcnt lgkmcnt(10)
buffer_store_dwordx4 a[12:15], v56, s[12:15], s39 offen offset:3072 sc1
ds_write_b32 v188, v135 offset:2304
v_cvt_pk_bf16_f32 v129, v88, v89
v_pk_mul_f32 v[140:141], v[88:89], v[70:71] op_sel:[0,0] op_sel_hi:[0,1]
v_pk_fma_f32 v[140:141], v[88:89], v[70:71], v[140:141] op_sel:[1,1,0] op_sel_hi:[1,0,1] neg_lo:[1,0,0]
ds_write_b32 v188, v128 offset:2592
v_cvt_pk_bf16_f32 v130, v140, v141
ds_write_b32 v188, v129 offset:2880
v_cvt_pk_bf16_f32 v131, v90, v91
v_pk_mul_f32 v[142:143], v[90:91], v[70:71] op_sel:[0,0] op_sel_hi:[0,1]
v_pk_fma_f32 v[142:143], v[90:91], v[70:71], v[142:143] op_sel:[1,1,0] op_sel_hi:[1,0,1] neg_lo:[1,0,0]
s_waitcnt lgkmcnt(11)
buffer_store_dwordx4 a[16:19], v57, s[12:15], s39 offen offset:0 sc1
ds_write_b32 v188, v130 offset:3168
v_cvt_pk_bf16_f32 v132, v142, v143
ds_write_b32 v188, v131 offset:3456
v_cvt_pk_bf16_f32 v133, v92, v93
v_pk_mul_f32 v[136:137], v[92:93], v[70:71] op_sel:[0,0] op_sel_hi:[0,1]
v_pk_fma_f32 v[136:137], v[92:93], v[70:71], v[136:137] op_sel:[1,1,0] op_sel_hi:[1,0,1] neg_lo:[1,0,0]
ds_write_b32 v188, v132 offset:3744
v_cvt_pk_bf16_f32 v134, v136, v137
ds_write_b32 v188, v133 offset:4032
s_add_u32 m0, s47, 65536
s_nop 0
buffer_load_dwordx4 v16, s[4:7], s28 offen offset:0 lds
ds_write_b32 v188, v134 offset:4320
ds_read_b128 v[160:163], v189 offset:0
ds_read_b128 v[164:167], v189 offset:64
ds_read_b128 v[168:171], v189 offset:128
ds_read_b128 v[172:175], v189 offset:192
v_pk_mul_f32 v[96:97], v[94:95], v[80:81] op_sel:[0,0] op_sel_hi:[0,1]
v_pk_fma_f32 v[96:97], v[94:95], v[80:81], v[96:97] op_sel:[1,1,0] op_sel_hi:[1,0,1] neg_lo:[1,0,0]
v_pk_mul_f32 v[98:99], v[94:95], v[82:83] op_sel:[0,0] op_sel_hi:[0,1]
v_pk_fma_f32 v[98:99], v[94:95], v[82:83], v[98:99] op_sel:[1,1,0] op_sel_hi:[1,0,1] neg_lo:[1,0,0]
buffer_load_dwordx4 v17, s[4:7], s28 offen offset:1024 lds
v_pk_mul_f32 v[100:101], v[94:95], v[84:85] op_sel:[0,0] op_sel_hi:[0,1]
v_pk_fma_f32 v[100:101], v[94:95], v[84:85], v[100:101] op_sel:[1,1,0] op_sel_hi:[1,0,1] neg_lo:[1,0,0]
v_pk_mul_f32 v[102:103], v[94:95], v[86:87] op_sel:[0,0] op_sel_hi:[0,1]
v_pk_fma_f32 v[102:103], v[94:95], v[86:87], v[102:103] op_sel:[1,1,0] op_sel_hi:[1,0,1] neg_lo:[1,0,0]
v_pk_mul_f32 v[104:105], v[94:95], v[88:89] op_sel:[0,0] op_sel_hi:[0,1]
v_pk_fma_f32 v[104:105], v[94:95], v[88:89], v[104:105] op_sel:[1,1,0] op_sel_hi:[1,0,1] neg_lo:[1,0,0]
v_pk_mul_f32 v[106:107], v[94:95], v[90:91] op_sel:[0,0] op_sel_hi:[0,1]
v_pk_fma_f32 v[106:107], v[94:95], v[90:91], v[106:107] op_sel:[1,1,0] op_sel_hi:[1,0,1] neg_lo:[1,0,0]
v_pk_mul_f32 v[108:109], v[94:95], v[92:93] op_sel:[0,0] op_sel_hi:[0,1]
buffer_load_dwordx4 v18, s[4:7], s28 offen offset:2048 lds
v_pk_fma_f32 v[108:109], v[94:95], v[92:93], v[108:109] op_sel:[1,1,0] op_sel_hi:[1,0,1] neg_lo:[1,0,0]
v_pk_mul_f32 v[110:111], v[94:95], v[94:95] op_sel:[0,0] op_sel_hi:[0,1]
v_pk_fma_f32 v[110:111], v[94:95], v[94:95], v[110:111] op_sel:[1,1,0] op_sel_hi:[1,0,1] neg_lo:[1,0,0]
s_waitcnt lgkmcnt(0)
v_mfma_f32_16x16x32_bf16 v[180:183], v[160:163], v[144:147], 0
v_mfma_f32_16x16x32_bf16 v[180:183], v[164:167], v[148:151], v[180:183]
v_mfma_f32_16x16x32_bf16 v[180:183], v[168:171], v[152:155], v[180:183]
buffer_load_dwordx4 v19, s[4:7], s28 offen offset:3072 lds
v_mfma_f32_16x16x32_bf16 v[180:183], v[172:175], v[156:159], v[180:183]
v_cvt_pk_bf16_f32 v135, v94, v95
v_cvt_pk_bf16_f32 v128, v96, v97
v_cvt_pk_bf16_f32 v129, v98, v99
v_cvt_pk_bf16_f32 v130, v100, v101
s_add_u32 m0, s48, 65536
s_nop 0
buffer_load_dwordx4 v20, s[8:11], s29 offen offset:0 lds
ds_write_b32 v188, v135 offset:0
v_cvt_pk_bf16_f32 v131, v102, v103
ds_write_b32 v188, v128 offset:288
v_cvt_pk_bf16_f32 v132, v104, v105
ds_write_b32 v188, v129 offset:576
v_cvt_pk_bf16_f32 v133, v106, v107
ds_write_b32 v188, v130 offset:864
v_cvt_pk_bf16_f32 v134, v108, v109
ds_write_b32 v188, v131 offset:1152
buffer_load_dwordx4 v21, s[8:11], s29 offen offset:1024 lds
v_cvt_pk_bf16_f32 v135, v110, v111
ds_write_b32 v188, v132 offset:1440
ds_write_b32 v188, v133 offset:1728
ds_write_b32 v188, v134 offset:2016
ds_write_b32 v188, v135 offset:2304
ds_read_b128 v[160:163], v189 offset:0
ds_read_b128 v[164:167], v189 offset:64
ds_read_b128 v[168:171], v189 offset:128
ds_read_b128 v[172:175], v189 offset:192
buffer_load_dwordx4 v22, s[8:11], s29 offen offset:2048 lds
s_mul_i32 s101, s3, 3072
v_lshrrev_b32 v123, 1, v3
v_and_b32 v124, 1, v3
v_lshlrev_b32 v190, 9, v123
v_lshl_add_u32 v190, v2, 5, v190
v_lshl_add_u32 v190, v124, 4, v190
v_add_u32 v190, s101, v190
v_sub_u32 v124, 4, v123
v_lshlrev_b32 v191, v124, v2
v_lshl_add_u32 v225, v3, 8, s101
buffer_load_dwordx4 v23, s[8:11], s29 offen offset:3072 lds
s_add_u32 s27, s27, 1
s_cmp_eq_u32 s27, 10
s_cselect_b32 s27, 0, s27
s_lshl_b32 s28, s27, 7
s_mul_i32 s29, s27, 221184
v_add_u32 v191, v191, v225
v_mul_u32_u24 v123, 120, v123
v_add3_u32 v224, v191, v123, 8
v_lshl_add_u32 v225, v2, 2, v225
s_waitcnt lgkmcnt(0)
v_mfma_f32_16x16x32_bf16 v[184:187], v[160:163], v[144:147], 0
v_mfma_f32_16x16x32_bf16 v[184:187], v[164:167], v[148:151], v[184:187]
v_mfma_f32_16x16x32_bf16 v[184:187], v[168:171], v[152:155], v[184:187]
v_mfma_f32_16x16x32_bf16 v[184:187], v[172:175], v[156:159], v[184:187]
ds_write_b128 v190, v[176:179]
ds_write_b64 v191, v[180:181] offset:1024
ds_write_b64 v224, v[182:183] offset:1024
s_nop 4
ds_write_b32 v225, v184 offset:2048
ds_write_b32 v225, v185 offset:2112
ds_write_b32 v225, v186 offset:2176
ds_write_b32 v225, v187 offset:2240
v_readfirstlane_b32 s21, v11
v_readfirstlane_b32 s20, v10
s_cmp_eq_u32 s21, 0
s_cbranch_scc1 slow3
back4:
s_waitcnt vmcnt(21)
s_waitcnt vmcnt(8)
v_cmp_ne_u32 vcc, 0, v1
v_mov_b32 v12, 2146435072
s_nop 0
v_cndmask_b32 v12, 0, v12, vcc
buffer_store_dwordx2 v[10:11], v12, s[12:15], s40 offen sc1
s_lshr_b32 s101, s3, 1
s_mul_i32 s100, s101, 6144
s_mul_i32 s101, s101, 8320
s_add_u32 s101, s101, 16368
v_lshlrev_b32 v65, 4, v1
v_sub_u32 v65, s101, v65
s_and_b32 s101, s3, 1
s_lshl_b32 s101, s101, 8
s_add_u32 s101, s101, s100
v_lshl_add_u32 v64, v1, 2, s101
s_waitcnt lgkmcnt(0)
s_barrier
buffer_store_dwordx2 v[10:11], v63, s[12:15], s52 offen sc1
ds_read_b32 v94, v64 offset:2048
ds_read_b32 v95, v64 offset:2052
ds_read_b32 v96, v64 offset:5120
ds_read_b32 v97, v64 offset:5124
s_bitcmp1_b32 s3, 0
s_cbranch_scc1 ex5
s_movk_i32 s30, 0x200
v_cmp_gt_u32 vcc, 32, v1
v_lshlrev_b32 v92, 5, v1
v_lshl_add_u32 v93, v1, 4, s30
v_cndmask_b32 v93, v93, v92, vcc
v_cmp_ge_u32 vcc, 32, v1
v_add_u32 v92, -4, v92
v_max_i32 v92, 0, v92
v_cndmask_b32 v92, v93, v92, vcc
v_add_u32 v93, s100, v93
v_add_u32 v92, s100, v92
ds_read_b128 v[68:71], v93
ds_read_b128 v[72:75], v93 offset:3072
ds_read_b128 v[76:79], v93 offset:16
ds_read_b128 v[80:83], v93 offset:3088
ds_read_b32 v66, v92
ds_read_b32 v67, v92 offset:3072
v_cmp_eq_u32 vcc, 0, v1
v_mov_b32 v92, s54
s_mov_b32 s30, 0
s_mov_b32 s31, -1
v_cndmask_b32 v92, 0, v92, vcc
s_waitcnt lgkmcnt(0)
v_pk_add_f32 v[68:69], v[68:69], v[72:73]
v_pk_add_f32 v[70:71], v[70:71], v[74:75]
v_pk_add_f32 v[76:77], v[76:77], v[80:81]
v_pk_add_f32 v[78:79], v[78:79], v[82:83]
v_add_f32 v66, v66, v67
v_cndmask_b32 v66, v66, 0, vcc
v_cndmask_b32 v72, v69, v68, s[30:31]
v_cndmask_b32 v73, v70, v69, s[30:31]
v_cndmask_b32 v74, v71, v70, s[30:31]
v_cndmask_b32 v75, v76, v70, s[30:31]
v_cndmask_b32 v80, v77, v70, s[30:31]
v_cndmask_b32 v81, v78, v71, s[30:31]
v_cndmask_b32 v82, v79, v76, s[30:31]
v_add_f32 v68, v68, v92
v_cvt_pk_bf16_f32 v84, v82, v81
v_cvt_pk_bf16_f32 v85, v80, v75
v_cvt_pk_bf16_f32 v86, v74, v73
v_cvt_pk_bf16_f32 v87, v72, v68
v_cvt_pk_bf16_f32 v88, v81, v80
v_cvt_pk_bf16_f32 v89, v75, v74
v_cvt_pk_bf16_f32 v90, v73, v72
v_cvt_pk_bf16_f32 v91, v68, v66
ds_write_b128 v65, v[84:87]
ds_write_b128 v65, v[88:91] offset:4160
v_add_u32 v65, -2048, v65
s_branch ex6
ex5:
v_lshl_add_u32 v92, v1, 3, s100
ds_read_b64 v[68:69], v92 offset:1536
ds_read_b64 v[72:73], v92 offset:4608
ds_read_b32 v70, v92 offset:1544
ds_read_b32 v74, v92 offset:4616
v_and_b32 v93, 1, v1
v_bfe_u32 v66, v1, 1, 1
v_mul_u32_u24 v93, 4160, v93
s_lshr_b32 s101, s3, 1
s_mul_i32 s101, s101, 8320
s_add_u32 s101, s101, 12288
v_lshl_add_u32 v93, v66, 4, v93
v_mov_b32 v76, 0
v_mov_b32 v77, 0
v_mov_b32 v78, 0
v_mov_b32 v79, 0
v_add_u32 v93, s101, v93
v_add_u32 v65, -1024, v65
ds_write_b128 v93, v[76:79] offset:4096
s_waitcnt lgkmcnt(0)
v_pk_add_f32 v[68:69], v[68:69], v[72:73]
v_add_f32 v70, v70, v74
v_cvt_pk_bf16_f32 v84, v70, v70
v_cvt_pk_bf16_f32 v85, v69, v69
v_cvt_pk_bf16_f32 v86, v69, v68
v_cvt_pk_bf16_f32 v87, v68, v68
v_cvt_pk_bf16_f32 v88, v70, v69
v_cvt_pk_bf16_f32 v89, v69, v69
v_cvt_pk_bf16_f32 v90, v68, v68
v_cvt_pk_bf16_f32 v91, v68, v68
ds_write_b128 v65, v[84:87]
ds_write_b128 v65, v[88:91] offset:4160
v_add_u32 v65, -2048, v65
ex6:
v_and_b32 v66, 1, v1
v_add_f32 v94, v94, v96
v_cmp_eq_u32 vcc, 1, v66
v_add_f32 v95, v95, v97
s_nop 0
v_cndmask_b32 v96, v94, v95, vcc
v_cvt_pk_bf16_f32 v98, v95, v95
v_cvt_pk_bf16_f32 v99, v95, v96
v_cvt_pk_bf16_f32 v100, v94, v94
v_cvt_pk_bf16_f32 v101, v94, v94
v_cvt_pk_bf16_f32 v102, v95, v95
v_cvt_pk_bf16_f32 v103, v96, v94
v_cvt_pk_bf16_f32 v104, v94, v94
v_cvt_pk_bf16_f32 v105, v94, v94
ds_write_b128 v65, v[98:101]
ds_write_b128 v65, v[102:105] offset:4160
s_add_u32 m0, s47, 98304
s_nop 0
buffer_load_dwordx4 v16, s[4:7], s28 offen offset:0 lds
v_lshlrev_b32 v192, 16, v200
v_and_b32 v193, 0xffff0000, v200
v_lshlrev_b32 v194, 16, v201
v_and_b32 v195, 0xffff0000, v201
v_lshlrev_b32 v196, 16, v202
v_and_b32 v197, 0xffff0000, v202
v_lshlrev_b32 v198, 16, v203
v_and_b32 v199, 0xffff0000, v203
v_lshlrev_b32 v200, 16, v204
v_and_b32 v201, 0xffff0000, v204
v_lshlrev_b32 v202, 16, v205
buffer_load_dwordx4 v17, s[4:7], s28 offen offset:1024 lds
v_and_b32 v203, 0xffff0000, v205
v_lshlrev_b32 v204, 16, v206
v_and_b32 v205, 0xffff0000, v206
v_lshlrev_b32 v206, 16, v207
v_and_b32 v207, 0xffff0000, v207
s_lshr_b32 s101, s3, 1
s_lshl_b32 s101, s101, 13
s_add_u32 s101, s101, 32768
v_and_b32 v64, 7, v2
v_xor_b32 v64, v64, v3
v_lshl_add_u32 v65, v2, 7, s101
buffer_load_dwordx4 v18, s[4:7], s28 offen offset:2048 lds
v_lshl_add_u32 v24, v64, 4, v65
v_xor_b32 v25, 64, v24
v_add_u32 v26, 0x10000, v24
v_add_u32 v27, 0x10000, v25
v_bfe_u32 v66, v1, 2, 2
v_and_b32 v67, 3, v1
v_and_b32 v68, 1, v3
v_lshl_add_u32 v69, v3, 3, v66
s_and_b32 s101, s3, 1
v_lshl_or_b32 v70, v68, 2, v66
s_lshl_b32 s101, s101, 2
v_lshlrev_b32 v69, 8, v69
buffer_load_dwordx4 v19, s[4:7], s28 offen offset:3072 lds
v_xor_b32 v70, s101, v70
v_lshl_add_u32 v69, v67, 3, v69
v_add_u32 v69, 49152, v69
v_xor_b32 v71, 0, v70
v_lshl_add_u32 v28, v71, 5, v69
v_add_u32 v32, 0x10000, v28
v_xor_b32 v71, 1, v70
v_lshl_add_u32 v29, v71, 5, v69
v_add_u32 v33, 0x10000, v29
v_xor_b32 v71, 2, v70
v_lshl_add_u32 v30, v71, 5, v69
v_add_u32 v34, 0x10000, v30
v_xor_b32 v71, 3, v70
v_lshl_add_u32 v31, v71, 5, v69
v_add_u32 v35, 0x10000, v31
s_waitcnt lgkmcnt(0)
s_barrier
ds_read_b64_tr_b16 v[144:145], v28 offset:0
ds_read_b64_tr_b16 v[146:147], v28 offset:1024
ds_read_b128 v[128:131], v24 offset:0
ds_read_b128 v[132:135], v24 offset:2048
ds_read_b128 v[136:139], v24 offset:4096
ds_read_b128 v[140:143], v24 offset:6144
ds_read_b64_tr_b16 v[148:149], v29 offset:0
ds_read_b64_tr_b16 v[150:151], v29 offset:1024
ds_read_b64_tr_b16 v[152:153], v30 offset:0
ds_read_b64_tr_b16 v[154:155], v30 offset:1024
ds_read_b64_tr_b16 v[156:157], v31 offset:0
ds_read_b64_tr_b16 v[158:159], v31 offset:1024
s_waitcnt lgkmcnt(6)
v_mfma_f32_16x16x32_bf16 v[64:67], v[144:147], v[128:131], v[192:195]
s_add_u32 m0, s48, 98304
v_mfma_f32_16x16x32_bf16 v[68:71], v[144:147], v[132:135], v[192:195]
ds_read_b64_tr_b16 v[176:177], v28 offset:8192
buffer_load_dwordx4 v20, s[8:11], s29 offen offset:0 lds
v_mfma_f32_16x16x32_bf16 v[72:75], v[144:147], v[136:139], v[192:195]
ds_read_b64_tr_b16 v[178:179], v28 offset:9216
v_mfma_f32_16x16x32_bf16 v[76:79], v[144:147], v[140:143], v[192:195]
ds_read_b128 v[160:163], v25 offset:0
s_waitcnt lgkmcnt(7)
v_mfma_f32_16x16x32_bf16 v[80:83], v[148:151], v[128:131], v[196:199]
ds_read_b128 v[164:167], v25 offset:2048
v_mfma_f32_16x16x32_bf16 v[84:87], v[148:151], v[132:135], v[196:199]
ds_read_b128 v[168:171], v25 offset:4096
buffer_load_dwordx4 v21, s[8:11], s29 offen offset:1024 lds
v_mfma_f32_16x16x32_bf16 v[88:91], v[148:151], v[136:139], v[196:199]
ds_read_b128 v[172:175], v25 offset:6144
v_mfma_f32_16x16x32_bf16 v[92:95], v[148:151], v[140:143], v[196:199]
ds_read_b64_tr_b16 v[180:181], v29 offset:8192
s_waitcnt lgkmcnt(9)
v_mfma_f32_16x16x32_bf16 v[96:99], v[152:155], v[128:131], v[200:203]
ds_read_b64_tr_b16 v[182:183], v29 offset:9216
v_mfma_f32_16x16x32_bf16 v[100:103], v[152:155], v[132:135], v[200:203]
ds_read_b64_tr_b16 v[184:185], v30 offset:8192
buffer_load_dwordx4 v22, s[8:11], s29 offen offset:2048 lds
v_mfma_f32_16x16x32_bf16 v[104:107], v[152:155], v[136:139], v[200:203]
ds_read_b64_tr_b16 v[186:187], v30 offset:9216
v_mfma_f32_16x16x32_bf16 v[108:111], v[152:155], v[140:143], v[200:203]
ds_read_b64_tr_b16 v[188:189], v31 offset:8192
s_waitcnt lgkmcnt(11)
v_mfma_f32_16x16x32_bf16 v[112:115], v[156:159], v[128:131], v[204:207]
ds_read_b64_tr_b16 v[190:191], v31 offset:9216
v_mfma_f32_16x16x32_bf16 v[116:119], v[156:159], v[132:135], v[204:207]
buffer_load_dwordx4 v23, s[8:11], s29 offen offset:3072 lds
s_add_u32 s27, s27, 1
v_mfma_f32_16x16x32_bf16 v[120:123], v[156:159], v[136:139], v[204:207]
s_cmp_eq_u32 s27, 10
s_cselect_b32 s27, 0, s27
v_mfma_f32_16x16x32_bf16 v[124:127], v[156:159], v[140:143], v[204:207]
s_lshl_b32 s28, s27, 7
s_mul_i32 s29, s27, 221184
s_waitcnt lgkmcnt(6)
v_mfma_f32_16x16x32_bf16 v[64:67], v[176:179], v[160:163], v[64:67]
v_mfma_f32_16x16x32_bf16 v[68:71], v[176:179], v[164:167], v[68:71]
v_mfma_f32_16x16x32_bf16 v[72:75], v[176:179], v[168:171], v[72:75]
v_mfma_f32_16x16x32_bf16 v[76:79], v[176:179], v[172:175], v[76:79]
s_add_u32 m0, s47, 0
s_waitcnt lgkmcnt(0)
s_barrier
v_mfma_f32_16x16x32_bf16 v[80:83], v[180:183], v[160:163], v[80:83]
ds_read_b64_tr_b16 v[144:145], v28 offset:32768
buffer_load_dwordx4 v16, s[4:7], s28 offen offset:0 lds
v_mfma_f32_16x16x32_bf16 v[84:87], v[180:183], v[164:167], v[84:87]
ds_read_b64_tr_b16 v[146:147], v28 offset:33792
v_mfma_f32_16x16x32_bf16 v[88:91], v[180:183], v[168:171], v[88:91]
ds_read_b128 v[128:131], v24 offset:32768
v_mfma_f32_16x16x32_bf16 v[92:95], v[180:183], v[172:175], v[92:95]
ds_read_b128 v[132:135], v24 offset:34816
v_mfma_f32_16x16x32_bf16 v[96:99], v[184:187], v[160:163], v[96:99]
ds_read_b128 v[136:139], v24 offset:36864
buffer_load_dwordx4 v17, s[4:7], s28 offen offset:1024 lds
v_mfma_f32_16x16x32_bf16 v[100:103], v[184:187], v[164:167], v[100:103]
ds_read_b128 v[140:143], v24 offset:38912
v_mfma_f32_16x16x32_bf16 v[104:107], v[184:187], v[168:171], v[104:107]
ds_read_b64_tr_b16 v[148:149], v29 offset:32768
v_mfma_f32_16x16x32_bf16 v[108:111], v[184:187], v[172:175], v[108:111]
ds_read_b64_tr_b16 v[150:151], v29 offset:33792
v_mfma_f32_16x16x32_bf16 v[112:115], v[188:191], v[160:163], v[112:115]
ds_read_b64_tr_b16 v[152:153], v30 offset:32768
buffer_load_dwordx4 v18, s[4:7], s28 offen offset:2048 lds
v_mfma_f32_16x16x32_bf16 v[116:119], v[188:191], v[164:167], v[116:119]
ds_read_b64_tr_b16 v[154:155], v30 offset:33792
v_mfma_f32_16x16x32_bf16 v[120:123], v[188:191], v[168:171], v[120:123]
ds_read_b64_tr_b16 v[156:157], v31 offset:32768
v_mfma_f32_16x16x32_bf16 v[124:127], v[188:191], v[172:175], v[124:127]
ds_read_b64_tr_b16 v[158:159], v31 offset:33792
s_waitcnt lgkmcnt(6)
v_mfma_f32_16x16x32_bf16 v[64:67], v[144:147], v[128:131], v[64:67]
buffer_load_dwordx4 v19, s[4:7], s28 offen offset:3072 lds
s_add_u32 m0, s48, 0
v_mfma_f32_16x16x32_bf16 v[68:71], v[144:147], v[132:135], v[68:71]
ds_read_b64_tr_b16 v[176:177], v28 offset:40960
v_mfma_f32_16x16x32_bf16 v[72:75], v[144:147], v[136:139], v[72:75]
ds_read_b64_tr_b16 v[178:179], v28 offset:41984
v_mfma_f32_16x16x32_bf16 v[76:79], v[144:147], v[140:143], v[76:79]
ds_read_b128 v[160:163], v25 offset:32768
s_waitcnt lgkmcnt(7)
v_mfma_f32_16x16x32_bf16 v[80:83], v[148:151], v[128:131], v[80:83]
ds_read_b128 v[164:167], v25 offset:34816
buffer_load_dwordx4 v20, s[8:11], s29 offen offset:0 lds
v_mfma_f32_16x16x32_bf16 v[84:87], v[148:151], v[132:135], v[84:87]
ds_read_b128 v[168:171], v25 offset:36864
v_mfma_f32_16x16x32_bf16 v[88:91], v[148:151], v[136:139], v[88:91]
ds_read_b128 v[172:175], v25 offset:38912
v_mfma_f32_16x16x32_bf16 v[92:95], v[148:151], v[140:143], v[92:95]
ds_read_b64_tr_b16 v[180:181], v29 offset:40960
s_waitcnt lgkmcnt(9)
v_mfma_f32_16x16x32_bf16 v[96:99], v[152:155], v[128:131], v[96:99]
ds_read_b64_tr_b16 v[182:183], v29 offset:41984
buffer_load_dwordx4 v21, s[8:11], s29 offen offset:1024 lds
v_mfma_f32_16x16x32_bf16 v[100:103], v[152:155], v[132:135], v[100:103]
ds_read_b64_tr_b16 v[184:185], v30 offset:40960
v_mfma_f32_16x16x32_bf16 v[104:107], v[152:155], v[136:139], v[104:107]
ds_read_b64_tr_b16 v[186:187], v30 offset:41984
v_mfma_f32_16x16x32_bf16 v[108:111], v[152:155], v[140:143], v[108:111]
ds_read_b64_tr_b16 v[188:189], v31 offset:40960
s_waitcnt lgkmcnt(11)
v_mfma_f32_16x16x32_bf16 v[112:115], v[156:159], v[128:131], v[112:115]
ds_read_b64_tr_b16 v[190:191], v31 offset:41984
buffer_load_dwordx4 v22, s[8:11], s29 offen offset:2048 lds
v_mfma_f32_16x16x32_bf16 v[116:119], v[156:159], v[132:135], v[116:119]
v_mfma_f32_16x16x32_bf16 v[120:123], v[156:159], v[136:139], v[120:123]
v_mfma_f32_16x16x32_bf16 v[124:127], v[156:159], v[140:143], v[124:127]
s_waitcnt lgkmcnt(6)
v_mfma_f32_16x16x32_bf16 v[64:67], v[176:179], v[160:163], v[64:67]
buffer_load_dwordx4 v23, s[8:11], s29 offen offset:3072 lds
s_add_u32 s27, s27, 1
v_mfma_f32_16x16x32_bf16 v[68:71], v[176:179], v[164:167], v[68:71]
s_cmp_eq_u32 s27, 10
s_cselect_b32 s27, 0, s27
v_mfma_f32_16x16x32_bf16 v[72:75], v[176:179], v[168:171], v[72:75]
s_lshl_b32 s28, s27, 7
s_mul_i32 s29, s27, 221184
v_mfma_f32_16x16x32_bf16 v[76:79], v[176:179], v[172:175], v[76:79]
s_add_u32 m0, s47, 32768
s_waitcnt vmcnt(18)
s_waitcnt lgkmcnt(0)
s_barrier
v_mfma_f32_16x16x32_bf16 v[80:83], v[180:183], v[160:163], v[80:83]
ds_read_b64_tr_b16 v[144:145], v32 offset:0
buffer_load_dwordx4 v16, s[4:7], s28 offen offset:0 lds
v_mfma_f32_16x16x32_bf16 v[84:87], v[180:183], v[164:167], v[84:87]
ds_read_b64_tr_b16 v[146:147], v32 offset:1024
v_mfma_f32_16x16x32_bf16 v[88:91], v[180:183], v[168:171], v[88:91]
ds_read_b128 v[128:131], v26 offset:0
v_mfma_f32_16x16x32_bf16 v[92:95], v[180:183], v[172:175], v[92:95]
ds_read_b128 v[132:135], v26 offset:2048
v_mfma_f32_16x16x32_bf16 v[96:99], v[184:187], v[160:163], v[96:99]
ds_read_b128 v[136:139], v26 offset:4096
buffer_load_dwordx4 v17, s[4:7], s28 offen offset:1024 lds
v_mfma_f32_16x16x32_bf16 v[100:103], v[184:187], v[164:167], v[100:103]
ds_read_b128 v[140:143], v26 offset:6144
v_mfma_f32_16x16x32_bf16 v[104:107], v[184:187], v[168:171], v[104:107]
ds_read_b64_tr_b16 v[148:149], v33 offset:0
v_mfma_f32_16x16x32_bf16 v[108:111], v[184:187], v[172:175], v[108:111]
ds_read_b64_tr_b16 v[150:151], v33 offset:1024
v_mfma_f32_16x16x32_bf16 v[112:115], v[188:191], v[160:163], v[112:115]
ds_read_b64_tr_b16 v[152:153], v34 offset:0
buffer_load_dwordx4 v18, s[4:7], s28 offen offset:2048 lds
v_mfma_f32_16x16x32_bf16 v[116:119], v[188:191], v[164:167], v[116:119]
ds_read_b64_tr_b16 v[154:155], v34 offset:1024
v_mfma_f32_16x16x32_bf16 v[120:123], v[188:191], v[168:171], v[120:123]
ds_read_b64_tr_b16 v[156:157], v35 offset:0
v_mfma_f32_16x16x32_bf16 v[124:127], v[188:191], v[172:175], v[124:127]
ds_read_b64_tr_b16 v[158:159], v35 offset:1024
s_waitcnt lgkmcnt(6)
v_mfma_f32_16x16x32_bf16 v[64:67], v[144:147], v[128:131], v[64:67]
buffer_load_dwordx4 v19, s[4:7], s28 offen offset:3072 lds
s_add_u32 m0, s48, 32768
v_mfma_f32_16x16x32_bf16 v[68:71], v[144:147], v[132:135], v[68:71]
ds_read_b64_tr_b16 v[176:177], v32 offset:8192
v_mfma_f32_16x16x32_bf16 v[72:75], v[144:147], v[136:139], v[72:75]
ds_read_b64_tr_b16 v[178:179], v32 offset:9216
v_mfma_f32_16x16x32_bf16 v[76:79], v[144:147], v[140:143], v[76:79]
ds_read_b128 v[160:163], v27 offset:0
s_waitcnt lgkmcnt(7)
v_mfma_f32_16x16x32_bf16 v[80:83], v[148:151], v[128:131], v[80:83]
ds_read_b128 v[164:167], v27 offset:2048
buffer_load_dwordx4 v20, s[8:11], s29 offen offset:0 lds
v_mfma_f32_16x16x32_bf16 v[84:87], v[148:151], v[132:135], v[84:87]
ds_read_b128 v[168:171], v27 offset:4096
v_mfma_f32_16x16x32_bf16 v[88:91], v[148:151], v[136:139], v[88:91]
ds_read_b128 v[172:175], v27 offset:6144
v_mfma_f32_16x16x32_bf16 v[92:95], v[148:151], v[140:143], v[92:95]
ds_read_b64_tr_b16 v[180:181], v33 offset:8192
s_waitcnt lgkmcnt(9)
v_mfma_f32_16x16x32_bf16 v[96:99], v[152:155], v[128:131], v[96:99]
ds_read_b64_tr_b16 v[182:183], v33 offset:9216
buffer_load_dwordx4 v21, s[8:11], s29 offen offset:1024 lds
v_mfma_f32_16x16x32_bf16 v[100:103], v[152:155], v[132:135], v[100:103]
ds_read_b64_tr_b16 v[184:185], v34 offset:8192
v_mfma_f32_16x16x32_bf16 v[104:107], v[152:155], v[136:139], v[104:107]
ds_read_b64_tr_b16 v[186:187], v34 offset:9216
v_mfma_f32_16x16x32_bf16 v[108:111], v[152:155], v[140:143], v[108:111]
ds_read_b64_tr_b16 v[188:189], v35 offset:8192
s_waitcnt lgkmcnt(11)
v_mfma_f32_16x16x32_bf16 v[112:115], v[156:159], v[128:131], v[112:115]
ds_read_b64_tr_b16 v[190:191], v35 offset:9216
buffer_load_dwordx4 v22, s[8:11], s29 offen offset:2048 lds
v_mfma_f32_16x16x32_bf16 v[116:119], v[156:159], v[132:135], v[116:119]
v_mfma_f32_16x16x32_bf16 v[120:123], v[156:159], v[136:139], v[120:123]
v_mfma_f32_16x16x32_bf16 v[124:127], v[156:159], v[140:143], v[124:127]
s_waitcnt lgkmcnt(6)
v_mfma_f32_16x16x32_bf16 v[64:67], v[176:179], v[160:163], v[64:67]
buffer_load_dwordx4 v23, s[8:11], s29 offen offset:3072 lds
s_add_u32 s27, s27, 1
v_mfma_f32_16x16x32_bf16 v[68:71], v[176:179], v[164:167], v[68:71]
s_cmp_eq_u32 s27, 10
s_cselect_b32 s27, 0, s27
v_mfma_f32_16x16x32_bf16 v[72:75], v[176:179], v[168:171], v[72:75]
s_lshl_b32 s28, s27, 7
s_mul_i32 s29, s27, 221184
v_mfma_f32_16x16x32_bf16 v[76:79], v[176:179], v[172:175], v[76:79]
s_add_u32 m0, s47, 65536
s_waitcnt vmcnt(16)
s_waitcnt lgkmcnt(0)
s_barrier
v_mfma_f32_16x16x32_bf16 v[80:83], v[180:183], v[160:163], v[80:83]
ds_read_b64_tr_b16 v[144:145], v32 offset:32768
buffer_load_dwordx4 v16, s[4:7], s28 offen offset:0 lds
v_mfma_f32_16x16x32_bf16 v[84:87], v[180:183], v[164:167], v[84:87]
ds_read_b64_tr_b16 v[146:147], v32 offset:33792
v_mfma_f32_16x16x32_bf16 v[88:91], v[180:183], v[168:171], v[88:91]
ds_read_b128 v[128:131], v26 offset:32768
v_mfma_f32_16x16x32_bf16 v[92:95], v[180:183], v[172:175], v[92:95]
ds_read_b128 v[132:135], v26 offset:34816
v_mfma_f32_16x16x32_bf16 v[96:99], v[184:187], v[160:163], v[96:99]
ds_read_b128 v[136:139], v26 offset:36864
buffer_load_dwordx4 v17, s[4:7], s28 offen offset:1024 lds
v_mfma_f32_16x16x32_bf16 v[100:103], v[184:187], v[164:167], v[100:103]
ds_read_b128 v[140:143], v26 offset:38912
v_mfma_f32_16x16x32_bf16 v[104:107], v[184:187], v[168:171], v[104:107]
ds_read_b64_tr_b16 v[148:149], v33 offset:32768
v_mfma_f32_16x16x32_bf16 v[108:111], v[184:187], v[172:175], v[108:111]
ds_read_b64_tr_b16 v[150:151], v33 offset:33792
v_mfma_f32_16x16x32_bf16 v[112:115], v[188:191], v[160:163], v[112:115]
ds_read_b64_tr_b16 v[152:153], v34 offset:32768
buffer_load_dwordx4 v18, s[4:7], s28 offen offset:2048 lds
v_mfma_f32_16x16x32_bf16 v[116:119], v[188:191], v[164:167], v[116:119]
ds_read_b64_tr_b16 v[154:155], v34 offset:33792
v_mfma_f32_16x16x32_bf16 v[120:123], v[188:191], v[168:171], v[120:123]
ds_read_b64_tr_b16 v[156:157], v35 offset:32768
v_mfma_f32_16x16x32_bf16 v[124:127], v[188:191], v[172:175], v[124:127]
ds_read_b64_tr_b16 v[158:159], v35 offset:33792
s_waitcnt lgkmcnt(6)
v_mfma_f32_16x16x32_bf16 v[64:67], v[144:147], v[128:131], v[64:67]
buffer_load_dwordx4 v19, s[4:7], s28 offen offset:3072 lds
s_add_u32 m0, s48, 65536
v_mfma_f32_16x16x32_bf16 v[68:71], v[144:147], v[132:135], v[68:71]
ds_read_b64_tr_b16 v[176:177], v32 offset:40960
v_mfma_f32_16x16x32_bf16 v[72:75], v[144:147], v[136:139], v[72:75]
ds_read_b64_tr_b16 v[178:179], v32 offset:41984
v_mfma_f32_16x16x32_bf16 v[76:79], v[144:147], v[140:143], v[76:79]
ds_read_b128 v[160:163], v27 offset:32768
s_waitcnt lgkmcnt(7)
v_mfma_f32_16x16x32_bf16 v[80:83], v[148:151], v[128:131], v[80:83]
ds_read_b128 v[164:167], v27 offset:34816
buffer_load_dwordx4 v20, s[8:11], s29 offen offset:0 lds
v_mfma_f32_16x16x32_bf16 v[84:87], v[148:151], v[132:135], v[84:87]
ds_read_b128 v[168:171], v27 offset:36864
v_mfma_f32_16x16x32_bf16 v[88:91], v[148:151], v[136:139], v[88:91]
ds_read_b128 v[172:175], v27 offset:38912
v_mfma_f32_16x16x32_bf16 v[92:95], v[148:151], v[140:143], v[92:95]
ds_read_b64_tr_b16 v[180:181], v33 offset:40960
s_waitcnt lgkmcnt(9)
v_mfma_f32_16x16x32_bf16 v[96:99], v[152:155], v[128:131], v[96:99]
ds_read_b64_tr_b16 v[182:183], v33 offset:41984
buffer_load_dwordx4 v21, s[8:11], s29 offen offset:1024 lds
v_mfma_f32_16x16x32_bf16 v[100:103], v[152:155], v[132:135], v[100:103]
ds_read_b64_tr_b16 v[184:185], v34 offset:40960
v_mfma_f32_16x16x32_bf16 v[104:107], v[152:155], v[136:139], v[104:107]
ds_read_b64_tr_b16 v[186:187], v34 offset:41984
v_mfma_f32_16x16x32_bf16 v[108:111], v[152:155], v[140:143], v[108:111]
ds_read_b64_tr_b16 v[188:189], v35 offset:40960
s_waitcnt lgkmcnt(11)
v_mfma_f32_16x16x32_bf16 v[112:115], v[156:159], v[128:131], v[112:115]
ds_read_b64_tr_b16 v[190:191], v35 offset:41984
buffer_load_dwordx4 v22, s[8:11], s29 offen offset:2048 lds
v_mfma_f32_16x16x32_bf16 v[116:119], v[156:159], v[132:135], v[116:119]
v_mfma_f32_16x16x32_bf16 v[120:123], v[156:159], v[136:139], v[120:123]
v_mfma_f32_16x16x32_bf16 v[124:127], v[156:159], v[140:143], v[124:127]
s_waitcnt lgkmcnt(6)
v_mfma_f32_16x16x32_bf16 v[64:67], v[176:179], v[160:163], v[64:67]
buffer_load_dwordx4 v23, s[8:11], s29 offen offset:3072 lds
s_add_u32 s27, s27, 1
v_mfma_f32_16x16x32_bf16 v[68:71], v[176:179], v[164:167], v[68:71]
s_cmp_eq_u32 s27, 10
s_cselect_b32 s27, 0, s27
v_mfma_f32_16x16x32_bf16 v[72:75], v[176:179], v[168:171], v[72:75]
s_lshl_b32 s28, s27, 7
s_mul_i32 s29, s27, 221184
v_mfma_f32_16x16x32_bf16 v[76:79], v[176:179], v[172:175], v[76:79]
s_add_u32 m0, s47, 98304
s_waitcnt vmcnt(16)
s_waitcnt lgkmcnt(0)
s_barrier
v_mfma_f32_16x16x32_bf16 v[80:83], v[180:183], v[160:163], v[80:83]
ds_read_b64_tr_b16 v[144:145], v28 offset:0
buffer_load_dwordx4 v16, s[4:7], s28 offen offset:0 lds
v_mfma_f32_16x16x32_bf16 v[84:87], v[180:183], v[164:167], v[84:87]
ds_read_b64_tr_b16 v[146:147], v28 offset:1024
v_mfma_f32_16x16x32_bf16 v[88:91], v[180:183], v[168:171], v[88:91]
ds_read_b128 v[128:131], v24 offset:0
v_mfma_f32_16x16x32_bf16 v[92:95], v[180:183], v[172:175], v[92:95]
ds_read_b128 v[132:135], v24 offset:2048
v_mfma_f32_16x16x32_bf16 v[96:99], v[184:187], v[160:163], v[96:99]
ds_read_b128 v[136:139], v24 offset:4096
buffer_load_dwordx4 v17, s[4:7], s28 offen offset:1024 lds
v_mfma_f32_16x16x32_bf16 v[100:103], v[184:187], v[164:167], v[100:103]
ds_read_b128 v[140:143], v24 offset:6144
v_mfma_f32_16x16x32_bf16 v[104:107], v[184:187], v[168:171], v[104:107]
ds_read_b64_tr_b16 v[148:149], v29 offset:0
v_mfma_f32_16x16x32_bf16 v[108:111], v[184:187], v[172:175], v[108:111]
ds_read_b64_tr_b16 v[150:151], v29 offset:1024
v_mfma_f32_16x16x32_bf16 v[112:115], v[188:191], v[160:163], v[112:115]
ds_read_b64_tr_b16 v[152:153], v30 offset:0
buffer_load_dwordx4 v18, s[4:7], s28 offen offset:2048 lds
v_mfma_f32_16x16x32_bf16 v[116:119], v[188:191], v[164:167], v[116:119]
ds_read_b64_tr_b16 v[154:155], v30 offset:1024
v_mfma_f32_16x16x32_bf16 v[120:123], v[188:191], v[168:171], v[120:123]
ds_read_b64_tr_b16 v[156:157], v31 offset:0
v_mfma_f32_16x16x32_bf16 v[124:127], v[188:191], v[172:175], v[124:127]
ds_read_b64_tr_b16 v[158:159], v31 offset:1024
s_waitcnt lgkmcnt(6)
v_mfma_f32_16x16x32_bf16 v[64:67], v[144:147], v[128:131], v[64:67]
buffer_load_dwordx4 v19, s[4:7], s28 offen offset:3072 lds
s_add_u32 m0, s48, 98304
v_mfma_f32_16x16x32_bf16 v[68:71], v[144:147], v[132:135], v[68:71]
ds_read_b64_tr_b16 v[176:177], v28 offset:8192
v_mfma_f32_16x16x32_bf16 v[72:75], v[144:147], v[136:139], v[72:75]
ds_read_b64_tr_b16 v[178:179], v28 offset:9216
v_mfma_f32_16x16x32_bf16 v[76:79], v[144:147], v[140:143], v[76:79]
ds_read_b128 v[160:163], v25 offset:0
s_waitcnt lgkmcnt(7)
v_mfma_f32_16x16x32_bf16 v[80:83], v[148:151], v[128:131], v[80:83]
ds_read_b128 v[164:167], v25 offset:2048
buffer_load_dwordx4 v20, s[8:11], s29 offen offset:0 lds
v_mfma_f32_16x16x32_bf16 v[84:87], v[148:151], v[132:135], v[84:87]
ds_read_b128 v[168:171], v25 offset:4096
v_mfma_f32_16x16x32_bf16 v[88:91], v[148:151], v[136:139], v[88:91]
ds_read_b128 v[172:175], v25 offset:6144
v_mfma_f32_16x16x32_bf16 v[92:95], v[148:151], v[140:143], v[92:95]
ds_read_b64_tr_b16 v[180:181], v29 offset:8192
s_waitcnt lgkmcnt(9)
v_mfma_f32_16x16x32_bf16 v[96:99], v[152:155], v[128:131], v[96:99]
ds_read_b64_tr_b16 v[182:183], v29 offset:9216
buffer_load_dwordx4 v21, s[8:11], s29 offen offset:1024 lds
v_mfma_f32_16x16x32_bf16 v[100:103], v[152:155], v[132:135], v[100:103]
ds_read_b64_tr_b16 v[184:185], v30 offset:8192
v_mfma_f32_16x16x32_bf16 v[104:107], v[152:155], v[136:139], v[104:107]
ds_read_b64_tr_b16 v[186:187], v30 offset:9216
v_mfma_f32_16x16x32_bf16 v[108:111], v[152:155], v[140:143], v[108:111]
ds_read_b64_tr_b16 v[188:189], v31 offset:8192
s_waitcnt lgkmcnt(11)
v_mfma_f32_16x16x32_bf16 v[112:115], v[156:159], v[128:131], v[112:115]
ds_read_b64_tr_b16 v[190:191], v31 offset:9216
buffer_load_dwordx4 v22, s[8:11], s29 offen offset:2048 lds
v_mfma_f32_16x16x32_bf16 v[116:119], v[156:159], v[132:135], v[116:119]
v_mfma_f32_16x16x32_bf16 v[120:123], v[156:159], v[136:139], v[120:123]
v_mfma_f32_16x16x32_bf16 v[124:127], v[156:159], v[140:143], v[124:127]
s_waitcnt lgkmcnt(6)
v_mfma_f32_16x16x32_bf16 v[64:67], v[176:179], v[160:163], v[64:67]
buffer_load_dwordx4 v23, s[8:11], s29 offen offset:3072 lds
s_add_u32 s27, s27, 1
v_mfma_f32_16x16x32_bf16 v[68:71], v[176:179], v[164:167], v[68:71]
s_cmp_eq_u32 s27, 10
s_cselect_b32 s27, 0, s27
v_mfma_f32_16x16x32_bf16 v[72:75], v[176:179], v[168:171], v[72:75]
s_lshl_b32 s28, s27, 7
s_mul_i32 s29, s27, 221184
v_mfma_f32_16x16x32_bf16 v[76:79], v[176:179], v[172:175], v[76:79]
s_add_u32 m0, s47, 0
s_waitcnt vmcnt(16)
s_waitcnt lgkmcnt(0)
s_barrier
v_mfma_f32_16x16x32_bf16 v[80:83], v[180:183], v[160:163], v[80:83]
ds_read_b64_tr_b16 v[144:145], v28 offset:32768
buffer_load_dwordx4 v16, s[4:7], s28 offen offset:0 lds
v_mfma_f32_16x16x32_bf16 v[84:87], v[180:183], v[164:167], v[84:87]
ds_read_b64_tr_b16 v[146:147], v28 offset:33792
v_mfma_f32_16x16x32_bf16 v[88:91], v[180:183], v[168:171], v[88:91]
ds_read_b128 v[128:131], v24 offset:32768
v_mfma_f32_16x16x32_bf16 v[92:95], v[180:183], v[172:175], v[92:95]
ds_read_b128 v[132:135], v24 offset:34816
v_mfma_f32_16x16x32_bf16 v[96:99], v[184:187], v[160:163], v[96:99]
ds_read_b128 v[136:139], v24 offset:36864
buffer_load_dwordx4 v17, s[4:7], s28 offen offset:1024 lds
v_mfma_f32_16x16x32_bf16 v[100:103], v[184:187], v[164:167], v[100:103]
ds_read_b128 v[140:143], v24 offset:38912
v_mfma_f32_16x16x32_bf16 v[104:107], v[184:187], v[168:171], v[104:107]
ds_read_b64_tr_b16 v[148:149], v29 offset:32768
v_mfma_f32_16x16x32_bf16 v[108:111], v[184:187], v[172:175], v[108:111]
ds_read_b64_tr_b16 v[150:151], v29 offset:33792
v_mfma_f32_16x16x32_bf16 v[112:115], v[188:191], v[160:163], v[112:115]
ds_read_b64_tr_b16 v[152:153], v30 offset:32768
buffer_load_dwordx4 v18, s[4:7], s28 offen offset:2048 lds
v_mfma_f32_16x16x32_bf16 v[116:119], v[188:191], v[164:167], v[116:119]
ds_read_b64_tr_b16 v[154:155], v30 offset:33792
v_mfma_f32_16x16x32_bf16 v[120:123], v[188:191], v[168:171], v[120:123]
ds_read_b64_tr_b16 v[156:157], v31 offset:32768
v_mfma_f32_16x16x32_bf16 v[124:127], v[188:191], v[172:175], v[124:127]
ds_read_b64_tr_b16 v[158:159], v31 offset:33792
s_waitcnt lgkmcnt(6)
v_mfma_f32_16x16x32_bf16 v[64:67], v[144:147], v[128:131], v[64:67]
buffer_load_dwordx4 v19, s[4:7], s28 offen offset:3072 lds
s_add_u32 m0, s48, 0
v_mfma_f32_16x16x32_bf16 v[68:71], v[144:147], v[132:135], v[68:71]
ds_read_b64_tr_b16 v[176:177], v28 offset:40960
v_mfma_f32_16x16x32_bf16 v[72:75], v[144:147], v[136:139], v[72:75]
ds_read_b64_tr_b16 v[178:179], v28 offset:41984
v_mfma_f32_16x16x32_bf16 v[76:79], v[144:147], v[140:143], v[76:79]
ds_read_b128 v[160:163], v25 offset:32768
s_waitcnt lgkmcnt(7)
v_mfma_f32_16x16x32_bf16 v[80:83], v[148:151], v[128:131], v[80:83]
ds_read_b128 v[164:167], v25 offset:34816
buffer_load_dwordx4 v20, s[8:11], s29 offen offset:0 lds
v_mfma_f32_16x16x32_bf16 v[84:87], v[148:151], v[132:135], v[84:87]
ds_read_b128 v[168:171], v25 offset:36864
v_mfma_f32_16x16x32_bf16 v[88:91], v[148:151], v[136:139], v[88:91]
ds_read_b128 v[172:175], v25 offset:38912
v_mfma_f32_16x16x32_bf16 v[92:95], v[148:151], v[140:143], v[92:95]
ds_read_b64_tr_b16 v[180:181], v29 offset:40960
s_waitcnt lgkmcnt(9)
v_mfma_f32_16x16x32_bf16 v[96:99], v[152:155], v[128:131], v[96:99]
ds_read_b64_tr_b16 v[182:183], v29 offset:41984
buffer_load_dwordx4 v21, s[8:11], s29 offen offset:1024 lds
v_mfma_f32_16x16x32_bf16 v[100:103], v[152:155], v[132:135], v[100:103]
ds_read_b64_tr_b16 v[184:185], v30 offset:40960
v_mfma_f32_16x16x32_bf16 v[104:107], v[152:155], v[136:139], v[104:107]
ds_read_b64_tr_b16 v[186:187], v30 offset:41984
v_mfma_f32_16x16x32_bf16 v[108:111], v[152:155], v[140:143], v[108:111]
ds_read_b64_tr_b16 v[188:189], v31 offset:40960
s_waitcnt lgkmcnt(11)
v_mfma_f32_16x16x32_bf16 v[112:115], v[156:159], v[128:131], v[112:115]
ds_read_b64_tr_b16 v[190:191], v31 offset:41984
buffer_load_dwordx4 v22, s[8:11], s29 offen offset:2048 lds
v_mfma_f32_16x16x32_bf16 v[116:119], v[156:159], v[132:135], v[116:119]
s_mul_i32 s101, s3, 14
s_cmp_eq_u32 s3, 3
s_subb_u32 s101, s101, 0
s_lshr_b32 s100, s3, 1
s_sub_u32 s100, 13, s100
v_min_u32 v12, s100, v1
s_lshl_b32 s100, s26, 6
s_add_u32 s101, s101, s100
s_lshl_b32 s101, s101, 7
s_add_u32 s101, s101, 16908288
v_lshl_add_u32 v12, v12, 7, s101
buffer_load_dwordx2 v[226:227], v12, s[12:15], 0 offen sc1
v_mfma_f32_16x16x32_bf16 v[120:123], v[156:159], v[136:139], v[120:123]
v_mfma_f32_16x16x32_bf16 v[124:127], v[156:159], v[140:143], v[124:127]
s_waitcnt lgkmcnt(6)
v_mfma_f32_16x16x32_bf16 v[64:67], v[176:179], v[160:163], v[64:67]
buffer_load_dwordx4 v23, s[8:11], s29 offen offset:3072 lds
s_add_u32 s27, s27, 1
v_mfma_f32_16x16x32_bf16 v[68:71], v[176:179], v[164:167], v[68:71]
s_cmp_eq_u32 s27, 10
s_cselect_b32 s27, 0, s27
v_mfma_f32_16x16x32_bf16 v[72:75], v[176:179], v[168:171], v[72:75]
s_lshl_b32 s28, s27, 7
s_mul_i32 s29, s27, 221184
v_mfma_f32_16x16x32_bf16 v[76:79], v[176:179], v[172:175], v[76:79]
s_add_u32 m0, s47, 32768
s_waitcnt vmcnt(17)
s_waitcnt lgkmcnt(0)
s_barrier
v_mfma_f32_16x16x32_bf16 v[80:83], v[180:183], v[160:163], v[80:83]
ds_read_b64_tr_b16 v[144:145], v32 offset:0
buffer_load_dwordx4 v16, s[4:7], s28 offen offset:0 lds
v_mfma_f32_16x16x32_bf16 v[84:87], v[180:183], v[164:167], v[84:87]
ds_read_b64_tr_b16 v[146:147], v32 offset:1024
v_mfma_f32_16x16x32_bf16 v[88:91], v[180:183], v[168:171], v[88:91]
ds_read_b128 v[128:131], v26 offset:0
v_mfma_f32_16x16x32_bf16 v[92:95], v[180:183], v[172:175], v[92:95]
ds_read_b128 v[132:135], v26 offset:2048
v_mfma_f32_16x16x32_bf16 v[96:99], v[184:187], v[160:163], v[96:99]
ds_read_b128 v[136:139], v26 offset:4096
buffer_load_dwordx4 v17, s[4:7], s28 offen offset:1024 lds
v_mfma_f32_16x16x32_bf16 v[100:103], v[184:187], v[164:167], v[100:103]
ds_read_b128 v[140:143], v26 offset:6144
v_mfma_f32_16x16x32_bf16 v[104:107], v[184:187], v[168:171], v[104:107]
ds_read_b64_tr_b16 v[148:149], v33 offset:0
v_mfma_f32_16x16x32_bf16 v[108:111], v[184:187], v[172:175], v[108:111]
ds_read_b64_tr_b16 v[150:151], v33 offset:1024
v_mfma_f32_16x16x32_bf16 v[112:115], v[188:191], v[160:163], v[112:115]
ds_read_b64_tr_b16 v[152:153], v34 offset:0
buffer_load_dwordx4 v18, s[4:7], s28 offen offset:2048 lds
v_mfma_f32_16x16x32_bf16 v[116:119], v[188:191], v[164:167], v[116:119]
ds_read_b64_tr_b16 v[154:155], v34 offset:1024
v_mfma_f32_16x16x32_bf16 v[120:123], v[188:191], v[168:171], v[120:123]
ds_read_b64_tr_b16 v[156:157], v35 offset:0
v_mfma_f32_16x16x32_bf16 v[124:127], v[188:191], v[172:175], v[124:127]
ds_read_b64_tr_b16 v[158:159], v35 offset:1024
s_waitcnt lgkmcnt(6)
v_mfma_f32_16x16x32_bf16 v[64:67], v[144:147], v[128:131], v[64:67]
buffer_load_dwordx4 v19, s[4:7], s28 offen offset:3072 lds
s_add_u32 m0, s48, 32768
v_mfma_f32_16x16x32_bf16 v[68:71], v[144:147], v[132:135], v[68:71]
ds_read_b64_tr_b16 v[176:177], v32 offset:8192
v_mfma_f32_16x16x32_bf16 v[72:75], v[144:147], v[136:139], v[72:75]
ds_read_b64_tr_b16 v[178:179], v32 offset:9216
v_mfma_f32_16x16x32_bf16 v[76:79], v[144:147], v[140:143], v[76:79]
ds_read_b128 v[160:163], v27 offset:0
s_waitcnt lgkmcnt(7)
v_mfma_f32_16x16x32_bf16 v[80:83], v[148:151], v[128:131], v[80:83]
ds_read_b128 v[164:167], v27 offset:2048
buffer_load_dwordx4 v20, s[8:11], s29 offen offset:0 lds
v_mfma_f32_16x16x32_bf16 v[84:87], v[148:151], v[132:135], v[84:87]
ds_read_b128 v[168:171], v27 offset:4096
v_mfma_f32_16x16x32_bf16 v[88:91], v[148:151], v[136:139], v[88:91]
ds_read_b128 v[172:175], v27 offset:6144
v_mfma_f32_16x16x32_bf16 v[92:95], v[148:151], v[140:143], v[92:95]
ds_read_b64_tr_b16 v[180:181], v33 offset:8192
s_waitcnt lgkmcnt(9)
v_mfma_f32_16x16x32_bf16 v[96:99], v[152:155], v[128:131], v[96:99]
ds_read_b64_tr_b16 v[182:183], v33 offset:9216
buffer_load_dwordx4 v21, s[8:11], s29 offen offset:1024 lds
v_mfma_f32_16x16x32_bf16 v[100:103], v[152:155], v[132:135], v[100:103]
ds_read_b64_tr_b16 v[184:185], v34 offset:8192
v_mfma_f32_16x16x32_bf16 v[104:107], v[152:155], v[136:139], v[104:107]
ds_read_b64_tr_b16 v[186:187], v34 offset:9216
v_mfma_f32_16x16x32_bf16 v[108:111], v[152:155], v[140:143], v[108:111]
ds_read_b64_tr_b16 v[188:189], v35 offset:8192
s_waitcnt lgkmcnt(11)
v_mfma_f32_16x16x32_bf16 v[112:115], v[156:159], v[128:131], v[112:115]
ds_read_b64_tr_b16 v[190:191], v35 offset:9216
buffer_load_dwordx4 v22, s[8:11], s29 offen offset:2048 lds
v_mfma_f32_16x16x32_bf16 v[116:119], v[156:159], v[132:135], v[116:119]
v_mfma_f32_16x16x32_bf16 v[120:123], v[156:159], v[136:139], v[120:123]
v_mfma_f32_16x16x32_bf16 v[124:127], v[156:159], v[140:143], v[124:127]
s_waitcnt lgkmcnt(6)
v_mfma_f32_16x16x32_bf16 v[64:67], v[176:179], v[160:163], v[64:67]
buffer_load_dwordx4 v23, s[8:11], s29 offen offset:3072 lds
s_add_u32 s27, s27, 1
v_mfma_f32_16x16x32_bf16 v[68:71], v[176:179], v[164:167], v[68:71]
s_cmp_eq_u32 s27, 10
s_cselect_b32 s27, 0, s27
v_mfma_f32_16x16x32_bf16 v[72:75], v[176:179], v[168:171], v[72:75]
s_lshl_b32 s28, s27, 7
s_mul_i32 s29, s27, 221184
v_mfma_f32_16x16x32_bf16 v[76:79], v[176:179], v[172:175], v[76:79]
s_waitcnt vmcnt(9)
v_cmp_ne_u64 vcc, v[226:227], s[20:21]
s_cbranch_vccnz slow7
back8:
s_waitcnt lgkmcnt(0)
s_barrier
v_mfma_f32_16x16x32_bf16 v[80:83], v[180:183], v[160:163], v[80:83]
ds_read_b64_tr_b16 v[144:145], v32 offset:32768
v_mfma_f32_16x16x32_bf16 v[84:87], v[180:183], v[164:167], v[84:87]
ds_read_b64_tr_b16 v[146:147], v32 offset:33792
v_mfma_f32_16x16x32_bf16 v[88:91], v[180:183], v[168:171], v[88:91]
ds_read_b128 v[128:131], v26 offset:32768
v_mfma_f32_16x16x32_bf16 v[92:95], v[180:183], v[172:175], v[92:95]
ds_read_b128 v[132:135], v26 offset:34816
buffer_load_dwordx4 a[0:3], v56, s[12:15], s72 offen offset:0 sc1
v_mfma_f32_16x16x32_bf16 v[96:99], v[184:187], v[160:163], v[96:99]
ds_read_b128 v[136:139], v26 offset:36864
v_mfma_f32_16x16x32_bf16 v[100:103], v[184:187], v[164:167], v[100:103]
ds_read_b128 v[140:143], v26 offset:38912
v_mfma_f32_16x16x32_bf16 v[104:107], v[184:187], v[168:171], v[104:107]
ds_read_b64_tr_b16 v[148:149], v33 offset:32768
v_mfma_f32_16x16x32_bf16 v[108:111], v[184:187], v[172:175], v[108:111]
ds_read_b64_tr_b16 v[150:151], v33 offset:33792
v_mfma_f32_16x16x32_bf16 v[112:115], v[188:191], v[160:163], v[112:115]
ds_read_b64_tr_b16 v[152:153], v34 offset:32768
buffer_load_dwordx4 a[4:7], v56, s[12:15], s72 offen offset:1024 sc1
v_mfma_f32_16x16x32_bf16 v[116:119], v[188:191], v[164:167], v[116:119]
ds_read_b64_tr_b16 v[154:155], v34 offset:33792
v_mfma_f32_16x16x32_bf16 v[120:123], v[188:191], v[168:171], v[120:123]
ds_read_b64_tr_b16 v[156:157], v35 offset:32768
v_mfma_f32_16x16x32_bf16 v[124:127], v[188:191], v[172:175], v[124:127]
ds_read_b64_tr_b16 v[158:159], v35 offset:33792
s_waitcnt lgkmcnt(6)
v_mfma_f32_16x16x32_bf16 v[64:67], v[144:147], v[128:131], v[64:67]
v_mfma_f32_16x16x32_bf16 v[68:71], v[144:147], v[132:135], v[68:71]
ds_read_b64_tr_b16 v[176:177], v32 offset:40960
v_mfma_f32_16x16x32_bf16 v[72:75], v[144:147], v[136:139], v[72:75]
ds_read_b64_tr_b16 v[178:179], v32 offset:41984
buffer_load_dwordx4 a[8:11], v56, s[12:15], s72 offen offset:2048 sc1
v_mfma_f32_16x16x32_bf16 v[76:79], v[144:147], v[140:143], v[76:79]
ds_read_b128 v[160:163], v27 offset:32768
s_waitcnt lgkmcnt(7)
v_mfma_f32_16x16x32_bf16 v[80:83], v[148:151], v[128:131], v[80:83]
ds_read_b128 v[164:167], v27 offset:34816
v_mfma_f32_16x16x32_bf16 v[84:87], v[148:151], v[132:135], v[84:87]
ds_read_b128 v[168:171], v27 offset:36864
v_mfma_f32_16x16x32_bf16 v[88:91], v[148:151], v[136:139], v[88:91]
ds_read_b128 v[172:175], v27 offset:38912
buffer_load_dwordx4 a[12:15], v56, s[12:15], s72 offen offset:3072 sc1
v_mfma_f32_16x16x32_bf16 v[92:95], v[148:151], v[140:143], v[92:95]
ds_read_b64_tr_b16 v[180:181], v33 offset:40960
s_waitcnt lgkmcnt(9)
v_mfma_f32_16x16x32_bf16 v[96:99], v[152:155], v[128:131], v[96:99]
ds_read_b64_tr_b16 v[182:183], v33 offset:41984
v_mfma_f32_16x16x32_bf16 v[100:103], v[152:155], v[132:135], v[100:103]
ds_read_b64_tr_b16 v[184:185], v34 offset:40960
v_mfma_f32_16x16x32_bf16 v[104:107], v[152:155], v[136:139], v[104:107]
ds_read_b64_tr_b16 v[186:187], v34 offset:41984
buffer_load_dwordx4 a[16:19], v57, s[12:15], s72 offen sc1
v_mfma_f32_16x16x32_bf16 v[108:111], v[152:155], v[140:143], v[108:111]
ds_read_b64_tr_b16 v[188:189], v35 offset:40960
s_waitcnt lgkmcnt(11)
v_mfma_f32_16x16x32_bf16 v[112:115], v[156:159], v[128:131], v[112:115]
ds_read_b64_tr_b16 v[190:191], v35 offset:41984
v_mfma_f32_16x16x32_bf16 v[116:119], v[156:159], v[132:135], v[116:119]
v_mfma_f32_16x16x32_bf16 v[120:123], v[156:159], v[136:139], v[120:123]
buffer_load_dwordx4 a[20:23], v56, s[12:15], s73 offen offset:0 sc1
v_mfma_f32_16x16x32_bf16 v[124:127], v[156:159], v[140:143], v[124:127]
s_waitcnt lgkmcnt(6)
v_mfma_f32_16x16x32_bf16 v[64:67], v[176:179], v[160:163], v[64:67]
v_mfma_f32_16x16x32_bf16 v[68:71], v[176:179], v[164:167], v[68:71]
v_mfma_f32_16x16x32_bf16 v[72:75], v[176:179], v[168:171], v[72:75]
s_lshr_b32 s101, s24, 5
s_lshl_b32 s101, s101, 11
s_add_u32 s101, s101, 16875520
v_lshl_add_u32 v13, v2, 7, s101
buffer_load_dwordx2 v[14:15], v13, s[12:15], 0 offen sc1
v_mfma_f32_16x16x32_bf16 v[76:79], v[176:179], v[172:175], v[76:79]
s_waitcnt vmcnt(15)
s_waitcnt lgkmcnt(0)
s_barrier
v_mfma_f32_16x16x32_bf16 v[80:83], v[180:183], v[160:163], v[80:83]
ds_read_b64_tr_b16 v[144:145], v28 offset:0
v_mfma_f32_16x16x32_bf16 v[84:87], v[180:183], v[164:167], v[84:87]
ds_read_b64_tr_b16 v[146:147], v28 offset:1024
buffer_load_dwordx4 a[24:27], v56, s[12:15], s73 offen offset:1024 sc1
v_mfma_f32_16x16x32_bf16 v[88:91], v[180:183], v[168:171], v[88:91]
ds_read_b128 v[128:131], v24 offset:0
v_mfma_f32_16x16x32_bf16 v[92:95], v[180:183], v[172:175], v[92:95]
ds_read_b128 v[132:135], v24 offset:2048
v_mfma_f32_16x16x32_bf16 v[96:99], v[184:187], v[160:163], v[96:99]
ds_read_b128 v[136:139], v24 offset:4096
buffer_load_dwordx4 a[28:31], v56, s[12:15], s73 offen offset:2048 sc1
v_mfma_f32_16x16x32_bf16 v[100:103], v[184:187], v[164:167], v[100:103]
ds_read_b128 v[140:143], v24 offset:6144
v_mfma_f32_16x16x32_bf16 v[104:107], v[184:187], v[168:171], v[104:107]
ds_read_b64_tr_b16 v[148:149], v29 offset:0
v_mfma_f32_16x16x32_bf16 v[108:111], v[184:187], v[172:175], v[108:111]
ds_read_b64_tr_b16 v[150:151], v29 offset:1024
buffer_load_dwordx4 a[32:35], v56, s[12:15], s73 offen offset:3072 sc1
v_mfma_f32_16x16x32_bf16 v[112:115], v[188:191], v[160:163], v[112:115]
ds_read_b64_tr_b16 v[152:153], v30 offset:0
v_mfma_f32_16x16x32_bf16 v[116:119], v[188:191], v[164:167], v[116:119]
ds_read_b64_tr_b16 v[154:155], v30 offset:1024
v_mfma_f32_16x16x32_bf16 v[120:123], v[188:191], v[168:171], v[120:123]
ds_read_b64_tr_b16 v[156:157], v31 offset:0
buffer_load_dwordx4 a[36:39], v57, s[12:15], s73 offen sc1
v_mfma_f32_16x16x32_bf16 v[124:127], v[188:191], v[172:175], v[124:127]
ds_read_b64_tr_b16 v[158:159], v31 offset:1024
s_waitcnt lgkmcnt(6)
v_mfma_f32_16x16x32_bf16 v[64:67], v[144:147], v[128:131], v[64:67]
v_mfma_f32_16x16x32_bf16 v[68:71], v[144:147], v[132:135], v[68:71]
ds_read_b64_tr_b16 v[176:177], v28 offset:8192
v_mfma_f32_16x16x32_bf16 v[72:75], v[144:147], v[136:139], v[72:75]
ds_read_b64_tr_b16 v[178:179], v28 offset:9216
buffer_load_dwordx4 a[40:43], v56, s[12:15], s74 offen offset:0 sc1
v_mfma_f32_16x16x32_bf16 v[76:79], v[144:147], v[140:143], v[76:79]
ds_read_b128 v[160:163], v25 offset:0
s_waitcnt lgkmcnt(7)
v_mfma_f32_16x16x32_bf16 v[80:83], v[148:151], v[128:131], v[80:83]
ds_read_b128 v[164:167], v25 offset:2048
v_mfma_f32_16x16x32_bf16 v[84:87], v[148:151], v[132:135], v[84:87]
ds_read_b128 v[168:171], v25 offset:4096
v_mfma_f32_16x16x32_bf16 v[88:91], v[148:151], v[136:139], v[88:91]
ds_read_b128 v[172:175], v25 offset:6144
buffer_load_dwordx4 a[44:47], v56, s[12:15], s74 offen offset:1024 sc1
v_mfma_f32_16x16x32_bf16 v[92:95], v[148:151], v[140:143], v[92:95]
ds_read_b64_tr_b16 v[180:181], v29 offset:8192
s_waitcnt lgkmcnt(9)
v_mfma_f32_16x16x32_bf16 v[96:99], v[152:155], v[128:131], v[96:99]
ds_read_b64_tr_b16 v[182:183], v29 offset:9216
v_mfma_f32_16x16x32_bf16 v[100:103], v[152:155], v[132:135], v[100:103]
ds_read_b64_tr_b16 v[184:185], v30 offset:8192
v_mfma_f32_16x16x32_bf16 v[104:107], v[152:155], v[136:139], v[104:107]
ds_read_b64_tr_b16 v[186:187], v30 offset:9216
buffer_load_dwordx4 a[48:51], v56, s[12:15], s74 offen offset:2048 sc1
v_mfma_f32_16x16x32_bf16 v[108:111], v[152:155], v[140:143], v[108:111]
ds_read_b64_tr_b16 v[188:189], v31 offset:8192
s_waitcnt lgkmcnt(11)
v_mfma_f32_16x16x32_bf16 v[112:115], v[156:159], v[128:131], v[112:115]
ds_read_b64_tr_b16 v[190:191], v31 offset:9216
v_mfma_f32_16x16x32_bf16 v[116:119], v[156:159], v[132:135], v[116:119]
v_mfma_f32_16x16x32_bf16 v[120:123], v[156:159], v[136:139], v[120:123]
buffer_load_dwordx4 a[52:55], v56, s[12:15], s74 offen offset:3072 sc1
v_mfma_f32_16x16x32_bf16 v[124:127], v[156:159], v[140:143], v[124:127]
s_waitcnt lgkmcnt(6)
v_mfma_f32_16x16x32_bf16 v[64:67], v[176:179], v[160:163], v[64:67]
v_mfma_f32_16x16x32_bf16 v[68:71], v[176:179], v[164:167], v[68:71]
v_mfma_f32_16x16x32_bf16 v[72:75], v[176:179], v[168:171], v[72:75]
buffer_load_dwordx4 a[56:59], v57, s[12:15], s74 offen sc1
v_mfma_f32_16x16x32_bf16 v[76:79], v[176:179], v[172:175], v[76:79]
s_waitcnt vmcnt(16)
s_waitcnt lgkmcnt(0)
s_barrier
v_mfma_f32_16x16x32_bf16 v[80:83], v[180:183], v[160:163], v[80:83]
ds_read_b64_tr_b16 v[144:145], v28 offset:32768
v_mfma_f32_16x16x32_bf16 v[84:87], v[180:183], v[164:167], v[84:87]
ds_read_b64_tr_b16 v[146:147], v28 offset:33792
v_mfma_f32_16x16x32_bf16 v[88:91], v[180:183], v[168:171], v[88:91]
ds_read_b128 v[128:131], v24 offset:32768
buffer_load_dwordx4 a[60:63], v56, s[12:15], s75 offen offset:0 sc1
v_mfma_f32_16x16x32_bf16 v[92:95], v[180:183], v[172:175], v[92:95]
ds_read_b128 v[132:135], v24 offset:34816
v_mfma_f32_16x16x32_bf16 v[96:99], v[184:187], v[160:163], v[96:99]
ds_read_b128 v[136:139], v24 offset:36864
v_mfma_f32_16x16x32_bf16 v[100:103], v[184:187], v[164:167], v[100:103]
ds_read_b128 v[140:143], v24 offset:38912
v_mfma_f32_16x16x32_bf16 v[104:107], v[184:187], v[168:171], v[104:107]
ds_read_b64_tr_b16 v[148:149], v29 offset:32768
buffer_load_dwordx4 a[64:67], v56, s[12:15], s75 offen offset:1024 sc1
v_mfma_f32_16x16x32_bf16 v[108:111], v[184:187], v[172:175], v[108:111]
ds_read_b64_tr_b16 v[150:151], v29 offset:33792
v_mfma_f32_16x16x32_bf16 v[112:115], v[188:191], v[160:163], v[112:115]
ds_read_b64_tr_b16 v[152:153], v30 offset:32768
v_mfma_f32_16x16x32_bf16 v[116:119], v[188:191], v[164:167], v[116:119]
ds_read_b64_tr_b16 v[154:155], v30 offset:33792
v_mfma_f32_16x16x32_bf16 v[120:123], v[188:191], v[168:171], v[120:123]
ds_read_b64_tr_b16 v[156:157], v31 offset:32768
buffer_load_dwordx4 a[68:71], v56, s[12:15], s75 offen offset:2048 sc1
v_mfma_f32_16x16x32_bf16 v[124:127], v[188:191], v[172:175], v[124:127]
ds_read_b64_tr_b16 v[158:159], v31 offset:33792
s_waitcnt lgkmcnt(6)
v_mfma_f32_16x16x32_bf16 v[64:67], v[144:147], v[128:131], v[64:67]
v_mfma_f32_16x16x32_bf16 v[68:71], v[144:147], v[132:135], v[68:71]
ds_read_b64_tr_b16 v[176:177], v28 offset:40960
v_mfma_f32_16x16x32_bf16 v[72:75], v[144:147], v[136:139], v[72:75]
ds_read_b64_tr_b16 v[178:179], v28 offset:41984
buffer_load_dwordx4 a[72:75], v56, s[12:15], s75 offen offset:3072 sc1
v_mfma_f32_16x16x32_bf16 v[76:79], v[144:147], v[140:143], v[76:79]
ds_read_b128 v[160:163], v25 offset:32768
s_waitcnt lgkmcnt(7)
v_mfma_f32_16x16x32_bf16 v[80:83], v[148:151], v[128:131], v[80:83]
ds_read_b128 v[164:167], v25 offset:34816
v_mfma_f32_16x16x32_bf16 v[84:87], v[148:151], v[132:135], v[84:87]
ds_read_b128 v[168:171], v25 offset:36864
v_mfma_f32_16x16x32_bf16 v[88:91], v[148:151], v[136:139], v[88:91]
ds_read_b128 v[172:175], v25 offset:38912
buffer_load_dwordx4 a[76:79], v57, s[12:15], s75 offen sc1
v_mfma_f32_16x16x32_bf16 v[92:95], v[148:151], v[140:143], v[92:95]
ds_read_b64_tr_b16 v[180:181], v29 offset:40960
s_waitcnt lgkmcnt(9)
v_mfma_f32_16x16x32_bf16 v[96:99], v[152:155], v[128:131], v[96:99]
ds_read_b64_tr_b16 v[182:183], v29 offset:41984
v_mfma_f32_16x16x32_bf16 v[100:103], v[152:155], v[132:135], v[100:103]
ds_read_b64_tr_b16 v[184:185], v30 offset:40960
v_mfma_f32_16x16x32_bf16 v[104:107], v[152:155], v[136:139], v[104:107]
ds_read_b64_tr_b16 v[186:187], v30 offset:41984
buffer_load_dwordx4 a[80:83], v56, s[12:15], s76 offen offset:0 sc1
v_mfma_f32_16x16x32_bf16 v[108:111], v[152:155], v[140:143], v[108:111]
ds_read_b64_tr_b16 v[188:189], v31 offset:40960
s_waitcnt lgkmcnt(11)
v_mfma_f32_16x16x32_bf16 v[112:115], v[156:159], v[128:131], v[112:115]
ds_read_b64_tr_b16 v[190:191], v31 offset:41984
v_mfma_f32_16x16x32_bf16 v[116:119], v[156:159], v[132:135], v[116:119]
v_mfma_f32_16x16x32_bf16 v[120:123], v[156:159], v[136:139], v[120:123]
buffer_load_dwordx4 a[84:87], v56, s[12:15], s76 offen offset:1024 sc1
v_mfma_f32_16x16x32_bf16 v[124:127], v[156:159], v[140:143], v[124:127]
s_waitcnt lgkmcnt(6)
v_mfma_f32_16x16x32_bf16 v[64:67], v[176:179], v[160:163], v[64:67]
v_mfma_f32_16x16x32_bf16 v[68:71], v[176:179], v[164:167], v[68:71]
v_mfma_f32_16x16x32_bf16 v[72:75], v[176:179], v[168:171], v[72:75]
s_waitcnt vmcnt(16)
v_cmp_ne_u64 vcc, v[14:15], s[20:21]
s_cbranch_vccnz slow9
back10:
s_lshr_b32 s51, s24, 1
s_lshl_b32 s51, s51, 14
s_add_u32 s51, s51, 10485760
s_and_b32 s101, s24, 1
s_lshl_b32 s101, s101, 5
s_add_u32 s51, s51, s101
v_lshrrev_b32 v13, 1, v0
v_and_b32 v14, 1, v0
v_lshlrev_b32 v13, 6, v13
v_lshl_add_u32 v13, v14, 4, v13
s_add_u32 s52, s51, 8192
buffer_load_dwordx4 v[36:39], v13, s[12:15], s51 offen sc1
v_mfma_f32_16x16x32_bf16 v[76:79], v[176:179], v[172:175], v[76:79]
s_waitcnt lgkmcnt(0)
s_barrier
v_mfma_f32_16x16x32_bf16 v[80:83], v[180:183], v[160:163], v[80:83]
buffer_load_dwordx4 v[40:43], v13, s[12:15], s52 offen sc1
v_mfma_f32_16x16x32_bf16 v[84:87], v[180:183], v[164:167], v[84:87]
v_mfma_f32_16x16x32_bf16 v[88:91], v[180:183], v[168:171], v[88:91]
v_mfma_f32_16x16x32_bf16 v[92:95], v[180:183], v[172:175], v[92:95]
buffer_load_dwordx4 a[88:91], v56, s[12:15], s76 offen offset:2048 sc1
v_mfma_f32_16x16x32_bf16 v[96:99], v[184:187], v[160:163], v[96:99]
v_mfma_f32_16x16x32_bf16 v[100:103], v[184:187], v[164:167], v[100:103]
v_mfma_f32_16x16x32_bf16 v[104:107], v[184:187], v[168:171], v[104:107]
buffer_load_dwordx4 a[92:95], v56, s[12:15], s76 offen offset:3072 sc1
v_mfma_f32_16x16x32_bf16 v[108:111], v[184:187], v[172:175], v[108:111]
v_mfma_f32_16x16x32_bf16 v[112:115], v[188:191], v[160:163], v[112:115]
buffer_load_dwordx4 a[96:99], v57, s[12:15], s76 offen sc1
v_mfma_f32_16x16x32_bf16 v[116:119], v[188:191], v[164:167], v[116:119]
v_mfma_f32_16x16x32_bf16 v[120:123], v[188:191], v[168:171], v[120:123]
v_mfma_f32_16x16x32_bf16 v[124:127], v[188:191], v[172:175], v[124:127]
buffer_load_dwordx4 a[100:103], v56, s[12:15], s77 offen offset:0 sc1
s_nop 7
s_lshl_b32 s50, s22, 1
s_lshr_b32 s101, s3, 1
s_add_u32 s50, s50, s101
s_mul_i32 s50, s50, 221184
s_and_b32 s101, s3, 1
s_lshl_b32 s101, s101, 13
s_add_u32 s50, s50, s101
s_lshl_b32 s101, s23, 14
s_add_u32 s50, s50, s101
s_mov_b32 s32, 0xbdd2d3e8
s_mov_b32 s33, 0xbdd2d3e8
v_mov_b32 v128, 0xc0135761
v_mov_b32 v129, 0xc0135761
s_mov_b32 s34, 1.0
s_mov_b32 s35, 1.0
v_pk_mul_f32 v[132:133], v[64:65], v[64:65]
v_pk_mul_f32 v[134:135], v[66:67], v[66:67]
v_pk_mul_f32 v[136:137], v[80:81], v[80:81]
v_pk_mul_f32 v[138:139], v[82:83], v[82:83]
v_pk_fma_f32 v[132:133], v[132:133], s[32:33], v[128:129]
v_pk_fma_f32 v[134:135], v[134:135], s[32:33], v[128:129]
v_pk_fma_f32 v[136:137], v[136:137], s[32:33], v[128:129]
v_pk_fma_f32 v[138:139], v[138:139], s[32:33], v[128:129]
v_pk_mul_f32 v[132:133], v[132:133], v[64:65]
v_pk_mul_f32 v[134:135], v[134:135], v[66:67]
buffer_load_dwordx4 a[104:107], v56, s[12:15], s77 offen offset:1024 sc1
v_pk_mul_f32 v[136:137], v[136:137], v[80:81]
v_pk_mul_f32 v[138:139], v[138:139], v[82:83]
v_exp_f32_e64 v132, v132
v_exp_f32_e64 v133, v133
v_exp_f32_e64 v134, v134
v_exp_f32_e64 v135, v135
v_exp_f32_e64 v136, v136
v_exp_f32_e64 v137, v137
v_exp_f32_e64 v138, v138
v_exp_f32_e64 v139, v139
v_pk_add_f32 v[132:133], v[132:133], s[34:35]
v_pk_add_f32 v[134:135], v[134:135], s[34:35]
v_pk_add_f32 v[136:137], v[136:137], s[34:35]
v_pk_add_f32 v[138:139], v[138:139], s[34:35]
v_rcp_f32_e64 v132, v132
v_rcp_f32_e64 v133, v133
v_rcp_f32_e64 v134, v134
buffer_load_dwordx4 a[108:111], v56, s[12:15], s77 offen offset:2048 sc1
v_rcp_f32_e64 v135, v135
v_rcp_f32_e64 v136, v136
v_rcp_f32_e64 v137, v137
v_rcp_f32_e64 v138, v138
v_rcp_f32_e64 v139, v139
v_pk_mul_f32 v[132:133], v[132:133], v[64:65]
v_pk_mul_f32 v[134:135], v[134:135], v[66:67]
v_pk_mul_f32 v[136:137], v[136:137], v[80:81]
v_pk_mul_f32 v[138:139], v[138:139], v[82:83]
v_cvt_pk_bf16_f32 v148, v132, v133
v_cvt_pk_bf16_f32 v149, v134, v135
v_cvt_pk_bf16_f32 v150, v136, v137
v_cvt_pk_bf16_f32 v151, v138, v139
buffer_store_dwordx4 v[148:151], v56, s[12:15], s50 offen offset:0 sc1
v_pk_mul_f32 v[140:141], v[68:69], v[68:69]
v_pk_mul_f32 v[142:143], v[70:71], v[70:71]
v_pk_mul_f32 v[144:145], v[84:85], v[84:85]
v_pk_mul_f32 v[146:147], v[86:87], v[86:87]
v_pk_fma_f32 v[140:141], v[140:141], s[32:33], v[128:129]
v_pk_fma_f32 v[142:143], v[142:143], s[32:33], v[128:129]
v_pk_fma_f32 v[144:145], v[144:145], s[32:33], v[128:129]
buffer_load_dwordx4 a[112:115], v56, s[12:15], s77 offen offset:3072 sc1
v_pk_fma_f32 v[146:147], v[146:147], s[32:33], v[128:129]
v_pk_mul_f32 v[140:141], v[140:141], v[68:69]
v_pk_mul_f32 v[142:143], v[142:143], v[70:71]
v_pk_mul_f32 v[144:145], v[144:145], v[84:85]
v_pk_mul_f32 v[146:147], v[146:147], v[86:87]
v_exp_f32_e64 v140, v140
v_exp_f32_e64 v141, v141
v_exp_f32_e64 v142, v142
v_exp_f32_e64 v143, v143
v_exp_f32_e64 v144, v144
v_exp_f32_e64 v145, v145
v_exp_f32_e64 v146, v146
v_exp_f32_e64 v147, v147
v_pk_add_f32 v[140:141], v[140:141], s[34:35]
v_pk_add_f32 v[142:143], v[142:143], s[34:35]
v_pk_add_f32 v[144:145], v[144:145], s[34:35]
v_pk_add_f32 v[146:147], v[146:147], s[34:35]
v_rcp_f32_e64 v140, v140
buffer_load_dwordx4 a[116:119], v57, s[12:15], s77 offen sc1
v_rcp_f32_e64 v141, v141
v_rcp_f32_e64 v142, v142
v_rcp_f32_e64 v143, v143
v_rcp_f32_e64 v144, v144
v_rcp_f32_e64 v145, v145
v_rcp_f32_e64 v146, v146
v_rcp_f32_e64 v147, v147
v_pk_mul_f32 v[140:141], v[140:141], v[68:69]
v_pk_mul_f32 v[142:143], v[142:143], v[70:71]
v_pk_mul_f32 v[144:145], v[144:145], v[84:85]
v_pk_mul_f32 v[146:147], v[146:147], v[86:87]
v_cvt_pk_bf16_f32 v152, v140, v141
v_cvt_pk_bf16_f32 v153, v142, v143
v_cvt_pk_bf16_f32 v154, v144, v145
v_cvt_pk_bf16_f32 v155, v146, v147
buffer_store_dwordx4 v[152:155], v56, s[12:15], s50 offen offset:1024 sc1
v_pk_mul_f32 v[132:133], v[72:73], v[72:73]
v_pk_mul_f32 v[134:135], v[74:75], v[74:75]
v_pk_mul_f32 v[136:137], v[88:89], v[88:89]
v_pk_mul_f32 v[138:139], v[90:91], v[90:91]
buffer_load_dwordx4 a[120:123], v56, s[12:15], s78 offen offset:0 sc1
v_pk_fma_f32 v[132:133], v[132:133], s[32:33], v[128:129]
v_pk_fma_f32 v[134:135], v[134:135], s[32:33], v[128:129]
v_pk_fma_f32 v[136:137], v[136:137], s[32:33], v[128:129]
v_pk_fma_f32 v[138:139], v[138:139], s[32:33], v[128:129]
v_pk_mul_f32 v[132:133], v[132:133], v[72:73]
v_pk_mul_f32 v[134:135], v[134:135], v[74:75]
v_pk_mul_f32 v[136:137], v[136:137], v[88:89]
v_pk_mul_f32 v[138:139], v[138:139], v[90:91]
v_exp_f32_e64 v132, v132
v_exp_f32_e64 v133, v133
v_exp_f32_e64 v134, v134
v_exp_f32_e64 v135, v135
v_exp_f32_e64 v136, v136
v_exp_f32_e64 v137, v137
v_exp_f32_e64 v138, v138
v_exp_f32_e64 v139, v139
v_pk_add_f32 v[132:133], v[132:133], s[34:35]
v_pk_add_f32 v[134:135], v[134:135], s[34:35]
v_pk_add_f32 v[136:137], v[136:137], s[34:35]
buffer_load_dwordx4 a[124:127], v56, s[12:15], s78 offen offset:1024 sc1
v_pk_add_f32 v[138:139], v[138:139], s[34:35]
v_rcp_f32_e64 v132, v132
v_rcp_f32_e64 v133, v133
v_rcp_f32_e64 v134, v134
v_rcp_f32_e64 v135, v135
v_rcp_f32_e64 v136, v136
v_rcp_f32_e64 v137, v137
v_rcp_f32_e64 v138, v138
v_rcp_f32_e64 v139, v139
v_pk_mul_f32 v[132:133], v[132:133], v[72:73]
v_pk_mul_f32 v[134:135], v[134:135], v[74:75]
v_pk_mul_f32 v[136:137], v[136:137], v[88:89]
v_pk_mul_f32 v[138:139], v[138:139], v[90:91]
v_cvt_pk_bf16_f32 v156, v132, v133
v_cvt_pk_bf16_f32 v157, v134, v135
v_cvt_pk_bf16_f32 v158, v136, v137
v_cvt_pk_bf16_f32 v159, v138, v139
buffer_store_dwordx4 v[156:159], v56, s[12:15], s50 offen offset:2048 sc1
v_pk_mul_f32 v[140:141], v[76:77], v[76:77]
buffer_load_dwordx4 a[128:131], v56, s[12:15], s78 offen offset:2048 sc1
v_pk_mul_f32 v[142:143], v[78:79], v[78:79]
v_pk_mul_f32 v[144:145], v[92:93], v[92:93]
v_pk_mul_f32 v[146:147], v[94:95], v[94:95]
v_pk_fma_f32 v[140:141], v[140:141], s[32:33], v[128:129]
v_pk_fma_f32 v[142:143], v[142:143], s[32:33], v[128:129]
v_pk_fma_f32 v[144:145], v[144:145], s[32:33], v[128:129]
v_pk_fma_f32 v[146:147], v[146:147], s[32:33], v[128:129]
v_pk_mul_f32 v[140:141], v[140:141], v[76:77]
v_pk_mul_f32 v[142:143], v[142:143], v[78:79]
v_pk_mul_f32 v[144:145], v[144:145], v[92:93]
v_pk_mul_f32 v[146:147], v[146:147], v[94:95]
v_exp_f32_e64 v140, v140
v_exp_f32_e64 v141, v141
v_exp_f32_e64 v142, v142
v_exp_f32_e64 v143, v143
v_exp_f32_e64 v144, v144
v_exp_f32_e64 v145, v145
v_exp_f32_e64 v146, v146
v_exp_f32_e64 v147, v147
buffer_load_dwordx4 a[132:135], v56, s[12:15], s78 offen offset:3072 sc1
v_pk_add_f32 v[140:141], v[140:141], s[34:35]
v_pk_add_f32 v[142:143], v[142:143], s[34:35]
v_pk_add_f32 v[144:145], v[144:145], s[34:35]
v_pk_add_f32 v[146:147], v[146:147], s[34:35]
v_rcp_f32_e64 v140, v140
v_rcp_f32_e64 v141, v141
v_rcp_f32_e64 v142, v142
v_rcp_f32_e64 v143, v143
v_rcp_f32_e64 v144, v144
v_rcp_f32_e64 v145, v145
v_rcp_f32_e64 v146, v146
v_rcp_f32_e64 v147, v147
v_pk_mul_f32 v[140:141], v[140:141], v[76:77]
v_pk_mul_f32 v[142:143], v[142:143], v[78:79]
v_pk_mul_f32 v[144:145], v[144:145], v[92:93]
v_pk_mul_f32 v[146:147], v[146:147], v[94:95]
v_cvt_pk_bf16_f32 v148, v140, v141
v_cvt_pk_bf16_f32 v149, v142, v143
buffer_load_dwordx4 a[136:139], v57, s[12:15], s78 offen sc1
v_cvt_pk_bf16_f32 v150, v144, v145
v_cvt_pk_bf16_f32 v151, v146, v147
buffer_store_dwordx4 v[148:151], v56, s[12:15], s50 offen offset:3072 sc1
v_bfe_u32 v13, v0, 5, 2
v_pk_mul_f32 v[132:133], v[96:97], v[96:97]
v_and_b32 v14, 31, v0
v_pk_mul_f32 v[134:135], v[98:99], v[98:99]
v_mul_u32_u24 v13, 4672, v13
v_pk_mul_f32 v[136:137], v[112:113], v[112:113]
v_mov_b32 v16, 0
v_pk_mul_f32 v[138:139], v[114:115], v[114:115]
v_mov_b32 v17, 0
v_pk_fma_f32 v[132:133], v[132:133], s[32:33], v[128:129]
v_mov_b32 v18, 0
v_pk_fma_f32 v[134:135], v[134:135], s[32:33], v[128:129]
v_mov_b32 v19, 0
v_pk_fma_f32 v[136:137], v[136:137], s[32:33], v[128:129]
v_lshl_add_u32 v13, v14, 4, v13
v_pk_fma_f32 v[138:139], v[138:139], s[32:33], v[128:129]
v_and_b32 v14, 1, v0
v_pk_mul_f32 v[132:133], v[132:133], v[96:97]
v_mul_u32_u24 v14, 4672, v14
v_pk_mul_f32 v[134:135], v[134:135], v[98:99]
ds_write_b128 v13, v[16:19] offset:32768
v_pk_mul_f32 v[136:137], v[136:137], v[112:113]
v_lshrrev_b32 v13, 1, v0
v_pk_mul_f32 v[138:139], v[138:139], v[114:115]
buffer_load_dwordx4 a[140:143], v56, s[12:15], s79 offen offset:0 sc1
v_lshl_add_u32 v13, v13, 4, v14
v_exp_f32_e64 v132, v132
s_waitcnt vmcnt(18)
v_exp_f32_e64 v133, v133
ds_write_b128 v13, v[36:39] offset:33280
ds_write_b128 v13, v[40:43] offset:35328
v_exp_f32_e64 v134, v134
s_lshr_b32 s44, s3, 1
s_mul_i32 s42, s44, 8320
v_exp_f32_e64 v135, v135
s_add_u32 s44, s44, 0
s_mul_i32 s43, s44, 4672
v_exp_f32_e64 v136, v136
s_and_b32 s44, s3, 1
s_lshl_b32 s44, s44, 6
v_exp_f32_e64 v137, v137
s_sub_u32 s42, s42, s44
s_sub_u32 s43, s43, s44
v_exp_f32_e64 v138, v138
s_add_u32 s42, s42, 16350
s_add_u32 s43, s43, 32864
buffer_load_dwordx4 a[144:147], v56, s[12:15], s79 offen offset:1024 sc1
v_exp_f32_e64 v139, v139
v_and_b32 v35, 1, v2
v_xor_b32 v35, 1, v35
v_pk_add_f32 v[132:133], v[132:133], s[34:35]
v_mul_u32_u24 v35, 4158, v35
v_pk_add_f32 v[134:135], v[134:135], s[34:35]
v_lshl_add_u32 v35, v3, 4, v35
v_pk_add_f32 v[136:137], v[136:137], s[34:35]
v_lshlrev_b32 v32, 1, v2
v_pk_add_f32 v[138:139], v[138:139], s[34:35]
v_sub_u32 v35, v35, v32
v_rcp_f32_e64 v132, v132
v_add_u32 v32, s42, v35
v_lshl_add_u32 v35, v2, 5, s43
v_rcp_f32_e64 v133, v133
v_lshl_add_u32 v33, v3, 4, v35
s_lshr_b32 s44, s3, 1
v_rcp_f32_e64 v134, v134
s_mul_i32 s42, s44, 16448
s_and_b32 s44, s3, 1
v_rcp_f32_e64 v135, v135
s_lshl_b32 s44, s44, 13
buffer_load_dwordx4 a[148:151], v56, s[12:15], s79 offen offset:2048 sc1
s_add_u32 s42, s42, s44
v_rcp_f32_e64 v136, v136
s_add_u32 s42, s42, 53248
v_lshrrev_b32 v35, 1, v3
v_rcp_f32_e64 v137, v137
v_lshl_add_u32 v35, v35, 3, v2
v_and_b32 v35, 15, v35
v_rcp_f32_e64 v138, v138
v_lshl_add_u32 v34, v3, 8, s42
v_lshl_add_u32 v34, v35, 4, v34
v_rcp_f32_e64 v139, v139
v_add_u32 v28, -512, v32
v_add_u32 v29, -1536, v32
v_pk_mul_f32 v[132:133], v[132:133], v[96:97]
v_add_u32 v30, -2560, v32
v_pk_mul_f32 v[134:135], v[134:135], v[98:99]
v_add_u32 v31, -3584, v32
v_pk_mul_f32 v[136:137], v[136:137], v[112:113]
ds_read2_b32 v[160:161], v28 offset0:128 offset1:129
v_pk_mul_f32 v[138:139], v[138:139], v[114:115]
ds_read2_b32 v[162:163], v28 offset0:130 offset1:131
v_cvt_pk_bf16_f32 v152, v132, v133
ds_read2_b32 v[164:165], v28 offset0:0 offset1:1
buffer_load_dwordx4 a[152:155], v56, s[12:15], s79 offen offset:3072 sc1
v_cvt_pk_bf16_f32 v153, v134, v135
ds_read2_b32 v[166:167], v28 offset0:2 offset1:3
v_cvt_pk_bf16_f32 v154, v136, v137
ds_read2_b32 v[168:169], v29 offset0:128 offset1:129
v_cvt_pk_bf16_f32 v155, v138, v139
ds_read2_b32 v[170:171], v29 offset0:130 offset1:131
buffer_store_dwordx4 v[152:155], v57, s[12:15], s50 offen offset:0 sc1
ds_read2_b32 v[172:173], v29 offset0:0 offset1:1
v_pk_mul_f32 v[140:141], v[100:101], v[100:101]
ds_read2_b32 v[174:175], v29 offset0:2 offset1:3
v_pk_mul_f32 v[142:143], v[102:103], v[102:103]
ds_read2_b32 v[176:177], v30 offset0:128 offset1:129
v_pk_mul_f32 v[144:145], v[116:117], v[116:117]
ds_read2_b32 v[178:179], v30 offset0:130 offset1:131
v_pk_mul_f32 v[146:147], v[118:119], v[118:119]
ds_read2_b32 v[180:181], v30 offset0:0 offset1:1
v_pk_fma_f32 v[140:141], v[140:141], s[32:33], v[128:129]
ds_read2_b32 v[182:183], v30 offset0:2 offset1:3
v_pk_fma_f32 v[142:143], v[142:143], s[32:33], v[128:129]
ds_read2_b32 v[184:185], v31 offset0:128 offset1:129
v_pk_fma_f32 v[144:145], v[144:145], s[32:33], v[128:129]
ds_read2_b32 v[186:187], v31 offset0:130 offset1:131
v_pk_fma_f32 v[146:147], v[146:147], s[32:33], v[128:129]
ds_read2_b32 v[188:189], v31 offset0:0 offset1:1
v_pk_mul_f32 v[140:141], v[140:141], v[100:101]
ds_read2_b32 v[190:191], v31 offset0:2 offset1:3
v_pk_mul_f32 v[142:143], v[142:143], v[102:103]
buffer_load_dwordx4 a[156:159], v57, s[12:15], s79 offen sc1
v_pk_mul_f32 v[144:145], v[144:145], v[116:117]
v_pk_mul_f32 v[146:147], v[146:147], v[118:119]
v_exp_f32_e64 v140, v140
v_exp_f32_e64 v141, v141
v_exp_f32_e64 v142, v142
v_exp_f32_e64 v143, v143
v_exp_f32_e64 v144, v144
v_exp_f32_e64 v145, v145
v_exp_f32_e64 v146, v146
v_exp_f32_e64 v147, v147
v_pk_add_f32 v[140:141], v[140:141], s[34:35]
v_pk_add_f32 v[142:143], v[142:143], s[34:35]
v_pk_add_f32 v[144:145], v[144:145], s[34:35]
v_pk_add_f32 v[146:147], v[146:147], s[34:35]
v_rcp_f32_e64 v140, v140
v_rcp_f32_e64 v141, v141
v_rcp_f32_e64 v142, v142
buffer_load_dwordx4 a[160:163], v56, s[12:15], s80 offen offset:0 sc1
v_rcp_f32_e64 v143, v143
v_rcp_f32_e64 v144, v144
v_rcp_f32_e64 v145, v145
v_rcp_f32_e64 v146, v146
v_rcp_f32_e64 v147, v147
v_pk_mul_f32 v[140:141], v[140:141], v[100:101]
v_pk_mul_f32 v[142:143], v[142:143], v[102:103]
v_pk_mul_f32 v[144:145], v[144:145], v[116:117]
v_pk_mul_f32 v[146:147], v[146:147], v[118:119]
v_cvt_pk_bf16_f32 v156, v140, v141
v_cvt_pk_bf16_f32 v157, v142, v143
v_cvt_pk_bf16_f32 v158, v144, v145
v_cvt_pk_bf16_f32 v159, v146, v147
buffer_store_dwordx4 v[156:159], v57, s[12:15], s50 offen offset:1024 sc1
v_pk_mul_f32 v[132:133], v[104:105], v[104:105]
v_pk_mul_f32 v[134:135], v[106:107], v[106:107]
v_pk_mul_f32 v[136:137], v[120:121], v[120:121]
v_pk_mul_f32 v[138:139], v[122:123], v[122:123]
v_pk_fma_f32 v[132:133], v[132:133], s[32:33], v[128:129]
v_pk_fma_f32 v[134:135], v[134:135], s[32:33], v[128:129]
v_pk_fma_f32 v[136:137], v[136:137], s[32:33], v[128:129]
buffer_load_dwordx4 a[164:167], v56, s[12:15], s80 offen offset:1024 sc1
v_pk_fma_f32 v[138:139], v[138:139], s[32:33], v[128:129]
v_pk_mul_f32 v[132:133], v[132:133], v[104:105]
v_pk_mul_f32 v[134:135], v[134:135], v[106:107]
v_pk_mul_f32 v[136:137], v[136:137], v[120:121]
v_pk_mul_f32 v[138:139], v[138:139], v[122:123]
v_exp_f32_e64 v132, v132
v_exp_f32_e64 v133, v133
v_exp_f32_e64 v134, v134
v_exp_f32_e64 v135, v135
v_exp_f32_e64 v136, v136
v_exp_f32_e64 v137, v137
v_exp_f32_e64 v138, v138
v_exp_f32_e64 v139, v139
v_pk_add_f32 v[132:133], v[132:133], s[34:35]
v_pk_add_f32 v[134:135], v[134:135], s[34:35]
v_pk_add_f32 v[136:137], v[136:137], s[34:35]
v_pk_add_f32 v[138:139], v[138:139], s[34:35]
v_rcp_f32_e64 v132, v132
v_rcp_f32_e64 v133, v133
v_rcp_f32_e64 v134, v134
v_rcp_f32_e64 v135, v135
v_rcp_f32_e64 v136, v136
v_rcp_f32_e64 v137, v137
v_rcp_f32_e64 v138, v138
v_rcp_f32_e64 v139, v139
v_pk_mul_f32 v[132:133], v[132:133], v[104:105]
v_pk_mul_f32 v[134:135], v[134:135], v[106:107]
v_pk_mul_f32 v[136:137], v[136:137], v[120:121]
v_pk_mul_f32 v[138:139], v[138:139], v[122:123]
v_cvt_pk_bf16_f32 v148, v132, v133
v_cvt_pk_bf16_f32 v149, v134, v135
v_cvt_pk_bf16_f32 v150, v136, v137
v_cvt_pk_bf16_f32 v151, v138, v139
buffer_store_dwordx4 v[148:151], v57, s[12:15], s50 offen offset:2048 sc1
v_pk_mul_f32 v[140:141], v[108:109], v[108:109]
v_pk_mul_f32 v[142:143], v[110:111], v[110:111]
v_pk_mul_f32 v[144:145], v[124:125], v[124:125]
v_pk_mul_f32 v[146:147], v[126:127], v[126:127]
v_pk_fma_f32 v[140:141], v[140:141], s[32:33], v[128:129]
v_pk_fma_f32 v[142:143], v[142:143], s[32:33], v[128:129]
v_pk_fma_f32 v[144:145], v[144:145], s[32:33], v[128:129]
v_pk_fma_f32 v[146:147], v[146:147], s[32:33], v[128:129]
v_pk_mul_f32 v[140:141], v[140:141], v[108:109]
v_pk_mul_f32 v[142:143], v[142:143], v[110:111]
v_pk_mul_f32 v[144:145], v[144:145], v[124:125]
v_pk_mul_f32 v[146:147], v[146:147], v[126:127]
v_exp_f32_e64 v140, v140
v_exp_f32_e64 v141, v141
v_exp_f32_e64 v142, v142
v_exp_f32_e64 v143, v143
v_exp_f32_e64 v144, v144
v_exp_f32_e64 v145, v145
v_exp_f32_e64 v146, v146
v_exp_f32_e64 v147, v147
v_pk_add_f32 v[140:141], v[140:141], s[34:35]
v_pk_add_f32 v[142:143], v[142:143], s[34:35]
v_pk_add_f32 v[144:145], v[144:145], s[34:35]
v_pk_add_f32 v[146:147], v[146:147], s[34:35]
v_rcp_f32_e64 v140, v140
v_rcp_f32_e64 v141, v141
v_rcp_f32_e64 v142, v142
v_rcp_f32_e64 v143, v143
v_rcp_f32_e64 v144, v144
v_rcp_f32_e64 v145, v145
v_rcp_f32_e64 v146, v146
v_rcp_f32_e64 v147, v147
v_pk_mul_f32 v[140:141], v[140:141], v[108:109]
v_pk_mul_f32 v[142:143], v[142:143], v[110:111]
v_pk_mul_f32 v[144:145], v[144:145], v[124:125]
v_pk_mul_f32 v[146:147], v[146:147], v[126:127]
v_cvt_pk_bf16_f32 v152, v140, v141
v_cvt_pk_bf16_f32 v153, v142, v143
v_cvt_pk_bf16_f32 v154, v144, v145
v_cvt_pk_bf16_f32 v155, v146, v147
buffer_store_dwordx4 v[152:155], v57, s[12:15], s50 offen offset:3072 sc1
s_waitcnt lgkmcnt(15)
s_barrier
ds_read_b128 v[192:195], v33 offset:384
ds_read_b128 v[196:199], v33 offset:896
ds_read_b128 v[200:203], v33 offset:1408
ds_read_b128 v[204:207], v33 offset:1920
ds_read_b128 v[208:211], v33 offset:2432
ds_read_b128 v[212:215], v33 offset:2944
ds_read_b128 v[216:219], v33 offset:3456
ds_read_b128 v[220:223], v33 offset:3968
s_waitcnt lgkmcnt(15)
s_waitcnt lgkmcnt(7)
v_mfma_f32_16x16x32_bf16 v[64:67], v[160:163], v[192:195], 0
s_mul_i32 s100, s26, 160
v_lshl_add_u32 v12, v3, 3, s100
v_mfma_f32_16x16x32_bf16 v[68:71], v[164:167], v[192:195], 0
v_mfma_f32_16x16x32_bf16 v[72:75], v[168:171], v[192:195], 0
v_mfma_f32_16x16x32_bf16 v[76:79], v[172:175], v[192:195], 0
v_mfma_f32_16x16x32_bf16 v[80:83], v[176:179], v[192:195], 0
v_mfma_f32_16x16x32_bf16 v[84:87], v[180:183], v[192:195], 0
global_load_dwordx2 v[46:47], v12, s[62:63] offset:0
v_mfma_f32_16x16x32_bf16 v[88:91], v[184:187], v[192:195], 0
v_add_u32 v24, -640, v32
v_add_u32 v25, -1664, v32
v_mfma_f32_16x16x32_bf16 v[92:95], v[188:191], v[192:195], 0
v_add_u32 v26, -2688, v32
v_add_u32 v27, -3712, v32
s_waitcnt lgkmcnt(6)
v_mfma_f32_16x16x32_bf16 v[68:71], v[160:163], v[196:199], v[68:71]
ds_read_b128 v[128:131], v33 offset:256
v_mfma_f32_16x16x32_bf16 v[72:75], v[164:167], v[196:199], v[72:75]
ds_read2_b32 v[96:97], v24 offset0:128 offset1:129
global_load_dwordx2 v[48:49], v12, s[62:63] offset:32
v_mfma_f32_16x16x32_bf16 v[76:79], v[168:171], v[196:199], v[76:79]
ds_read2_b32 v[98:99], v24 offset0:130 offset1:131
v_mfma_f32_16x16x32_bf16 v[80:83], v[172:175], v[196:199], v[80:83]
ds_read2_b32 v[100:101], v24 offset0:0 offset1:1
v_mfma_f32_16x16x32_bf16 v[84:87], v[176:179], v[196:199], v[84:87]
ds_read2_b32 v[102:103], v24 offset0:2 offset1:3
v_mfma_f32_16x16x32_bf16 v[88:91], v[180:183], v[196:199], v[88:91]
ds_read2_b32 v[104:105], v25 offset0:128 offset1:129
v_mfma_f32_16x16x32_bf16 v[92:95], v[184:187], v[196:199], v[92:95]
ds_read2_b32 v[106:107], v25 offset0:130 offset1:131
global_load_dwordx2 v[50:51], v12, s[62:63] offset:64
s_waitcnt lgkmcnt(12)
v_mfma_f32_16x16x32_bf16 v[72:75], v[160:163], v[200:203], v[72:75]
ds_read2_b32 v[108:109], v25 offset0:0 offset1:1
v_mfma_f32_16x16x32_bf16 v[76:79], v[164:167], v[200:203], v[76:79]
ds_read2_b32 v[110:111], v25 offset0:2 offset1:3
v_mfma_f32_16x16x32_bf16 v[80:83], v[168:171], v[200:203], v[80:83]
ds_read2_b32 v[112:113], v26 offset0:128 offset1:129
v_mfma_f32_16x16x32_bf16 v[84:87], v[172:175], v[200:203], v[84:87]
ds_read2_b32 v[114:115], v26 offset0:130 offset1:131
global_load_dwordx2 v[52:53], v12, s[62:63] offset:96
v_mfma_f32_16x16x32_bf16 v[88:91], v[176:179], v[200:203], v[88:91]
ds_read2_b32 v[116:117], v26 offset0:0 offset1:1
v_mfma_f32_16x16x32_bf16 v[92:95], v[180:183], v[200:203], v[92:95]
ds_read2_b32 v[118:119], v26 offset0:2 offset1:3
s_waitcnt lgkmcnt(15)
v_mfma_f32_16x16x32_bf16 v[76:79], v[160:163], v[204:207], v[76:79]
ds_read2_b32 v[120:121], v27 offset0:128 offset1:129
v_mfma_f32_16x16x32_bf16 v[80:83], v[164:167], v[204:207], v[80:83]
ds_read2_b32 v[122:123], v27 offset0:130 offset1:131
v_mfma_f32_16x16x32_bf16 v[92:95], v[176:179], v[204:207], v[92:95]
ds_read2_b32 v[124:125], v27 offset0:0 offset1:1
global_load_dwordx2 v[54:55], v12, s[62:63] offset:128
v_mfma_f32_16x16x32_bf16 v[84:87], v[168:171], v[204:207], v[84:87]
ds_read2_b32 v[126:127], v27 offset0:2 offset1:3
v_mfma_f32_16x16x32_bf16 v[88:91], v[172:175], v[204:207], v[88:91]
ds_read_b128 v[132:135], v33 offset:768
v_mfma_f32_16x16x32_bf16 v[92:95], v[172:175], v[208:211], v[92:95]
ds_read_b128 v[136:139], v33 offset:1280
v_mfma_f32_16x16x32_bf16 v[80:83], v[160:163], v[208:211], v[80:83]
ds_read_b128 v[140:143], v33 offset:1792
buffer_load_dwordx4 a[168:171], v56, s[12:15], s80 offen offset:2048 sc1
v_mfma_f32_16x16x32_bf16 v[84:87], v[164:167], v[208:211], v[84:87]
ds_read_b128 v[144:147], v33 offset:2304
v_mfma_f32_16x16x32_bf16 v[92:95], v[168:171], v[212:215], v[92:95]
ds_read_b128 v[148:151], v33 offset:2816
v_mfma_f32_16x16x32_bf16 v[88:91], v[168:171], v[208:211], v[88:91]
ds_read_b128 v[152:155], v33 offset:3328
v_mfma_f32_16x16x32_bf16 v[84:87], v[160:163], v[212:215], v[84:87]
ds_read_b128 v[156:159], v33 offset:3840
s_waitcnt lgkmcnt(15)
v_mfma_f32_16x16x32_bf16 v[92:95], v[164:167], v[216:219], v[92:95]
buffer_load_dwordx4 a[172:175], v56, s[12:15], s80 offen offset:3072 sc1
v_mfma_f32_16x16x32_bf16 v[88:91], v[164:167], v[212:215], v[88:91]
v_mfma_f32_16x16x32_bf16 v[88:91], v[160:163], v[216:219], v[88:91]
v_mfma_f32_16x16x32_bf16 v[92:95], v[160:163], v[220:223], v[92:95]
s_lshl_b32 s51, s22, 11
s_lshl_b32 s101, s23, 7
s_add_u32 s51, s51, s101
s_add_u32 s51, s51, 16842752
s_waitcnt vmcnt(7)
s_barrier
buffer_store_dwordx2 v[10:11], v63, s[12:15], s51 offen sc1
v_mfma_f32_16x16x32_bf16 v[64:67], v[96:99], v[128:131], v[64:67]
buffer_load_dwordx4 a[176:179], v57, s[12:15], s80 offen sc1
v_mfma_f32_16x16x32_bf16 v[68:71], v[100:103], v[128:131], v[68:71]
v_mfma_f32_16x16x32_bf16 v[72:75], v[104:107], v[128:131], v[72:75]
v_add_u32 v28, -768, v32
v_add_u32 v29, -1792, v32
v_mfma_f32_16x16x32_bf16 v[76:79], v[108:111], v[128:131], v[76:79]
v_add_u32 v30, -2816, v32
v_add_u32 v31, -3840, v32
s_waitcnt lgkmcnt(13)
v_mfma_f32_16x16x32_bf16 v[80:83], v[112:115], v[128:131], v[80:83]
ds_read_b128 v[192:195], v33 offset:128
buffer_load_dwordx4 a[180:183], v56, s[12:15], s81 offen offset:0 sc1
s_waitcnt lgkmcnt(12)
v_mfma_f32_16x16x32_bf16 v[84:87], v[116:119], v[128:131], v[84:87]
ds_read2_b32 v[160:161], v28 offset0:128 offset1:129
s_waitcnt lgkmcnt(11)
v_mfma_f32_16x16x32_bf16 v[88:91], v[120:123], v[128:131], v[88:91]
ds_read2_b32 v[162:163], v28 offset0:130 offset1:131
s_waitcnt lgkmcnt(10)
v_mfma_f32_16x16x32_bf16 v[92:95], v[124:127], v[128:131], v[92:95]
ds_read2_b32 v[164:165], v28 offset0:0 offset1:1
s_waitcnt lgkmcnt(10)
v_mfma_f32_16x16x32_bf16 v[68:71], v[96:99], v[132:135], v[68:71]
ds_read2_b32 v[166:167], v28 offset0:2 offset1:3
buffer_load_dwordx4 a[184:187], v56, s[12:15], s81 offen offset:1024 sc1
v_mfma_f32_16x16x32_bf16 v[72:75], v[100:103], v[132:135], v[72:75]
ds_read2_b32 v[168:169], v29 offset0:128 offset1:129
v_mfma_f32_16x16x32_bf16 v[76:79], v[104:107], v[132:135], v[76:79]
ds_read2_b32 v[170:171], v29 offset0:130 offset1:131
v_mfma_f32_16x16x32_bf16 v[80:83], v[108:111], v[132:135], v[80:83]
ds_read2_b32 v[172:173], v29 offset0:0 offset1:1
v_mfma_f32_16x16x32_bf16 v[84:87], v[112:115], v[132:135], v[84:87]
ds_read2_b32 v[174:175], v29 offset0:2 offset1:3
buffer_load_dwordx4 a[188:191], v56, s[12:15], s81 offen offset:2048 sc1
v_mfma_f32_16x16x32_bf16 v[88:91], v[116:119], v[132:135], v[88:91]
ds_read2_b32 v[176:177], v30 offset0:128 offset1:129
v_mfma_f32_16x16x32_bf16 v[92:95], v[120:123], v[132:135], v[92:95]
ds_read2_b32 v[178:179], v30 offset0:130 offset1:131
s_waitcnt lgkmcnt(15)
v_mfma_f32_16x16x32_bf16 v[72:75], v[96:99], v[136:139], v[72:75]
ds_read2_b32 v[180:181], v30 offset0:0 offset1:1
v_mfma_f32_16x16x32_bf16 v[76:79], v[100:103], v[136:139], v[76:79]
ds_read2_b32 v[182:183], v30 offset0:2 offset1:3
buffer_load_dwordx4 a[192:195], v56, s[12:15], s81 offen offset:3072 sc1
v_mfma_f32_16x16x32_bf16 v[80:83], v[104:107], v[136:139], v[80:83]
ds_read2_b32 v[184:185], v31 offset0:128 offset1:129
v_mfma_f32_16x16x32_bf16 v[84:87], v[108:111], v[136:139], v[84:87]
ds_read2_b32 v[186:187], v31 offset0:130 offset1:131
v_mfma_f32_16x16x32_bf16 v[88:91], v[112:115], v[136:139], v[88:91]
ds_read2_b32 v[188:189], v31 offset0:0 offset1:1
v_mfma_f32_16x16x32_bf16 v[92:95], v[116:119], v[136:139], v[92:95]
ds_read2_b32 v[190:191], v31 offset0:2 offset1:3
buffer_load_dwordx4 a[196:199], v57, s[12:15], s81 offen sc1
v_mfma_f32_16x16x32_bf16 v[76:79], v[96:99], v[140:143], v[76:79]
ds_read_b128 v[196:199], v33 offset:640
v_mfma_f32_16x16x32_bf16 v[80:83], v[100:103], v[140:143], v[80:83]
ds_read_b128 v[200:203], v33 offset:1152
v_mfma_f32_16x16x32_bf16 v[92:95], v[112:115], v[140:143], v[92:95]
ds_read_b128 v[204:207], v33 offset:1664
v_mfma_f32_16x16x32_bf16 v[84:87], v[104:107], v[140:143], v[84:87]
ds_read_b128 v[208:211], v33 offset:2176
buffer_load_dwordx4 a[200:203], v56, s[12:15], s82 offen offset:0 sc1
v_mfma_f32_16x16x32_bf16 v[88:91], v[108:111], v[140:143], v[88:91]
ds_read_b128 v[212:215], v33 offset:2688
s_waitcnt lgkmcnt(15)
v_mfma_f32_16x16x32_bf16 v[92:95], v[108:111], v[144:147], v[92:95]
ds_read_b128 v[216:219], v33 offset:3200
v_mfma_f32_16x16x32_bf16 v[80:83], v[96:99], v[144:147], v[80:83]
ds_read_b128 v[220:223], v33 offset:3712
v_mfma_f32_16x16x32_bf16 v[84:87], v[100:103], v[144:147], v[84:87]
buffer_load_dwordx4 a[204:207], v56, s[12:15], s82 offen offset:1024 sc1
v_mfma_f32_16x16x32_bf16 v[92:95], v[104:107], v[148:151], v[92:95]
v_mfma_f32_16x16x32_bf16 v[88:91], v[104:107], v[144:147], v[88:91]
v_mfma_f32_16x16x32_bf16 v[84:87], v[96:99], v[148:151], v[84:87]
v_mfma_f32_16x16x32_bf16 v[92:95], v[100:103], v[152:155], v[92:95]
buffer_load_dwordx4 a[208:211], v56, s[12:15], s82 offen offset:2048 sc1
v_mfma_f32_16x16x32_bf16 v[88:91], v[100:103], v[148:151], v[88:91]
v_mfma_f32_16x16x32_bf16 v[88:91], v[96:99], v[152:155], v[88:91]
v_mfma_f32_16x16x32_bf16 v[92:95], v[96:99], v[156:159], v[92:95]
v_mfma_f32_16x16x32_bf16 v[64:67], v[160:163], v[192:195], v[64:67]
buffer_load_dwordx4 a[212:215], v56, s[12:15], s82 offen offset:3072 sc1
v_mfma_f32_16x16x32_bf16 v[68:71], v[164:167], v[192:195], v[68:71]
v_mfma_f32_16x16x32_bf16 v[72:75], v[168:171], v[192:195], v[72:75]
v_add_u32 v24, -896, v32
v_add_u32 v25, -1920, v32
s_waitcnt lgkmcnt(15)
v_mfma_f32_16x16x32_bf16 v[76:79], v[172:175], v[192:195], v[76:79]
v_add_u32 v26, -2944, v32
v_add_u32 v27, -3968, v32
s_waitcnt lgkmcnt(13)
v_mfma_f32_16x16x32_bf16 v[80:83], v[176:179], v[192:195], v[80:83]
ds_read_b128 v[128:131], v33 offset:0
buffer_load_dwordx4 a[216:219], v57, s[12:15], s82 offen sc1
s_waitcnt lgkmcnt(12)
v_mfma_f32_16x16x32_bf16 v[84:87], v[180:183], v[192:195], v[84:87]
ds_read2_b32 v[96:97], v24 offset0:128 offset1:129
s_waitcnt lgkmcnt(11)
v_mfma_f32_16x16x32_bf16 v[88:91], v[184:187], v[192:195], v[88:91]
ds_read2_b32 v[98:99], v24 offset0:130 offset1:131
s_waitcnt lgkmcnt(10)
v_mfma_f32_16x16x32_bf16 v[92:95], v[188:191], v[192:195], v[92:95]
ds_read2_b32 v[100:101], v24 offset0:0 offset1:1
s_waitcnt lgkmcnt(10)
v_mfma_f32_16x16x32_bf16 v[68:71], v[160:163], v[196:199], v[68:71]
ds_read2_b32 v[102:103], v24 offset0:2 offset1:3
buffer_load_dwordx4 a[220:223], v56, s[12:15], s83 offen offset:0 sc1
v_mfma_f32_16x16x32_bf16 v[72:75], v[164:167], v[196:199], v[72:75]
ds_read2_b32 v[104:105], v25 offset0:128 offset1:129
v_mfma_f32_16x16x32_bf16 v[76:79], v[168:171], v[196:199], v[76:79]
ds_read2_b32 v[106:107], v25 offset0:130 offset1:131
v_mfma_f32_16x16x32_bf16 v[80:83], v[172:175], v[196:199], v[80:83]
ds_read2_b32 v[108:109], v25 offset0:0 offset1:1
v_mfma_f32_16x16x32_bf16 v[84:87], v[176:179], v[196:199], v[84:87]
ds_read2_b32 v[110:111], v25 offset0:2 offset1:3
buffer_load_dwordx4 a[224:227], v56, s[12:15], s83 offen offset:1024 sc1
v_mfma_f32_16x16x32_bf16 v[88:91], v[180:183], v[196:199], v[88:91]
ds_read2_b32 v[112:113], v26 offset0:128 offset1:129
v_mfma_f32_16x16x32_bf16 v[92:95], v[184:187], v[196:199], v[92:95]
ds_read2_b32 v[114:115], v26 offset0:130 offset1:131
s_waitcnt lgkmcnt(15)
v_mfma_f32_16x16x32_bf16 v[72:75], v[160:163], v[200:203], v[72:75]
ds_read2_b32 v[116:117], v26 offset0:0 offset1:1
v_mfma_f32_16x16x32_bf16 v[76:79], v[164:167], v[200:203], v[76:79]
ds_read2_b32 v[118:119], v26 offset0:2 offset1:3
buffer_load_dwordx4 a[228:231], v56, s[12:15], s83 offen offset:2048 sc1
v_mfma_f32_16x16x32_bf16 v[80:83], v[168:171], v[200:203], v[80:83]
ds_read2_b32 v[120:121], v27 offset0:128 offset1:129
v_mfma_f32_16x16x32_bf16 v[84:87], v[172:175], v[200:203], v[84:87]
ds_read2_b32 v[122:123], v27 offset0:130 offset1:131
v_mfma_f32_16x16x32_bf16 v[88:91], v[176:179], v[200:203], v[88:91]
ds_read2_b32 v[124:125], v27 offset0:0 offset1:1
v_mfma_f32_16x16x32_bf16 v[92:95], v[180:183], v[200:203], v[92:95]
ds_read2_b32 v[126:127], v27 offset0:2 offset1:3
buffer_load_dwordx4 a[232:235], v56, s[12:15], s83 offen offset:3072 sc1
v_mfma_f32_16x16x32_bf16 v[76:79], v[160:163], v[204:207], v[76:79]
ds_read_b128 v[132:135], v33 offset:512
v_mfma_f32_16x16x32_bf16 v[80:83], v[164:167], v[204:207], v[80:83]
ds_read_b128 v[136:139], v33 offset:1024
v_mfma_f32_16x16x32_bf16 v[92:95], v[176:179], v[204:207], v[92:95]
ds_read_b128 v[140:143], v33 offset:1536
v_mfma_f32_16x16x32_bf16 v[84:87], v[168:171], v[204:207], v[84:87]
ds_read_b128 v[144:147], v33 offset:2048
buffer_load_dwordx4 a[236:239], v57, s[12:15], s83 offen sc1
v_mfma_f32_16x16x32_bf16 v[88:91], v[172:175], v[204:207], v[88:91]
ds_read_b128 v[148:151], v33 offset:2560
s_waitcnt lgkmcnt(15)
v_mfma_f32_16x16x32_bf16 v[92:95], v[172:175], v[208:211], v[92:95]
ds_read_b128 v[152:155], v33 offset:3072
v_mfma_f32_16x16x32_bf16 v[80:83], v[160:163], v[208:211], v[80:83]
ds_read_b128 v[156:159], v33 offset:3584
v_mfma_f32_16x16x32_bf16 v[84:87], v[164:167], v[208:211], v[84:87]
buffer_load_dwordx4 a[240:243], v56, s[12:15], s84 offen offset:0 sc1
v_mfma_f32_16x16x32_bf16 v[92:95], v[168:171], v[212:215], v[92:95]
v_mfma_f32_16x16x32_bf16 v[88:91], v[168:171], v[208:211], v[88:91]
v_mfma_f32_16x16x32_bf16 v[84:87], v[160:163], v[212:215], v[84:87]
v_mfma_f32_16x16x32_bf16 v[92:95], v[164:167], v[216:219], v[92:95]
buffer_load_dwordx4 a[244:247], v56, s[12:15], s84 offen offset:1024 sc1
v_mfma_f32_16x16x32_bf16 v[88:91], v[164:167], v[212:215], v[88:91]
v_mfma_f32_16x16x32_bf16 v[88:91], v[160:163], v[216:219], v[88:91]
v_mfma_f32_16x16x32_bf16 v[92:95], v[160:163], v[220:223], v[92:95]
v_mfma_f32_16x16x32_bf16 v[64:67], v[96:99], v[128:131], v[64:67]
buffer_load_dwordx4 a[248:251], v56, s[12:15], s84 offen offset:2048 sc1
v_mfma_f32_16x16x32_bf16 v[68:71], v[100:103], v[128:131], v[68:71]
s_waitcnt lgkmcnt(7)
v_mfma_f32_16x16x32_bf16 v[92:95], v[124:127], v[128:131], v[92:95]
s_nop 3
ds_write_b128 v34, v[64:67] offset:0
s_waitcnt lgkmcnt(7)
v_mfma_f32_16x16x32_bf16 v[68:71], v[96:99], v[132:135], v[68:71]
v_mfma_f32_16x16x32_bf16 v[72:75], v[104:107], v[128:131], v[72:75]
buffer_load_dwordx4 a[252:255], v56, s[12:15], s84 offen offset:3072 sc1
v_mfma_f32_16x16x32_bf16 v[88:91], v[120:123], v[128:131], v[88:91]
s_nop 4
ds_write_b128 v34, v[68:71] offset:1024
v_mfma_f32_16x16x32_bf16 v[72:75], v[100:103], v[132:135], v[72:75]
v_mfma_f32_16x16x32_bf16 v[92:95], v[120:123], v[132:135], v[92:95]
s_waitcnt lgkmcnt(7)
v_mfma_f32_16x16x32_bf16 v[72:75], v[96:99], v[136:139], v[72:75]
s_lshr_b32 s100, s25, 1
s_lshl_b32 s100, s100, 11
s_add_u32 s100, s100, 16842752
v_lshl_add_u32 v13, v2, 7, s100
buffer_load_dwordx2 v[14:15], v13, s[12:15], 0 offen sc1
v_mfma_f32_16x16x32_bf16 v[76:79], v[108:111], v[128:131], v[76:79]
v_mfma_f32_16x16x32_bf16 v[84:87], v[116:119], v[128:131], v[84:87]
s_nop 0
ds_write_b128 v34, v[72:75] offset:2048
v_mfma_f32_16x16x32_bf16 v[76:79], v[104:107], v[132:135], v[76:79]
v_mfma_f32_16x16x32_bf16 v[88:91], v[116:119], v[132:135], v[88:91]
buffer_load_dwordx4 v[232:235], v57, s[12:15], s84 offen sc1
v_mfma_f32_16x16x32_bf16 v[76:79], v[100:103], v[136:139], v[76:79]
v_mfma_f32_16x16x32_bf16 v[92:95], v[116:119], v[136:139], v[92:95]
s_waitcnt lgkmcnt(7)
v_mfma_f32_16x16x32_bf16 v[76:79], v[96:99], v[140:143], v[76:79]
v_mfma_f32_16x16x32_bf16 v[80:83], v[112:115], v[128:131], v[80:83]
buffer_load_dwordx4 v[236:239], v56, s[12:15], s85 offen offset:0 sc1
v_mfma_f32_16x16x32_bf16 v[84:87], v[112:115], v[132:135], v[84:87]
s_nop 4
ds_write_b128 v34, v[76:79] offset:3072
v_mfma_f32_16x16x32_bf16 v[80:83], v[108:111], v[132:135], v[80:83]
v_mfma_f32_16x16x32_bf16 v[88:91], v[112:115], v[136:139], v[88:91]
v_mfma_f32_16x16x32_bf16 v[80:83], v[104:107], v[136:139], v[80:83]
buffer_load_dwordx4 v[240:243], v56, s[12:15], s85 offen offset:1024 sc1
v_mfma_f32_16x16x32_bf16 v[92:95], v[112:115], v[140:143], v[92:95]
v_mfma_f32_16x16x32_bf16 v[80:83], v[100:103], v[140:143], v[80:83]
v_mfma_f32_16x16x32_bf16 v[84:87], v[108:111], v[136:139], v[84:87]
s_waitcnt lgkmcnt(7)
v_mfma_f32_16x16x32_bf16 v[80:83], v[96:99], v[144:147], v[80:83]
buffer_load_dwordx4 v[244:247], v56, s[12:15], s85 offen offset:2048 sc1
v_mfma_f32_16x16x32_bf16 v[84:87], v[104:107], v[140:143], v[84:87]
v_mfma_f32_16x16x32_bf16 v[88:91], v[108:111], v[140:143], v[88:91]
s_nop 4
ds_write_b128 v34, v[80:83] offset:4096
v_mfma_f32_16x16x32_bf16 v[84:87], v[100:103], v[144:147], v[84:87]
v_mfma_f32_16x16x32_bf16 v[92:95], v[108:111], v[144:147], v[92:95]
buffer_load_dwordx4 v[248:251], v56, s[12:15], s85 offen offset:3072 sc1
s_waitcnt lgkmcnt(7)
v_mfma_f32_16x16x32_bf16 v[84:87], v[96:99], v[148:151], v[84:87]
v_mfma_f32_16x16x32_bf16 v[88:91], v[104:107], v[144:147], v[88:91]
v_mfma_f32_16x16x32_bf16 v[92:95], v[104:107], v[148:151], v[92:95]
s_nop 5
ds_write_b128 v34, v[84:87] offset:5120
v_mfma_f32_16x16x32_bf16 v[88:91], v[100:103], v[148:151], v[88:91]
buffer_load_dwordx4 v[252:255], v57, s[12:15], s85 offen sc1
s_waitcnt lgkmcnt(7)
v_mfma_f32_16x16x32_bf16 v[92:95], v[100:103], v[152:155], v[92:95]
v_mfma_f32_16x16x32_bf16 v[88:91], v[96:99], v[152:155], v[88:91]
s_waitcnt lgkmcnt(6)
v_mfma_f32_16x16x32_bf16 v[92:95], v[96:99], v[156:159], v[92:95]
s_waitcnt vmcnt(6)
v_cmp_ne_u64 vcc, v[14:15], s[20:21]
s_nop 3
s_mov_b64 s[46:47], vcc
s_cmp_eq_u64 s[46:47], 0
s_cselect_b32 s42, s86, 2146435072
s_cselect_b32 s43, s87, 2146435072
s_cselect_b32 s44, s88, 2146435072
s_cselect_b32 s45, s89, 2146435072
ds_write_b128 v34, v[88:91] offset:6144
ds_write_b128 v34, v[92:95] offset:7168
buffer_load_dwordx4 v[144:147], v58, s[12:15], s42 offen sc1
buffer_load_dwordx4 v[148:151], v59, s[12:15], s42 offen sc1
s_lshl_b32 s101, s3, 10
s_add_u32 s101, s101, 53248
buffer_load_dwordx4 v[152:155], v60, s[12:15], s42 offen sc1
v_and_b32 v25, 1, v1
v_bfe_u32 v26, v1, 1, 1
v_lshrrev_b32 v27, 2, v1
buffer_load_dwordx4 v[156:159], v61, s[12:15], s42 offen sc1
v_lshl_add_u32 v27, v25, 3, v27
v_and_b32 v27, 15, v27
v_mul_u32_u24 v26, 16448, v26
v_lshl_add_u32 v26, v25, 9, v26
v_lshl_add_u32 v26, v27, 4, v26
v_add_u32 v26, s101, v26
v_lshrrev_b32 v27, 2, v0
v_mul_u32_u24 v27, 20480, v27
v_and_b32 v25, 3, v0
v_lshl_add_u32 v27, v25, 4, v27
s_add_u32 s101, s24, 0
s_lshl_b32 s51, s101, 6
s_add_u32 s51, s51, 13631488
s_add_u32 s52, s51, 1310720
s_lshl_b32 s50, s101, 7
s_add_u32 s50, s50, 16973824
s_waitcnt lgkmcnt(0)
s_barrier
ds_read_b128 v[96:99], v26 offset:0
ds_read_b128 v[100:103], v26 offset:256
ds_read_b128 v[104:107], v26 offset:8192
ds_read_b128 v[108:111], v26 offset:8448
ds_read_b128 v[112:115], v26 offset:4096
ds_read_b128 v[116:119], v26 offset:4352
ds_read_b128 v[120:123], v26 offset:12288
ds_read_b128 v[124:127], v26 offset:12544
s_waitcnt lgkmcnt(4)
v_pk_add_f32 v[96:97], v[96:97], v[104:105]
v_pk_add_f32 v[98:99], v[98:99], v[106:107]
v_pk_add_f32 v[100:101], v[100:101], v[108:109]
v_pk_add_f32 v[102:103], v[102:103], v[110:111]
v_cvt_pk_bf16_f32 v128, v96, v97
v_cvt_pk_bf16_f32 v129, v98, v99
v_cvt_pk_bf16_f32 v130, v100, v101
v_cvt_pk_bf16_f32 v131, v102, v103
buffer_store_dwordx4 v[128:131], v27, s[12:15], s51 offen sc1
s_waitcnt lgkmcnt(0)
v_pk_add_f32 v[112:113], v[112:113], v[120:121]
v_pk_add_f32 v[114:115], v[114:115], v[122:123]
v_pk_add_f32 v[116:117], v[116:117], v[124:125]
v_pk_add_f32 v[118:119], v[118:119], v[126:127]
v_cvt_pk_bf16_f32 v132, v112, v113
v_cvt_pk_bf16_f32 v133, v114, v115
v_cvt_pk_bf16_f32 v134, v116, v117
v_cvt_pk_bf16_f32 v135, v118, v119
buffer_store_dwordx4 v[132:135], v27, s[12:15], s52 offen sc1
buffer_load_dwordx4 v[160:163], v58, s[12:15], s43 offen sc1
buffer_load_dwordx4 v[164:167], v59, s[12:15], s43 offen sc1
buffer_load_dwordx4 v[168:171], v60, s[12:15], s43 offen sc1
buffer_load_dwordx4 v[172:175], v61, s[12:15], s43 offen sc1
buffer_load_dwordx4 v[176:179], v58, s[12:15], s44 offen sc1
buffer_load_dwordx4 v[180:183], v59, s[12:15], s44 offen sc1
buffer_load_dwordx4 v[184:187], v60, s[12:15], s44 offen sc1
buffer_load_dwordx4 v[188:191], v61, s[12:15], s44 offen sc1
buffer_load_dwordx4 v[192:195], v58, s[12:15], s45 offen sc1
buffer_load_dwordx4 v[196:199], v59, s[12:15], s45 offen sc1
buffer_load_dwordx4 v[200:203], v60, s[12:15], s45 offen sc1
buffer_load_dwordx4 v[204:207], v61, s[12:15], s45 offen sc1
s_cmp_lg_u64 s[46:47], 0
s_cbranch_scc1 slow11
back12:
v_lshlrev_b32 v36, 16, v46
v_and_b32 v37, 0xffff0000, v46
v_lshlrev_b32 v38, 16, v47
v_and_b32 v39, 0xffff0000, v47
v_lshlrev_b32 v40, 16, v48
v_and_b32 v41, 0xffff0000, v48
v_lshlrev_b32 v42, 16, v49
v_and_b32 v43, 0xffff0000, v49
v_lshlrev_b32 v44, 16, v50
v_and_b32 v45, 0xffff0000, v50
v_lshlrev_b32 v46, 16, v51
v_and_b32 v47, 0xffff0000, v51
v_lshlrev_b32 v48, 16, v52
v_and_b32 v49, 0xffff0000, v52
v_lshlrev_b32 v50, 16, v53
v_and_b32 v51, 0xffff0000, v53
v_lshlrev_b32 v52, 16, v54
v_and_b32 v53, 0xffff0000, v54
v_lshlrev_b32 v54, 16, v55
v_and_b32 v55, 0xffff0000, v55
s_mov_b32 s16, s66
s_mov_b32 s17, s67
s_mov_b32 s18, 2621440
s_mov_b32 s19, 0x20000
s_mov_b32 s101, 192
v_cmp_ne_u32 vcc, s101, v0
v_mov_b32 v15, 2146435072
s_nop 0
v_cndmask_b32 v15, 0, v15, vcc
s_waitcnt vmcnt(14)
v_mfma_f32_16x16x32_bf16 v[64:67], a[0:3], v[144:147], v[36:39]
v_mfma_f32_16x16x32_bf16 v[68:71], a[4:7], v[144:147], v[40:43]
buffer_load_dwordx4 v[208:211], v58, s[12:15], s90 offen sc1
v_mfma_f32_16x16x32_bf16 v[72:75], a[8:11], v[144:147], v[44:47]
v_mfma_f32_16x16x32_bf16 v[76:79], a[12:15], v[144:147], v[48:51]
v_mfma_f32_16x16x32_bf16 v[80:83], a[16:19], v[144:147], v[52:55]
v_mfma_f32_16x16x32_bf16 v[84:87], a[0:3], v[148:151], 0
v_mfma_f32_16x16x32_bf16 v[88:91], a[4:7], v[148:151], 0
buffer_load_dwordx4 v[212:215], v59, s[12:15], s90 offen sc1
v_mfma_f32_16x16x32_bf16 v[92:95], a[8:11], v[148:151], 0
v_mfma_f32_16x16x32_bf16 v[96:99], a[12:15], v[148:151], 0
v_mfma_f32_16x16x32_bf16 v[100:103], a[16:19], v[148:151], 0
v_mfma_f32_16x16x32_bf16 v[104:107], a[0:3], v[152:155], 0
v_mfma_f32_16x16x32_bf16 v[108:111], a[4:7], v[152:155], 0
buffer_load_dwordx4 v[216:219], v60, s[12:15], s90 offen sc1
v_mfma_f32_16x16x32_bf16 v[112:115], a[8:11], v[152:155], 0
v_mfma_f32_16x16x32_bf16 v[116:119], a[12:15], v[152:155], 0
v_mfma_f32_16x16x32_bf16 v[120:123], a[16:19], v[152:155], 0
v_mfma_f32_16x16x32_bf16 v[124:127], a[0:3], v[156:159], 0
v_mfma_f32_16x16x32_bf16 v[128:131], a[4:7], v[156:159], 0
buffer_load_dwordx4 v[220:223], v61, s[12:15], s90 offen sc1
v_mfma_f32_16x16x32_bf16 v[132:135], a[8:11], v[156:159], 0
v_mfma_f32_16x16x32_bf16 v[136:139], a[12:15], v[156:159], 0
v_mfma_f32_16x16x32_bf16 v[140:143], a[16:19], v[156:159], 0
s_waitcnt vmcnt(12)
s_barrier
buffer_store_dwordx2 v[10:11], v15, s[12:15], s50 offen sc1
v_mfma_f32_16x16x32_bf16 v[64:67], a[20:23], v[160:163], v[64:67]
s_xor_b32 s101, s3, 1
s_mul_i32 s101, s101, 15360
v_mfma_f32_16x16x32_bf16 v[68:71], a[24:27], v[160:163], v[68:71]
s_add_u32 s101, s101, 86528
buffer_load_dwordx4 v[144:147], v58, s[12:15], s91 offen sc1
v_add_u32 v25, s101, v56
s_xor_b32 s101, s3, 2
v_mfma_f32_16x16x32_bf16 v[72:75], a[28:31], v[160:163], v[72:75]
s_mul_i32 s101, s101, 15360
v_mfma_f32_16x16x32_bf16 v[76:79], a[32:35], v[160:163], v[76:79]
s_add_u32 s101, s101, 91648
v_add_u32 v26, s101, v56
v_mfma_f32_16x16x32_bf16 v[80:83], a[36:39], v[160:163], v[80:83]
s_xor_b32 s101, s3, 3
v_mfma_f32_16x16x32_bf16 v[84:87], a[20:23], v[164:167], v[84:87]
s_mul_i32 s101, s101, 15360
v_mfma_f32_16x16x32_bf16 v[88:91], a[24:27], v[164:167], v[88:91]
s_add_u32 s101, s101, 96768
v_add_u32 v27, s101, v56
buffer_load_dwordx4 v[148:151], v59, s[12:15], s91 offen sc1
s_mul_i32 s101, s3, 15360
v_mfma_f32_16x16x32_bf16 v[92:95], a[28:31], v[164:167], v[92:95]
s_add_u32 s101, s101, 86528
v_add_u32 v24, s101, v56
v_mfma_f32_16x16x32_bf16 v[96:99], a[32:35], v[164:167], v[96:99]
s_mul_i32 s101, s3, 3072
v_mfma_f32_16x16x32_bf16 v[100:103], a[36:39], v[164:167], v[100:103]
s_add_u32 s101, s101, 147968
v_add_u32 v28, s101, v56
v_mfma_f32_16x16x32_bf16 v[104:107], a[20:23], v[168:171], v[104:107]
v_lshl_add_u32 v29, v1, 3, s101
v_mfma_f32_16x16x32_bf16 v[108:111], a[24:27], v[168:171], v[108:111]
v_mul_u32_u24 v30, 176, v2
v_lshl_add_u32 v30, v3, 3, v30
buffer_load_dwordx4 v[152:155], v60, s[12:15], s91 offen sc1
v_add_u32 v30, s101, v30
v_mfma_f32_16x16x32_bf16 v[112:115], a[28:31], v[168:171], v[112:115]
v_mfma_f32_16x16x32_bf16 v[116:119], a[32:35], v[168:171], v[116:119]
v_mfma_f32_16x16x32_bf16 v[120:123], a[36:39], v[168:171], v[120:123]
v_mfma_f32_16x16x32_bf16 v[124:127], a[20:23], v[172:175], v[124:127]
v_mfma_f32_16x16x32_bf16 v[128:131], a[24:27], v[172:175], v[128:131]
buffer_load_dwordx4 v[156:159], v61, s[12:15], s91 offen sc1
v_mfma_f32_16x16x32_bf16 v[132:135], a[28:31], v[172:175], v[132:135]
v_mfma_f32_16x16x32_bf16 v[136:139], a[32:35], v[172:175], v[136:139]
v_mfma_f32_16x16x32_bf16 v[140:143], a[36:39], v[172:175], v[140:143]
s_waitcnt vmcnt(13)
v_mfma_f32_16x16x32_bf16 v[64:67], a[40:43], v[176:179], v[64:67]
v_add_u32 v12, 0, v1
v_mul_u32_u24 v13, 6554, v12
v_mfma_f32_16x16x32_bf16 v[68:71], a[44:47], v[176:179], v[68:71]
v_lshrrev_b32 v13, 16, v13
v_mul_u32_u24 v14, 10, v13
buffer_load_dwordx4 v[160:163], v58, s[12:15], s92 offen sc1
v_sub_u32 v12, v12, v14
v_mfma_f32_16x16x32_bf16 v[72:75], a[48:51], v[176:179], v[72:75]
v_mul_u32_u24 v14, 176, v13
v_lshl_add_u32 v14, v12, 4, v14
v_mfma_f32_16x16x32_bf16 v[76:79], a[52:55], v[176:179], v[76:79]
v_add_u32 v16, s101, v14
v_mul_u32_u24 v14, 1280, v13
v_mfma_f32_16x16x32_bf16 v[80:83], a[56:59], v[176:179], v[80:83]
v_lshl_add_u32 v20, v12, 4, v14
v_add_u32 v12, 64, v1
v_mfma_f32_16x16x32_bf16 v[84:87], a[40:43], v[180:183], v[84:87]
v_mul_u32_u24 v13, 6554, v12
v_mfma_f32_16x16x32_bf16 v[88:91], a[44:47], v[180:183], v[88:91]
v_lshrrev_b32 v13, 16, v13
v_mul_u32_u24 v14, 10, v13
buffer_load_dwordx4 v[164:167], v59, s[12:15], s92 offen sc1
v_sub_u32 v12, v12, v14
v_mul_u32_u24 v14, 176, v13
v_mfma_f32_16x16x32_bf16 v[92:95], a[48:51], v[180:183], v[92:95]
v_lshl_add_u32 v14, v12, 4, v14
v_mfma_f32_16x16x32_bf16 v[96:99], a[52:55], v[180:183], v[96:99]
v_add_u32 v17, s101, v14
v_mul_u32_u24 v14, 1280, v13
v_mfma_f32_16x16x32_bf16 v[100:103], a[56:59], v[180:183], v[100:103]
v_lshl_add_u32 v21, v12, 4, v14
v_add_u32 v12, 128, v1
v_mfma_f32_16x16x32_bf16 v[104:107], a[40:43], v[184:187], v[104:107]
v_mul_u32_u24 v13, 6554, v12
v_mfma_f32_16x16x32_bf16 v[108:111], a[44:47], v[184:187], v[108:111]
v_lshrrev_b32 v13, 16, v13
v_mul_u32_u24 v14, 10, v13
buffer_load_dwordx4 v[168:171], v60, s[12:15], s92 offen sc1
v_sub_u32 v12, v12, v14
v_mul_u32_u24 v14, 176, v13
v_mfma_f32_16x16x32_bf16 v[112:115], a[48:51], v[184:187], v[112:115]
v_lshl_add_u32 v14, v12, 4, v14
v_mfma_f32_16x16x32_bf16 v[116:119], a[52:55], v[184:187], v[116:119]
v_add_u32 v18, s101, v14
v_mul_u32_u24 v14, 1280, v13
v_mfma_f32_16x16x32_bf16 v[120:123], a[56:59], v[184:187], v[120:123]
v_lshl_add_u32 v22, v12, 4, v14
v_mfma_f32_16x16x32_bf16 v[124:127], a[40:43], v[188:191], v[124:127]
v_cmp_gt_u32 vcc, 32, v1
v_mov_b32 v12, 2146435072
v_mfma_f32_16x16x32_bf16 v[128:131], a[44:47], v[188:191], v[128:131]
v_cndmask_b32 v22, v12, v22, vcc
buffer_load_dwordx4 v[172:175], v61, s[12:15], s92 offen sc1
v_mfma_f32_16x16x32_bf16 v[132:135], a[48:51], v[188:191], v[132:135]
v_mfma_f32_16x16x32_bf16 v[136:139], a[52:55], v[188:191], v[136:139]
v_mfma_f32_16x16x32_bf16 v[140:143], a[56:59], v[188:191], v[140:143]
s_waitcnt vmcnt(13)
v_mfma_f32_16x16x32_bf16 v[64:67], a[60:63], v[192:195], v[64:67]
v_mfma_f32_16x16x32_bf16 v[68:71], a[64:67], v[192:195], v[68:71]
buffer_load_dwordx4 v[176:179], v58, s[12:15], s93 offen sc1
v_mfma_f32_16x16x32_bf16 v[72:75], a[68:71], v[192:195], v[72:75]
v_mfma_f32_16x16x32_bf16 v[76:79], a[72:75], v[192:195], v[76:79]
v_mfma_f32_16x16x32_bf16 v[80:83], a[76:79], v[192:195], v[80:83]
v_mfma_f32_16x16x32_bf16 v[84:87], a[60:63], v[196:199], v[84:87]
v_mfma_f32_16x16x32_bf16 v[88:91], a[64:67], v[196:199], v[88:91]
buffer_load_dwordx4 v[180:183], v59, s[12:15], s93 offen sc1
v_mfma_f32_16x16x32_bf16 v[92:95], a[68:71], v[196:199], v[92:95]
v_mfma_f32_16x16x32_bf16 v[96:99], a[72:75], v[196:199], v[96:99]
v_mfma_f32_16x16x32_bf16 v[100:103], a[76:79], v[196:199], v[100:103]
v_mfma_f32_16x16x32_bf16 v[104:107], a[60:63], v[200:203], v[104:107]
v_mfma_f32_16x16x32_bf16 v[108:111], a[64:67], v[200:203], v[108:111]
buffer_load_dwordx4 v[184:187], v60, s[12:15], s93 offen sc1
v_mfma_f32_16x16x32_bf16 v[112:115], a[68:71], v[200:203], v[112:115]
v_mfma_f32_16x16x32_bf16 v[116:119], a[72:75], v[200:203], v[116:119]
v_mfma_f32_16x16x32_bf16 v[120:123], a[76:79], v[200:203], v[120:123]
v_mfma_f32_16x16x32_bf16 v[124:127], a[60:63], v[204:207], v[124:127]
v_mfma_f32_16x16x32_bf16 v[128:131], a[64:67], v[204:207], v[128:131]
buffer_load_dwordx4 v[188:191], v61, s[12:15], s93 offen sc1
v_mfma_f32_16x16x32_bf16 v[132:135], a[68:71], v[204:207], v[132:135]
v_mfma_f32_16x16x32_bf16 v[136:139], a[72:75], v[204:207], v[136:139]
v_mfma_f32_16x16x32_bf16 v[140:143], a[76:79], v[204:207], v[140:143]
s_waitcnt vmcnt(13)
v_mfma_f32_16x16x32_bf16 v[64:67], a[80:83], v[208:211], v[64:67]
v_mfma_f32_16x16x32_bf16 v[68:71], a[84:87], v[208:211], v[68:71]
buffer_load_dwordx4 v[192:195], v58, s[12:15], s94 offen sc1
v_mfma_f32_16x16x32_bf16 v[72:75], a[88:91], v[208:211], v[72:75]
v_mfma_f32_16x16x32_bf16 v[76:79], a[92:95], v[208:211], v[76:79]
v_mfma_f32_16x16x32_bf16 v[80:83], a[96:99], v[208:211], v[80:83]
v_mfma_f32_16x16x32_bf16 v[84:87], a[80:83], v[212:215], v[84:87]
v_mfma_f32_16x16x32_bf16 v[88:91], a[84:87], v[212:215], v[88:91]
buffer_load_dwordx4 v[196:199], v59, s[12:15], s94 offen sc1
v_mfma_f32_16x16x32_bf16 v[92:95], a[88:91], v[212:215], v[92:95]
v_mfma_f32_16x16x32_bf16 v[96:99], a[92:95], v[212:215], v[96:99]
v_mfma_f32_16x16x32_bf16 v[100:103], a[96:99], v[212:215], v[100:103]
v_mfma_f32_16x16x32_bf16 v[104:107], a[80:83], v[216:219], v[104:107]
v_mfma_f32_16x16x32_bf16 v[108:111], a[84:87], v[216:219], v[108:111]
buffer_load_dwordx4 v[200:203], v60, s[12:15], s94 offen sc1
v_mfma_f32_16x16x32_bf16 v[112:115], a[88:91], v[216:219], v[112:115]
v_mfma_f32_16x16x32_bf16 v[116:119], a[92:95], v[216:219], v[116:119]
v_mfma_f32_16x16x32_bf16 v[120:123], a[96:99], v[216:219], v[120:123]
v_mfma_f32_16x16x32_bf16 v[124:127], a[80:83], v[220:223], v[124:127]
v_mfma_f32_16x16x32_bf16 v[128:131], a[84:87], v[220:223], v[128:131]
buffer_load_dwordx4 v[204:207], v61, s[12:15], s94 offen sc1
v_mfma_f32_16x16x32_bf16 v[132:135], a[88:91], v[220:223], v[132:135]
v_mfma_f32_16x16x32_bf16 v[136:139], a[92:95], v[220:223], v[136:139]
v_mfma_f32_16x16x32_bf16 v[140:143], a[96:99], v[220:223], v[140:143]
s_waitcnt vmcnt(12)
v_mfma_f32_16x16x32_bf16 v[64:67], a[100:103], v[144:147], v[64:67]
v_mfma_f32_16x16x32_bf16 v[68:71], a[104:107], v[144:147], v[68:71]
buffer_load_dwordx4 v[208:211], v58, s[12:15], s95 offen sc1
v_mfma_f32_16x16x32_bf16 v[72:75], a[108:111], v[144:147], v[72:75]
v_mfma_f32_16x16x32_bf16 v[76:79], a[112:115], v[144:147], v[76:79]
v_mfma_f32_16x16x32_bf16 v[80:83], a[116:119], v[144:147], v[80:83]
v_mfma_f32_16x16x32_bf16 v[84:87], a[100:103], v[148:151], v[84:87]
v_mfma_f32_16x16x32_bf16 v[88:91], a[104:107], v[148:151], v[88:91]
buffer_load_dwordx4 v[212:215], v59, s[12:15], s95 offen sc1
v_mfma_f32_16x16x32_bf16 v[92:95], a[108:111], v[148:151], v[92:95]
v_mfma_f32_16x16x32_bf16 v[96:99], a[112:115], v[148:151], v[96:99]
v_mfma_f32_16x16x32_bf16 v[100:103], a[116:119], v[148:151], v[100:103]
v_mfma_f32_16x16x32_bf16 v[104:107], a[100:103], v[152:155], v[104:107]
v_mfma_f32_16x16x32_bf16 v[108:111], a[104:107], v[152:155], v[108:111]
buffer_load_dwordx4 v[216:219], v60, s[12:15], s95 offen sc1
v_mfma_f32_16x16x32_bf16 v[112:115], a[108:111], v[152:155], v[112:115]
v_mfma_f32_16x16x32_bf16 v[116:119], a[112:115], v[152:155], v[116:119]
v_mfma_f32_16x16x32_bf16 v[120:123], a[116:119], v[152:155], v[120:123]
v_mfma_f32_16x16x32_bf16 v[124:127], a[100:103], v[156:159], v[124:127]
v_mfma_f32_16x16x32_bf16 v[128:131], a[104:107], v[156:159], v[128:131]
buffer_load_dwordx4 v[220:223], v61, s[12:15], s95 offen sc1
v_mfma_f32_16x16x32_bf16 v[132:135], a[108:111], v[156:159], v[132:135]
v_mfma_f32_16x16x32_bf16 v[136:139], a[112:115], v[156:159], v[136:139]
v_mfma_f32_16x16x32_bf16 v[140:143], a[116:119], v[156:159], v[140:143]
s_waitcnt vmcnt(12)
v_mfma_f32_16x16x32_bf16 v[64:67], a[120:123], v[160:163], v[64:67]
v_mfma_f32_16x16x32_bf16 v[68:71], a[124:127], v[160:163], v[68:71]
buffer_load_dwordx4 v[144:147], v58, s[12:15], s96 offen sc1
v_mfma_f32_16x16x32_bf16 v[72:75], a[128:131], v[160:163], v[72:75]
v_mfma_f32_16x16x32_bf16 v[76:79], a[132:135], v[160:163], v[76:79]
v_mfma_f32_16x16x32_bf16 v[80:83], a[136:139], v[160:163], v[80:83]
v_mfma_f32_16x16x32_bf16 v[84:87], a[120:123], v[164:167], v[84:87]
v_mfma_f32_16x16x32_bf16 v[88:91], a[124:127], v[164:167], v[88:91]
buffer_load_dwordx4 v[148:151], v59, s[12:15], s96 offen sc1
v_mfma_f32_16x16x32_bf16 v[92:95], a[128:131], v[164:167], v[92:95]
v_mfma_f32_16x16x32_bf16 v[96:99], a[132:135], v[164:167], v[96:99]
v_mfma_f32_16x16x32_bf16 v[100:103], a[136:139], v[164:167], v[100:103]
v_mfma_f32_16x16x32_bf16 v[104:107], a[120:123], v[168:171], v[104:107]
v_mfma_f32_16x16x32_bf16 v[108:111], a[124:127], v[168:171], v[108:111]
buffer_load_dwordx4 v[152:155], v60, s[12:15], s96 offen sc1
v_mfma_f32_16x16x32_bf16 v[112:115], a[128:131], v[168:171], v[112:115]
v_mfma_f32_16x16x32_bf16 v[116:119], a[132:135], v[168:171], v[116:119]
v_mfma_f32_16x16x32_bf16 v[120:123], a[136:139], v[168:171], v[120:123]
v_mfma_f32_16x16x32_bf16 v[124:127], a[120:123], v[172:175], v[124:127]
v_mfma_f32_16x16x32_bf16 v[128:131], a[124:127], v[172:175], v[128:131]
buffer_load_dwordx4 v[156:159], v61, s[12:15], s96 offen sc1
v_mfma_f32_16x16x32_bf16 v[132:135], a[128:131], v[172:175], v[132:135]
v_mfma_f32_16x16x32_bf16 v[136:139], a[132:135], v[172:175], v[136:139]
v_mfma_f32_16x16x32_bf16 v[140:143], a[136:139], v[172:175], v[140:143]
s_waitcnt vmcnt(12)
v_mfma_f32_16x16x32_bf16 v[64:67], a[140:143], v[176:179], v[64:67]
v_mfma_f32_16x16x32_bf16 v[68:71], a[144:147], v[176:179], v[68:71]
buffer_load_dwordx4 v[160:163], v58, s[12:15], s97 offen sc1
v_mfma_f32_16x16x32_bf16 v[72:75], a[148:151], v[176:179], v[72:75]
v_mfma_f32_16x16x32_bf16 v[76:79], a[152:155], v[176:179], v[76:79]
v_mfma_f32_16x16x32_bf16 v[80:83], a[156:159], v[176:179], v[80:83]
v_mfma_f32_16x16x32_bf16 v[84:87], a[140:143], v[180:183], v[84:87]
v_mfma_f32_16x16x32_bf16 v[88:91], a[144:147], v[180:183], v[88:91]
buffer_load_dwordx4 v[164:167], v59, s[12:15], s97 offen sc1
v_mfma_f32_16x16x32_bf16 v[92:95], a[148:151], v[180:183], v[92:95]
v_mfma_f32_16x16x32_bf16 v[96:99], a[152:155], v[180:183], v[96:99]
v_mfma_f32_16x16x32_bf16 v[100:103], a[156:159], v[180:183], v[100:103]
v_mfma_f32_16x16x32_bf16 v[104:107], a[140:143], v[184:187], v[104:107]
v_mfma_f32_16x16x32_bf16 v[108:111], a[144:147], v[184:187], v[108:111]
buffer_load_dwordx4 v[168:171], v60, s[12:15], s97 offen sc1
v_mfma_f32_16x16x32_bf16 v[112:115], a[148:151], v[184:187], v[112:115]
v_mfma_f32_16x16x32_bf16 v[116:119], a[152:155], v[184:187], v[116:119]
v_mfma_f32_16x16x32_bf16 v[120:123], a[156:159], v[184:187], v[120:123]
v_mfma_f32_16x16x32_bf16 v[124:127], a[140:143], v[188:191], v[124:127]
v_mfma_f32_16x16x32_bf16 v[128:131], a[144:147], v[188:191], v[128:131]
buffer_load_dwordx4 v[172:175], v61, s[12:15], s97 offen sc1
v_mfma_f32_16x16x32_bf16 v[132:135], a[148:151], v[188:191], v[132:135]
v_mfma_f32_16x16x32_bf16 v[136:139], a[152:155], v[188:191], v[136:139]
v_mfma_f32_16x16x32_bf16 v[140:143], a[156:159], v[188:191], v[140:143]
s_waitcnt vmcnt(12)
v_mfma_f32_16x16x32_bf16 v[64:67], a[160:163], v[192:195], v[64:67]
v_mfma_f32_16x16x32_bf16 v[68:71], a[164:167], v[192:195], v[68:71]
buffer_load_dwordx4 v[176:179], v58, s[12:15], s98 offen sc1
v_mfma_f32_16x16x32_bf16 v[72:75], a[168:171], v[192:195], v[72:75]
v_mfma_f32_16x16x32_bf16 v[76:79], a[172:175], v[192:195], v[76:79]
v_mfma_f32_16x16x32_bf16 v[80:83], a[176:179], v[192:195], v[80:83]
v_mfma_f32_16x16x32_bf16 v[84:87], a[160:163], v[196:199], v[84:87]
v_mfma_f32_16x16x32_bf16 v[88:91], a[164:167], v[196:199], v[88:91]
buffer_load_dwordx4 v[180:183], v59, s[12:15], s98 offen sc1
v_mfma_f32_16x16x32_bf16 v[92:95], a[168:171], v[196:199], v[92:95]
v_mfma_f32_16x16x32_bf16 v[96:99], a[172:175], v[196:199], v[96:99]
v_mfma_f32_16x16x32_bf16 v[100:103], a[176:179], v[196:199], v[100:103]
v_mfma_f32_16x16x32_bf16 v[104:107], a[160:163], v[200:203], v[104:107]
s_mul_i32 s101, s26, 5120
s_add_u32 s101, s101, 16973824
v_min_u32 v13, 39, v1
v_lshl_add_u32 v13, v13, 7, s101
buffer_load_dwordx2 v[14:15], v13, s[12:15], 0 offen sc1
v_mfma_f32_16x16x32_bf16 v[108:111], a[164:167], v[200:203], v[108:111]
buffer_load_dwordx4 v[184:187], v60, s[12:15], s98 offen sc1
v_mfma_f32_16x16x32_bf16 v[112:115], a[168:171], v[200:203], v[112:115]
v_mfma_f32_16x16x32_bf16 v[116:119], a[172:175], v[200:203], v[116:119]
v_mfma_f32_16x16x32_bf16 v[120:123], a[176:179], v[200:203], v[120:123]
v_mfma_f32_16x16x32_bf16 v[124:127], a[160:163], v[204:207], v[124:127]
v_mfma_f32_16x16x32_bf16 v[128:131], a[164:167], v[204:207], v[128:131]
buffer_load_dwordx4 v[188:191], v61, s[12:15], s98 offen sc1
v_mfma_f32_16x16x32_bf16 v[132:135], a[168:171], v[204:207], v[132:135]
v_mfma_f32_16x16x32_bf16 v[136:139], a[172:175], v[204:207], v[136:139]
v_mfma_f32_16x16x32_bf16 v[140:143], a[176:179], v[204:207], v[140:143]
s_waitcnt vmcnt(13)
v_mfma_f32_16x16x32_bf16 v[64:67], a[180:183], v[208:211], v[64:67]
v_mfma_f32_16x16x32_bf16 v[68:71], a[184:187], v[208:211], v[68:71]
buffer_load_dwordx4 v[192:195], v58, s[12:15], s99 offen sc1
v_mfma_f32_16x16x32_bf16 v[72:75], a[188:191], v[208:211], v[72:75]
v_mfma_f32_16x16x32_bf16 v[76:79], a[192:195], v[208:211], v[76:79]
v_mfma_f32_16x16x32_bf16 v[80:83], a[196:199], v[208:211], v[80:83]
v_mfma_f32_16x16x32_bf16 v[84:87], a[180:183], v[212:215], v[84:87]
v_mfma_f32_16x16x32_bf16 v[88:91], a[184:187], v[212:215], v[88:91]
buffer_load_dwordx4 v[196:199], v59, s[12:15], s99 offen sc1
v_mfma_f32_16x16x32_bf16 v[92:95], a[188:191], v[212:215], v[92:95]
v_mfma_f32_16x16x32_bf16 v[96:99], a[192:195], v[212:215], v[96:99]
v_mfma_f32_16x16x32_bf16 v[100:103], a[196:199], v[212:215], v[100:103]
v_mfma_f32_16x16x32_bf16 v[104:107], a[180:183], v[216:219], v[104:107]
v_mfma_f32_16x16x32_bf16 v[108:111], a[184:187], v[216:219], v[108:111]
buffer_load_dwordx4 v[200:203], v60, s[12:15], s99 offen sc1
v_mfma_f32_16x16x32_bf16 v[112:115], a[188:191], v[216:219], v[112:115]
v_mfma_f32_16x16x32_bf16 v[116:119], a[192:195], v[216:219], v[116:119]
v_mfma_f32_16x16x32_bf16 v[120:123], a[196:199], v[216:219], v[120:123]
v_mfma_f32_16x16x32_bf16 v[124:127], a[180:183], v[220:223], v[124:127]
v_mfma_f32_16x16x32_bf16 v[128:131], a[184:187], v[220:223], v[128:131]
buffer_load_dwordx4 v[204:207], v61, s[12:15], s99 offen sc1
v_mfma_f32_16x16x32_bf16 v[132:135], a[188:191], v[220:223], v[132:135]
v_mfma_f32_16x16x32_bf16 v[136:139], a[192:195], v[220:223], v[136:139]
v_mfma_f32_16x16x32_bf16 v[140:143], a[196:199], v[220:223], v[140:143]
s_waitcnt vmcnt(13)
v_mfma_f32_16x16x32_bf16 v[64:67], a[200:203], v[144:147], v[64:67]
v_mfma_f32_16x16x32_bf16 v[68:71], a[204:207], v[144:147], v[68:71]
v_mfma_f32_16x16x32_bf16 v[72:75], a[208:211], v[144:147], v[72:75]
v_mfma_f32_16x16x32_bf16 v[76:79], a[212:215], v[144:147], v[76:79]
v_mfma_f32_16x16x32_bf16 v[80:83], a[216:219], v[144:147], v[80:83]
v_mfma_f32_16x16x32_bf16 v[84:87], a[200:203], v[148:151], v[84:87]
v_mfma_f32_16x16x32_bf16 v[88:91], a[204:207], v[148:151], v[88:91]
v_mfma_f32_16x16x32_bf16 v[92:95], a[208:211], v[148:151], v[92:95]
v_mfma_f32_16x16x32_bf16 v[96:99], a[212:215], v[148:151], v[96:99]
v_mfma_f32_16x16x32_bf16 v[100:103], a[216:219], v[148:151], v[100:103]
v_mfma_f32_16x16x32_bf16 v[104:107], a[200:203], v[152:155], v[104:107]
v_mfma_f32_16x16x32_bf16 v[108:111], a[204:207], v[152:155], v[108:111]
v_mfma_f32_16x16x32_bf16 v[112:115], a[208:211], v[152:155], v[112:115]
v_mfma_f32_16x16x32_bf16 v[116:119], a[212:215], v[152:155], v[116:119]
v_mfma_f32_16x16x32_bf16 v[120:123], a[216:219], v[152:155], v[120:123]
v_mfma_f32_16x16x32_bf16 v[124:127], a[200:203], v[156:159], v[124:127]
v_mfma_f32_16x16x32_bf16 v[128:131], a[204:207], v[156:159], v[128:131]
v_mfma_f32_16x16x32_bf16 v[132:135], a[208:211], v[156:159], v[132:135]
v_mfma_f32_16x16x32_bf16 v[136:139], a[212:215], v[156:159], v[136:139]
v_mfma_f32_16x16x32_bf16 v[140:143], a[216:219], v[156:159], v[140:143]
s_waitcnt vmcnt(9)
v_mfma_f32_16x16x32_bf16 v[84:87], a[220:223], v[164:167], v[84:87]
v_mfma_f32_16x16x32_bf16 v[88:91], a[224:227], v[164:167], v[88:91]
s_waitcnt vmcnt(6)
v_cmp_ne_u64 vcc, v[14:15], s[20:21]
v_mfma_f32_16x16x32_bf16 v[92:95], a[228:231], v[164:167], v[92:95]
s_cbranch_vccnz slow13
back14:
v_mfma_f32_16x16x32_bf16 v[96:99], a[232:235], v[164:167], v[96:99]
s_lshl_b32 s101, s25, 2
s_add_u32 s101, s101, s3
v_mfma_f32_16x16x32_bf16 v[100:103], a[236:239], v[164:167], v[100:103]
s_mul_i32 s51, s101, 20480
s_lshl_b32 s52, s101, 6
s_waitcnt vmcnt(4)
s_mul_i32 s101, s26, 2560
s_add_u32 s51, s51, s101
v_mfma_f32_16x16x32_bf16 v[84:87], a[240:243], v[180:183], v[84:87]
s_add_u32 s51, s51, 13631488
s_add_u32 s52, s52, 16777216
v_mfma_f32_16x16x32_bf16 v[88:91], a[244:247], v[180:183], v[88:91]
v_cmp_gt_u32 vcc, 32, v1
v_mov_b32 v12, 2146435072
v_mfma_f32_16x16x32_bf16 v[92:95], a[248:251], v[180:183], v[92:95]
v_lshlrev_b32 v13, 2, v2
v_cndmask_b32 v12, v12, v56, vcc
v_mfma_f32_16x16x32_bf16 v[96:99], a[252:255], v[180:183], v[96:99]
buffer_load_dwordx4 v[208:211], v56, s[12:15], s51 offen sc1
buffer_load_dwordx4 v[212:215], v56, s[12:15], s51 offen offset:1024 sc1
v_mfma_f32_16x16x32_bf16 v[100:103], v[232:235], v[180:183], v[100:103]
buffer_load_dwordx4 v[216:219], v12, s[12:15], s51 offen offset:2048 sc1
buffer_load_dword v62, v13, s[12:15], s52 offen sc1
s_waitcnt vmcnt(4)
s_lshl_b32 s101, s25, 2
s_add_u32 s101, s101, s3
v_mfma_f32_16x16x32_bf16 v[84:87], v[236:239], v[196:199], v[84:87]
s_mul_i32 s51, s101, 20480
s_mul_i32 s101, s26, 160
v_mfma_f32_16x16x32_bf16 v[88:91], v[240:243], v[196:199], v[88:91]
s_add_u32 s51, s51, s101
v_mfma_f32_16x16x32_bf16 v[92:95], v[244:247], v[196:199], v[92:95]
v_mfma_f32_16x16x32_bf16 v[96:99], v[248:251], v[196:199], v[96:99]
v_mfma_f32_16x16x32_bf16 v[100:103], v[252:255], v[196:199], v[100:103]
v_mfma_f32_16x16x32_bf16 v[104:107], a[220:223], v[168:171], v[104:107]
v_mfma_f32_16x16x32_bf16 v[108:111], a[224:227], v[168:171], v[108:111]
v_mfma_f32_16x16x32_bf16 v[112:115], a[228:231], v[168:171], v[112:115]
ds_write_b128 v25, v[84:87] offset:0
v_mfma_f32_16x16x32_bf16 v[116:119], a[232:235], v[168:171], v[116:119]
v_mfma_f32_16x16x32_bf16 v[120:123], a[236:239], v[168:171], v[120:123]
v_mfma_f32_16x16x32_bf16 v[104:107], a[240:243], v[184:187], v[104:107]
ds_write_b128 v25, v[88:91] offset:1024
v_mfma_f32_16x16x32_bf16 v[108:111], a[244:247], v[184:187], v[108:111]
v_mfma_f32_16x16x32_bf16 v[112:115], a[248:251], v[184:187], v[112:115]
v_mfma_f32_16x16x32_bf16 v[116:119], a[252:255], v[184:187], v[116:119]
ds_write_b128 v25, v[92:95] offset:2048
v_mfma_f32_16x16x32_bf16 v[120:123], v[232:235], v[184:187], v[120:123]
v_mfma_f32_16x16x32_bf16 v[104:107], v[236:239], v[200:203], v[104:107]
v_mfma_f32_16x16x32_bf16 v[108:111], v[240:243], v[200:203], v[108:111]
ds_write_b128 v25, v[96:99] offset:3072
v_mfma_f32_16x16x32_bf16 v[112:115], v[244:247], v[200:203], v[112:115]
v_mfma_f32_16x16x32_bf16 v[116:119], v[248:251], v[200:203], v[116:119]
v_mfma_f32_16x16x32_bf16 v[120:123], v[252:255], v[200:203], v[120:123]
ds_write_b128 v25, v[100:103] offset:4096
v_mfma_f32_16x16x32_bf16 v[124:127], a[220:223], v[172:175], v[124:127]
v_mfma_f32_16x16x32_bf16 v[128:131], a[224:227], v[172:175], v[128:131]
v_mfma_f32_16x16x32_bf16 v[132:135], a[228:231], v[172:175], v[132:135]
ds_write_b128 v26, v[104:107] offset:0
v_mfma_f32_16x16x32_bf16 v[136:139], a[232:235], v[172:175], v[136:139]
v_mfma_f32_16x16x32_bf16 v[140:143], a[236:239], v[172:175], v[140:143]
v_mfma_f32_16x16x32_bf16 v[124:127], a[240:243], v[188:191], v[124:127]
ds_write_b128 v26, v[108:111] offset:1024
v_mfma_f32_16x16x32_bf16 v[128:131], a[244:247], v[188:191], v[128:131]
v_mfma_f32_16x16x32_bf16 v[132:135], a[248:251], v[188:191], v[132:135]
v_mfma_f32_16x16x32_bf16 v[136:139], a[252:255], v[188:191], v[136:139]
ds_write_b128 v26, v[112:115] offset:2048
v_mfma_f32_16x16x32_bf16 v[140:143], v[232:235], v[188:191], v[140:143]
v_mfma_f32_16x16x32_bf16 v[124:127], v[236:239], v[204:207], v[124:127]
v_mfma_f32_16x16x32_bf16 v[128:131], v[240:243], v[204:207], v[128:131]
ds_write_b128 v26, v[116:119] offset:3072
v_mfma_f32_16x16x32_bf16 v[132:135], v[244:247], v[204:207], v[132:135]
v_mfma_f32_16x16x32_bf16 v[136:139], v[248:251], v[204:207], v[136:139]
v_mfma_f32_16x16x32_bf16 v[140:143], v[252:255], v[204:207], v[140:143]
ds_write_b128 v26, v[120:123] offset:4096
v_mfma_f32_16x16x32_bf16 v[64:67], a[220:223], v[160:163], v[64:67]
v_mfma_f32_16x16x32_bf16 v[68:71], a[224:227], v[160:163], v[68:71]
v_mfma_f32_16x16x32_bf16 v[72:75], a[228:231], v[160:163], v[72:75]
ds_write_b128 v27, v[124:127] offset:0
v_mfma_f32_16x16x32_bf16 v[76:79], a[232:235], v[160:163], v[76:79]
v_mfma_f32_16x16x32_bf16 v[80:83], a[236:239], v[160:163], v[80:83]
v_mfma_f32_16x16x32_bf16 v[64:67], a[240:243], v[176:179], v[64:67]
ds_write_b128 v27, v[128:131] offset:1024
v_mfma_f32_16x16x32_bf16 v[68:71], a[244:247], v[176:179], v[68:71]
v_mfma_f32_16x16x32_bf16 v[72:75], a[248:251], v[176:179], v[72:75]
v_mfma_f32_16x16x32_bf16 v[76:79], a[252:255], v[176:179], v[76:79]
ds_write_b128 v27, v[132:135] offset:2048
v_mfma_f32_16x16x32_bf16 v[80:83], v[232:235], v[176:179], v[80:83]
v_mfma_f32_16x16x32_bf16 v[64:67], v[236:239], v[192:195], v[64:67]
v_mfma_f32_16x16x32_bf16 v[68:71], v[240:243], v[192:195], v[68:71]
ds_write_b128 v27, v[136:139] offset:3072
v_mfma_f32_16x16x32_bf16 v[72:75], v[244:247], v[192:195], v[72:75]
v_mfma_f32_16x16x32_bf16 v[76:79], v[248:251], v[192:195], v[76:79]
v_mfma_f32_16x16x32_bf16 v[80:83], v[252:255], v[192:195], v[80:83]
ds_write_b128 v27, v[140:143] offset:4096
s_waitcnt vmcnt(0)
ds_write_b128 v28, v[208:211] offset:0
ds_write_b128 v28, v[212:215] offset:1024
ds_write_b128 v28, v[216:219] offset:2048
s_waitcnt lgkmcnt(0)
s_barrier
ds_read_b64_tr_b16 v[36:37], v29 offset:0
ds_read_b128 v[84:87], v24 offset:0
ds_read_b128 v[104:107], v24 offset:5120
ds_read_b128 v[124:127], v24 offset:10240
ds_read_b64_tr_b16 v[38:39], v29 offset:512
ds_read_b128 v[88:91], v24 offset:1024
ds_read_b128 v[108:111], v24 offset:6144
ds_read_b128 v[128:131], v24 offset:11264
ds_read_b64_tr_b16 v[40:41], v29 offset:1024
ds_read_b128 v[92:95], v24 offset:2048
ds_read_b128 v[112:115], v24 offset:7168
ds_read_b128 v[132:135], v24 offset:12288
ds_read_b64_tr_b16 v[42:43], v29 offset:1536
ds_read_b128 v[96:99], v24 offset:3072
ds_read_b128 v[116:119], v24 offset:8192
ds_read_b128 v[136:139], v24 offset:13312
ds_read_b64_tr_b16 v[44:45], v29 offset:2048
ds_read_b128 v[100:103], v24 offset:4096
ds_read_b128 v[120:123], v24 offset:9216
ds_read_b128 v[140:143], v24 offset:14336
s_waitcnt lgkmcnt(15)
v_pk_add_f32 v[64:65], v[64:65], v[84:85]
v_pk_add_f32 v[66:67], v[66:67], v[86:87]
v_pk_add_f32 v[64:65], v[64:65], v[104:105]
v_pk_add_f32 v[66:67], v[66:67], v[106:107]
v_pk_add_f32 v[64:65], v[64:65], v[124:125]
v_pk_add_f32 v[66:67], v[66:67], v[126:127]
v_lshlrev_b32 v48, 16, v36
v_and_b32 v49, 0xffff0000, v36
v_lshlrev_b32 v50, 16, v37
v_and_b32 v51, 0xffff0000, v37
v_pk_add_f32 v[48:49], v[48:49], v[64:65] neg_lo:[0,1] neg_hi:[0,1]
v_pk_add_f32 v[50:51], v[50:51], v[66:67] neg_lo:[0,1] neg_hi:[0,1]
v_pk_fma_f32 v[64:65], v[48:49], v[62:63], v[64:65] op_sel_hi:[1,0,1]
v_pk_fma_f32 v[66:67], v[50:51], v[62:63], v[66:67] op_sel_hi:[1,0,1]
v_cvt_pk_bf16_f32 v52, v64, v65
v_cvt_pk_bf16_f32 v53, v66, v67
ds_write_b64 v30, v[52:53] offset:0
s_waitcnt lgkmcnt(13)
v_pk_add_f32 v[68:69], v[68:69], v[88:89]
v_pk_add_f32 v[70:71], v[70:71], v[90:91]
v_pk_add_f32 v[68:69], v[68:69], v[108:109]
v_pk_add_f32 v[70:71], v[70:71], v[110:111]
v_pk_add_f32 v[68:69], v[68:69], v[128:129]
v_pk_add_f32 v[70:71], v[70:71], v[130:131]
v_lshlrev_b32 v48, 16, v38
v_and_b32 v49, 0xffff0000, v38
v_lshlrev_b32 v50, 16, v39
v_and_b32 v51, 0xffff0000, v39
v_pk_add_f32 v[48:49], v[48:49], v[68:69] neg_lo:[0,1] neg_hi:[0,1]
v_pk_add_f32 v[50:51], v[50:51], v[70:71] neg_lo:[0,1] neg_hi:[0,1]
v_pk_fma_f32 v[68:69], v[48:49], v[62:63], v[68:69] op_sel_hi:[1,0,1]
v_pk_fma_f32 v[70:71], v[50:51], v[62:63], v[70:71] op_sel_hi:[1,0,1]
v_cvt_pk_bf16_f32 v54, v68, v69
v_cvt_pk_bf16_f32 v55, v70, v71
ds_write_b64 v30, v[54:55] offset:32
s_waitcnt lgkmcnt(10)
v_pk_add_f32 v[72:73], v[72:73], v[92:93]
v_pk_add_f32 v[74:75], v[74:75], v[94:95]
v_pk_add_f32 v[72:73], v[72:73], v[112:113]
v_pk_add_f32 v[74:75], v[74:75], v[114:115]
v_pk_add_f32 v[72:73], v[72:73], v[132:133]
v_pk_add_f32 v[74:75], v[74:75], v[134:135]
v_lshlrev_b32 v48, 16, v40
v_and_b32 v49, 0xffff0000, v40
v_lshlrev_b32 v50, 16, v41
v_and_b32 v51, 0xffff0000, v41
v_pk_add_f32 v[48:49], v[48:49], v[72:73] neg_lo:[0,1] neg_hi:[0,1]
v_pk_add_f32 v[50:51], v[50:51], v[74:75] neg_lo:[0,1] neg_hi:[0,1]
v_pk_fma_f32 v[72:73], v[48:49], v[62:63], v[72:73] op_sel_hi:[1,0,1]
v_pk_fma_f32 v[74:75], v[50:51], v[62:63], v[74:75] op_sel_hi:[1,0,1]
v_cvt_pk_bf16_f32 v52, v72, v73
v_cvt_pk_bf16_f32 v53, v74, v75
ds_write_b64 v30, v[52:53] offset:64
s_waitcnt lgkmcnt(7)
v_pk_add_f32 v[76:77], v[76:77], v[96:97]
v_pk_add_f32 v[78:79], v[78:79], v[98:99]
v_pk_add_f32 v[76:77], v[76:77], v[116:117]
v_pk_add_f32 v[78:79], v[78:79], v[118:119]
v_pk_add_f32 v[76:77], v[76:77], v[136:137]
v_pk_add_f32 v[78:79], v[78:79], v[138:139]
v_lshlrev_b32 v48, 16, v42
v_and_b32 v49, 0xffff0000, v42
v_lshlrev_b32 v50, 16, v43
v_and_b32 v51, 0xffff0000, v43
v_pk_add_f32 v[48:49], v[48:49], v[76:77] neg_lo:[0,1] neg_hi:[0,1]
v_pk_add_f32 v[50:51], v[50:51], v[78:79] neg_lo:[0,1] neg_hi:[0,1]
v_pk_fma_f32 v[76:77], v[48:49], v[62:63], v[76:77] op_sel_hi:[1,0,1]
v_pk_fma_f32 v[78:79], v[50:51], v[62:63], v[78:79] op_sel_hi:[1,0,1]
v_cvt_pk_bf16_f32 v54, v76, v77
v_cvt_pk_bf16_f32 v55, v78, v79
ds_write_b64 v30, v[54:55] offset:96
s_waitcnt lgkmcnt(4)
v_pk_add_f32 v[80:81], v[80:81], v[100:101]
v_pk_add_f32 v[82:83], v[82:83], v[102:103]
v_pk_add_f32 v[80:81], v[80:81], v[120:121]
v_pk_add_f32 v[82:83], v[82:83], v[122:123]
v_pk_add_f32 v[80:81], v[80:81], v[140:141]
v_pk_add_f32 v[82:83], v[82:83], v[142:143]
v_lshlrev_b32 v48, 16, v44
v_and_b32 v49, 0xffff0000, v44
v_lshlrev_b32 v50, 16, v45
v_and_b32 v51, 0xffff0000, v45
v_pk_add_f32 v[48:49], v[48:49], v[80:81] neg_lo:[0,1] neg_hi:[0,1]
v_pk_add_f32 v[50:51], v[50:51], v[82:83] neg_lo:[0,1] neg_hi:[0,1]
v_pk_fma_f32 v[80:81], v[48:49], v[62:63], v[80:81] op_sel_hi:[1,0,1]
v_pk_fma_f32 v[82:83], v[50:51], v[62:63], v[82:83] op_sel_hi:[1,0,1]
v_cvt_pk_bf16_f32 v52, v80, v81
v_cvt_pk_bf16_f32 v53, v82, v83
ds_write_b64 v30, v[52:53] offset:128
ds_read_b128 v[96:99], v16
ds_read_b128 v[100:103], v17
ds_read_b128 v[104:107], v18
s_waitcnt lgkmcnt(2)
buffer_store_dwordx4 v[96:99], v20, s[16:19], s51 offen
s_waitcnt lgkmcnt(1)
buffer_store_dwordx4 v[100:103], v21, s[16:19], s51 offen
s_waitcnt lgkmcnt(0)
buffer_store_dwordx4 v[104:107], v22, s[16:19], s51 offen
s_endpgm
slow3:
s_mov_b32 s100, 0
v_mov_b32 v13, 0
slow3l:
global_load_dwordx2 v[10:11], v13, s[68:69] sc1
s_add_u32 s100, s100, 1
s_waitcnt vmcnt(0)
v_readfirstlane_b32 s21, v11
v_readfirstlane_b32 s20, v10
s_cmp_ge_u32 s100, 0x8000
s_cbranch_scc1 slow3x
s_cmp_eq_u32 s21, 0
s_cbranch_scc1 slow3l
slow3x:
s_nop 4
s_branch back4
slow7:
s_mov_b32 s100, 0
slow7l:
buffer_load_dwordx2 v[226:227], v12, s[12:15], 0 offen sc1
s_add_u32 s100, s100, 1
s_cmp_ge_u32 s100, 0x8000
s_cbranch_scc1 slow7x
s_waitcnt vmcnt(0)
v_cmp_ne_u64 vcc, v[226:227], s[20:21]
s_cbranch_vccnz slow7l
slow7x:
s_waitcnt vmcnt(0)
s_branch back8
slow9:
s_mov_b32 s100, 0
slow9l:
buffer_load_dwordx2 v[14:15], v13, s[12:15], 0 offen sc1
s_add_u32 s100, s100, 1
s_cmp_ge_u32 s100, 0x8000
s_cbranch_scc1 slow9x
s_waitcnt vmcnt(0)
v_cmp_ne_u64 vcc, v[14:15], s[20:21]
s_cbranch_vccnz slow9l
slow9x:
s_waitcnt vmcnt(0)
s_branch back10
slow11:
s_mov_b32 s100, 0
slow11l:
buffer_load_dwordx2 v[14:15], v13, s[12:15], 0 offen sc1
s_add_u32 s100, s100, 1
s_cmp_ge_u32 s100, 0x8000
s_cbranch_scc1 slow11x
s_waitcnt vmcnt(0)
v_cmp_ne_u64 vcc, v[14:15], s[20:21]
s_cbranch_vccnz slow11l
slow11x:
s_waitcnt vmcnt(0)
buffer_load_dwordx4 v[144:147], v58, s[12:15], s86 offen sc1
buffer_load_dwordx4 v[148:151], v59, s[12:15], s86 offen sc1
buffer_load_dwordx4 v[152:155], v60, s[12:15], s86 offen sc1
buffer_load_dwordx4 v[156:159], v61, s[12:15], s86 offen sc1
buffer_load_dwordx4 v[160:163], v58, s[12:15], s87 offen sc1
buffer_load_dwordx4 v[164:167], v59, s[12:15], s87 offen sc1
buffer_load_dwordx4 v[168:171], v60, s[12:15], s87 offen sc1
buffer_load_dwordx4 v[172:175], v61, s[12:15], s87 offen sc1
buffer_load_dwordx4 v[176:179], v58, s[12:15], s88 offen sc1
buffer_load_dwordx4 v[180:183], v59, s[12:15], s88 offen sc1
buffer_load_dwordx4 v[184:187], v60, s[12:15], s88 offen sc1
buffer_load_dwordx4 v[188:191], v61, s[12:15], s88 offen sc1
buffer_load_dwordx4 v[192:195], v58, s[12:15], s89 offen sc1
buffer_load_dwordx4 v[196:199], v59, s[12:15], s89 offen sc1
buffer_load_dwordx4 v[200:203], v60, s[12:15], s89 offen sc1
buffer_load_dwordx4 v[204:207], v61, s[12:15], s89 offen sc1
v_mov_b32 v12, 2146435072
buffer_load_dword v229, v12, s[12:15], 0 offen
buffer_load_dword v229, v12, s[12:15], 0 offen
s_branch back12
slow13:
s_mov_b32 s100, 0
slow13l:
buffer_load_dwordx2 v[14:15], v13, s[12:15], 0 offen sc1
s_add_u32 s100, s100, 1
s_cmp_ge_u32 s100, 0x8000
s_cbranch_scc1 slow13x
s_waitcnt vmcnt(0)
v_cmp_ne_u64 vcc, v[14:15], s[20:21]
s_cbranch_vccnz slow13l
slow13x:
s_waitcnt vmcnt(0)
s_branch back14
L_A_end:
L_B:
s_getpc_b64 s[20:21]
pc15:
v_lshlrev_b32 v4, 7, v0
v_min_u32 v4, L_B_end-pc15-4, v4
global_load_dword v229, v4, s[20:21]
s_mul_i32 s101, s29, 6
s_add_u32 s101, s101, s31
s_sub_u32 s101, s101, 24
s_lshr_b32 s23, s101, 2
s_and_b32 s101, s101, 3
s_lshl_b32 s22, s28, 2
s_add_u32 s22, s22, s101
s_mul_i32 s24, s30, 6
s_add_u32 s24, s24, s31
s_lshl_b32 s24, s24, 1
s_add_u32 s24, s24, 144
s_add_u32 s101, s22, s23
s_mul_i32 s101, s101, 3
s_add_u32 s101, s101, 6
s_mul_i32 s100, s101, 6554
s_lshr_b32 s100, s100, 16
s_mul_i32 s100, s100, 10
s_sub_u32 s27, s101, s100
s_lshl_b32 s101, s24, 9
v_lshlrev_b32 v5, 1, v0
v_add_u32 v12, s101, v5
s_lshl_b32 s101, s24, 2
s_waitcnt lgkmcnt(0)
global_load_ushort v36, v12, s[38:39]
global_load_ushort v37, v12, s[40:41]
global_load_ushort v38, v12, s[42:43]
global_load_ushort v39, v12, s[44:45]
global_load_ushort v40, v12, s[46:47]
global_load_ushort v41, v12, s[48:49]
global_load_ushort v4, v12, s[38:39] offset:512
global_load_ushort v5, v12, s[40:41] offset:512
global_load_ushort v6, v12, s[42:43] offset:512
global_load_ushort v7, v12, s[44:45] offset:512
global_load_ushort v8, v12, s[46:47] offset:512
global_load_ushort v9, v12, s[48:49] offset:512
s_add_u32 s50, s50, s101
s_addc_u32 s51, s51, 0
s_add_u32 s52, s52, s101
s_addc_u32 s53, s53, 0
s_load_dwordx2 s[0:1], s[50:51], 0
s_load_dwordx2 s[54:55], s[52:53], 0
s_mov_b32 s12, s70
s_mov_b32 s13, s71
s_mov_b32 s14, 33554432
s_mov_b32 s15, 0x20000
s_mov_b32 s4, s36
s_mov_b32 s5, s37
s_mov_b32 s6, 2621440
s_mov_b32 s7, 0x20000
s_mov_b32 s8, s56
s_mov_b32 s9, s57
s_mov_b32 s10, 2211840
s_mov_b32 s11, 0x20000
s_lshl_b32 s28, s27, 7
s_mul_i32 s29, s27, 221184
s_lshl_b32 s47, s3, 12
s_add_u32 s47, s47, 32768
s_lshl_b32 s48, s3, 11
s_add_u32 s48, s48, 49152
s_lshl_b32 s101, s22, 2
s_add_u32 s101, s101, s3
s_mul_i32 s101, s101, 40960
v_lshrrev_b32 v64, 3, v1
v_and_b32 v65, 7, v1
v_xor_b32 v66, v64, v65
v_mul_u32_u24 v67, 1280, v64
v_lshl_add_u32 v67, v66, 4, v67
v_add_u32 v16, s101, v67
v_add_u32 v17, 9216, v16
v_add_u32 v18, 18432, v16
v_add_u32 v19, 27648, v16
s_mul_i32 s101, s3, 55296
s_lshl_b32 s100, s23, 7
s_add_u32 s101, s101, s100
s_add_u32 s101, s101, 3072
v_mul_u32_u24 v67, 3456, v64
v_and_b32 v64, 1, v1
v_lshl_add_u32 v67, v64, 4, v67
v_add_u32 v67, s101, v67
v_lshrrev_b32 v65, 1, v65
v_and_b32 v64, 1, v3
v_xor_b32 v65, v65, v64
v_xor_b32 v66, 2, v65
v_lshl_add_u32 v20, v65, 5, v67
v_lshl_add_u32 v21, v66, 5, v67
v_add_u32 v21, 26624, v21
s_mov_b32 s36, s27
s_mov_b32 s37, s31
s_add_u32 m0, s47, 0
s_nop 0
buffer_load_dwordx4 v16, s[4:7], s28 offen offset:0 lds
buffer_load_dwordx4 v17, s[4:7], s28 offen offset:1024 lds
buffer_load_dwordx4 v18, s[4:7], s28 offen offset:2048 lds
buffer_load_dwordx4 v19, s[4:7], s28 offen offset:3072 lds
v_mov_b32 v13, 0
global_load_dwordx2 v[10:11], v13, s[68:69] sc1
s_lshl_b32 s101, s23, 7
s_and_b32 s100, s3, 1
s_lshl_b32 s100, s100, 6
s_add_u32 s101, s101, s100
s_add_u32 s101, s101, 3072
v_lshl_add_u32 v42, v3, 3, s101
v_cmp_eq_u32 vcc, 0, v0
v_mov_b32 v63, 2146435072
v_lshlrev_b32 v56, 4, v1
v_cndmask_b32 v63, v63, 0, vcc
v_add_u32 v57, 4096, v56
s_xor_b32 s101, s3, 0
s_lshl_b32 s101, s101, 10
v_add_u32 v58, s101, v56
s_xor_b32 s101, s3, 1
s_lshl_b32 s101, s101, 10
v_add_u32 v59, s101, v56
s_xor_b32 s101, s3, 2
s_lshl_b32 s101, s101, 10
v_add_u32 v60, s101, v56
s_xor_b32 s101, s3, 3
s_lshl_b32 s101, s101, 10
v_add_u32 v61, s101, v56
s_and_b32 s42, s37, 3
s_mul_i32 s42, s42, 3
s_lshr_b32 s43, s37, 2
s_mul_i32 s43, s43, 5
s_add_u32 s42, s42, s43
s_mul_i32 s43, s42, 5042
s_lshr_b32 s43, s43, 16
s_mul_i32 s43, s43, 13
s_sub_u32 s42, s42, s43
s_mul_i32 s43, s3, 14
s_cmp_eq_u32 s3, 3
s_cselect_b32 s44, 1, 0
s_sub_u32 s43, s43, s44
s_cmp_lt_u32 s3, 2
s_cselect_b32 s44, 14, 13
s_add_u32 s44, s44, s43
s_add_u32 s42, s42, s43
s_mul_i32 s45, s26, 276480
s_add_u32 s45, s45, 7340032
s_mul_i32 s46, s25, 221184
s_mul_i32 s72, s42, 5120
s_add_u32 s72, s72, s45
s_lshl_b32 s86, s42, 12
s_add_u32 s86, s86, s46
s_add_u32 s42, s42, 1
s_cmp_eq_u32 s42, s44
s_cselect_b32 s42, s43, s42
s_mul_i32 s73, s42, 5120
s_add_u32 s73, s73, s45
s_lshl_b32 s87, s42, 12
s_add_u32 s87, s87, s46
s_add_u32 s42, s42, 1
s_cmp_eq_u32 s42, s44
s_cselect_b32 s42, s43, s42
s_mul_i32 s74, s42, 5120
s_add_u32 s74, s74, s45
s_lshl_b32 s88, s42, 12
s_add_u32 s88, s88, s46
s_add_u32 s42, s42, 1
s_cmp_eq_u32 s42, s44
s_cselect_b32 s42, s43, s42
s_mul_i32 s75, s42, 5120
s_add_u32 s75, s75, s45
s_lshl_b32 s89, s42, 12
s_add_u32 s89, s89, s46
s_add_u32 s42, s42, 1
s_cmp_eq_u32 s42, s44
s_cselect_b32 s42, s43, s42
s_mul_i32 s76, s42, 5120
s_add_u32 s76, s76, s45
s_lshl_b32 s90, s42, 12
s_add_u32 s90, s90, s46
s_add_u32 s42, s42, 1
s_cmp_eq_u32 s42, s44
s_cselect_b32 s42, s43, s42
s_mul_i32 s77, s42, 5120
s_add_u32 s77, s77, s45
s_lshl_b32 s91, s42, 12
s_add_u32 s91, s91, s46
s_add_u32 s42, s42, 1
s_cmp_eq_u32 s42, s44
s_cselect_b32 s42, s43, s42
s_mul_i32 s78, s42, 5120
s_add_u32 s78, s78, s45
s_lshl_b32 s92, s42, 12
s_add_u32 s92, s92, s46
s_add_u32 s42, s42, 1
s_cmp_eq_u32 s42, s44
s_cselect_b32 s42, s43, s42
s_mul_i32 s79, s42, 5120
s_add_u32 s79, s79, s45
s_lshl_b32 s93, s42, 12
s_add_u32 s93, s93, s46
s_add_u32 s42, s42, 1
s_cmp_eq_u32 s42, s44
s_cselect_b32 s42, s43, s42
s_mul_i32 s80, s42, 5120
s_add_u32 s80, s80, s45
s_lshl_b32 s94, s42, 12
s_add_u32 s94, s94, s46
s_add_u32 s42, s42, 1
s_cmp_eq_u32 s42, s44
s_cselect_b32 s42, s43, s42
s_mul_i32 s81, s42, 5120
s_add_u32 s81, s81, s45
s_lshl_b32 s95, s42, 12
s_add_u32 s95, s95, s46
s_add_u32 s42, s42, 1
s_cmp_eq_u32 s42, s44
s_cselect_b32 s42, s43, s42
s_mul_i32 s82, s42, 5120
s_add_u32 s82, s82, s45
s_lshl_b32 s96, s42, 12
s_add_u32 s96, s96, s46
s_add_u32 s42, s42, 1
s_cmp_eq_u32 s42, s44
s_cselect_b32 s42, s43, s42
s_mul_i32 s83, s42, 5120
s_add_u32 s83, s83, s45
s_lshl_b32 s97, s42, 12
s_add_u32 s97, s97, s46
s_add_u32 s42, s42, 1
s_cmp_eq_u32 s42, s44
s_cselect_b32 s42, s43, s42
s_mul_i32 s84, s42, 5120
s_add_u32 s84, s84, s45
s_lshl_b32 s98, s42, 12
s_add_u32 s98, s98, s46
s_add_u32 s42, s42, 1
s_cmp_eq_u32 s42, s44
s_cselect_b32 s42, s43, s42
s_mul_i32 s85, s42, 5120
s_add_u32 s85, s85, s45
s_lshl_b32 s99, s42, 12
s_add_u32 s99, s99, s46
s_cmp_lt_u32 s3, 2
s_cselect_b32 s85, s85, 2146435072
s_cselect_b32 s99, s99, 2146435072
s_waitcnt lgkmcnt(0)
s_lshr_b32 s101, s3, 1
s_lshl_b32 s101, s101, 4
s_lshr_b32 s0, s0, s101
s_lshl_b32 s0, s0, 16
s_lshr_b32 s54, s54, s101
s_lshl_b32 s54, s54, 16
v_mov_b32 v122, 0x3fb8aa3b
v_mul_f32 v122, s0, v122
s_mul_i32 s101, s3, 4608
v_exp_f32 v122, v122
s_add_u32 s101, s101, 12288
v_lshl_add_u32 v188, v1, 2, s101
v_cvt_pk_bf16_f32 v122, v122, v122
v_mul_u32_u24 v189, 288, v2
v_lshlrev_b32 v122, 16, v122
v_lshl_add_u32 v189, v3, 4, v189
v_add_u32 v189, s101, v189
s_waitcnt vmcnt(11)
s_waitcnt vmcnt(5)
v_lshlrev_b32 v36, 16, v36
v_lshlrev_b32 v37, 16, v37
v_lshlrev_b32 v38, 16, v38
v_lshlrev_b32 v39, 16, v39
v_lshlrev_b32 v40, 16, v40
v_lshlrev_b32 v41, 16, v41
v_mul_f32 v120, v122, v36
s_add_u32 m0, s48, 0
s_nop 0
buffer_load_dwordx4 v20, s[8:11], s29 offen offset:0 lds
v_mul_f32 v121, v122, v37
v_mul_f32 v120, 0x3fb8aa3b, v120
v_mul_f32 v121, 0x3e22f983, v121
v_mul_f32 v123, 0x41000000, v120
v_mul_f32 v124, 0xc1000000, v121
v_exp_f32 v123, v123
v_fract_f32 v124, v124
v_mul_f32 v38, v122, v38
v_cos_f32 v116, v124
v_sin_f32 v117, v124
v_mul_f32 v39, v122, v39
v_pk_mul_f32 v[116:117], v[116:117], v[122:123] op_sel:[0,1] op_sel_hi:[1,1]
v_mul_f32 v112, v40, v38
v_mul_f32 v113, v40, v39
v_fma_f32 v112, -v41, v39, v112
v_fma_f32 v113, -v41, v38, -v113
v_cvt_pk_bf16_f32 v128, v112, v113
v_pk_mul_f32 v[114:115], v[112:113], v[116:117] op_sel:[0,0] op_sel_hi:[0,1]
v_pk_fma_f32 v[114:115], v[112:113], v[116:117], v[114:115] op_sel:[1,1,0] op_sel_hi:[1,0,1] neg_lo:[1,0,0]
v_cvt_pk_bf16_f32 v129, v114, v115
buffer_load_dwordx4 v21, s[8:11], s29 offen offset:1024 lds
s_add_u32 s27, s27, 1
s_cmp_eq_u32 s27, 10
s_cselect_b32 s27, 0, s27
s_lshl_b32 s28, s27, 7
s_mul_i32 s29, s27, 221184
ds_write_b32 v188, v128 offset:0
v_pk_mul_f32 v[112:113], v[114:115], v[116:117] op_sel:[0,0] op_sel_hi:[0,1]
v_pk_fma_f32 v[112:113], v[114:115], v[116:117], v[112:113] op_sel:[1,1,0] op_sel_hi:[1,0,1] neg_lo:[1,0,0]
v_cvt_pk_bf16_f32 v130, v112, v113
ds_write_b32 v188, v129 offset:288
v_pk_mul_f32 v[114:115], v[112:113], v[116:117] op_sel:[0,0] op_sel_hi:[0,1]
v_pk_fma_f32 v[114:115], v[112:113], v[116:117], v[114:115] op_sel:[1,1,0] op_sel_hi:[1,0,1] neg_lo:[1,0,0]
v_cvt_pk_bf16_f32 v131, v114, v115
ds_write_b32 v188, v130 offset:576
v_pk_mul_f32 v[112:113], v[114:115], v[116:117] op_sel:[0,0] op_sel_hi:[0,1]
v_pk_fma_f32 v[112:113], v[114:115], v[116:117], v[112:113] op_sel:[1,1,0] op_sel_hi:[1,0,1] neg_lo:[1,0,0]
v_cvt_pk_bf16_f32 v132, v112, v113
ds_write_b32 v188, v131 offset:864
v_pk_mul_f32 v[114:115], v[112:113], v[116:117] op_sel:[0,0] op_sel_hi:[0,1]
v_pk_fma_f32 v[114:115], v[112:113], v[116:117], v[114:115] op_sel:[1,1,0] op_sel_hi:[1,0,1] neg_lo:[1,0,0]
v_cvt_pk_bf16_f32 v133, v114, v115
ds_write_b32 v188, v132 offset:1152
v_pk_mul_f32 v[112:113], v[114:115], v[116:117] op_sel:[0,0] op_sel_hi:[0,1]
v_pk_fma_f32 v[112:113], v[114:115], v[116:117], v[112:113] op_sel:[1,1,0] op_sel_hi:[1,0,1] neg_lo:[1,0,0]
global_load_dwordx2 v[200:201], v42, s[58:59] offset:0
global_load_dwordx2 v[202:203], v42, s[58:59] offset:32
v_cvt_pk_bf16_f32 v134, v112, v113
ds_write_b32 v188, v133 offset:1440
v_pk_mul_f32 v[114:115], v[112:113], v[116:117] op_sel:[0,0] op_sel_hi:[0,1]
v_pk_fma_f32 v[114:115], v[112:113], v[116:117], v[114:115] op_sel:[1,1,0] op_sel_hi:[1,0,1] neg_lo:[1,0,0]
v_cvt_pk_bf16_f32 v135, v114, v115
ds_write_b32 v188, v134 offset:1728
v_pk_mul_f32 v[112:113], v[114:115], v[116:117] op_sel:[0,0] op_sel_hi:[0,1]
v_pk_fma_f32 v[112:113], v[114:115], v[116:117], v[112:113] op_sel:[1,1,0] op_sel_hi:[1,0,1] neg_lo:[1,0,0]
v_cvt_pk_bf16_f32 v128, v112, v113
ds_write_b32 v188, v135 offset:2016
v_pk_mul_f32 v[114:115], v[112:113], v[116:117] op_sel:[0,0] op_sel_hi:[0,1]
v_pk_fma_f32 v[114:115], v[112:113], v[116:117], v[114:115] op_sel:[1,1,0] op_sel_hi:[1,0,1] neg_lo:[1,0,0]
v_cvt_pk_bf16_f32 v129, v114, v115
ds_write_b32 v188, v128 offset:2304
v_pk_mul_f32 v[112:113], v[114:115], v[116:117] op_sel:[0,0] op_sel_hi:[0,1]
v_pk_fma_f32 v[112:113], v[114:115], v[116:117], v[112:113] op_sel:[1,1,0] op_sel_hi:[1,0,1] neg_lo:[1,0,0]
v_cvt_pk_bf16_f32 v130, v112, v113
ds_write_b32 v188, v129 offset:2592
v_pk_mul_f32 v[114:115], v[112:113], v[116:117] op_sel:[0,0] op_sel_hi:[0,1]
v_pk_fma_f32 v[114:115], v[112:113], v[116:117], v[114:115] op_sel:[1,1,0] op_sel_hi:[1,0,1] neg_lo:[1,0,0]
v_cvt_pk_bf16_f32 v131, v114, v115
ds_write_b32 v188, v130 offset:2880
v_pk_mul_f32 v[112:113], v[114:115], v[116:117] op_sel:[0,0] op_sel_hi:[0,1]
s_add_u32 m0, s47, 32768
s_nop 0
buffer_load_dwordx4 v16, s[4:7], s28 offen offset:0 lds
v_pk_fma_f32 v[112:113], v[114:115], v[116:117], v[112:113] op_sel:[1,1,0] op_sel_hi:[1,0,1] neg_lo:[1,0,0]
v_cvt_pk_bf16_f32 v132, v112, v113
ds_write_b32 v188, v131 offset:3168
v_pk_mul_f32 v[114:115], v[112:113], v[116:117] op_sel:[0,0] op_sel_hi:[0,1]
v_pk_fma_f32 v[114:115], v[112:113], v[116:117], v[114:115] op_sel:[1,1,0] op_sel_hi:[1,0,1] neg_lo:[1,0,0]
v_cvt_pk_bf16_f32 v133, v114, v115
ds_write_b32 v188, v132 offset:3456
v_pk_mul_f32 v[112:113], v[114:115], v[116:117] op_sel:[0,0] op_sel_hi:[0,1]
v_pk_fma_f32 v[112:113], v[114:115], v[116:117], v[112:113] op_sel:[1,1,0] op_sel_hi:[1,0,1] neg_lo:[1,0,0]
v_cvt_pk_bf16_f32 v134, v112, v113
ds_write_b32 v188, v133 offset:3744
v_pk_mul_f32 v[114:115], v[112:113], v[116:117] op_sel:[0,0] op_sel_hi:[0,1]
v_pk_fma_f32 v[114:115], v[112:113], v[116:117], v[114:115] op_sel:[1,1,0] op_sel_hi:[1,0,1] neg_lo:[1,0,0]
v_cvt_pk_bf16_f32 v135, v114, v115
ds_write_b32 v188, v134 offset:4032
ds_write_b32 v188, v135 offset:4320
ds_read_b128 v[144:147], v189 offset:0
ds_read_b128 v[148:151], v189 offset:64
ds_read_b128 v[152:155], v189 offset:128
ds_read_b128 v[156:159], v189 offset:192
v_mul_f32 v125, 1.0, v120
v_mul_f32 v126, 1.0, v121
v_exp_f32 v125, v125
buffer_load_dwordx4 v17, s[4:7], s28 offen offset:1024 lds
v_fract_f32 v126, v126
v_cos_f32 v64, v126
v_sin_f32 v65, v126
s_nop 0
v_pk_mul_f32 v[64:65], v[64:65], v[124:125] op_sel:[0,1] op_sel_hi:[1,1]
v_mul_f32 v125, 0x43000000, v120
v_mul_f32 v126, 0x43000000, v121
v_exp_f32 v125, v125
v_fract_f32 v126, v126
v_cos_f32 v80, v126
v_sin_f32 v81, v126
s_nop 0
v_pk_mul_f32 v[80:81], v[80:81], v[124:125] op_sel:[0,1] op_sel_hi:[1,1]
v_mov_b32 v135, 0x3f80
v_cvt_pk_bf16_f32 v128, v64, v65
v_cvt_pk_bf16_f32 v129, v80, v81
v_pk_mul_f32 v[66:67], v[64:65], v[64:65] op_sel:[0,0] op_sel_hi:[0,1]
ds_write_b32 v188, v135
buffer_load_dwordx4 v18, s[4:7], s28 offen offset:2048 lds
v_pk_fma_f32 v[66:67], v[64:65], v[64:65], v[66:67] op_sel:[1,1,0] op_sel_hi:[1,0,1] neg_lo:[1,0,0]
ds_write_b32 v188, v128 offset:288
v_cvt_pk_bf16_f32 v130, v66, v67
ds_write_b32 v188, v129 offset:2304
v_pk_mul_f32 v[68:69], v[66:67], v[64:65] op_sel:[0,0] op_sel_hi:[0,1]
v_pk_fma_f32 v[68:69], v[66:67], v[64:65], v[68:69] op_sel:[1,1,0] op_sel_hi:[1,0,1] neg_lo:[1,0,0]
v_cvt_pk_bf16_f32 v131, v68, v69
ds_write_b32 v188, v130 offset:576
v_pk_mul_f32 v[70:71], v[66:67], v[66:67] op_sel:[0,0] op_sel_hi:[0,1]
v_pk_fma_f32 v[70:71], v[66:67], v[66:67], v[70:71] op_sel:[1,1,0] op_sel_hi:[1,0,1] neg_lo:[1,0,0]
v_cvt_pk_bf16_f32 v132, v70, v71
ds_write_b32 v188, v131 offset:864
v_pk_mul_f32 v[72:73], v[70:71], v[64:65] op_sel:[0,0] op_sel_hi:[0,1]
v_pk_fma_f32 v[72:73], v[70:71], v[64:65], v[72:73] op_sel:[1,1,0] op_sel_hi:[1,0,1] neg_lo:[1,0,0]
v_cvt_pk_bf16_f32 v133, v72, v73
ds_write_b32 v188, v132 offset:1152
v_pk_mul_f32 v[74:75], v[70:71], v[66:67] op_sel:[0,0] op_sel_hi:[0,1]
v_pk_fma_f32 v[74:75], v[70:71], v[66:67], v[74:75] op_sel:[1,1,0] op_sel_hi:[1,0,1] neg_lo:[1,0,0]
v_cvt_pk_bf16_f32 v134, v74, v75
ds_write_b32 v188, v133 offset:1440
v_pk_mul_f32 v[76:77], v[70:71], v[68:69] op_sel:[0,0] op_sel_hi:[0,1]
v_pk_fma_f32 v[76:77], v[70:71], v[68:69], v[76:77] op_sel:[1,1,0] op_sel_hi:[1,0,1] neg_lo:[1,0,0]
v_cvt_pk_bf16_f32 v135, v76, v77
ds_write_b32 v188, v134 offset:1728
buffer_load_dwordx4 v19, s[4:7], s28 offen offset:3072 lds
v_pk_mul_f32 v[136:137], v[80:81], v[64:65] op_sel:[0,0] op_sel_hi:[0,1]
v_pk_fma_f32 v[136:137], v[80:81], v[64:65], v[136:137] op_sel:[1,1,0] op_sel_hi:[1,0,1] neg_lo:[1,0,0]
v_cvt_pk_bf16_f32 v128, v136, v137
ds_write_b32 v188, v135 offset:2016
v_pk_mul_f32 v[138:139], v[80:81], v[66:67] op_sel:[0,0] op_sel_hi:[0,1]
v_pk_fma_f32 v[138:139], v[80:81], v[66:67], v[138:139] op_sel:[1,1,0] op_sel_hi:[1,0,1] neg_lo:[1,0,0]
v_cvt_pk_bf16_f32 v129, v138, v139
ds_write_b32 v188, v128 offset:2592
v_pk_mul_f32 v[140:141], v[80:81], v[68:69] op_sel:[0,0] op_sel_hi:[0,1]
v_pk_fma_f32 v[140:141], v[80:81], v[68:69], v[140:141] op_sel:[1,1,0] op_sel_hi:[1,0,1] neg_lo:[1,0,0]
v_cvt_pk_bf16_f32 v130, v140, v141
ds_write_b32 v188, v129 offset:2880
v_pk_mul_f32 v[142:143], v[80:81], v[70:71] op_sel:[0,0] op_sel_hi:[0,1]
v_pk_fma_f32 v[142:143], v[80:81], v[70:71], v[142:143] op_sel:[1,1,0] op_sel_hi:[1,0,1] neg_lo:[1,0,0]
v_cvt_pk_bf16_f32 v131, v142, v143
ds_write_b32 v188, v130 offset:3168
v_pk_mul_f32 v[136:137], v[80:81], v[72:73] op_sel:[0,0] op_sel_hi:[0,1]
v_pk_fma_f32 v[136:137], v[80:81], v[72:73], v[136:137] op_sel:[1,1,0] op_sel_hi:[1,0,1] neg_lo:[1,0,0]
v_cvt_pk_bf16_f32 v132, v136, v137
ds_write_b32 v188, v131 offset:3456
v_pk_mul_f32 v[138:139], v[80:81], v[74:75] op_sel:[0,0] op_sel_hi:[0,1]
v_pk_fma_f32 v[138:139], v[80:81], v[74:75], v[138:139] op_sel:[1,1,0] op_sel_hi:[1,0,1] neg_lo:[1,0,0]
v_cvt_pk_bf16_f32 v133, v138, v139
ds_write_b32 v188, v132 offset:3744
s_add_u32 m0, s48, 32768
s_nop 0
buffer_load_dwordx4 v20, s[8:11], s29 offen offset:0 lds
v_pk_mul_f32 v[140:141], v[80:81], v[76:77] op_sel:[0,0] op_sel_hi:[0,1]
v_pk_fma_f32 v[140:141], v[80:81], v[76:77], v[140:141] op_sel:[1,1,0] op_sel_hi:[1,0,1] neg_lo:[1,0,0]
v_cvt_pk_bf16_f32 v134, v140, v141
ds_write_b32 v188, v133 offset:4032
ds_write_b32 v188, v134 offset:4320
ds_read_b128 v[160:163], v189 offset:0
ds_read_b128 v[164:167], v189 offset:64
ds_read_b128 v[168:171], v189 offset:128
ds_read_b128 v[172:175], v189 offset:192
v_pk_mul_f32 v[82:83], v[80:81], v[80:81] op_sel:[0,0] op_sel_hi:[0,1]
v_pk_fma_f32 v[82:83], v[80:81], v[80:81], v[82:83] op_sel:[1,1,0] op_sel_hi:[1,0,1] neg_lo:[1,0,0]
v_pk_mul_f32 v[84:85], v[82:83], v[80:81] op_sel:[0,0] op_sel_hi:[0,1]
v_pk_fma_f32 v[84:85], v[82:83], v[80:81], v[84:85] op_sel:[1,1,0] op_sel_hi:[1,0,1] neg_lo:[1,0,0]
v_pk_mul_f32 v[86:87], v[82:83], v[82:83] op_sel:[0,0] op_sel_hi:[0,1]
v_pk_fma_f32 v[86:87], v[82:83], v[82:83], v[86:87] op_sel:[1,1,0] op_sel_hi:[1,0,1] neg_lo:[1,0,0]
v_pk_mul_f32 v[88:89], v[86:87], v[80:81] op_sel:[0,0] op_sel_hi:[0,1]
v_pk_fma_f32 v[88:89], v[86:87], v[80:81], v[88:89] op_sel:[1,1,0] op_sel_hi:[1,0,1] neg_lo:[1,0,0]
v_pk_mul_f32 v[90:91], v[86:87], v[82:83] op_sel:[0,0] op_sel_hi:[0,1]
v_pk_fma_f32 v[90:91], v[86:87], v[82:83], v[90:91] op_sel:[1,1,0] op_sel_hi:[1,0,1] neg_lo:[1,0,0]
v_pk_mul_f32 v[92:93], v[86:87], v[84:85] op_sel:[0,0] op_sel_hi:[0,1]
v_pk_fma_f32 v[92:93], v[86:87], v[84:85], v[92:93] op_sel:[1,1,0] op_sel_hi:[1,0,1] neg_lo:[1,0,0]
v_pk_mul_f32 v[94:95], v[86:87], v[86:87] op_sel:[0,0] op_sel_hi:[0,1]
v_pk_fma_f32 v[94:95], v[86:87], v[86:87], v[94:95] op_sel:[1,1,0] op_sel_hi:[1,0,1] neg_lo:[1,0,0]
s_waitcnt lgkmcnt(0)
buffer_load_dwordx4 v21, s[8:11], s29 offen offset:1024 lds
s_add_u32 s27, s27, 1
s_cmp_eq_u32 s27, 10
s_cselect_b32 s27, 0, s27
s_lshl_b32 s28, s27, 7
s_mul_i32 s29, s27, 221184
v_mfma_f32_16x16x32_bf16 v[176:179], v[160:163], v[144:147], 0
v_mfma_f32_16x16x32_bf16 v[176:179], v[164:167], v[148:151], v[176:179]
v_mfma_f32_16x16x32_bf16 v[176:179], v[168:171], v[152:155], v[176:179]
v_mfma_f32_16x16x32_bf16 v[176:179], v[172:175], v[156:159], v[176:179]
v_cvt_pk_bf16_f32 v135, v82, v83
v_pk_mul_f32 v[142:143], v[82:83], v[66:67] op_sel:[0,0] op_sel_hi:[0,1]
v_pk_fma_f32 v[142:143], v[82:83], v[66:67], v[142:143] op_sel:[1,1,0] op_sel_hi:[1,0,1] neg_lo:[1,0,0]
v_cvt_pk_bf16_f32 v128, v142, v143
ds_write_b32 v188, v135 offset:0
v_pk_mul_f32 v[136:137], v[82:83], v[70:71] op_sel:[0,0] op_sel_hi:[0,1]
s_add_u32 m0, s47, 65536
s_nop 0
buffer_load_dwordx4 v16, s[4:7], s28 offen offset:0 lds
v_pk_fma_f32 v[136:137], v[82:83], v[70:71], v[136:137] op_sel:[1,1,0] op_sel_hi:[1,0,1] neg_lo:[1,0,0]
v_cvt_pk_bf16_f32 v129, v136, v137
ds_write_b32 v188, v128 offset:288
v_pk_mul_f32 v[138:139], v[82:83], v[74:75] op_sel:[0,0] op_sel_hi:[0,1]
v_pk_fma_f32 v[138:139], v[82:83], v[74:75], v[138:139] op_sel:[1,1,0] op_sel_hi:[1,0,1] neg_lo:[1,0,0]
v_cvt_pk_bf16_f32 v130, v138, v139
ds_write_b32 v188, v129 offset:576
v_cvt_pk_bf16_f32 v131, v84, v85
v_pk_mul_f32 v[140:141], v[84:85], v[66:67] op_sel:[0,0] op_sel_hi:[0,1]
v_pk_fma_f32 v[140:141], v[84:85], v[66:67], v[140:141] op_sel:[1,1,0] op_sel_hi:[1,0,1] neg_lo:[1,0,0]
ds_write_b32 v188, v130 offset:864
v_cvt_pk_bf16_f32 v132, v140, v141
ds_write_b32 v188, v131 offset:1152
v_pk_mul_f32 v[142:143], v[84:85], v[70:71] op_sel:[0,0] op_sel_hi:[0,1]
v_pk_fma_f32 v[142:143], v[84:85], v[70:71], v[142:143] op_sel:[1,1,0] op_sel_hi:[1,0,1] neg_lo:[1,0,0]
v_cvt_pk_bf16_f32 v133, v142, v143
ds_write_b32 v188, v132 offset:1440
v_pk_mul_f32 v[136:137], v[84:85], v[74:75] op_sel:[0,0] op_sel_hi:[0,1]
v_pk_fma_f32 v[136:137], v[84:85], v[74:75], v[136:137] op_sel:[1,1,0] op_sel_hi:[1,0,1] neg_lo:[1,0,0]
v_cvt_pk_bf16_f32 v134, v136, v137
ds_write_b32 v188, v133 offset:1728
v_cvt_pk_bf16_f32 v135, v86, v87
v_pk_mul_f32 v[138:139], v[86:87], v[70:71] op_sel:[0,0] op_sel_hi:[0,1]
buffer_load_dwordx4 v17, s[4:7], s28 offen offset:1024 lds
v_pk_fma_f32 v[138:139], v[86:87], v[70:71], v[138:139] op_sel:[1,1,0] op_sel_hi:[1,0,1] neg_lo:[1,0,0]
ds_write_b32 v188, v134 offset:2016
v_cvt_pk_bf16_f32 v128, v138, v139
ds_write_b32 v188, v135 offset:2304
v_cvt_pk_bf16_f32 v129, v88, v89
v_pk_mul_f32 v[140:141], v[88:89], v[70:71] op_sel:[0,0] op_sel_hi:[0,1]
v_pk_fma_f32 v[140:141], v[88:89], v[70:71], v[140:141] op_sel:[1,1,0] op_sel_hi:[1,0,1] neg_lo:[1,0,0]
ds_write_b32 v188, v128 offset:2592
v_cvt_pk_bf16_f32 v130, v140, v141
ds_write_b32 v188, v129 offset:2880
v_cvt_pk_bf16_f32 v131, v90, v91
v_pk_mul_f32 v[142:143], v[90:91], v[70:71] op_sel:[0,0] op_sel_hi:[0,1]
v_pk_fma_f32 v[142:143], v[90:91], v[70:71], v[142:143] op_sel:[1,1,0] op_sel_hi:[1,0,1] neg_lo:[1,0,0]
ds_write_b32 v188, v130 offset:3168
v_cvt_pk_bf16_f32 v132, v142, v143
ds_write_b32 v188, v131 offset:3456
v_cvt_pk_bf16_f32 v133, v92, v93
v_pk_mul_f32 v[136:137], v[92:93], v[70:71] op_sel:[0,0] op_sel_hi:[0,1]
v_pk_fma_f32 v[136:137], v[92:93], v[70:71], v[136:137] op_sel:[1,1,0] op_sel_hi:[1,0,1] neg_lo:[1,0,0]
ds_write_b32 v188, v132 offset:3744
v_cvt_pk_bf16_f32 v134, v136, v137
ds_write_b32 v188, v133 offset:4032
ds_write_b32 v188, v134 offset:4320
ds_read_b128 v[160:163], v189 offset:0
buffer_load_dwordx4 v18, s[4:7], s28 offen offset:2048 lds
ds_read_b128 v[164:167], v189 offset:64
ds_read_b128 v[168:171], v189 offset:128
ds_read_b128 v[172:175], v189 offset:192
v_pk_mul_f32 v[96:97], v[94:95], v[80:81] op_sel:[0,0] op_sel_hi:[0,1]
v_pk_fma_f32 v[96:97], v[94:95], v[80:81], v[96:97] op_sel:[1,1,0] op_sel_hi:[1,0,1] neg_lo:[1,0,0]
v_pk_mul_f32 v[98:99], v[94:95], v[82:83] op_sel:[0,0] op_sel_hi:[0,1]
v_pk_fma_f32 v[98:99], v[94:95], v[82:83], v[98:99] op_sel:[1,1,0] op_sel_hi:[1,0,1] neg_lo:[1,0,0]
v_pk_mul_f32 v[100:101], v[94:95], v[84:85] op_sel:[0,0] op_sel_hi:[0,1]
v_pk_fma_f32 v[100:101], v[94:95], v[84:85], v[100:101] op_sel:[1,1,0] op_sel_hi:[1,0,1] neg_lo:[1,0,0]
v_pk_mul_f32 v[102:103], v[94:95], v[86:87] op_sel:[0,0] op_sel_hi:[0,1]
v_pk_fma_f32 v[102:103], v[94:95], v[86:87], v[102:103] op_sel:[1,1,0] op_sel_hi:[1,0,1] neg_lo:[1,0,0]
v_pk_mul_f32 v[104:105], v[94:95], v[88:89] op_sel:[0,0] op_sel_hi:[0,1]
v_pk_fma_f32 v[104:105], v[94:95], v[88:89], v[104:105] op_sel:[1,1,0] op_sel_hi:[1,0,1] neg_lo:[1,0,0]
v_pk_mul_f32 v[106:107], v[94:95], v[90:91] op_sel:[0,0] op_sel_hi:[0,1]
v_pk_fma_f32 v[106:107], v[94:95], v[90:91], v[106:107] op_sel:[1,1,0] op_sel_hi:[1,0,1] neg_lo:[1,0,0]
v_pk_mul_f32 v[108:109], v[94:95], v[92:93] op_sel:[0,0] op_sel_hi:[0,1]
v_pk_fma_f32 v[108:109], v[94:95], v[92:93], v[108:109] op_sel:[1,1,0] op_sel_hi:[1,0,1] neg_lo:[1,0,0]
v_pk_mul_f32 v[110:111], v[94:95], v[94:95] op_sel:[0,0] op_sel_hi:[0,1]
v_pk_fma_f32 v[110:111], v[94:95], v[94:95], v[110:111] op_sel:[1,1,0] op_sel_hi:[1,0,1] neg_lo:[1,0,0]
s_waitcnt lgkmcnt(0)
v_mfma_f32_16x16x32_bf16 v[180:183], v[160:163], v[144:147], 0
v_mfma_f32_16x16x32_bf16 v[180:183], v[164:167], v[148:151], v[180:183]
buffer_load_dwordx4 v19, s[4:7], s28 offen offset:3072 lds
v_mfma_f32_16x16x32_bf16 v[180:183], v[168:171], v[152:155], v[180:183]
v_mfma_f32_16x16x32_bf16 v[180:183], v[172:175], v[156:159], v[180:183]
v_cvt_pk_bf16_f32 v135, v94, v95
v_cvt_pk_bf16_f32 v128, v96, v97
v_cvt_pk_bf16_f32 v129, v98, v99
v_cvt_pk_bf16_f32 v130, v100, v101
ds_write_b32 v188, v135 offset:0
v_cvt_pk_bf16_f32 v131, v102, v103
ds_write_b32 v188, v128 offset:288
v_cvt_pk_bf16_f32 v132, v104, v105
ds_write_b32 v188, v129 offset:576
v_cvt_pk_bf16_f32 v133, v106, v107
ds_write_b32 v188, v130 offset:864
v_cvt_pk_bf16_f32 v134, v108, v109
ds_write_b32 v188, v131 offset:1152
v_cvt_pk_bf16_f32 v135, v110, v111
ds_write_b32 v188, v132 offset:1440
ds_write_b32 v188, v133 offset:1728
ds_write_b32 v188, v134 offset:2016
s_add_u32 m0, s48, 65536
s_nop 0
buffer_load_dwordx4 v20, s[8:11], s29 offen offset:0 lds
ds_write_b32 v188, v135 offset:2304
ds_read_b128 v[160:163], v189 offset:0
ds_read_b128 v[164:167], v189 offset:64
ds_read_b128 v[168:171], v189 offset:128
ds_read_b128 v[172:175], v189 offset:192
s_mul_i32 s101, s3, 3072
v_lshrrev_b32 v123, 1, v3
v_and_b32 v124, 1, v3
v_lshlrev_b32 v190, 9, v123
v_lshl_add_u32 v190, v2, 5, v190
v_lshl_add_u32 v190, v124, 4, v190
v_add_u32 v190, s101, v190
v_sub_u32 v124, 4, v123
v_lshlrev_b32 v191, v124, v2
v_lshl_add_u32 v225, v3, 8, s101
v_add_u32 v191, v191, v225
v_mul_u32_u24 v123, 120, v123
v_add3_u32 v224, v191, v123, 8
v_lshl_add_u32 v225, v2, 2, v225
s_waitcnt lgkmcnt(0)
v_mfma_f32_16x16x32_bf16 v[184:187], v[160:163], v[144:147], 0
v_mfma_f32_16x16x32_bf16 v[184:187], v[164:167], v[148:151], v[184:187]
buffer_load_dwordx4 v21, s[8:11], s29 offen offset:1024 lds
s_add_u32 s27, s27, 1
s_cmp_eq_u32 s27, 10
s_cselect_b32 s27, 0, s27
s_lshl_b32 s28, s27, 7
s_mul_i32 s29, s27, 221184
v_mfma_f32_16x16x32_bf16 v[184:187], v[168:171], v[152:155], v[184:187]
v_mfma_f32_16x16x32_bf16 v[184:187], v[172:175], v[156:159], v[184:187]
ds_write_b128 v190, v[176:179]
ds_write_b64 v191, v[180:181] offset:1024
ds_write_b64 v224, v[182:183] offset:1024
s_nop 4
ds_write_b32 v225, v184 offset:2048
ds_write_b32 v225, v185 offset:2112
ds_write_b32 v225, v186 offset:2176
ds_write_b32 v225, v187 offset:2240
s_lshr_b32 s101, s3, 1
s_mul_i32 s100, s101, 6144
s_mul_i32 s101, s101, 8320
s_add_u32 s101, s101, 16368
v_lshlrev_b32 v65, 4, v1
v_sub_u32 v65, s101, v65
s_and_b32 s101, s3, 1
s_lshl_b32 s101, s101, 8
s_add_u32 s101, s101, s100
v_lshl_add_u32 v64, v1, 2, s101
s_waitcnt lgkmcnt(0)
s_barrier
ds_read_b32 v94, v64 offset:2048
ds_read_b32 v95, v64 offset:2052
ds_read_b32 v96, v64 offset:5120
ds_read_b32 v97, v64 offset:5124
s_bitcmp1_b32 s3, 0
s_cbranch_scc1 ex16
s_movk_i32 s30, 0x200
v_cmp_gt_u32 vcc, 32, v1
v_lshlrev_b32 v92, 5, v1
v_lshl_add_u32 v93, v1, 4, s30
v_cndmask_b32 v93, v93, v92, vcc
v_cmp_ge_u32 vcc, 32, v1
v_add_u32 v92, -4, v92
v_max_i32 v92, 0, v92
v_cndmask_b32 v92, v93, v92, vcc
v_add_u32 v93, s100, v93
v_add_u32 v92, s100, v92
ds_read_b128 v[68:71], v93
ds_read_b128 v[72:75], v93 offset:3072
ds_read_b128 v[76:79], v93 offset:16
ds_read_b128 v[80:83], v93 offset:3088
ds_read_b32 v66, v92
ds_read_b32 v67, v92 offset:3072
v_cmp_eq_u32 vcc, 0, v1
v_mov_b32 v92, s54
s_mov_b32 s30, 0
s_mov_b32 s31, -1
v_cndmask_b32 v92, 0, v92, vcc
s_waitcnt lgkmcnt(0)
v_pk_add_f32 v[68:69], v[68:69], v[72:73]
v_pk_add_f32 v[70:71], v[70:71], v[74:75]
v_pk_add_f32 v[76:77], v[76:77], v[80:81]
v_pk_add_f32 v[78:79], v[78:79], v[82:83]
v_add_f32 v66, v66, v67
v_cndmask_b32 v66, v66, 0, vcc
v_cndmask_b32 v72, v69, v68, s[30:31]
v_cndmask_b32 v73, v70, v69, s[30:31]
v_cndmask_b32 v74, v71, v70, s[30:31]
v_cndmask_b32 v75, v76, v70, s[30:31]
v_cndmask_b32 v80, v77, v70, s[30:31]
v_cndmask_b32 v81, v78, v71, s[30:31]
v_cndmask_b32 v82, v79, v76, s[30:31]
v_add_f32 v68, v68, v92
v_cvt_pk_bf16_f32 v84, v82, v81
v_cvt_pk_bf16_f32 v85, v80, v75
v_cvt_pk_bf16_f32 v86, v74, v73
v_cvt_pk_bf16_f32 v87, v72, v68
v_cvt_pk_bf16_f32 v88, v81, v80
v_cvt_pk_bf16_f32 v89, v75, v74
v_cvt_pk_bf16_f32 v90, v73, v72
v_cvt_pk_bf16_f32 v91, v68, v66
ds_write_b128 v65, v[84:87]
ds_write_b128 v65, v[88:91] offset:4160
v_add_u32 v65, -2048, v65
s_branch ex17
ex16:
v_lshl_add_u32 v92, v1, 3, s100
ds_read_b64 v[68:69], v92 offset:1536
ds_read_b64 v[72:73], v92 offset:4608
ds_read_b32 v70, v92 offset:1544
ds_read_b32 v74, v92 offset:4616
v_and_b32 v93, 1, v1
v_bfe_u32 v66, v1, 1, 1
v_mul_u32_u24 v93, 4160, v93
s_lshr_b32 s101, s3, 1
s_mul_i32 s101, s101, 8320
s_add_u32 s101, s101, 12288
v_lshl_add_u32 v93, v66, 4, v93
v_mov_b32 v76, 0
v_mov_b32 v77, 0
v_mov_b32 v78, 0
v_mov_b32 v79, 0
v_add_u32 v93, s101, v93
v_add_u32 v65, -1024, v65
ds_write_b128 v93, v[76:79] offset:4096
s_waitcnt lgkmcnt(0)
v_pk_add_f32 v[68:69], v[68:69], v[72:73]
v_add_f32 v70, v70, v74
v_cvt_pk_bf16_f32 v84, v70, v70
v_cvt_pk_bf16_f32 v85, v69, v69
v_cvt_pk_bf16_f32 v86, v69, v68
v_cvt_pk_bf16_f32 v87, v68, v68
v_cvt_pk_bf16_f32 v88, v70, v69
v_cvt_pk_bf16_f32 v89, v69, v69
v_cvt_pk_bf16_f32 v90, v68, v68
v_cvt_pk_bf16_f32 v91, v68, v68
ds_write_b128 v65, v[84:87]
ds_write_b128 v65, v[88:91] offset:4160
v_add_u32 v65, -2048, v65
ex17:
v_and_b32 v66, 1, v1
v_add_f32 v94, v94, v96
v_cmp_eq_u32 vcc, 1, v66
v_add_f32 v95, v95, v97
s_nop 0
v_cndmask_b32 v96, v94, v95, vcc
v_cvt_pk_bf16_f32 v98, v95, v95
v_cvt_pk_bf16_f32 v99, v95, v96
v_cvt_pk_bf16_f32 v100, v94, v94
v_cvt_pk_bf16_f32 v101, v94, v94
v_cvt_pk_bf16_f32 v102, v95, v95
v_cvt_pk_bf16_f32 v103, v96, v94
v_cvt_pk_bf16_f32 v104, v94, v94
v_cvt_pk_bf16_f32 v105, v94, v94
ds_write_b128 v65, v[98:101]
ds_write_b128 v65, v[102:105] offset:4160
s_waitcnt vmcnt(16)
v_readfirstlane_b32 s21, v11
v_readfirstlane_b32 s20, v10
s_cmp_eq_u32 s21, 0
s_cbranch_scc1 slow18
back19:
s_waitcnt vmcnt(12)
s_add_u32 m0, s47, 98304
s_nop 0
buffer_load_dwordx4 v16, s[4:7], s28 offen offset:0 lds
v_lshlrev_b32 v192, 16, v200
v_and_b32 v193, 0xffff0000, v200
v_lshlrev_b32 v194, 16, v201
v_and_b32 v195, 0xffff0000, v201
v_lshlrev_b32 v196, 16, v202
v_and_b32 v197, 0xffff0000, v202
v_lshlrev_b32 v198, 16, v203
v_and_b32 v199, 0xffff0000, v203
buffer_load_dwordx4 v17, s[4:7], s28 offen offset:1024 lds
s_lshr_b32 s101, s3, 1
s_lshl_b32 s101, s101, 13
s_add_u32 s101, s101, 32768
v_and_b32 v64, 7, v2
v_xor_b32 v64, v64, v3
v_lshl_add_u32 v65, v2, 7, s101
v_lshl_add_u32 v24, v64, 4, v65
v_xor_b32 v25, 64, v24
v_add_u32 v26, 0x10000, v24
buffer_load_dwordx4 v18, s[4:7], s28 offen offset:2048 lds
v_add_u32 v27, 0x10000, v25
v_bfe_u32 v66, v1, 2, 2
v_and_b32 v67, 3, v1
v_and_b32 v68, 1, v3
v_lshl_add_u32 v69, v3, 3, v66
s_and_b32 s101, s3, 1
v_lshrrev_b32 v70, 1, v66
v_lshl_or_b32 v70, v68, 1, v70
s_lshl_b32 s101, s101, 1
buffer_load_dwordx4 v19, s[4:7], s28 offen offset:3072 lds
v_lshlrev_b32 v69, 7, v69
v_xor_b32 v70, s101, v70
v_lshl_add_u32 v69, v67, 3, v69
v_add_u32 v69, 49152, v69
v_xor_b32 v71, 0, v70
v_lshl_add_u32 v28, v71, 5, v69
v_add_u32 v32, 0x10000, v28
v_xor_b32 v71, 1, v70
v_lshl_add_u32 v29, v71, 5, v69
v_add_u32 v33, 0x10000, v29
s_waitcnt lgkmcnt(0)
s_barrier
ds_read_b64_tr_b16 v[144:145], v28 offset:0
ds_read_b64_tr_b16 v[146:147], v28 offset:512
ds_read_b128 v[128:131], v24 offset:0
ds_read_b128 v[132:135], v24 offset:2048
ds_read_b128 v[136:139], v24 offset:4096
ds_read_b128 v[140:143], v24 offset:6144
ds_read_b64_tr_b16 v[148:149], v29 offset:0
ds_read_b64_tr_b16 v[150:151], v29 offset:512
s_waitcnt lgkmcnt(2)
v_mfma_f32_16x16x32_bf16 v[64:67], v[144:147], v[128:131], v[192:195]
s_add_u32 m0, s48, 98304
v_mfma_f32_16x16x32_bf16 v[68:71], v[144:147], v[132:135], v[192:195]
ds_read_b64_tr_b16 v[176:177], v28 offset:4096
ds_read_b64_tr_b16 v[178:179], v28 offset:4608
buffer_load_dwordx4 v20, s[8:11], s29 offen offset:0 lds
v_mfma_f32_16x16x32_bf16 v[72:75], v[144:147], v[136:139], v[192:195]
ds_read_b128 v[160:163], v25 offset:0
v_mfma_f32_16x16x32_bf16 v[76:79], v[144:147], v[140:143], v[192:195]
ds_read_b128 v[164:167], v25 offset:2048
s_waitcnt lgkmcnt(4)
v_mfma_f32_16x16x32_bf16 v[80:83], v[148:151], v[128:131], v[196:199]
ds_read_b128 v[168:171], v25 offset:4096
ds_read_b128 v[172:175], v25 offset:6144
v_mfma_f32_16x16x32_bf16 v[84:87], v[148:151], v[132:135], v[196:199]
ds_read_b64_tr_b16 v[180:181], v29 offset:4096
buffer_load_dwordx4 v21, s[8:11], s29 offen offset:1024 lds
s_add_u32 s27, s27, 1
v_mfma_f32_16x16x32_bf16 v[88:91], v[148:151], v[136:139], v[196:199]
ds_read_b64_tr_b16 v[182:183], v29 offset:4608
s_cmp_eq_u32 s27, 10
s_cselect_b32 s27, 0, s27
v_mfma_f32_16x16x32_bf16 v[92:95], v[148:151], v[140:143], v[196:199]
s_lshl_b32 s28, s27, 7
s_mul_i32 s29, s27, 221184
s_waitcnt lgkmcnt(2)
v_mfma_f32_16x16x32_bf16 v[64:67], v[176:179], v[160:163], v[64:67]
v_mfma_f32_16x16x32_bf16 v[68:71], v[176:179], v[164:167], v[68:71]
s_add_u32 m0, s47, 0
s_waitcnt vmcnt(12)
s_waitcnt lgkmcnt(0)
s_barrier
v_mfma_f32_16x16x32_bf16 v[72:75], v[176:179], v[168:171], v[72:75]
ds_read_b64_tr_b16 v[144:145], v28 offset:32768
ds_read_b64_tr_b16 v[146:147], v28 offset:33280
buffer_load_dwordx4 v16, s[4:7], s28 offen offset:0 lds
v_mfma_f32_16x16x32_bf16 v[76:79], v[176:179], v[172:175], v[76:79]
ds_read_b128 v[128:131], v24 offset:32768
v_mfma_f32_16x16x32_bf16 v[80:83], v[180:183], v[160:163], v[80:83]
ds_read_b128 v[132:135], v24 offset:34816
buffer_load_dwordx4 v17, s[4:7], s28 offen offset:1024 lds
v_mfma_f32_16x16x32_bf16 v[84:87], v[180:183], v[164:167], v[84:87]
ds_read_b128 v[136:139], v24 offset:36864
ds_read_b128 v[140:143], v24 offset:38912
v_mfma_f32_16x16x32_bf16 v[88:91], v[180:183], v[168:171], v[88:91]
ds_read_b64_tr_b16 v[148:149], v29 offset:32768
v_mfma_f32_16x16x32_bf16 v[92:95], v[180:183], v[172:175], v[92:95]
ds_read_b64_tr_b16 v[150:151], v29 offset:33280
buffer_load_dwordx4 v18, s[4:7], s28 offen offset:2048 lds
s_waitcnt lgkmcnt(2)
v_mfma_f32_16x16x32_bf16 v[64:67], v[144:147], v[128:131], v[64:67]
v_mfma_f32_16x16x32_bf16 v[68:71], v[144:147], v[132:135], v[68:71]
ds_read_b64_tr_b16 v[176:177], v28 offset:36864
ds_read_b64_tr_b16 v[178:179], v28 offset:37376
v_mfma_f32_16x16x32_bf16 v[72:75], v[144:147], v[136:139], v[72:75]
ds_read_b128 v[160:163], v25 offset:32768
buffer_load_dwordx4 v19, s[4:7], s28 offen offset:3072 lds
s_add_u32 m0, s48, 0
v_mfma_f32_16x16x32_bf16 v[76:79], v[144:147], v[140:143], v[76:79]
ds_read_b128 v[164:167], v25 offset:34816
s_waitcnt lgkmcnt(4)
v_mfma_f32_16x16x32_bf16 v[80:83], v[148:151], v[128:131], v[80:83]
ds_read_b128 v[168:171], v25 offset:36864
ds_read_b128 v[172:175], v25 offset:38912
buffer_load_dwordx4 v20, s[8:11], s29 offen offset:0 lds
v_mfma_f32_16x16x32_bf16 v[84:87], v[148:151], v[132:135], v[84:87]
ds_read_b64_tr_b16 v[180:181], v29 offset:36864
v_mfma_f32_16x16x32_bf16 v[88:91], v[148:151], v[136:139], v[88:91]
ds_read_b64_tr_b16 v[182:183], v29 offset:37376
v_mfma_f32_16x16x32_bf16 v[92:95], v[148:151], v[140:143], v[92:95]
buffer_load_dwordx4 v21, s[8:11], s29 offen offset:1024 lds
s_add_u32 s27, s27, 1
s_waitcnt lgkmcnt(2)
v_mfma_f32_16x16x32_bf16 v[64:67], v[176:179], v[160:163], v[64:67]
s_cmp_eq_u32 s27, 10
s_cselect_b32 s27, 0, s27
s_lshl_b32 s28, s27, 7
v_mfma_f32_16x16x32_bf16 v[68:71], v[176:179], v[164:167], v[68:71]
s_mul_i32 s29, s27, 221184
s_add_u32 m0, s47, 32768
s_waitcnt vmcnt(12)
s_waitcnt lgkmcnt(0)
s_barrier
v_mfma_f32_16x16x32_bf16 v[72:75], v[176:179], v[168:171], v[72:75]
ds_read_b64_tr_b16 v[144:145], v32 offset:0
ds_read_b64_tr_b16 v[146:147], v32 offset:512
buffer_load_dwordx4 v16, s[4:7], s28 offen offset:0 lds
v_mfma_f32_16x16x32_bf16 v[76:79], v[176:179], v[172:175], v[76:79]
ds_read_b128 v[128:131], v26 offset:0
v_mfma_f32_16x16x32_bf16 v[80:83], v[180:183], v[160:163], v[80:83]
ds_read_b128 v[132:135], v26 offset:2048
buffer_load_dwordx4 v17, s[4:7], s28 offen offset:1024 lds
v_mfma_f32_16x16x32_bf16 v[84:87], v[180:183], v[164:167], v[84:87]
ds_read_b128 v[136:139], v26 offset:4096
ds_read_b128 v[140:143], v26 offset:6144
v_mfma_f32_16x16x32_bf16 v[88:91], v[180:183], v[168:171], v[88:91]
ds_read_b64_tr_b16 v[148:149], v33 offset:0
v_mfma_f32_16x16x32_bf16 v[92:95], v[180:183], v[172:175], v[92:95]
ds_read_b64_tr_b16 v[150:151], v33 offset:512
buffer_load_dwordx4 v18, s[4:7], s28 offen offset:2048 lds
s_waitcnt lgkmcnt(2)
v_mfma_f32_16x16x32_bf16 v[64:67], v[144:147], v[128:131], v[64:67]
v_mfma_f32_16x16x32_bf16 v[68:71], v[144:147], v[132:135], v[68:71]
ds_read_b64_tr_b16 v[176:177], v32 offset:4096
ds_read_b64_tr_b16 v[178:179], v32 offset:4608
v_mfma_f32_16x16x32_bf16 v[72:75], v[144:147], v[136:139], v[72:75]
ds_read_b128 v[160:163], v27 offset:0
buffer_load_dwordx4 v19, s[4:7], s28 offen offset:3072 lds
s_add_u32 m0, s48, 32768
v_mfma_f32_16x16x32_bf16 v[76:79], v[144:147], v[140:143], v[76:79]
ds_read_b128 v[164:167], v27 offset:2048
s_waitcnt lgkmcnt(4)
v_mfma_f32_16x16x32_bf16 v[80:83], v[148:151], v[128:131], v[80:83]
ds_read_b128 v[168:171], v27 offset:4096
ds_read_b128 v[172:175], v27 offset:6144
buffer_load_dwordx4 v20, s[8:11], s29 offen offset:0 lds
v_mfma_f32_16x16x32_bf16 v[84:87], v[148:151], v[132:135], v[84:87]
ds_read_b64_tr_b16 v[180:181], v33 offset:4096
v_mfma_f32_16x16x32_bf16 v[88:91], v[148:151], v[136:139], v[88:91]
ds_read_b64_tr_b16 v[182:183], v33 offset:4608
v_mfma_f32_16x16x32_bf16 v[92:95], v[148:151], v[140:143], v[92:95]
buffer_load_dwordx4 v21, s[8:11], s29 offen offset:1024 lds
s_add_u32 s27, s27, 1
s_waitcnt lgkmcnt(2)
v_mfma_f32_16x16x32_bf16 v[64:67], v[176:179], v[160:163], v[64:67]
s_cmp_eq_u32 s27, 10
s_cselect_b32 s27, 0, s27
s_lshl_b32 s28, s27, 7
v_mfma_f32_16x16x32_bf16 v[68:71], v[176:179], v[164:167], v[68:71]
s_mul_i32 s29, s27, 221184
s_add_u32 m0, s47, 65536
s_waitcnt vmcnt(12)
s_waitcnt lgkmcnt(0)
s_barrier
v_mfma_f32_16x16x32_bf16 v[72:75], v[176:179], v[168:171], v[72:75]
ds_read_b64_tr_b16 v[144:145], v32 offset:32768
ds_read_b64_tr_b16 v[146:147], v32 offset:33280
buffer_load_dwordx4 v16, s[4:7], s28 offen offset:0 lds
v_mfma_f32_16x16x32_bf16 v[76:79], v[176:179], v[172:175], v[76:79]
ds_read_b128 v[128:131], v26 offset:32768
v_mfma_f32_16x16x32_bf16 v[80:83], v[180:183], v[160:163], v[80:83]
ds_read_b128 v[132:135], v26 offset:34816
buffer_load_dwordx4 v17, s[4:7], s28 offen offset:1024 lds
v_mfma_f32_16x16x32_bf16 v[84:87], v[180:183], v[164:167], v[84:87]
ds_read_b128 v[136:139], v26 offset:36864
ds_read_b128 v[140:143], v26 offset:38912
v_mfma_f32_16x16x32_bf16 v[88:91], v[180:183], v[168:171], v[88:91]
ds_read_b64_tr_b16 v[148:149], v33 offset:32768
v_mfma_f32_16x16x32_bf16 v[92:95], v[180:183], v[172:175], v[92:95]
ds_read_b64_tr_b16 v[150:151], v33 offset:33280
buffer_load_dwordx4 v18, s[4:7], s28 offen offset:2048 lds
s_waitcnt lgkmcnt(2)
v_mfma_f32_16x16x32_bf16 v[64:67], v[144:147], v[128:131], v[64:67]
v_mfma_f32_16x16x32_bf16 v[68:71], v[144:147], v[132:135], v[68:71]
ds_read_b64_tr_b16 v[176:177], v32 offset:36864
ds_read_b64_tr_b16 v[178:179], v32 offset:37376
v_mfma_f32_16x16x32_bf16 v[72:75], v[144:147], v[136:139], v[72:75]
ds_read_b128 v[160:163], v27 offset:32768
buffer_load_dwordx4 v19, s[4:7], s28 offen offset:3072 lds
s_add_u32 m0, s48, 65536
v_mfma_f32_16x16x32_bf16 v[76:79], v[144:147], v[140:143], v[76:79]
ds_read_b128 v[164:167], v27 offset:34816
s_waitcnt lgkmcnt(4)
v_mfma_f32_16x16x32_bf16 v[80:83], v[148:151], v[128:131], v[80:83]
ds_read_b128 v[168:171], v27 offset:36864
ds_read_b128 v[172:175], v27 offset:38912
buffer_load_dwordx4 v20, s[8:11], s29 offen offset:0 lds
v_mfma_f32_16x16x32_bf16 v[84:87], v[148:151], v[132:135], v[84:87]
ds_read_b64_tr_b16 v[180:181], v33 offset:36864
v_mfma_f32_16x16x32_bf16 v[88:91], v[148:151], v[136:139], v[88:91]
ds_read_b64_tr_b16 v[182:183], v33 offset:37376
v_mfma_f32_16x16x32_bf16 v[92:95], v[148:151], v[140:143], v[92:95]
buffer_load_dwordx4 v21, s[8:11], s29 offen offset:1024 lds
s_add_u32 s27, s27, 1
s_waitcnt lgkmcnt(2)
v_mfma_f32_16x16x32_bf16 v[64:67], v[176:179], v[160:163], v[64:67]
s_cmp_eq_u32 s27, 10
s_cselect_b32 s27, 0, s27
s_lshl_b32 s28, s27, 7
v_mfma_f32_16x16x32_bf16 v[68:71], v[176:179], v[164:167], v[68:71]
s_mul_i32 s29, s27, 221184
s_add_u32 m0, s47, 98304
s_waitcnt vmcnt(12)
s_waitcnt lgkmcnt(0)
s_barrier
v_mfma_f32_16x16x32_bf16 v[72:75], v[176:179], v[168:171], v[72:75]
ds_read_b64_tr_b16 v[144:145], v28 offset:0
ds_read_b64_tr_b16 v[146:147], v28 offset:512
buffer_load_dwordx4 v16, s[4:7], s28 offen offset:0 lds
v_mfma_f32_16x16x32_bf16 v[76:79], v[176:179], v[172:175], v[76:79]
ds_read_b128 v[128:131], v24 offset:0
v_mfma_f32_16x16x32_bf16 v[80:83], v[180:183], v[160:163], v[80:83]
ds_read_b128 v[132:135], v24 offset:2048
buffer_load_dwordx4 v17, s[4:7], s28 offen offset:1024 lds
v_mfma_f32_16x16x32_bf16 v[84:87], v[180:183], v[164:167], v[84:87]
ds_read_b128 v[136:139], v24 offset:4096
ds_read_b128 v[140:143], v24 offset:6144
v_mfma_f32_16x16x32_bf16 v[88:91], v[180:183], v[168:171], v[88:91]
ds_read_b64_tr_b16 v[148:149], v29 offset:0
v_mfma_f32_16x16x32_bf16 v[92:95], v[180:183], v[172:175], v[92:95]
ds_read_b64_tr_b16 v[150:151], v29 offset:512
buffer_load_dwordx4 v18, s[4:7], s28 offen offset:2048 lds
s_waitcnt lgkmcnt(2)
v_mfma_f32_16x16x32_bf16 v[64:67], v[144:147], v[128:131], v[64:67]
v_mfma_f32_16x16x32_bf16 v[68:71], v[144:147], v[132:135], v[68:71]
ds_read_b64_tr_b16 v[176:177], v28 offset:4096
ds_read_b64_tr_b16 v[178:179], v28 offset:4608
v_mfma_f32_16x16x32_bf16 v[72:75], v[144:147], v[136:139], v[72:75]
ds_read_b128 v[160:163], v25 offset:0
buffer_load_dwordx4 v19, s[4:7], s28 offen offset:3072 lds
s_add_u32 m0, s48, 98304
v_mfma_f32_16x16x32_bf16 v[76:79], v[144:147], v[140:143], v[76:79]
ds_read_b128 v[164:167], v25 offset:2048
s_waitcnt lgkmcnt(4)
v_mfma_f32_16x16x32_bf16 v[80:83], v[148:151], v[128:131], v[80:83]
ds_read_b128 v[168:171], v25 offset:4096
ds_read_b128 v[172:175], v25 offset:6144
buffer_load_dwordx4 v20, s[8:11], s29 offen offset:0 lds
v_mfma_f32_16x16x32_bf16 v[84:87], v[148:151], v[132:135], v[84:87]
ds_read_b64_tr_b16 v[180:181], v29 offset:4096
v_mfma_f32_16x16x32_bf16 v[88:91], v[148:151], v[136:139], v[88:91]
ds_read_b64_tr_b16 v[182:183], v29 offset:4608
v_mfma_f32_16x16x32_bf16 v[92:95], v[148:151], v[140:143], v[92:95]
buffer_load_dwordx4 v21, s[8:11], s29 offen offset:1024 lds
s_add_u32 s27, s27, 1
s_waitcnt lgkmcnt(2)
v_mfma_f32_16x16x32_bf16 v[64:67], v[176:179], v[160:163], v[64:67]
s_cmp_eq_u32 s27, 10
s_cselect_b32 s27, 0, s27
s_lshl_b32 s28, s27, 7
v_mfma_f32_16x16x32_bf16 v[68:71], v[176:179], v[164:167], v[68:71]
s_mul_i32 s29, s27, 221184
s_add_u32 m0, s47, 0
s_waitcnt vmcnt(12)
s_waitcnt lgkmcnt(0)
s_barrier
v_mfma_f32_16x16x32_bf16 v[72:75], v[176:179], v[168:171], v[72:75]
ds_read_b64_tr_b16 v[144:145], v28 offset:32768
ds_read_b64_tr_b16 v[146:147], v28 offset:33280
buffer_load_dwordx4 v16, s[4:7], s28 offen offset:0 lds
v_mfma_f32_16x16x32_bf16 v[76:79], v[176:179], v[172:175], v[76:79]
ds_read_b128 v[128:131], v24 offset:32768
v_mfma_f32_16x16x32_bf16 v[80:83], v[180:183], v[160:163], v[80:83]
ds_read_b128 v[132:135], v24 offset:34816
buffer_load_dwordx4 v17, s[4:7], s28 offen offset:1024 lds
v_mfma_f32_16x16x32_bf16 v[84:87], v[180:183], v[164:167], v[84:87]
ds_read_b128 v[136:139], v24 offset:36864
ds_read_b128 v[140:143], v24 offset:38912
v_mfma_f32_16x16x32_bf16 v[88:91], v[180:183], v[168:171], v[88:91]
ds_read_b64_tr_b16 v[148:149], v29 offset:32768
v_mfma_f32_16x16x32_bf16 v[92:95], v[180:183], v[172:175], v[92:95]
ds_read_b64_tr_b16 v[150:151], v29 offset:33280
buffer_load_dwordx4 v18, s[4:7], s28 offen offset:2048 lds
s_waitcnt lgkmcnt(2)
v_mfma_f32_16x16x32_bf16 v[64:67], v[144:147], v[128:131], v[64:67]
v_mfma_f32_16x16x32_bf16 v[68:71], v[144:147], v[132:135], v[68:71]
ds_read_b64_tr_b16 v[176:177], v28 offset:36864
ds_read_b64_tr_b16 v[178:179], v28 offset:37376
v_mfma_f32_16x16x32_bf16 v[72:75], v[144:147], v[136:139], v[72:75]
ds_read_b128 v[160:163], v25 offset:32768
buffer_load_dwordx4 v19, s[4:7], s28 offen offset:3072 lds
s_add_u32 m0, s48, 0
v_mfma_f32_16x16x32_bf16 v[76:79], v[144:147], v[140:143], v[76:79]
ds_read_b128 v[164:167], v25 offset:34816
s_waitcnt lgkmcnt(4)
v_mfma_f32_16x16x32_bf16 v[80:83], v[148:151], v[128:131], v[80:83]
ds_read_b128 v[168:171], v25 offset:36864
ds_read_b128 v[172:175], v25 offset:38912
buffer_load_dwordx4 v20, s[8:11], s29 offen offset:0 lds
v_mfma_f32_16x16x32_bf16 v[84:87], v[148:151], v[132:135], v[84:87]
ds_read_b64_tr_b16 v[180:181], v29 offset:36864
v_mfma_f32_16x16x32_bf16 v[88:91], v[148:151], v[136:139], v[88:91]
ds_read_b64_tr_b16 v[182:183], v29 offset:37376
v_mfma_f32_16x16x32_bf16 v[92:95], v[148:151], v[140:143], v[92:95]
buffer_load_dwordx4 v21, s[8:11], s29 offen offset:1024 lds
s_add_u32 s27, s27, 1
s_waitcnt lgkmcnt(2)
v_mfma_f32_16x16x32_bf16 v[64:67], v[176:179], v[160:163], v[64:67]
s_cmp_eq_u32 s27, 10
s_cselect_b32 s27, 0, s27
s_lshl_b32 s28, s27, 7
v_mfma_f32_16x16x32_bf16 v[68:71], v[176:179], v[164:167], v[68:71]
s_mul_i32 s29, s27, 221184
s_add_u32 m0, s47, 32768
s_waitcnt vmcnt(12)
s_waitcnt lgkmcnt(0)
s_barrier
v_mfma_f32_16x16x32_bf16 v[72:75], v[176:179], v[168:171], v[72:75]
ds_read_b64_tr_b16 v[144:145], v32 offset:0
ds_read_b64_tr_b16 v[146:147], v32 offset:512
buffer_load_dwordx4 v16, s[4:7], s28 offen offset:0 lds
v_mfma_f32_16x16x32_bf16 v[76:79], v[176:179], v[172:175], v[76:79]
ds_read_b128 v[128:131], v26 offset:0
v_mfma_f32_16x16x32_bf16 v[80:83], v[180:183], v[160:163], v[80:83]
ds_read_b128 v[132:135], v26 offset:2048
buffer_load_dwordx4 v17, s[4:7], s28 offen offset:1024 lds
v_mfma_f32_16x16x32_bf16 v[84:87], v[180:183], v[164:167], v[84:87]
ds_read_b128 v[136:139], v26 offset:4096
ds_read_b128 v[140:143], v26 offset:6144
v_mfma_f32_16x16x32_bf16 v[88:91], v[180:183], v[168:171], v[88:91]
ds_read_b64_tr_b16 v[148:149], v33 offset:0
v_mfma_f32_16x16x32_bf16 v[92:95], v[180:183], v[172:175], v[92:95]
ds_read_b64_tr_b16 v[150:151], v33 offset:512
buffer_load_dwordx4 v18, s[4:7], s28 offen offset:2048 lds
s_waitcnt lgkmcnt(2)
v_mfma_f32_16x16x32_bf16 v[64:67], v[144:147], v[128:131], v[64:67]
v_mfma_f32_16x16x32_bf16 v[68:71], v[144:147], v[132:135], v[68:71]
ds_read_b64_tr_b16 v[176:177], v32 offset:4096
ds_read_b64_tr_b16 v[178:179], v32 offset:4608
v_mfma_f32_16x16x32_bf16 v[72:75], v[144:147], v[136:139], v[72:75]
ds_read_b128 v[160:163], v27 offset:0
buffer_load_dwordx4 v19, s[4:7], s28 offen offset:3072 lds
s_add_u32 m0, s48, 32768
v_mfma_f32_16x16x32_bf16 v[76:79], v[144:147], v[140:143], v[76:79]
ds_read_b128 v[164:167], v27 offset:2048
s_waitcnt lgkmcnt(4)
v_mfma_f32_16x16x32_bf16 v[80:83], v[148:151], v[128:131], v[80:83]
ds_read_b128 v[168:171], v27 offset:4096
ds_read_b128 v[172:175], v27 offset:6144
buffer_load_dwordx4 v20, s[8:11], s29 offen offset:0 lds
v_mfma_f32_16x16x32_bf16 v[84:87], v[148:151], v[132:135], v[84:87]
ds_read_b64_tr_b16 v[180:181], v33 offset:4096
v_mfma_f32_16x16x32_bf16 v[88:91], v[148:151], v[136:139], v[88:91]
ds_read_b64_tr_b16 v[182:183], v33 offset:4608
v_mfma_f32_16x16x32_bf16 v[92:95], v[148:151], v[140:143], v[92:95]
buffer_load_dwordx4 v21, s[8:11], s29 offen offset:1024 lds
s_add_u32 s27, s27, 1
s_waitcnt lgkmcnt(2)
v_mfma_f32_16x16x32_bf16 v[64:67], v[176:179], v[160:163], v[64:67]
s_cmp_eq_u32 s27, 10
s_cselect_b32 s27, 0, s27
s_lshl_b32 s28, s27, 7
v_mfma_f32_16x16x32_bf16 v[68:71], v[176:179], v[164:167], v[68:71]
s_mul_i32 s29, s27, 221184
s_waitcnt vmcnt(12)
s_waitcnt lgkmcnt(0)
s_barrier
v_mfma_f32_16x16x32_bf16 v[72:75], v[176:179], v[168:171], v[72:75]
ds_read_b64_tr_b16 v[144:145], v32 offset:32768
ds_read_b64_tr_b16 v[146:147], v32 offset:33280
v_mfma_f32_16x16x32_bf16 v[76:79], v[176:179], v[172:175], v[76:79]
ds_read_b128 v[128:131], v26 offset:32768
v_mfma_f32_16x16x32_bf16 v[80:83], v[180:183], v[160:163], v[80:83]
ds_read_b128 v[132:135], v26 offset:34816
v_mfma_f32_16x16x32_bf16 v[84:87], v[180:183], v[164:167], v[84:87]
ds_read_b128 v[136:139], v26 offset:36864
ds_read_b128 v[140:143], v26 offset:38912
v_mfma_f32_16x16x32_bf16 v[88:91], v[180:183], v[168:171], v[88:91]
ds_read_b64_tr_b16 v[148:149], v33 offset:32768
v_mfma_f32_16x16x32_bf16 v[92:95], v[180:183], v[172:175], v[92:95]
ds_read_b64_tr_b16 v[150:151], v33 offset:33280
s_waitcnt lgkmcnt(2)
v_mfma_f32_16x16x32_bf16 v[64:67], v[144:147], v[128:131], v[64:67]
v_mfma_f32_16x16x32_bf16 v[68:71], v[144:147], v[132:135], v[68:71]
ds_read_b64_tr_b16 v[176:177], v32 offset:36864
ds_read_b64_tr_b16 v[178:179], v32 offset:37376
v_mfma_f32_16x16x32_bf16 v[72:75], v[144:147], v[136:139], v[72:75]
ds_read_b128 v[160:163], v27 offset:32768
v_mfma_f32_16x16x32_bf16 v[76:79], v[144:147], v[140:143], v[76:79]
ds_read_b128 v[164:167], v27 offset:34816
s_waitcnt lgkmcnt(4)
v_mfma_f32_16x16x32_bf16 v[80:83], v[148:151], v[128:131], v[80:83]
ds_read_b128 v[168:171], v27 offset:36864
ds_read_b128 v[172:175], v27 offset:38912
v_mfma_f32_16x16x32_bf16 v[84:87], v[148:151], v[132:135], v[84:87]
ds_read_b64_tr_b16 v[180:181], v33 offset:36864
v_mfma_f32_16x16x32_bf16 v[88:91], v[148:151], v[136:139], v[88:91]
ds_read_b64_tr_b16 v[182:183], v33 offset:37376
v_mfma_f32_16x16x32_bf16 v[92:95], v[148:151], v[140:143], v[92:95]
s_waitcnt lgkmcnt(2)
v_mfma_f32_16x16x32_bf16 v[64:67], v[176:179], v[160:163], v[64:67]
v_mfma_f32_16x16x32_bf16 v[68:71], v[176:179], v[164:167], v[68:71]
s_waitcnt vmcnt(6)
s_waitcnt lgkmcnt(0)
s_barrier
v_mfma_f32_16x16x32_bf16 v[72:75], v[176:179], v[168:171], v[72:75]
ds_read_b64_tr_b16 v[144:145], v28 offset:0
ds_read_b64_tr_b16 v[146:147], v28 offset:512
v_mfma_f32_16x16x32_bf16 v[76:79], v[176:179], v[172:175], v[76:79]
ds_read_b128 v[128:131], v24 offset:0
v_mfma_f32_16x16x32_bf16 v[80:83], v[180:183], v[160:163], v[80:83]
ds_read_b128 v[132:135], v24 offset:2048
v_mfma_f32_16x16x32_bf16 v[84:87], v[180:183], v[164:167], v[84:87]
ds_read_b128 v[136:139], v24 offset:4096
ds_read_b128 v[140:143], v24 offset:6144
v_mfma_f32_16x16x32_bf16 v[88:91], v[180:183], v[168:171], v[88:91]
ds_read_b64_tr_b16 v[148:149], v29 offset:0
v_mfma_f32_16x16x32_bf16 v[92:95], v[180:183], v[172:175], v[92:95]
ds_read_b64_tr_b16 v[150:151], v29 offset:512
s_waitcnt lgkmcnt(2)
v_mfma_f32_16x16x32_bf16 v[64:67], v[144:147], v[128:131], v[64:67]
v_mfma_f32_16x16x32_bf16 v[68:71], v[144:147], v[132:135], v[68:71]
ds_read_b64_tr_b16 v[176:177], v28 offset:4096
ds_read_b64_tr_b16 v[178:179], v28 offset:4608
v_mfma_f32_16x16x32_bf16 v[72:75], v[144:147], v[136:139], v[72:75]
ds_read_b128 v[160:163], v25 offset:0
v_mfma_f32_16x16x32_bf16 v[76:79], v[144:147], v[140:143], v[76:79]
ds_read_b128 v[164:167], v25 offset:2048
s_waitcnt lgkmcnt(4)
v_mfma_f32_16x16x32_bf16 v[80:83], v[148:151], v[128:131], v[80:83]
ds_read_b128 v[168:171], v25 offset:4096
ds_read_b128 v[172:175], v25 offset:6144
v_mfma_f32_16x16x32_bf16 v[84:87], v[148:151], v[132:135], v[84:87]
ds_read_b64_tr_b16 v[180:181], v29 offset:4096
v_mfma_f32_16x16x32_bf16 v[88:91], v[148:151], v[136:139], v[88:91]
ds_read_b64_tr_b16 v[182:183], v29 offset:4608
v_mfma_f32_16x16x32_bf16 v[92:95], v[148:151], v[140:143], v[92:95]
s_waitcnt lgkmcnt(2)
v_mfma_f32_16x16x32_bf16 v[64:67], v[176:179], v[160:163], v[64:67]
v_mfma_f32_16x16x32_bf16 v[68:71], v[176:179], v[164:167], v[68:71]
s_waitcnt vmcnt(0)
s_waitcnt lgkmcnt(0)
s_barrier
v_mfma_f32_16x16x32_bf16 v[72:75], v[176:179], v[168:171], v[72:75]
ds_read_b64_tr_b16 v[144:145], v28 offset:32768
ds_read_b64_tr_b16 v[146:147], v28 offset:33280
v_mfma_f32_16x16x32_bf16 v[76:79], v[176:179], v[172:175], v[76:79]
ds_read_b128 v[128:131], v24 offset:32768
v_mfma_f32_16x16x32_bf16 v[80:83], v[180:183], v[160:163], v[80:83]
ds_read_b128 v[132:135], v24 offset:34816
v_mfma_f32_16x16x32_bf16 v[84:87], v[180:183], v[164:167], v[84:87]
ds_read_b128 v[136:139], v24 offset:36864
ds_read_b128 v[140:143], v24 offset:38912
v_mfma_f32_16x16x32_bf16 v[88:91], v[180:183], v[168:171], v[88:91]
ds_read_b64_tr_b16 v[148:149], v29 offset:32768
v_mfma_f32_16x16x32_bf16 v[92:95], v[180:183], v[172:175], v[92:95]
ds_read_b64_tr_b16 v[150:151], v29 offset:33280
s_waitcnt lgkmcnt(2)
v_mfma_f32_16x16x32_bf16 v[64:67], v[144:147], v[128:131], v[64:67]
v_mfma_f32_16x16x32_bf16 v[68:71], v[144:147], v[132:135], v[68:71]
ds_read_b64_tr_b16 v[176:177], v28 offset:36864
ds_read_b64_tr_b16 v[178:179], v28 offset:37376
v_mfma_f32_16x16x32_bf16 v[72:75], v[144:147], v[136:139], v[72:75]
ds_read_b128 v[160:163], v25 offset:32768
v_mfma_f32_16x16x32_bf16 v[76:79], v[144:147], v[140:143], v[76:79]
ds_read_b128 v[164:167], v25 offset:34816
s_waitcnt lgkmcnt(4)
v_mfma_f32_16x16x32_bf16 v[80:83], v[148:151], v[128:131], v[80:83]
ds_read_b128 v[168:171], v25 offset:36864
ds_read_b128 v[172:175], v25 offset:38912
v_mfma_f32_16x16x32_bf16 v[84:87], v[148:151], v[132:135], v[84:87]
ds_read_b64_tr_b16 v[180:181], v29 offset:36864
v_mfma_f32_16x16x32_bf16 v[88:91], v[148:151], v[136:139], v[88:91]
ds_read_b64_tr_b16 v[182:183], v29 offset:37376
v_mfma_f32_16x16x32_bf16 v[92:95], v[148:151], v[140:143], v[92:95]
s_waitcnt lgkmcnt(2)
v_mfma_f32_16x16x32_bf16 v[64:67], v[176:179], v[160:163], v[64:67]
v_mfma_f32_16x16x32_bf16 v[68:71], v[176:179], v[164:167], v[68:71]
s_waitcnt lgkmcnt(0)
s_barrier
v_mfma_f32_16x16x32_bf16 v[72:75], v[176:179], v[168:171], v[72:75]
v_mfma_f32_16x16x32_bf16 v[76:79], v[176:179], v[172:175], v[76:79]
v_mfma_f32_16x16x32_bf16 v[80:83], v[180:183], v[160:163], v[80:83]
v_mfma_f32_16x16x32_bf16 v[84:87], v[180:183], v[164:167], v[84:87]
v_mfma_f32_16x16x32_bf16 v[88:91], v[180:183], v[168:171], v[88:91]
v_mfma_f32_16x16x32_bf16 v[92:95], v[180:183], v[172:175], v[92:95]
s_nop 7
s_lshl_b32 s50, s22, 1
s_lshr_b32 s101, s3, 1
s_add_u32 s50, s50, s101
s_mul_i32 s50, s50, 221184
s_and_b32 s101, s3, 1
s_lshl_b32 s101, s101, 12
s_add_u32 s50, s50, s101
s_lshl_b32 s101, s23, 13
s_add_u32 s50, s50, s101
s_add_u32 s50, s50, 196608
s_mov_b32 s32, 0xbdd2d3e8
s_mov_b32 s33, 0xbdd2d3e8
v_mov_b32 v128, 0xc0135761
v_mov_b32 v129, 0xc0135761
s_mov_b32 s34, 1.0
s_mov_b32 s35, 1.0
v_pk_mul_f32 v[132:133], v[64:65], v[64:65]
v_pk_mul_f32 v[134:135], v[66:67], v[66:67]
v_pk_mul_f32 v[136:137], v[80:81], v[80:81]
v_pk_mul_f32 v[138:139], v[82:83], v[82:83]
v_pk_fma_f32 v[132:133], v[132:133], s[32:33], v[128:129]
v_pk_fma_f32 v[134:135], v[134:135], s[32:33], v[128:129]
v_pk_fma_f32 v[136:137], v[136:137], s[32:33], v[128:129]
v_pk_fma_f32 v[138:139], v[138:139], s[32:33], v[128:129]
v_pk_mul_f32 v[132:133], v[132:133], v[64:65]
v_pk_mul_f32 v[134:135], v[134:135], v[66:67]
v_pk_mul_f32 v[136:137], v[136:137], v[80:81]
v_pk_mul_f32 v[138:139], v[138:139], v[82:83]
v_exp_f32_e64 v132, v132
v_exp_f32_e64 v133, v133
v_exp_f32_e64 v134, v134
v_exp_f32_e64 v135, v135
v_exp_f32_e64 v136, v136
v_exp_f32_e64 v137, v137
v_exp_f32_e64 v138, v138
v_exp_f32_e64 v139, v139
v_pk_add_f32 v[132:133], v[132:133], s[34:35]
v_pk_add_f32 v[134:135], v[134:135], s[34:35]
v_pk_add_f32 v[136:137], v[136:137], s[34:35]
v_pk_add_f32 v[138:139], v[138:139], s[34:35]
v_rcp_f32_e64 v132, v132
v_rcp_f32_e64 v133, v133
v_rcp_f32_e64 v134, v134
v_rcp_f32_e64 v135, v135
v_rcp_f32_e64 v136, v136
v_rcp_f32_e64 v137, v137
v_rcp_f32_e64 v138, v138
v_rcp_f32_e64 v139, v139
v_pk_mul_f32 v[132:133], v[132:133], v[64:65]
v_pk_mul_f32 v[134:135], v[134:135], v[66:67]
v_pk_mul_f32 v[136:137], v[136:137], v[80:81]
v_pk_mul_f32 v[138:139], v[138:139], v[82:83]
v_cvt_pk_bf16_f32 v192, v132, v133
v_cvt_pk_bf16_f32 v193, v134, v135
v_cvt_pk_bf16_f32 v194, v136, v137
v_cvt_pk_bf16_f32 v195, v138, v139
v_pk_mul_f32 v[140:141], v[68:69], v[68:69]
v_pk_mul_f32 v[142:143], v[70:71], v[70:71]
v_pk_mul_f32 v[144:145], v[84:85], v[84:85]
v_pk_mul_f32 v[146:147], v[86:87], v[86:87]
v_pk_fma_f32 v[140:141], v[140:141], s[32:33], v[128:129]
v_pk_fma_f32 v[142:143], v[142:143], s[32:33], v[128:129]
v_pk_fma_f32 v[144:145], v[144:145], s[32:33], v[128:129]
v_pk_fma_f32 v[146:147], v[146:147], s[32:33], v[128:129]
v_pk_mul_f32 v[140:141], v[140:141], v[68:69]
v_pk_mul_f32 v[142:143], v[142:143], v[70:71]
v_pk_mul_f32 v[144:145], v[144:145], v[84:85]
v_pk_mul_f32 v[146:147], v[146:147], v[86:87]
v_exp_f32_e64 v140, v140
v_exp_f32_e64 v141, v141
v_exp_f32_e64 v142, v142
v_exp_f32_e64 v143, v143
v_exp_f32_e64 v144, v144
v_exp_f32_e64 v145, v145
v_exp_f32_e64 v146, v146
v_exp_f32_e64 v147, v147
v_pk_add_f32 v[140:141], v[140:141], s[34:35]
v_pk_add_f32 v[142:143], v[142:143], s[34:35]
v_pk_add_f32 v[144:145], v[144:145], s[34:35]
v_pk_add_f32 v[146:147], v[146:147], s[34:35]
v_rcp_f32_e64 v140, v140
v_rcp_f32_e64 v141, v141
v_rcp_f32_e64 v142, v142
v_rcp_f32_e64 v143, v143
v_rcp_f32_e64 v144, v144
v_rcp_f32_e64 v145, v145
v_rcp_f32_e64 v146, v146
v_rcp_f32_e64 v147, v147
v_pk_mul_f32 v[140:141], v[140:141], v[68:69]
v_pk_mul_f32 v[142:143], v[142:143], v[70:71]
v_pk_mul_f32 v[144:145], v[144:145], v[84:85]
v_pk_mul_f32 v[146:147], v[146:147], v[86:87]
v_cvt_pk_bf16_f32 v196, v140, v141
v_cvt_pk_bf16_f32 v197, v142, v143
v_cvt_pk_bf16_f32 v198, v144, v145
v_cvt_pk_bf16_f32 v199, v146, v147
v_pk_mul_f32 v[132:133], v[72:73], v[72:73]
v_pk_mul_f32 v[134:135], v[74:75], v[74:75]
v_pk_mul_f32 v[136:137], v[88:89], v[88:89]
v_pk_mul_f32 v[138:139], v[90:91], v[90:91]
v_pk_fma_f32 v[132:133], v[132:133], s[32:33], v[128:129]
v_pk_fma_f32 v[134:135], v[134:135], s[32:33], v[128:129]
v_pk_fma_f32 v[136:137], v[136:137], s[32:33], v[128:129]
v_pk_fma_f32 v[138:139], v[138:139], s[32:33], v[128:129]
v_pk_mul_f32 v[132:133], v[132:133], v[72:73]
v_pk_mul_f32 v[134:135], v[134:135], v[74:75]
v_pk_mul_f32 v[136:137], v[136:137], v[88:89]
v_pk_mul_f32 v[138:139], v[138:139], v[90:91]
v_exp_f32_e64 v132, v132
v_exp_f32_e64 v133, v133
v_exp_f32_e64 v134, v134
v_exp_f32_e64 v135, v135
v_exp_f32_e64 v136, v136
v_exp_f32_e64 v137, v137
v_exp_f32_e64 v138, v138
v_exp_f32_e64 v139, v139
v_pk_add_f32 v[132:133], v[132:133], s[34:35]
v_pk_add_f32 v[134:135], v[134:135], s[34:35]
v_pk_add_f32 v[136:137], v[136:137], s[34:35]
v_pk_add_f32 v[138:139], v[138:139], s[34:35]
v_rcp_f32_e64 v132, v132
v_rcp_f32_e64 v133, v133
v_rcp_f32_e64 v134, v134
v_rcp_f32_e64 v135, v135
v_rcp_f32_e64 v136, v136
v_rcp_f32_e64 v137, v137
v_rcp_f32_e64 v138, v138
v_rcp_f32_e64 v139, v139
v_pk_mul_f32 v[132:133], v[132:133], v[72:73]
v_pk_mul_f32 v[134:135], v[134:135], v[74:75]
v_pk_mul_f32 v[136:137], v[136:137], v[88:89]
v_pk_mul_f32 v[138:139], v[138:139], v[90:91]
v_cvt_pk_bf16_f32 v200, v132, v133
v_cvt_pk_bf16_f32 v201, v134, v135
v_cvt_pk_bf16_f32 v202, v136, v137
v_cvt_pk_bf16_f32 v203, v138, v139
v_pk_mul_f32 v[140:141], v[76:77], v[76:77]
v_pk_mul_f32 v[142:143], v[78:79], v[78:79]
v_pk_mul_f32 v[144:145], v[92:93], v[92:93]
v_pk_mul_f32 v[146:147], v[94:95], v[94:95]
v_pk_fma_f32 v[140:141], v[140:141], s[32:33], v[128:129]
v_pk_fma_f32 v[142:143], v[142:143], s[32:33], v[128:129]
v_pk_fma_f32 v[144:145], v[144:145], s[32:33], v[128:129]
v_pk_fma_f32 v[146:147], v[146:147], s[32:33], v[128:129]
v_pk_mul_f32 v[140:141], v[140:141], v[76:77]
v_pk_mul_f32 v[142:143], v[142:143], v[78:79]
v_pk_mul_f32 v[144:145], v[144:145], v[92:93]
v_pk_mul_f32 v[146:147], v[146:147], v[94:95]
v_exp_f32_e64 v140, v140
v_exp_f32_e64 v141, v141
v_exp_f32_e64 v142, v142
v_exp_f32_e64 v143, v143
v_exp_f32_e64 v144, v144
v_exp_f32_e64 v145, v145
v_exp_f32_e64 v146, v146
v_exp_f32_e64 v147, v147
v_pk_add_f32 v[140:141], v[140:141], s[34:35]
v_pk_add_f32 v[142:143], v[142:143], s[34:35]
v_pk_add_f32 v[144:145], v[144:145], s[34:35]
v_pk_add_f32 v[146:147], v[146:147], s[34:35]
v_rcp_f32_e64 v140, v140
v_rcp_f32_e64 v141, v141
v_rcp_f32_e64 v142, v142
v_rcp_f32_e64 v143, v143
v_rcp_f32_e64 v144, v144
v_rcp_f32_e64 v145, v145
v_rcp_f32_e64 v146, v146
v_rcp_f32_e64 v147, v147
v_pk_mul_f32 v[140:141], v[140:141], v[76:77]
v_pk_mul_f32 v[142:143], v[142:143], v[78:79]
v_pk_mul_f32 v[144:145], v[144:145], v[92:93]
v_pk_mul_f32 v[146:147], v[146:147], v[94:95]
v_cvt_pk_bf16_f32 v204, v140, v141
v_cvt_pk_bf16_f32 v205, v142, v143
v_cvt_pk_bf16_f32 v206, v144, v145
v_cvt_pk_bf16_f32 v207, v146, v147
s_lshr_b32 s101, s3, 1
s_lshl_b32 s101, s101, 4
s_lshr_b32 s1, s1, s101
s_lshl_b32 s1, s1, 16
s_lshr_b32 s55, s55, s101
s_lshl_b32 s55, s55, 16
v_mov_b32 v122, 0x3fb8aa3b
v_mul_f32 v122, s1, v122
s_mul_i32 s101, s3, 4608
v_exp_f32 v122, v122
s_add_u32 s101, s101, 51456
v_lshl_add_u32 v188, v1, 2, s101
s_mov_b32 m0, s101
v_cvt_pk_bf16_f32 v122, v122, v122
v_mul_u32_u24 v189, 288, v2
v_lshlrev_b32 v122, 16, v122
v_lshl_add_u32 v189, v3, 4, v189
v_add_u32 v189, s101, v189
v_lshlrev_b32 v4, 16, v4
v_lshlrev_b32 v5, 16, v5
v_lshlrev_b32 v6, 16, v6
v_lshlrev_b32 v7, 16, v7
v_lshlrev_b32 v8, 16, v8
v_lshlrev_b32 v9, 16, v9
v_mul_f32 v120, v122, v4
v_mul_f32 v121, v122, v5
v_mul_f32 v120, 0x3fb8aa3b, v120
v_mul_f32 v121, 0x3e22f983, v121
v_mul_f32 v123, 0x41000000, v120
v_mul_f32 v124, 0xc1000000, v121
v_exp_f32 v123, v123
v_fract_f32 v124, v124
v_mul_f32 v6, v122, v6
v_cos_f32 v116, v124
v_sin_f32 v117, v124
v_mul_f32 v7, v122, v7
v_pk_mul_f32 v[116:117], v[116:117], v[122:123] op_sel:[0,1] op_sel_hi:[1,1]
v_mul_f32 v112, v8, v6
v_mul_f32 v113, v8, v7
v_fma_f32 v112, -v9, v7, v112
v_fma_f32 v113, -v9, v6, -v113
v_cvt_pk_bf16_f32 v128, v112, v113
v_pk_mul_f32 v[114:115], v[112:113], v[116:117] op_sel:[0,0] op_sel_hi:[0,1]
v_pk_fma_f32 v[114:115], v[112:113], v[116:117], v[114:115] op_sel:[1,1,0] op_sel_hi:[1,0,1] neg_lo:[1,0,0]
v_cvt_pk_bf16_f32 v129, v114, v115
ds_write_addtid_b32 v128 offset:0
v_pk_mul_f32 v[112:113], v[114:115], v[116:117] op_sel:[0,0] op_sel_hi:[0,1]
v_pk_fma_f32 v[112:113], v[114:115], v[116:117], v[112:113] op_sel:[1,1,0] op_sel_hi:[1,0,1] neg_lo:[1,0,0]
v_cvt_pk_bf16_f32 v130, v112, v113
ds_write_addtid_b32 v129 offset:288
v_pk_mul_f32 v[114:115], v[112:113], v[116:117] op_sel:[0,0] op_sel_hi:[0,1]
v_pk_fma_f32 v[114:115], v[112:113], v[116:117], v[114:115] op_sel:[1,1,0] op_sel_hi:[1,0,1] neg_lo:[1,0,0]
v_cvt_pk_bf16_f32 v131, v114, v115
s_lshr_b32 s101, s24, 5
s_lshl_b32 s101, s101, 11
s_add_u32 s101, s101, 16875520
v_lshl_add_u32 v13, v2, 7, s101
buffer_load_dwordx2 v[14:15], v13, s[12:15], 0 offen sc1
ds_write_addtid_b32 v130 offset:576
v_pk_mul_f32 v[112:113], v[114:115], v[116:117] op_sel:[0,0] op_sel_hi:[0,1]
v_pk_fma_f32 v[112:113], v[114:115], v[116:117], v[112:113] op_sel:[1,1,0] op_sel_hi:[1,0,1] neg_lo:[1,0,0]
v_cvt_pk_bf16_f32 v132, v112, v113
ds_write_addtid_b32 v131 offset:864
v_pk_mul_f32 v[114:115], v[112:113], v[116:117] op_sel:[0,0] op_sel_hi:[0,1]
v_pk_fma_f32 v[114:115], v[112:113], v[116:117], v[114:115] op_sel:[1,1,0] op_sel_hi:[1,0,1] neg_lo:[1,0,0]
v_cvt_pk_bf16_f32 v133, v114, v115
ds_write_addtid_b32 v132 offset:1152
v_pk_mul_f32 v[112:113], v[114:115], v[116:117] op_sel:[0,0] op_sel_hi:[0,1]
v_pk_fma_f32 v[112:113], v[114:115], v[116:117], v[112:113] op_sel:[1,1,0] op_sel_hi:[1,0,1] neg_lo:[1,0,0]
s_mul_i32 s101, s3, 14
s_cmp_eq_u32 s3, 3
s_subb_u32 s101, s101, 0
s_lshr_b32 s100, s3, 1
s_sub_u32 s100, 13, s100
v_min_u32 v12, s100, v1
s_lshl_b32 s100, s26, 6
s_add_u32 s101, s101, s100
s_lshl_b32 s101, s101, 7
s_add_u32 s101, s101, 16908288
v_lshl_add_u32 v12, v12, 7, s101
buffer_load_dwordx2 v[226:227], v12, s[12:15], 0 offen sc1
v_cvt_pk_bf16_f32 v134, v112, v113
ds_write_addtid_b32 v133 offset:1440
v_pk_mul_f32 v[114:115], v[112:113], v[116:117] op_sel:[0,0] op_sel_hi:[0,1]
v_pk_fma_f32 v[114:115], v[112:113], v[116:117], v[114:115] op_sel:[1,1,0] op_sel_hi:[1,0,1] neg_lo:[1,0,0]
v_cvt_pk_bf16_f32 v135, v114, v115
ds_write_addtid_b32 v134 offset:1728
v_pk_mul_f32 v[112:113], v[114:115], v[116:117] op_sel:[0,0] op_sel_hi:[0,1]
v_pk_fma_f32 v[112:113], v[114:115], v[116:117], v[112:113] op_sel:[1,1,0] op_sel_hi:[1,0,1] neg_lo:[1,0,0]
v_cvt_pk_bf16_f32 v128, v112, v113
ds_write_addtid_b32 v135 offset:2016
v_pk_mul_f32 v[114:115], v[112:113], v[116:117] op_sel:[0,0] op_sel_hi:[0,1]
v_pk_fma_f32 v[114:115], v[112:113], v[116:117], v[114:115] op_sel:[1,1,0] op_sel_hi:[1,0,1] neg_lo:[1,0,0]
v_cvt_pk_bf16_f32 v129, v114, v115
ds_write_addtid_b32 v128 offset:2304
v_pk_mul_f32 v[112:113], v[114:115], v[116:117] op_sel:[0,0] op_sel_hi:[0,1]
v_pk_fma_f32 v[112:113], v[114:115], v[116:117], v[112:113] op_sel:[1,1,0] op_sel_hi:[1,0,1] neg_lo:[1,0,0]
v_cvt_pk_bf16_f32 v130, v112, v113
ds_write_addtid_b32 v129 offset:2592
v_pk_mul_f32 v[114:115], v[112:113], v[116:117] op_sel:[0,0] op_sel_hi:[0,1]
v_pk_fma_f32 v[114:115], v[112:113], v[116:117], v[114:115] op_sel:[1,1,0] op_sel_hi:[1,0,1] neg_lo:[1,0,0]
v_cvt_pk_bf16_f32 v131, v114, v115
ds_write_addtid_b32 v130 offset:2880
v_pk_mul_f32 v[112:113], v[114:115], v[116:117] op_sel:[0,0] op_sel_hi:[0,1]
v_pk_fma_f32 v[112:113], v[114:115], v[116:117], v[112:113] op_sel:[1,1,0] op_sel_hi:[1,0,1] neg_lo:[1,0,0]
v_cvt_pk_bf16_f32 v132, v112, v113
ds_write_addtid_b32 v131 offset:3168
v_pk_mul_f32 v[114:115], v[112:113], v[116:117] op_sel:[0,0] op_sel_hi:[0,1]
v_pk_fma_f32 v[114:115], v[112:113], v[116:117], v[114:115] op_sel:[1,1,0] op_sel_hi:[1,0,1] neg_lo:[1,0,0]
v_cvt_pk_bf16_f32 v133, v114, v115
ds_write_addtid_b32 v132 offset:3456
v_pk_mul_f32 v[112:113], v[114:115], v[116:117] op_sel:[0,0] op_sel_hi:[0,1]
v_pk_fma_f32 v[112:113], v[114:115], v[116:117], v[112:113] op_sel:[1,1,0] op_sel_hi:[1,0,1] neg_lo:[1,0,0]
v_cvt_pk_bf16_f32 v134, v112, v113
ds_write_addtid_b32 v133 offset:3744
v_pk_mul_f32 v[114:115], v[112:113], v[116:117] op_sel:[0,0] op_sel_hi:[0,1]
v_pk_fma_f32 v[114:115], v[112:113], v[116:117], v[114:115] op_sel:[1,1,0] op_sel_hi:[1,0,1] neg_lo:[1,0,0]
v_cvt_pk_bf16_f32 v135, v114, v115
ds_write_addtid_b32 v134 offset:4032
ds_write_addtid_b32 v135 offset:4320
ds_read_b128 v[144:147], v189 offset:0
ds_read_b128 v[148:151], v189 offset:64
ds_read_b128 v[152:155], v189 offset:128
ds_read_b128 v[156:159], v189 offset:192
v_mul_f32 v125, 1.0, v120
v_mul_f32 v126, 1.0, v121
v_exp_f32 v125, v125
v_fract_f32 v126, v126
v_cos_f32 v64, v126
v_sin_f32 v65, v126
s_nop 0
v_pk_mul_f32 v[64:65], v[64:65], v[124:125] op_sel:[0,1] op_sel_hi:[1,1]
v_mul_f32 v125, 0x43000000, v120
v_mul_f32 v126, 0x43000000, v121
v_exp_f32 v125, v125
v_fract_f32 v126, v126
v_cos_f32 v80, v126
v_sin_f32 v81, v126
s_nop 0
v_pk_mul_f32 v[80:81], v[80:81], v[124:125] op_sel:[0,1] op_sel_hi:[1,1]
v_mov_b32 v135, 0x3f80
v_cvt_pk_bf16_f32 v128, v64, v65
v_cvt_pk_bf16_f32 v129, v80, v81
v_pk_mul_f32 v[66:67], v[64:65], v[64:65] op_sel:[0,0] op_sel_hi:[0,1]
ds_write_b32 v188, v135
v_pk_fma_f32 v[66:67], v[64:65], v[64:65], v[66:67] op_sel:[1,1,0] op_sel_hi:[1,0,1] neg_lo:[1,0,0]
ds_write_addtid_b32 v128 offset:288
v_cvt_pk_bf16_f32 v130, v66, v67
ds_write_addtid_b32 v129 offset:2304
v_pk_mul_f32 v[68:69], v[66:67], v[64:65] op_sel:[0,0] op_sel_hi:[0,1]
v_pk_fma_f32 v[68:69], v[66:67], v[64:65], v[68:69] op_sel:[1,1,0] op_sel_hi:[1,0,1] neg_lo:[1,0,0]
v_cvt_pk_bf16_f32 v131, v68, v69
ds_write_addtid_b32 v130 offset:576
v_pk_mul_f32 v[70:71], v[66:67], v[66:67] op_sel:[0,0] op_sel_hi:[0,1]
v_pk_fma_f32 v[70:71], v[66:67], v[66:67], v[70:71] op_sel:[1,1,0] op_sel_hi:[1,0,1] neg_lo:[1,0,0]
v_cvt_pk_bf16_f32 v132, v70, v71
ds_write_addtid_b32 v131 offset:864
v_pk_mul_f32 v[72:73], v[70:71], v[64:65] op_sel:[0,0] op_sel_hi:[0,1]
v_pk_fma_f32 v[72:73], v[70:71], v[64:65], v[72:73] op_sel:[1,1,0] op_sel_hi:[1,0,1] neg_lo:[1,0,0]
v_cvt_pk_bf16_f32 v133, v72, v73
ds_write_addtid_b32 v132 offset:1152
v_pk_mul_f32 v[74:75], v[70:71], v[66:67] op_sel:[0,0] op_sel_hi:[0,1]
v_pk_fma_f32 v[74:75], v[70:71], v[66:67], v[74:75] op_sel:[1,1,0] op_sel_hi:[1,0,1] neg_lo:[1,0,0]
v_cvt_pk_bf16_f32 v134, v74, v75
ds_write_addtid_b32 v133 offset:1440
v_pk_mul_f32 v[76:77], v[70:71], v[68:69] op_sel:[0,0] op_sel_hi:[0,1]
v_pk_fma_f32 v[76:77], v[70:71], v[68:69], v[76:77] op_sel:[1,1,0] op_sel_hi:[1,0,1] neg_lo:[1,0,0]
v_cvt_pk_bf16_f32 v135, v76, v77
ds_write_addtid_b32 v134 offset:1728
v_pk_mul_f32 v[136:137], v[80:81], v[64:65] op_sel:[0,0] op_sel_hi:[0,1]
v_pk_fma_f32 v[136:137], v[80:81], v[64:65], v[136:137] op_sel:[1,1,0] op_sel_hi:[1,0,1] neg_lo:[1,0,0]
v_cvt_pk_bf16_f32 v128, v136, v137
ds_write_addtid_b32 v135 offset:2016
v_pk_mul_f32 v[138:139], v[80:81], v[66:67] op_sel:[0,0] op_sel_hi:[0,1]
v_pk_fma_f32 v[138:139], v[80:81], v[66:67], v[138:139] op_sel:[1,1,0] op_sel_hi:[1,0,1] neg_lo:[1,0,0]
s_waitcnt vmcnt(1)
v_cmp_ne_u64 vcc, v[14:15], s[20:21]
s_cbranch_vccnz slow20
back21:
s_lshr_b32 s51, s24, 1
s_lshl_b32 s51, s51, 14
s_add_u32 s51, s51, 10485760
v_lshlrev_b32 v13, 4, v0
buffer_load_dwordx4 v[36:39], v13, s[12:15], s51 offen sc1
v_cvt_pk_bf16_f32 v129, v138, v139
ds_write_addtid_b32 v128 offset:2592
v_pk_mul_f32 v[140:141], v[80:81], v[68:69] op_sel:[0,0] op_sel_hi:[0,1]
v_pk_fma_f32 v[140:141], v[80:81], v[68:69], v[140:141] op_sel:[1,1,0] op_sel_hi:[1,0,1] neg_lo:[1,0,0]
v_cvt_pk_bf16_f32 v130, v140, v141
ds_write_addtid_b32 v129 offset:2880
v_pk_mul_f32 v[142:143], v[80:81], v[70:71] op_sel:[0,0] op_sel_hi:[0,1]
v_pk_fma_f32 v[142:143], v[80:81], v[70:71], v[142:143] op_sel:[1,1,0] op_sel_hi:[1,0,1] neg_lo:[1,0,0]
v_cvt_pk_bf16_f32 v131, v142, v143
s_add_u32 s51, s51, 4096
buffer_load_dwordx4 v[40:43], v13, s[12:15], s51 offen sc1
ds_write_addtid_b32 v130 offset:3168
v_pk_mul_f32 v[136:137], v[80:81], v[72:73] op_sel:[0,0] op_sel_hi:[0,1]
v_pk_fma_f32 v[136:137], v[80:81], v[72:73], v[136:137] op_sel:[1,1,0] op_sel_hi:[1,0,1] neg_lo:[1,0,0]
v_cvt_pk_bf16_f32 v132, v136, v137
ds_write_addtid_b32 v131 offset:3456
v_pk_mul_f32 v[138:139], v[80:81], v[74:75] op_sel:[0,0] op_sel_hi:[0,1]
v_pk_fma_f32 v[138:139], v[80:81], v[74:75], v[138:139] op_sel:[1,1,0] op_sel_hi:[1,0,1] neg_lo:[1,0,0]
v_cvt_pk_bf16_f32 v133, v138, v139
ds_write_addtid_b32 v132 offset:3744
v_pk_mul_f32 v[140:141], v[80:81], v[76:77] op_sel:[0,0] op_sel_hi:[0,1]
v_pk_fma_f32 v[140:141], v[80:81], v[76:77], v[140:141] op_sel:[1,1,0] op_sel_hi:[1,0,1] neg_lo:[1,0,0]
v_cvt_pk_bf16_f32 v134, v140, v141
ds_write_addtid_b32 v133 offset:4032
ds_write_addtid_b32 v134 offset:4320
s_add_u32 s51, s51, 4096
buffer_load_dwordx4 v[44:47], v13, s[12:15], s51 offen sc1
ds_read_b128 v[160:163], v189 offset:0
ds_read_b128 v[164:167], v189 offset:64
ds_read_b128 v[168:171], v189 offset:128
ds_read_b128 v[172:175], v189 offset:192
v_pk_mul_f32 v[82:83], v[80:81], v[80:81] op_sel:[0,0] op_sel_hi:[0,1]
v_pk_fma_f32 v[82:83], v[80:81], v[80:81], v[82:83] op_sel:[1,1,0] op_sel_hi:[1,0,1] neg_lo:[1,0,0]
v_pk_mul_f32 v[84:85], v[82:83], v[80:81] op_sel:[0,0] op_sel_hi:[0,1]
v_pk_fma_f32 v[84:85], v[82:83], v[80:81], v[84:85] op_sel:[1,1,0] op_sel_hi:[1,0,1] neg_lo:[1,0,0]
v_pk_mul_f32 v[86:87], v[82:83], v[82:83] op_sel:[0,0] op_sel_hi:[0,1]
v_pk_fma_f32 v[86:87], v[82:83], v[82:83], v[86:87] op_sel:[1,1,0] op_sel_hi:[1,0,1] neg_lo:[1,0,0]
v_pk_mul_f32 v[88:89], v[86:87], v[80:81] op_sel:[0,0] op_sel_hi:[0,1]
v_pk_fma_f32 v[88:89], v[86:87], v[80:81], v[88:89] op_sel:[1,1,0] op_sel_hi:[1,0,1] neg_lo:[1,0,0]
v_pk_mul_f32 v[90:91], v[86:87], v[82:83] op_sel:[0,0] op_sel_hi:[0,1]
v_pk_fma_f32 v[90:91], v[86:87], v[82:83], v[90:91] op_sel:[1,1,0] op_sel_hi:[1,0,1] neg_lo:[1,0,0]
s_add_u32 s51, s51, 4096
buffer_load_dwordx4 v[48:51], v13, s[12:15], s51 offen sc1
v_pk_mul_f32 v[92:93], v[86:87], v[84:85] op_sel:[0,0] op_sel_hi:[0,1]
v_pk_fma_f32 v[92:93], v[86:87], v[84:85], v[92:93] op_sel:[1,1,0] op_sel_hi:[1,0,1] neg_lo:[1,0,0]
v_pk_mul_f32 v[94:95], v[86:87], v[86:87] op_sel:[0,0] op_sel_hi:[0,1]
v_pk_fma_f32 v[94:95], v[86:87], v[86:87], v[94:95] op_sel:[1,1,0] op_sel_hi:[1,0,1] neg_lo:[1,0,0]
s_waitcnt lgkmcnt(0)
v_mfma_f32_16x16x32_bf16 v[176:179], v[160:163], v[144:147], 0
v_mfma_f32_16x16x32_bf16 v[176:179], v[164:167], v[148:151], v[176:179]
v_mfma_f32_16x16x32_bf16 v[176:179], v[168:171], v[152:155], v[176:179]
v_mfma_f32_16x16x32_bf16 v[176:179], v[172:175], v[156:159], v[176:179]
s_waitcnt vmcnt(4)
v_cmp_ne_u64 vcc, v[226:227], s[20:21]
s_cbranch_vccnz slow22
back23:
v_cvt_pk_bf16_f32 v135, v82, v83
v_pk_mul_f32 v[142:143], v[82:83], v[66:67] op_sel:[0,0] op_sel_hi:[0,1]
v_pk_fma_f32 v[142:143], v[82:83], v[66:67], v[142:143] op_sel:[1,1,0] op_sel_hi:[1,0,1] neg_lo:[1,0,0]
v_cvt_pk_bf16_f32 v128, v142, v143
ds_write_addtid_b32 v135 offset:0
v_pk_mul_f32 v[136:137], v[82:83], v[70:71] op_sel:[0,0] op_sel_hi:[0,1]
v_pk_fma_f32 v[136:137], v[82:83], v[70:71], v[136:137] op_sel:[1,1,0] op_sel_hi:[1,0,1] neg_lo:[1,0,0]
v_cvt_pk_bf16_f32 v129, v136, v137
ds_write_addtid_b32 v128 offset:288
v_pk_mul_f32 v[138:139], v[82:83], v[74:75] op_sel:[0,0] op_sel_hi:[0,1]
v_pk_fma_f32 v[138:139], v[82:83], v[74:75], v[138:139] op_sel:[1,1,0] op_sel_hi:[1,0,1] neg_lo:[1,0,0]
v_cvt_pk_bf16_f32 v130, v138, v139
ds_write_addtid_b32 v129 offset:576
v_cvt_pk_bf16_f32 v131, v84, v85
v_pk_mul_f32 v[140:141], v[84:85], v[66:67] op_sel:[0,0] op_sel_hi:[0,1]
v_pk_fma_f32 v[140:141], v[84:85], v[66:67], v[140:141] op_sel:[1,1,0] op_sel_hi:[1,0,1] neg_lo:[1,0,0]
ds_write_addtid_b32 v130 offset:864
v_cvt_pk_bf16_f32 v132, v140, v141
ds_write_addtid_b32 v131 offset:1152
v_pk_mul_f32 v[142:143], v[84:85], v[70:71] op_sel:[0,0] op_sel_hi:[0,1]
v_pk_fma_f32 v[142:143], v[84:85], v[70:71], v[142:143] op_sel:[1,1,0] op_sel_hi:[1,0,1] neg_lo:[1,0,0]
v_cvt_pk_bf16_f32 v133, v142, v143
ds_write_addtid_b32 v132 offset:1440
v_pk_mul_f32 v[136:137], v[84:85], v[74:75] op_sel:[0,0] op_sel_hi:[0,1]
v_pk_fma_f32 v[136:137], v[84:85], v[74:75], v[136:137] op_sel:[1,1,0] op_sel_hi:[1,0,1] neg_lo:[1,0,0]
v_cvt_pk_bf16_f32 v134, v136, v137
ds_write_addtid_b32 v133 offset:1728
buffer_store_dwordx4 v[192:195], v56, s[12:15], s50 offen offset:0 sc1
v_cvt_pk_bf16_f32 v135, v86, v87
v_pk_mul_f32 v[138:139], v[86:87], v[70:71] op_sel:[0,0] op_sel_hi:[0,1]
v_pk_fma_f32 v[138:139], v[86:87], v[70:71], v[138:139] op_sel:[1,1,0] op_sel_hi:[1,0,1] neg_lo:[1,0,0]
ds_write_addtid_b32 v134 offset:2016
v_cvt_pk_bf16_f32 v128, v138, v139
ds_write_addtid_b32 v135 offset:2304
v_cvt_pk_bf16_f32 v129, v88, v89
v_pk_mul_f32 v[140:141], v[88:89], v[70:71] op_sel:[0,0] op_sel_hi:[0,1]
v_pk_fma_f32 v[140:141], v[88:89], v[70:71], v[140:141] op_sel:[1,1,0] op_sel_hi:[1,0,1] neg_lo:[1,0,0]
ds_write_addtid_b32 v128 offset:2592
v_cvt_pk_bf16_f32 v130, v140, v141
ds_write_addtid_b32 v129 offset:2880
v_cvt_pk_bf16_f32 v131, v90, v91
v_pk_mul_f32 v[142:143], v[90:91], v[70:71] op_sel:[0,0] op_sel_hi:[0,1]
v_pk_fma_f32 v[142:143], v[90:91], v[70:71], v[142:143] op_sel:[1,1,0] op_sel_hi:[1,0,1] neg_lo:[1,0,0]
buffer_store_dwordx4 v[196:199], v56, s[12:15], s50 offen offset:1024 sc1
ds_write_addtid_b32 v130 offset:3168
v_cvt_pk_bf16_f32 v132, v142, v143
ds_write_addtid_b32 v131 offset:3456
v_cvt_pk_bf16_f32 v133, v92, v93
v_pk_mul_f32 v[136:137], v[92:93], v[70:71] op_sel:[0,0] op_sel_hi:[0,1]
v_pk_fma_f32 v[136:137], v[92:93], v[70:71], v[136:137] op_sel:[1,1,0] op_sel_hi:[1,0,1] neg_lo:[1,0,0]
ds_write_addtid_b32 v132 offset:3744
v_cvt_pk_bf16_f32 v134, v136, v137
ds_write_addtid_b32 v133 offset:4032
ds_write_addtid_b32 v134 offset:4320
ds_read_b128 v[160:163], v189 offset:0
ds_read_b128 v[164:167], v189 offset:64
ds_read_b128 v[168:171], v189 offset:128
ds_read_b128 v[172:175], v189 offset:192
v_pk_mul_f32 v[96:97], v[94:95], v[80:81] op_sel:[0,0] op_sel_hi:[0,1]
buffer_store_dwordx4 v[200:203], v56, s[12:15], s50 offen offset:2048 sc1
v_pk_fma_f32 v[96:97], v[94:95], v[80:81], v[96:97] op_sel:[1,1,0] op_sel_hi:[1,0,1] neg_lo:[1,0,0]
v_pk_mul_f32 v[98:99], v[94:95], v[82:83] op_sel:[0,0] op_sel_hi:[0,1]
v_pk_fma_f32 v[98:99], v[94:95], v[82:83], v[98:99] op_sel:[1,1,0] op_sel_hi:[1,0,1] neg_lo:[1,0,0]
v_pk_mul_f32 v[100:101], v[94:95], v[84:85] op_sel:[0,0] op_sel_hi:[0,1]
v_pk_fma_f32 v[100:101], v[94:95], v[84:85], v[100:101] op_sel:[1,1,0] op_sel_hi:[1,0,1] neg_lo:[1,0,0]
v_pk_mul_f32 v[102:103], v[94:95], v[86:87] op_sel:[0,0] op_sel_hi:[0,1]
v_pk_fma_f32 v[102:103], v[94:95], v[86:87], v[102:103] op_sel:[1,1,0] op_sel_hi:[1,0,1] neg_lo:[1,0,0]
v_pk_mul_f32 v[104:105], v[94:95], v[88:89] op_sel:[0,0] op_sel_hi:[0,1]
v_pk_fma_f32 v[104:105], v[94:95], v[88:89], v[104:105] op_sel:[1,1,0] op_sel_hi:[1,0,1] neg_lo:[1,0,0]
v_pk_mul_f32 v[106:107], v[94:95], v[90:91] op_sel:[0,0] op_sel_hi:[0,1]
v_pk_fma_f32 v[106:107], v[94:95], v[90:91], v[106:107] op_sel:[1,1,0] op_sel_hi:[1,0,1] neg_lo:[1,0,0]
v_pk_mul_f32 v[108:109], v[94:95], v[92:93] op_sel:[0,0] op_sel_hi:[0,1]
v_pk_fma_f32 v[108:109], v[94:95], v[92:93], v[108:109] op_sel:[1,1,0] op_sel_hi:[1,0,1] neg_lo:[1,0,0]
v_pk_mul_f32 v[110:111], v[94:95], v[94:95] op_sel:[0,0] op_sel_hi:[0,1]
v_pk_fma_f32 v[110:111], v[94:95], v[94:95], v[110:111] op_sel:[1,1,0] op_sel_hi:[1,0,1] neg_lo:[1,0,0]
s_waitcnt lgkmcnt(0)
buffer_store_dwordx4 v[204:207], v56, s[12:15], s50 offen offset:3072 sc1
v_mfma_f32_16x16x32_bf16 v[180:183], v[160:163], v[144:147], 0
v_mfma_f32_16x16x32_bf16 v[180:183], v[164:167], v[148:151], v[180:183]
v_mfma_f32_16x16x32_bf16 v[180:183], v[168:171], v[152:155], v[180:183]
v_mfma_f32_16x16x32_bf16 v[180:183], v[172:175], v[156:159], v[180:183]
v_cvt_pk_bf16_f32 v135, v94, v95
v_cvt_pk_bf16_f32 v128, v96, v97
v_cvt_pk_bf16_f32 v129, v98, v99
v_cvt_pk_bf16_f32 v130, v100, v101
ds_write_addtid_b32 v135 offset:0
v_cvt_pk_bf16_f32 v131, v102, v103
ds_write_addtid_b32 v128 offset:288
v_cvt_pk_bf16_f32 v132, v104, v105
ds_write_addtid_b32 v129 offset:576
v_cvt_pk_bf16_f32 v133, v106, v107
ds_write_addtid_b32 v130 offset:864
v_cvt_pk_bf16_f32 v134, v108, v109
ds_write_addtid_b32 v131 offset:1152
v_cvt_pk_bf16_f32 v135, v110, v111
ds_write_addtid_b32 v132 offset:1440
ds_write_addtid_b32 v133 offset:1728
ds_write_addtid_b32 v134 offset:2016
ds_write_addtid_b32 v135 offset:2304
ds_read_b128 v[160:163], v189 offset:0
ds_read_b128 v[164:167], v189 offset:64
ds_read_b128 v[168:171], v189 offset:128
ds_read_b128 v[172:175], v189 offset:192
s_mul_i32 s101, s3, 3072
v_lshrrev_b32 v123, 1, v3
v_and_b32 v124, 1, v3
v_lshlrev_b32 v190, 9, v123
v_lshl_add_u32 v190, v2, 5, v190
v_lshl_add_u32 v190, v124, 4, v190
v_add_u32 v190, s101, v190
v_sub_u32 v124, 4, v123
v_lshlrev_b32 v191, v124, v2
v_lshl_add_u32 v225, v3, 8, s101
v_add_u32 v191, v191, v225
v_mul_u32_u24 v123, 120, v123
v_add3_u32 v224, v191, v123, 8
v_lshl_add_u32 v225, v2, 2, v225
s_waitcnt lgkmcnt(0)
v_mfma_f32_16x16x32_bf16 v[184:187], v[160:163], v[144:147], 0
v_mfma_f32_16x16x32_bf16 v[184:187], v[164:167], v[148:151], v[184:187]
v_mfma_f32_16x16x32_bf16 v[184:187], v[168:171], v[152:155], v[184:187]
v_mfma_f32_16x16x32_bf16 v[184:187], v[172:175], v[156:159], v[184:187]
ds_write_b128 v190, v[176:179]
ds_write_b64 v191, v[180:181] offset:1024
ds_write_b64 v224, v[182:183] offset:1024
s_nop 4
ds_write_b32 v225, v184 offset:2048
ds_write_b32 v225, v185 offset:2112
ds_write_b32 v225, v186 offset:2176
ds_write_b32 v225, v187 offset:2240
s_lshr_b32 s101, s3, 1
s_mul_i32 s100, s101, 6144
s_mul_i32 s101, s101, 8320
s_add_u32 s101, s101, 135152
v_lshlrev_b32 v65, 4, v1
v_sub_u32 v65, s101, v65
s_and_b32 s101, s3, 1
s_lshl_b32 s101, s101, 8
s_add_u32 s101, s101, s100
v_lshl_add_u32 v64, v1, 2, s101
s_waitcnt lgkmcnt(0)
s_barrier
ds_read_b32 v94, v64 offset:2048
ds_read_b32 v95, v64 offset:2052
ds_read_b32 v96, v64 offset:5120
ds_read_b32 v97, v64 offset:5124
s_bitcmp1_b32 s3, 0
s_cbranch_scc1 ex24
s_movk_i32 s30, 0x200
v_cmp_gt_u32 vcc, 32, v1
v_lshlrev_b32 v92, 5, v1
v_lshl_add_u32 v93, v1, 4, s30
v_cndmask_b32 v93, v93, v92, vcc
v_cmp_ge_u32 vcc, 32, v1
v_add_u32 v92, -4, v92
v_max_i32 v92, 0, v92
v_cndmask_b32 v92, v93, v92, vcc
v_add_u32 v93, s100, v93
v_add_u32 v92, s100, v92
ds_read_b128 v[68:71], v93
ds_read_b128 v[72:75], v93 offset:3072
ds_read_b128 v[76:79], v93 offset:16
ds_read_b128 v[80:83], v93 offset:3088
ds_read_b32 v66, v92
ds_read_b32 v67, v92 offset:3072
v_cmp_eq_u32 vcc, 0, v1
v_mov_b32 v92, s55
s_mov_b32 s30, 0
s_mov_b32 s31, -1
v_cndmask_b32 v92, 0, v92, vcc
s_waitcnt lgkmcnt(0)
v_pk_add_f32 v[68:69], v[68:69], v[72:73]
v_pk_add_f32 v[70:71], v[70:71], v[74:75]
v_pk_add_f32 v[76:77], v[76:77], v[80:81]
v_pk_add_f32 v[78:79], v[78:79], v[82:83]
v_add_f32 v66, v66, v67
v_cndmask_b32 v66, v66, 0, vcc
v_cndmask_b32 v72, v69, v68, s[30:31]
v_cndmask_b32 v73, v70, v69, s[30:31]
v_cndmask_b32 v74, v71, v70, s[30:31]
v_cndmask_b32 v75, v76, v70, s[30:31]
v_cndmask_b32 v80, v77, v70, s[30:31]
v_cndmask_b32 v81, v78, v71, s[30:31]
v_cndmask_b32 v82, v79, v76, s[30:31]
v_add_f32 v68, v68, v92
v_cvt_pk_bf16_f32 v84, v82, v81
v_cvt_pk_bf16_f32 v85, v80, v75
v_cvt_pk_bf16_f32 v86, v74, v73
v_cvt_pk_bf16_f32 v87, v72, v68
v_cvt_pk_bf16_f32 v88, v81, v80
v_cvt_pk_bf16_f32 v89, v75, v74
v_cvt_pk_bf16_f32 v90, v73, v72
v_cvt_pk_bf16_f32 v91, v68, v66
ds_write_b128 v65, v[84:87]
ds_write_b128 v65, v[88:91] offset:4160
v_add_u32 v65, -2048, v65
s_branch ex25
ex24:
v_lshl_add_u32 v92, v1, 3, s100
ds_read_b64 v[68:69], v92 offset:1536
ds_read_b64 v[72:73], v92 offset:4608
ds_read_b32 v70, v92 offset:1544
ds_read_b32 v74, v92 offset:4616
v_and_b32 v93, 1, v1
v_bfe_u32 v66, v1, 1, 1
v_mul_u32_u24 v93, 4160, v93
s_lshr_b32 s101, s3, 1
s_mul_i32 s101, s101, 8320
s_add_u32 s101, s101, 131072
v_lshl_add_u32 v93, v66, 4, v93
v_mov_b32 v76, 0
v_mov_b32 v77, 0
v_mov_b32 v78, 0
v_mov_b32 v79, 0
v_add_u32 v93, s101, v93
v_add_u32 v65, -1024, v65
ds_write_b128 v93, v[76:79] offset:4096
s_waitcnt lgkmcnt(0)
v_pk_add_f32 v[68:69], v[68:69], v[72:73]
v_add_f32 v70, v70, v74
v_cvt_pk_bf16_f32 v84, v70, v70
v_cvt_pk_bf16_f32 v85, v69, v69
v_cvt_pk_bf16_f32 v86, v69, v68
v_cvt_pk_bf16_f32 v87, v68, v68
v_cvt_pk_bf16_f32 v88, v70, v69
v_cvt_pk_bf16_f32 v89, v69, v69
v_cvt_pk_bf16_f32 v90, v68, v68
v_cvt_pk_bf16_f32 v91, v68, v68
ds_write_b128 v65, v[84:87]
ds_write_b128 v65, v[88:91] offset:4160
v_add_u32 v65, -2048, v65
ex25:
v_and_b32 v66, 1, v1
v_add_f32 v94, v94, v96
v_cmp_eq_u32 vcc, 1, v66
v_add_f32 v95, v95, v97
s_nop 0
v_cndmask_b32 v96, v94, v95, vcc
v_cvt_pk_bf16_f32 v98, v95, v95
v_cvt_pk_bf16_f32 v99, v95, v96
v_cvt_pk_bf16_f32 v100, v94, v94
v_cvt_pk_bf16_f32 v101, v94, v94
v_cvt_pk_bf16_f32 v102, v95, v95
v_cvt_pk_bf16_f32 v103, v96, v94
v_cvt_pk_bf16_f32 v104, v94, v94
v_cvt_pk_bf16_f32 v105, v94, v94
ds_write_b128 v65, v[98:101]
ds_write_b128 v65, v[102:105] offset:4160
s_lshr_b32 s44, s3, 1
s_mul_i32 s42, s44, 8320
s_add_u32 s44, s44, 0
s_mul_i32 s43, s44, 4672
s_and_b32 s44, s3, 1
s_lshl_b32 s44, s44, 6
s_sub_u32 s42, s42, s44
s_sub_u32 s43, s43, s44
s_add_u32 s42, s42, 16350
s_add_u32 s43, s43, 32864
v_and_b32 v35, 1, v2
v_xor_b32 v35, 1, v35
v_mul_u32_u24 v35, 4158, v35
v_lshl_add_u32 v35, v3, 4, v35
v_lshlrev_b32 v32, 1, v2
v_sub_u32 v35, v35, v32
v_add_u32 v32, s42, v35
v_lshl_add_u32 v35, v2, 5, s43
v_lshl_add_u32 v33, v3, 4, v35
s_lshr_b32 s44, s3, 1
s_mul_i32 s42, s44, 16448
s_and_b32 s44, s3, 1
s_lshl_b32 s44, s44, 13
s_add_u32 s42, s42, s44
s_add_u32 s42, s42, 53248
v_lshrrev_b32 v35, 1, v3
v_lshl_add_u32 v35, v35, 3, v2
v_and_b32 v35, 15, v35
v_lshl_add_u32 v34, v3, 8, s42
v_lshl_add_u32 v34, v35, 4, v34
v_add_u32 v28, -512, v32
v_add_u32 v29, -1536, v32
v_add_u32 v30, -2560, v32
v_add_u32 v31, -3584, v32
ds_read2_b32 v[160:161], v28 offset0:128 offset1:129
ds_read2_b32 v[162:163], v28 offset0:130 offset1:131
ds_read2_b32 v[164:165], v28 offset0:0 offset1:1
ds_read2_b32 v[166:167], v28 offset0:2 offset1:3
ds_read2_b32 v[168:169], v29 offset0:128 offset1:129
ds_read2_b32 v[170:171], v29 offset0:130 offset1:131
ds_read2_b32 v[172:173], v29 offset0:0 offset1:1
ds_read2_b32 v[174:175], v29 offset0:2 offset1:3
ds_read2_b32 v[176:177], v30 offset0:128 offset1:129
ds_read2_b32 v[178:179], v30 offset0:130 offset1:131
ds_read2_b32 v[180:181], v30 offset0:0 offset1:1
ds_read2_b32 v[182:183], v30 offset0:2 offset1:3
ds_read2_b32 v[184:185], v31 offset0:128 offset1:129
ds_read2_b32 v[186:187], v31 offset0:130 offset1:131
ds_read2_b32 v[188:189], v31 offset0:0 offset1:1
ds_read2_b32 v[190:191], v31 offset0:2 offset1:3
v_bfe_u32 v13, v0, 5, 2
v_and_b32 v14, 31, v0
v_mul_u32_u24 v13, 4672, v13
v_mov_b32 v16, 0
v_mov_b32 v17, 0
v_mov_b32 v18, 0
v_mov_b32 v19, 0
v_lshl_add_u32 v13, v14, 4, v13
v_and_b32 v14, 3, v0
v_mul_u32_u24 v14, 4672, v14
ds_write_b128 v13, v[16:19] offset:32768
v_lshrrev_b32 v13, 2, v0
v_lshl_add_u32 v13, v13, 4, v14
s_waitcnt vmcnt(4)
ds_write_b128 v13, v[36:39] offset:33280
ds_write_b128 v13, v[40:43] offset:34304
ds_write_b128 v13, v[44:47] offset:35328
ds_write_b128 v13, v[48:51] offset:36352
s_waitcnt lgkmcnt(0)
s_barrier
ds_read_b128 v[192:195], v33 offset:384
ds_read_b128 v[196:199], v33 offset:896
ds_read_b128 v[200:203], v33 offset:1408
ds_read_b128 v[204:207], v33 offset:1920
ds_read_b128 v[208:211], v33 offset:2432
ds_read_b128 v[212:215], v33 offset:2944
ds_read_b128 v[216:219], v33 offset:3456
ds_read_b128 v[220:223], v33 offset:3968
s_waitcnt lgkmcnt(7)
v_mfma_f32_16x16x32_bf16 v[64:67], v[160:163], v[192:195], 0
buffer_load_dwordx4 a[0:3], v56, s[12:15], s72 offen offset:0 sc1
v_mfma_f32_16x16x32_bf16 v[68:71], v[164:167], v[192:195], 0
v_mfma_f32_16x16x32_bf16 v[72:75], v[168:171], v[192:195], 0
v_mfma_f32_16x16x32_bf16 v[76:79], v[172:175], v[192:195], 0
v_mfma_f32_16x16x32_bf16 v[80:83], v[176:179], v[192:195], 0
buffer_load_dwordx4 a[4:7], v56, s[12:15], s72 offen offset:1024 sc1
v_mfma_f32_16x16x32_bf16 v[84:87], v[180:183], v[192:195], 0
v_mfma_f32_16x16x32_bf16 v[88:91], v[184:187], v[192:195], 0
v_add_u32 v24, -640, v32
v_add_u32 v25, -1664, v32
v_mfma_f32_16x16x32_bf16 v[92:95], v[188:191], v[192:195], 0
v_add_u32 v26, -2688, v32
v_add_u32 v27, -3712, v32
s_waitcnt lgkmcnt(6)
v_mfma_f32_16x16x32_bf16 v[68:71], v[160:163], v[196:199], v[68:71]
ds_read_b128 v[128:131], v33 offset:256
buffer_load_dwordx4 a[8:11], v56, s[12:15], s72 offen offset:2048 sc1
v_mfma_f32_16x16x32_bf16 v[72:75], v[164:167], v[196:199], v[72:75]
ds_read2_b32 v[96:97], v24 offset0:128 offset1:129
v_mfma_f32_16x16x32_bf16 v[76:79], v[168:171], v[196:199], v[76:79]
ds_read2_b32 v[98:99], v24 offset0:130 offset1:131
v_mfma_f32_16x16x32_bf16 v[80:83], v[172:175], v[196:199], v[80:83]
ds_read2_b32 v[100:101], v24 offset0:0 offset1:1
v_mfma_f32_16x16x32_bf16 v[84:87], v[176:179], v[196:199], v[84:87]
ds_read2_b32 v[102:103], v24 offset0:2 offset1:3
buffer_load_dwordx4 a[12:15], v56, s[12:15], s72 offen offset:3072 sc1
v_mfma_f32_16x16x32_bf16 v[88:91], v[180:183], v[196:199], v[88:91]
ds_read2_b32 v[104:105], v25 offset0:128 offset1:129
v_mfma_f32_16x16x32_bf16 v[92:95], v[184:187], v[196:199], v[92:95]
ds_read2_b32 v[106:107], v25 offset0:130 offset1:131
s_waitcnt lgkmcnt(12)
v_mfma_f32_16x16x32_bf16 v[72:75], v[160:163], v[200:203], v[72:75]
ds_read2_b32 v[108:109], v25 offset0:0 offset1:1
v_mfma_f32_16x16x32_bf16 v[76:79], v[164:167], v[200:203], v[76:79]
ds_read2_b32 v[110:111], v25 offset0:2 offset1:3
buffer_load_dwordx4 a[16:19], v57, s[12:15], s72 offen sc1
v_mfma_f32_16x16x32_bf16 v[80:83], v[168:171], v[200:203], v[80:83]
ds_read2_b32 v[112:113], v26 offset0:128 offset1:129
v_mfma_f32_16x16x32_bf16 v[84:87], v[172:175], v[200:203], v[84:87]
ds_read2_b32 v[114:115], v26 offset0:130 offset1:131
v_mfma_f32_16x16x32_bf16 v[88:91], v[176:179], v[200:203], v[88:91]
ds_read2_b32 v[116:117], v26 offset0:0 offset1:1
v_mfma_f32_16x16x32_bf16 v[92:95], v[180:183], v[200:203], v[92:95]
ds_read2_b32 v[118:119], v26 offset0:2 offset1:3
buffer_load_dwordx4 a[20:23], v56, s[12:15], s73 offen offset:0 sc1
s_waitcnt lgkmcnt(15)
v_mfma_f32_16x16x32_bf16 v[76:79], v[160:163], v[204:207], v[76:79]
ds_read2_b32 v[120:121], v27 offset0:128 offset1:129
v_mfma_f32_16x16x32_bf16 v[80:83], v[164:167], v[204:207], v[80:83]
ds_read2_b32 v[122:123], v27 offset0:130 offset1:131
v_mfma_f32_16x16x32_bf16 v[92:95], v[176:179], v[204:207], v[92:95]
ds_read2_b32 v[124:125], v27 offset0:0 offset1:1
v_mfma_f32_16x16x32_bf16 v[84:87], v[168:171], v[204:207], v[84:87]
ds_read2_b32 v[126:127], v27 offset0:2 offset1:3
buffer_load_dwordx4 a[24:27], v56, s[12:15], s73 offen offset:1024 sc1
v_mfma_f32_16x16x32_bf16 v[88:91], v[172:175], v[204:207], v[88:91]
ds_read_b128 v[132:135], v33 offset:768
v_mfma_f32_16x16x32_bf16 v[92:95], v[172:175], v[208:211], v[92:95]
ds_read_b128 v[136:139], v33 offset:1280
v_mfma_f32_16x16x32_bf16 v[80:83], v[160:163], v[208:211], v[80:83]
ds_read_b128 v[140:143], v33 offset:1792
v_mfma_f32_16x16x32_bf16 v[84:87], v[164:167], v[208:211], v[84:87]
ds_read_b128 v[144:147], v33 offset:2304
buffer_load_dwordx4 a[28:31], v56, s[12:15], s73 offen offset:2048 sc1
v_mfma_f32_16x16x32_bf16 v[92:95], v[168:171], v[212:215], v[92:95]
ds_read_b128 v[148:151], v33 offset:2816
v_mfma_f32_16x16x32_bf16 v[88:91], v[168:171], v[208:211], v[88:91]
ds_read_b128 v[152:155], v33 offset:3328
v_mfma_f32_16x16x32_bf16 v[84:87], v[160:163], v[212:215], v[84:87]
ds_read_b128 v[156:159], v33 offset:3840
s_waitcnt lgkmcnt(15)
v_mfma_f32_16x16x32_bf16 v[92:95], v[164:167], v[216:219], v[92:95]
buffer_load_dwordx4 a[32:35], v56, s[12:15], s73 offen offset:3072 sc1
v_mfma_f32_16x16x32_bf16 v[88:91], v[164:167], v[212:215], v[88:91]
v_mfma_f32_16x16x32_bf16 v[88:91], v[160:163], v[216:219], v[88:91]
v_mfma_f32_16x16x32_bf16 v[92:95], v[160:163], v[220:223], v[92:95]
v_mfma_f32_16x16x32_bf16 v[64:67], v[96:99], v[128:131], v[64:67]
buffer_load_dwordx4 a[36:39], v57, s[12:15], s73 offen sc1
v_mfma_f32_16x16x32_bf16 v[68:71], v[100:103], v[128:131], v[68:71]
v_mfma_f32_16x16x32_bf16 v[72:75], v[104:107], v[128:131], v[72:75]
v_add_u32 v28, -768, v32
v_add_u32 v29, -1792, v32
v_mfma_f32_16x16x32_bf16 v[76:79], v[108:111], v[128:131], v[76:79]
v_add_u32 v30, -2816, v32
v_add_u32 v31, -3840, v32
s_waitcnt lgkmcnt(13)
v_mfma_f32_16x16x32_bf16 v[80:83], v[112:115], v[128:131], v[80:83]
ds_read_b128 v[192:195], v33 offset:128
buffer_load_dwordx4 a[40:43], v56, s[12:15], s74 offen offset:0 sc1
s_waitcnt lgkmcnt(12)
v_mfma_f32_16x16x32_bf16 v[84:87], v[116:119], v[128:131], v[84:87]
ds_read2_b32 v[160:161], v28 offset0:128 offset1:129
s_waitcnt lgkmcnt(11)
v_mfma_f32_16x16x32_bf16 v[88:91], v[120:123], v[128:131], v[88:91]
ds_read2_b32 v[162:163], v28 offset0:130 offset1:131
s_waitcnt lgkmcnt(10)
v_mfma_f32_16x16x32_bf16 v[92:95], v[124:127], v[128:131], v[92:95]
ds_read2_b32 v[164:165], v28 offset0:0 offset1:1
s_waitcnt lgkmcnt(10)
v_mfma_f32_16x16x32_bf16 v[68:71], v[96:99], v[132:135], v[68:71]
ds_read2_b32 v[166:167], v28 offset0:2 offset1:3
buffer_load_dwordx4 a[44:47], v56, s[12:15], s74 offen offset:1024 sc1
v_mfma_f32_16x16x32_bf16 v[72:75], v[100:103], v[132:135], v[72:75]
ds_read2_b32 v[168:169], v29 offset0:128 offset1:129
v_mfma_f32_16x16x32_bf16 v[76:79], v[104:107], v[132:135], v[76:79]
ds_read2_b32 v[170:171], v29 offset0:130 offset1:131
v_mfma_f32_16x16x32_bf16 v[80:83], v[108:111], v[132:135], v[80:83]
ds_read2_b32 v[172:173], v29 offset0:0 offset1:1
v_mfma_f32_16x16x32_bf16 v[84:87], v[112:115], v[132:135], v[84:87]
ds_read2_b32 v[174:175], v29 offset0:2 offset1:3
buffer_load_dwordx4 a[48:51], v56, s[12:15], s74 offen offset:2048 sc1
v_mfma_f32_16x16x32_bf16 v[88:91], v[116:119], v[132:135], v[88:91]
ds_read2_b32 v[176:177], v30 offset0:128 offset1:129
v_mfma_f32_16x16x32_bf16 v[92:95], v[120:123], v[132:135], v[92:95]
ds_read2_b32 v[178:179], v30 offset0:130 offset1:131
s_waitcnt lgkmcnt(15)
v_mfma_f32_16x16x32_bf16 v[72:75], v[96:99], v[136:139], v[72:75]
ds_read2_b32 v[180:181], v30 offset0:0 offset1:1
v_mfma_f32_16x16x32_bf16 v[76:79], v[100:103], v[136:139], v[76:79]
ds_read2_b32 v[182:183], v30 offset0:2 offset1:3
buffer_load_dwordx4 a[52:55], v56, s[12:15], s74 offen offset:3072 sc1
v_mfma_f32_16x16x32_bf16 v[80:83], v[104:107], v[136:139], v[80:83]
ds_read2_b32 v[184:185], v31 offset0:128 offset1:129
v_mfma_f32_16x16x32_bf16 v[84:87], v[108:111], v[136:139], v[84:87]
ds_read2_b32 v[186:187], v31 offset0:130 offset1:131
v_mfma_f32_16x16x32_bf16 v[88:91], v[112:115], v[136:139], v[88:91]
ds_read2_b32 v[188:189], v31 offset0:0 offset1:1
v_mfma_f32_16x16x32_bf16 v[92:95], v[116:119], v[136:139], v[92:95]
ds_read2_b32 v[190:191], v31 offset0:2 offset1:3
buffer_load_dwordx4 a[56:59], v57, s[12:15], s74 offen sc1
v_mfma_f32_16x16x32_bf16 v[76:79], v[96:99], v[140:143], v[76:79]
ds_read_b128 v[196:199], v33 offset:640
v_mfma_f32_16x16x32_bf16 v[80:83], v[100:103], v[140:143], v[80:83]
ds_read_b128 v[200:203], v33 offset:1152
v_mfma_f32_16x16x32_bf16 v[92:95], v[112:115], v[140:143], v[92:95]
ds_read_b128 v[204:207], v33 offset:1664
v_mfma_f32_16x16x32_bf16 v[84:87], v[104:107], v[140:143], v[84:87]
ds_read_b128 v[208:211], v33 offset:2176
buffer_load_dwordx4 a[60:63], v56, s[12:15], s75 offen offset:0 sc1
v_mfma_f32_16x16x32_bf16 v[88:91], v[108:111], v[140:143], v[88:91]
ds_read_b128 v[212:215], v33 offset:2688
s_waitcnt lgkmcnt(15)
v_mfma_f32_16x16x32_bf16 v[92:95], v[108:111], v[144:147], v[92:95]
ds_read_b128 v[216:219], v33 offset:3200
v_mfma_f32_16x16x32_bf16 v[80:83], v[96:99], v[144:147], v[80:83]
ds_read_b128 v[220:223], v33 offset:3712
v_mfma_f32_16x16x32_bf16 v[84:87], v[100:103], v[144:147], v[84:87]
buffer_load_dwordx4 a[64:67], v56, s[12:15], s75 offen offset:1024 sc1
v_mfma_f32_16x16x32_bf16 v[92:95], v[104:107], v[148:151], v[92:95]
v_mfma_f32_16x16x32_bf16 v[88:91], v[104:107], v[144:147], v[88:91]
v_mfma_f32_16x16x32_bf16 v[84:87], v[96:99], v[148:151], v[84:87]
v_mfma_f32_16x16x32_bf16 v[92:95], v[100:103], v[152:155], v[92:95]
buffer_load_dwordx4 a[68:71], v56, s[12:15], s75 offen offset:2048 sc1
v_mfma_f32_16x16x32_bf16 v[88:91], v[100:103], v[148:151], v[88:91]
v_mfma_f32_16x16x32_bf16 v[88:91], v[96:99], v[152:155], v[88:91]
v_mfma_f32_16x16x32_bf16 v[92:95], v[96:99], v[156:159], v[92:95]
s_lshl_b32 s51, s22, 11
s_lshl_b32 s101, s23, 7
s_add_u32 s51, s51, s101
s_add_u32 s51, s51, 16844288
s_waitcnt vmcnt(18)
s_barrier
buffer_store_dwordx2 v[10:11], v63, s[12:15], s51 offen sc1
v_mfma_f32_16x16x32_bf16 v[64:67], v[160:163], v[192:195], v[64:67]
buffer_load_dwordx4 a[72:75], v56, s[12:15], s75 offen offset:3072 sc1
v_mfma_f32_16x16x32_bf16 v[68:71], v[164:167], v[192:195], v[68:71]
v_mfma_f32_16x16x32_bf16 v[72:75], v[168:171], v[192:195], v[72:75]
v_add_u32 v24, -896, v32
v_add_u32 v25, -1920, v32
s_waitcnt lgkmcnt(15)
v_mfma_f32_16x16x32_bf16 v[76:79], v[172:175], v[192:195], v[76:79]
v_add_u32 v26, -2944, v32
v_add_u32 v27, -3968, v32
s_waitcnt lgkmcnt(13)
v_mfma_f32_16x16x32_bf16 v[80:83], v[176:179], v[192:195], v[80:83]
ds_read_b128 v[128:131], v33 offset:0
buffer_load_dwordx4 a[76:79], v57, s[12:15], s75 offen sc1
s_waitcnt lgkmcnt(12)
v_mfma_f32_16x16x32_bf16 v[84:87], v[180:183], v[192:195], v[84:87]
ds_read2_b32 v[96:97], v24 offset0:128 offset1:129
s_waitcnt lgkmcnt(11)
v_mfma_f32_16x16x32_bf16 v[88:91], v[184:187], v[192:195], v[88:91]
ds_read2_b32 v[98:99], v24 offset0:130 offset1:131
s_waitcnt lgkmcnt(10)
v_mfma_f32_16x16x32_bf16 v[92:95], v[188:191], v[192:195], v[92:95]
ds_read2_b32 v[100:101], v24 offset0:0 offset1:1
s_waitcnt lgkmcnt(10)
v_mfma_f32_16x16x32_bf16 v[68:71], v[160:163], v[196:199], v[68:71]
ds_read2_b32 v[102:103], v24 offset0:2 offset1:3
buffer_load_dwordx4 a[80:83], v56, s[12:15], s76 offen offset:0 sc1
v_mfma_f32_16x16x32_bf16 v[72:75], v[164:167], v[196:199], v[72:75]
ds_read2_b32 v[104:105], v25 offset0:128 offset1:129
v_mfma_f32_16x16x32_bf16 v[76:79], v[168:171], v[196:199], v[76:79]
ds_read2_b32 v[106:107], v25 offset0:130 offset1:131
v_mfma_f32_16x16x32_bf16 v[80:83], v[172:175], v[196:199], v[80:83]
ds_read2_b32 v[108:109], v25 offset0:0 offset1:1
v_mfma_f32_16x16x32_bf16 v[84:87], v[176:179], v[196:199], v[84:87]
ds_read2_b32 v[110:111], v25 offset0:2 offset1:3
buffer_load_dwordx4 a[84:87], v56, s[12:15], s76 offen offset:1024 sc1
v_mfma_f32_16x16x32_bf16 v[88:91], v[180:183], v[196:199], v[88:91]
ds_read2_b32 v[112:113], v26 offset0:128 offset1:129
v_mfma_f32_16x16x32_bf16 v[92:95], v[184:187], v[196:199], v[92:95]
ds_read2_b32 v[114:115], v26 offset0:130 offset1:131
s_waitcnt lgkmcnt(15)
v_mfma_f32_16x16x32_bf16 v[72:75], v[160:163], v[200:203], v[72:75]
ds_read2_b32 v[116:117], v26 offset0:0 offset1:1
v_mfma_f32_16x16x32_bf16 v[76:79], v[164:167], v[200:203], v[76:79]
ds_read2_b32 v[118:119], v26 offset0:2 offset1:3
buffer_load_dwordx4 a[88:91], v56, s[12:15], s76 offen offset:2048 sc1
v_mfma_f32_16x16x32_bf16 v[80:83], v[168:171], v[200:203], v[80:83]
ds_read2_b32 v[120:121], v27 offset0:128 offset1:129
v_mfma_f32_16x16x32_bf16 v[84:87], v[172:175], v[200:203], v[84:87]
ds_read2_b32 v[122:123], v27 offset0:130 offset1:131
v_mfma_f32_16x16x32_bf16 v[88:91], v[176:179], v[200:203], v[88:91]
ds_read2_b32 v[124:125], v27 offset0:0 offset1:1
v_mfma_f32_16x16x32_bf16 v[92:95], v[180:183], v[200:203], v[92:95]
ds_read2_b32 v[126:127], v27 offset0:2 offset1:3
buffer_load_dwordx4 a[92:95], v56, s[12:15], s76 offen offset:3072 sc1
v_mfma_f32_16x16x32_bf16 v[76:79], v[160:163], v[204:207], v[76:79]
ds_read_b128 v[132:135], v33 offset:512
v_mfma_f32_16x16x32_bf16 v[80:83], v[164:167], v[204:207], v[80:83]
ds_read_b128 v[136:139], v33 offset:1024
v_mfma_f32_16x16x32_bf16 v[92:95], v[176:179], v[204:207], v[92:95]
ds_read_b128 v[140:143], v33 offset:1536
v_mfma_f32_16x16x32_bf16 v[84:87], v[168:171], v[204:207], v[84:87]
ds_read_b128 v[144:147], v33 offset:2048
buffer_load_dwordx4 a[96:99], v57, s[12:15], s76 offen sc1
v_mfma_f32_16x16x32_bf16 v[88:91], v[172:175], v[204:207], v[88:91]
ds_read_b128 v[148:151], v33 offset:2560
s_waitcnt lgkmcnt(15)
v_mfma_f32_16x16x32_bf16 v[92:95], v[172:175], v[208:211], v[92:95]
ds_read_b128 v[152:155], v33 offset:3072
v_mfma_f32_16x16x32_bf16 v[80:83], v[160:163], v[208:211], v[80:83]
ds_read_b128 v[156:159], v33 offset:3584
v_mfma_f32_16x16x32_bf16 v[84:87], v[164:167], v[208:211], v[84:87]
buffer_load_dwordx4 a[100:103], v56, s[12:15], s77 offen offset:0 sc1
v_mfma_f32_16x16x32_bf16 v[92:95], v[168:171], v[212:215], v[92:95]
v_mfma_f32_16x16x32_bf16 v[88:91], v[168:171], v[208:211], v[88:91]
v_mfma_f32_16x16x32_bf16 v[84:87], v[160:163], v[212:215], v[84:87]
v_mfma_f32_16x16x32_bf16 v[92:95], v[164:167], v[216:219], v[92:95]
buffer_load_dwordx4 a[104:107], v56, s[12:15], s77 offen offset:1024 sc1
v_mfma_f32_16x16x32_bf16 v[88:91], v[164:167], v[212:215], v[88:91]
v_mfma_f32_16x16x32_bf16 v[88:91], v[160:163], v[216:219], v[88:91]
v_mfma_f32_16x16x32_bf16 v[92:95], v[160:163], v[220:223], v[92:95]
v_mfma_f32_16x16x32_bf16 v[64:67], v[96:99], v[128:131], v[64:67]
buffer_load_dwordx4 a[108:111], v56, s[12:15], s77 offen offset:2048 sc1
v_mfma_f32_16x16x32_bf16 v[68:71], v[100:103], v[128:131], v[68:71]
s_waitcnt lgkmcnt(7)
v_mfma_f32_16x16x32_bf16 v[92:95], v[124:127], v[128:131], v[92:95]
s_lshr_b32 s44, s3, 1
s_mul_i32 s42, s44, 8320
s_add_u32 s44, s44, 2
s_nop 0
ds_write_b128 v34, v[64:67] offset:0
s_waitcnt lgkmcnt(7)
v_mfma_f32_16x16x32_bf16 v[68:71], v[96:99], v[132:135], v[68:71]
s_mul_i32 s43, s44, 4672
s_and_b32 s44, s3, 1
s_lshl_b32 s44, s44, 6
v_mfma_f32_16x16x32_bf16 v[72:75], v[104:107], v[128:131], v[72:75]
s_sub_u32 s42, s42, s44
s_sub_u32 s43, s43, s44
s_add_u32 s42, s42, 135134
buffer_load_dwordx4 a[112:115], v56, s[12:15], s77 offen offset:3072 sc1
v_mfma_f32_16x16x32_bf16 v[88:91], v[120:123], v[128:131], v[88:91]
s_add_u32 s43, s43, 32864
v_and_b32 v35, 1, v2
v_xor_b32 v35, 1, v35
ds_write_b128 v34, v[68:71] offset:1024
v_mfma_f32_16x16x32_bf16 v[72:75], v[100:103], v[132:135], v[72:75]
v_mul_u32_u24 v35, 4158, v35
v_lshl_add_u32 v35, v3, 4, v35
v_lshlrev_b32 v32, 1, v2
v_mfma_f32_16x16x32_bf16 v[92:95], v[120:123], v[132:135], v[92:95]
v_sub_u32 v35, v35, v32
v_add_u32 v32, s42, v35
v_lshl_add_u32 v35, v2, 5, s43
s_waitcnt lgkmcnt(7)
v_mfma_f32_16x16x32_bf16 v[72:75], v[96:99], v[136:139], v[72:75]
v_lshl_add_u32 v33, v3, 4, v35
buffer_load_dwordx4 a[116:119], v57, s[12:15], s77 offen sc1
v_mfma_f32_16x16x32_bf16 v[76:79], v[108:111], v[128:131], v[76:79]
v_add_u32 v28, -512, v32
v_add_u32 v29, -1536, v32
v_mfma_f32_16x16x32_bf16 v[84:87], v[116:119], v[128:131], v[84:87]
v_add_u32 v30, -2560, v32
v_add_u32 v31, -3584, v32
ds_write_b128 v34, v[72:75] offset:2048
v_mfma_f32_16x16x32_bf16 v[76:79], v[104:107], v[132:135], v[76:79]
ds_read_b128 v[192:195], v33 offset:384
v_mfma_f32_16x16x32_bf16 v[88:91], v[116:119], v[132:135], v[88:91]
ds_read2_b32 v[160:161], v28 offset0:128 offset1:129
buffer_load_dwordx4 a[120:123], v56, s[12:15], s78 offen offset:0 sc1
v_mfma_f32_16x16x32_bf16 v[76:79], v[100:103], v[136:139], v[76:79]
ds_read2_b32 v[162:163], v28 offset0:130 offset1:131
v_mfma_f32_16x16x32_bf16 v[92:95], v[116:119], v[136:139], v[92:95]
ds_read2_b32 v[164:165], v28 offset0:0 offset1:1
s_waitcnt lgkmcnt(11)
v_mfma_f32_16x16x32_bf16 v[76:79], v[96:99], v[140:143], v[76:79]
ds_read2_b32 v[166:167], v28 offset0:2 offset1:3
v_mfma_f32_16x16x32_bf16 v[80:83], v[112:115], v[128:131], v[80:83]
ds_read2_b32 v[168:169], v29 offset0:128 offset1:129
buffer_load_dwordx4 a[124:127], v56, s[12:15], s78 offen offset:1024 sc1
v_mfma_f32_16x16x32_bf16 v[84:87], v[112:115], v[132:135], v[84:87]
ds_read2_b32 v[170:171], v29 offset0:130 offset1:131
s_nop 1
ds_write_b128 v34, v[76:79] offset:3072
v_mfma_f32_16x16x32_bf16 v[80:83], v[108:111], v[132:135], v[80:83]
ds_read2_b32 v[172:173], v29 offset0:0 offset1:1
v_mfma_f32_16x16x32_bf16 v[88:91], v[112:115], v[136:139], v[88:91]
ds_read2_b32 v[174:175], v29 offset0:2 offset1:3
v_mfma_f32_16x16x32_bf16 v[80:83], v[104:107], v[136:139], v[80:83]
ds_read2_b32 v[176:177], v30 offset0:128 offset1:129
buffer_load_dwordx4 a[128:131], v56, s[12:15], s78 offen offset:2048 sc1
v_mfma_f32_16x16x32_bf16 v[92:95], v[112:115], v[140:143], v[92:95]
ds_read2_b32 v[178:179], v30 offset0:130 offset1:131
v_mfma_f32_16x16x32_bf16 v[80:83], v[100:103], v[140:143], v[80:83]
ds_read2_b32 v[180:181], v30 offset0:0 offset1:1
v_mfma_f32_16x16x32_bf16 v[84:87], v[108:111], v[136:139], v[84:87]
ds_read2_b32 v[182:183], v30 offset0:2 offset1:3
s_waitcnt lgkmcnt(15)
v_mfma_f32_16x16x32_bf16 v[80:83], v[96:99], v[144:147], v[80:83]
ds_read2_b32 v[184:185], v31 offset0:128 offset1:129
buffer_load_dwordx4 a[132:135], v56, s[12:15], s78 offen offset:3072 sc1
v_mfma_f32_16x16x32_bf16 v[84:87], v[104:107], v[140:143], v[84:87]
ds_read2_b32 v[186:187], v31 offset0:130 offset1:131
v_mfma_f32_16x16x32_bf16 v[88:91], v[108:111], v[140:143], v[88:91]
ds_read2_b32 v[188:189], v31 offset0:0 offset1:1
s_nop 1
ds_write_b128 v34, v[80:83] offset:4096
v_mfma_f32_16x16x32_bf16 v[84:87], v[100:103], v[144:147], v[84:87]
ds_read2_b32 v[190:191], v31 offset0:2 offset1:3
v_mfma_f32_16x16x32_bf16 v[92:95], v[108:111], v[144:147], v[92:95]
ds_read_b128 v[196:199], v33 offset:896
buffer_load_dwordx4 a[136:139], v57, s[12:15], s78 offen sc1
v_mfma_f32_16x16x32_bf16 v[84:87], v[96:99], v[148:151], v[84:87]
ds_read_b128 v[200:203], v33 offset:1408
v_mfma_f32_16x16x32_bf16 v[88:91], v[104:107], v[144:147], v[88:91]
ds_read_b128 v[204:207], v33 offset:1920
v_mfma_f32_16x16x32_bf16 v[92:95], v[104:107], v[148:151], v[92:95]
ds_read_b128 v[208:211], v33 offset:2432
s_nop 2
ds_write_b128 v34, v[84:87] offset:5120
v_mfma_f32_16x16x32_bf16 v[88:91], v[100:103], v[148:151], v[88:91]
ds_read_b128 v[212:215], v33 offset:2944
buffer_load_dwordx4 a[140:143], v56, s[12:15], s79 offen offset:0 sc1
v_mfma_f32_16x16x32_bf16 v[92:95], v[100:103], v[152:155], v[92:95]
ds_read_b128 v[216:219], v33 offset:3456
v_mfma_f32_16x16x32_bf16 v[88:91], v[96:99], v[152:155], v[88:91]
ds_read_b128 v[220:223], v33 offset:3968
v_mfma_f32_16x16x32_bf16 v[92:95], v[96:99], v[156:159], v[92:95]
s_nop 5
ds_write_b128 v34, v[88:91] offset:6144
s_nop 0
ds_write_b128 v34, v[92:95] offset:7168
buffer_load_dwordx4 a[144:147], v56, s[12:15], s79 offen offset:1024 sc1
buffer_load_dwordx4 a[148:151], v56, s[12:15], s79 offen offset:2048 sc1
s_lshl_b32 s101, s3, 10
s_add_u32 s101, s101, 53248
v_and_b32 v25, 1, v1
v_bfe_u32 v26, v1, 1, 1
v_lshrrev_b32 v27, 2, v1
v_lshl_add_u32 v27, v25, 3, v27
v_and_b32 v27, 15, v27
v_mul_u32_u24 v26, 16448, v26
v_lshl_add_u32 v26, v25, 9, v26
v_lshl_add_u32 v26, v27, 4, v26
v_add_u32 v26, s101, v26
v_lshrrev_b32 v27, 2, v0
v_mul_u32_u24 v27, 20480, v27
v_and_b32 v25, 3, v0
v_lshl_add_u32 v27, v25, 4, v27
s_add_u32 s101, s24, 0
s_lshl_b32 s51, s101, 6
s_add_u32 s51, s51, 13631488
s_add_u32 s52, s51, 1310720
s_lshl_b32 s50, s101, 7
s_add_u32 s50, s50, 16973824
s_waitcnt lgkmcnt(0)
s_barrier
ds_read_b128 v[96:99], v26 offset:0
ds_read_b128 v[100:103], v26 offset:256
ds_read_b128 v[104:107], v26 offset:8192
ds_read_b128 v[108:111], v26 offset:8448
ds_read_b128 v[112:115], v26 offset:4096
ds_read_b128 v[116:119], v26 offset:4352
ds_read_b128 v[120:123], v26 offset:12288
ds_read_b128 v[124:127], v26 offset:12544
s_waitcnt lgkmcnt(4)
v_pk_add_f32 v[96:97], v[96:97], v[104:105]
v_pk_add_f32 v[98:99], v[98:99], v[106:107]
v_pk_add_f32 v[100:101], v[100:101], v[108:109]
v_pk_add_f32 v[102:103], v[102:103], v[110:111]
v_cvt_pk_bf16_f32 v128, v96, v97
v_cvt_pk_bf16_f32 v129, v98, v99
v_cvt_pk_bf16_f32 v130, v100, v101
v_cvt_pk_bf16_f32 v131, v102, v103
buffer_store_dwordx4 v[128:131], v27, s[12:15], s51 offen sc1
s_waitcnt lgkmcnt(0)
v_pk_add_f32 v[112:113], v[112:113], v[120:121]
v_pk_add_f32 v[114:115], v[114:115], v[122:123]
v_pk_add_f32 v[116:117], v[116:117], v[124:125]
v_pk_add_f32 v[118:119], v[118:119], v[126:127]
v_cvt_pk_bf16_f32 v132, v112, v113
v_cvt_pk_bf16_f32 v133, v114, v115
v_cvt_pk_bf16_f32 v134, v116, v117
v_cvt_pk_bf16_f32 v135, v118, v119
buffer_store_dwordx4 v[132:135], v27, s[12:15], s52 offen sc1
v_mfma_f32_16x16x32_bf16 v[64:67], v[160:163], v[192:195], 0
s_mul_i32 s100, s26, 160
v_lshl_add_u32 v12, v3, 3, s100
v_mfma_f32_16x16x32_bf16 v[68:71], v[164:167], v[192:195], 0
v_mfma_f32_16x16x32_bf16 v[72:75], v[168:171], v[192:195], 0
v_mfma_f32_16x16x32_bf16 v[76:79], v[172:175], v[192:195], 0
v_mfma_f32_16x16x32_bf16 v[80:83], v[176:179], v[192:195], 0
global_load_dwordx2 v[46:47], v12, s[62:63] offset:0
v_mfma_f32_16x16x32_bf16 v[84:87], v[180:183], v[192:195], 0
v_mfma_f32_16x16x32_bf16 v[88:91], v[184:187], v[192:195], 0
v_add_u32 v24, -640, v32
v_add_u32 v25, -1664, v32
v_mfma_f32_16x16x32_bf16 v[92:95], v[188:191], v[192:195], 0
v_add_u32 v26, -2688, v32
v_add_u32 v27, -3712, v32
v_mfma_f32_16x16x32_bf16 v[68:71], v[160:163], v[196:199], v[68:71]
ds_read_b128 v[128:131], v33 offset:256
global_load_dwordx2 v[48:49], v12, s[62:63] offset:32
v_mfma_f32_16x16x32_bf16 v[72:75], v[164:167], v[196:199], v[72:75]
ds_read2_b32 v[96:97], v24 offset0:128 offset1:129
v_mfma_f32_16x16x32_bf16 v[76:79], v[168:171], v[196:199], v[76:79]
ds_read2_b32 v[98:99], v24 offset0:130 offset1:131
v_mfma_f32_16x16x32_bf16 v[80:83], v[172:175], v[196:199], v[80:83]
ds_read2_b32 v[100:101], v24 offset0:0 offset1:1
v_mfma_f32_16x16x32_bf16 v[84:87], v[176:179], v[196:199], v[84:87]
ds_read2_b32 v[102:103], v24 offset0:2 offset1:3
global_load_dwordx2 v[50:51], v12, s[62:63] offset:64
v_mfma_f32_16x16x32_bf16 v[88:91], v[180:183], v[196:199], v[88:91]
ds_read2_b32 v[104:105], v25 offset0:128 offset1:129
v_mfma_f32_16x16x32_bf16 v[92:95], v[184:187], v[196:199], v[92:95]
ds_read2_b32 v[106:107], v25 offset0:130 offset1:131
v_mfma_f32_16x16x32_bf16 v[72:75], v[160:163], v[200:203], v[72:75]
ds_read2_b32 v[108:109], v25 offset0:0 offset1:1
v_mfma_f32_16x16x32_bf16 v[76:79], v[164:167], v[200:203], v[76:79]
ds_read2_b32 v[110:111], v25 offset0:2 offset1:3
global_load_dwordx2 v[52:53], v12, s[62:63] offset:96
v_mfma_f32_16x16x32_bf16 v[80:83], v[168:171], v[200:203], v[80:83]
ds_read2_b32 v[112:113], v26 offset0:128 offset1:129
v_mfma_f32_16x16x32_bf16 v[84:87], v[172:175], v[200:203], v[84:87]
ds_read2_b32 v[114:115], v26 offset0:130 offset1:131
v_mfma_f32_16x16x32_bf16 v[88:91], v[176:179], v[200:203], v[88:91]
ds_read2_b32 v[116:117], v26 offset0:0 offset1:1
v_mfma_f32_16x16x32_bf16 v[92:95], v[180:183], v[200:203], v[92:95]
ds_read2_b32 v[118:119], v26 offset0:2 offset1:3
global_load_dwordx2 v[54:55], v12, s[62:63] offset:128
v_mfma_f32_16x16x32_bf16 v[76:79], v[160:163], v[204:207], v[76:79]
ds_read2_b32 v[120:121], v27 offset0:128 offset1:129
v_mfma_f32_16x16x32_bf16 v[80:83], v[164:167], v[204:207], v[80:83]
ds_read2_b32 v[122:123], v27 offset0:130 offset1:131
v_mfma_f32_16x16x32_bf16 v[92:95], v[176:179], v[204:207], v[92:95]
ds_read2_b32 v[124:125], v27 offset0:0 offset1:1
v_mfma_f32_16x16x32_bf16 v[84:87], v[168:171], v[204:207], v[84:87]
ds_read2_b32 v[126:127], v27 offset0:2 offset1:3
buffer_load_dwordx4 a[152:155], v56, s[12:15], s79 offen offset:3072 sc1
v_mfma_f32_16x16x32_bf16 v[88:91], v[172:175], v[204:207], v[88:91]
ds_read_b128 v[132:135], v33 offset:768
v_mfma_f32_16x16x32_bf16 v[92:95], v[172:175], v[208:211], v[92:95]
ds_read_b128 v[136:139], v33 offset:1280
v_mfma_f32_16x16x32_bf16 v[80:83], v[160:163], v[208:211], v[80:83]
ds_read_b128 v[140:143], v33 offset:1792
v_mfma_f32_16x16x32_bf16 v[84:87], v[164:167], v[208:211], v[84:87]
ds_read_b128 v[144:147], v33 offset:2304
buffer_load_dwordx4 a[156:159], v57, s[12:15], s79 offen sc1
v_mfma_f32_16x16x32_bf16 v[92:95], v[168:171], v[212:215], v[92:95]
ds_read_b128 v[148:151], v33 offset:2816
v_mfma_f32_16x16x32_bf16 v[88:91], v[168:171], v[208:211], v[88:91]
ds_read_b128 v[152:155], v33 offset:3328
v_mfma_f32_16x16x32_bf16 v[84:87], v[160:163], v[212:215], v[84:87]
ds_read_b128 v[156:159], v33 offset:3840
v_mfma_f32_16x16x32_bf16 v[92:95], v[164:167], v[216:219], v[92:95]
buffer_load_dwordx4 a[160:163], v56, s[12:15], s80 offen offset:0 sc1
v_mfma_f32_16x16x32_bf16 v[88:91], v[164:167], v[212:215], v[88:91]
v_mfma_f32_16x16x32_bf16 v[88:91], v[160:163], v[216:219], v[88:91]
v_mfma_f32_16x16x32_bf16 v[92:95], v[160:163], v[220:223], v[92:95]
s_waitcnt lgkmcnt(15)
v_mfma_f32_16x16x32_bf16 v[64:67], v[96:99], v[128:131], v[64:67]
buffer_load_dwordx4 a[164:167], v56, s[12:15], s80 offen offset:1024 sc1
v_mfma_f32_16x16x32_bf16 v[68:71], v[100:103], v[128:131], v[68:71]
v_mfma_f32_16x16x32_bf16 v[72:75], v[104:107], v[128:131], v[72:75]
v_add_u32 v28, -768, v32
v_add_u32 v29, -1792, v32
v_mfma_f32_16x16x32_bf16 v[76:79], v[108:111], v[128:131], v[76:79]
v_add_u32 v30, -2816, v32
v_add_u32 v31, -3840, v32
s_waitcnt lgkmcnt(13)
v_mfma_f32_16x16x32_bf16 v[80:83], v[112:115], v[128:131], v[80:83]
ds_read_b128 v[192:195], v33 offset:128
buffer_load_dwordx4 a[168:171], v56, s[12:15], s80 offen offset:2048 sc1
s_waitcnt lgkmcnt(12)
v_mfma_f32_16x16x32_bf16 v[84:87], v[116:119], v[128:131], v[84:87]
ds_read2_b32 v[160:161], v28 offset0:128 offset1:129
s_waitcnt lgkmcnt(11)
v_mfma_f32_16x16x32_bf16 v[88:91], v[120:123], v[128:131], v[88:91]
ds_read2_b32 v[162:163], v28 offset0:130 offset1:131
s_waitcnt lgkmcnt(10)
v_mfma_f32_16x16x32_bf16 v[92:95], v[124:127], v[128:131], v[92:95]
ds_read2_b32 v[164:165], v28 offset0:0 offset1:1
s_waitcnt lgkmcnt(10)
v_mfma_f32_16x16x32_bf16 v[68:71], v[96:99], v[132:135], v[68:71]
ds_read2_b32 v[166:167], v28 offset0:2 offset1:3
buffer_load_dwordx4 a[172:175], v56, s[12:15], s80 offen offset:3072 sc1
v_mfma_f32_16x16x32_bf16 v[72:75], v[100:103], v[132:135], v[72:75]
ds_read2_b32 v[168:169], v29 offset0:128 offset1:129
v_mfma_f32_16x16x32_bf16 v[76:79], v[104:107], v[132:135], v[76:79]
ds_read2_b32 v[170:171], v29 offset0:130 offset1:131
v_mfma_f32_16x16x32_bf16 v[80:83], v[108:111], v[132:135], v[80:83]
ds_read2_b32 v[172:173], v29 offset0:0 offset1:1
buffer_load_dwordx4 a[176:179], v57, s[12:15], s80 offen sc1
v_mfma_f32_16x16x32_bf16 v[84:87], v[112:115], v[132:135], v[84:87]
ds_read2_b32 v[174:175], v29 offset0:2 offset1:3
v_mfma_f32_16x16x32_bf16 v[88:91], v[116:119], v[132:135], v[88:91]
ds_read2_b32 v[176:177], v30 offset0:128 offset1:129
v_mfma_f32_16x16x32_bf16 v[92:95], v[120:123], v[132:135], v[92:95]
ds_read2_b32 v[178:179], v30 offset0:130 offset1:131
s_waitcnt lgkmcnt(15)
v_mfma_f32_16x16x32_bf16 v[72:75], v[96:99], v[136:139], v[72:75]
ds_read2_b32 v[180:181], v30 offset0:0 offset1:1
buffer_load_dwordx4 a[180:183], v56, s[12:15], s81 offen offset:0 sc1
v_mfma_f32_16x16x32_bf16 v[76:79], v[100:103], v[136:139], v[76:79]
ds_read2_b32 v[182:183], v30 offset0:2 offset1:3
v_mfma_f32_16x16x32_bf16 v[80:83], v[104:107], v[136:139], v[80:83]
ds_read2_b32 v[184:185], v31 offset0:128 offset1:129
v_mfma_f32_16x16x32_bf16 v[84:87], v[108:111], v[136:139], v[84:87]
ds_read2_b32 v[186:187], v31 offset0:130 offset1:131
buffer_load_dwordx4 a[184:187], v56, s[12:15], s81 offen offset:1024 sc1
v_mfma_f32_16x16x32_bf16 v[88:91], v[112:115], v[136:139], v[88:91]
ds_read2_b32 v[188:189], v31 offset0:0 offset1:1
v_mfma_f32_16x16x32_bf16 v[92:95], v[116:119], v[136:139], v[92:95]
ds_read2_b32 v[190:191], v31 offset0:2 offset1:3
v_mfma_f32_16x16x32_bf16 v[76:79], v[96:99], v[140:143], v[76:79]
ds_read_b128 v[196:199], v33 offset:640
v_mfma_f32_16x16x32_bf16 v[80:83], v[100:103], v[140:143], v[80:83]
ds_read_b128 v[200:203], v33 offset:1152
buffer_load_dwordx4 a[188:191], v56, s[12:15], s81 offen offset:2048 sc1
v_mfma_f32_16x16x32_bf16 v[92:95], v[112:115], v[140:143], v[92:95]
ds_read_b128 v[204:207], v33 offset:1664
v_mfma_f32_16x16x32_bf16 v[84:87], v[104:107], v[140:143], v[84:87]
ds_read_b128 v[208:211], v33 offset:2176
v_mfma_f32_16x16x32_bf16 v[88:91], v[108:111], v[140:143], v[88:91]
ds_read_b128 v[212:215], v33 offset:2688
s_waitcnt lgkmcnt(15)
v_mfma_f32_16x16x32_bf16 v[92:95], v[108:111], v[144:147], v[92:95]
ds_read_b128 v[216:219], v33 offset:3200
buffer_load_dwordx4 a[192:195], v56, s[12:15], s81 offen offset:3072 sc1
v_mfma_f32_16x16x32_bf16 v[80:83], v[96:99], v[144:147], v[80:83]
ds_read_b128 v[220:223], v33 offset:3712
v_mfma_f32_16x16x32_bf16 v[84:87], v[100:103], v[144:147], v[84:87]
v_mfma_f32_16x16x32_bf16 v[92:95], v[104:107], v[148:151], v[92:95]
buffer_load_dwordx4 a[196:199], v57, s[12:15], s81 offen sc1
v_mfma_f32_16x16x32_bf16 v[88:91], v[104:107], v[144:147], v[88:91]
v_mfma_f32_16x16x32_bf16 v[84:87], v[96:99], v[148:151], v[84:87]
v_mfma_f32_16x16x32_bf16 v[92:95], v[100:103], v[152:155], v[92:95]
v_mfma_f32_16x16x32_bf16 v[88:91], v[100:103], v[148:151], v[88:91]
buffer_load_dwordx4 a[200:203], v56, s[12:15], s82 offen offset:0 sc1
v_mfma_f32_16x16x32_bf16 v[88:91], v[96:99], v[152:155], v[88:91]
v_mfma_f32_16x16x32_bf16 v[92:95], v[96:99], v[156:159], v[92:95]
s_waitcnt vmcnt(18)
s_barrier
buffer_store_dwordx2 v[10:11], v63, s[12:15], s50 offen sc1
v_mfma_f32_16x16x32_bf16 v[64:67], v[160:163], v[192:195], v[64:67]
buffer_load_dwordx4 a[204:207], v56, s[12:15], s82 offen offset:1024 sc1
v_mfma_f32_16x16x32_bf16 v[68:71], v[164:167], v[192:195], v[68:71]
v_mfma_f32_16x16x32_bf16 v[72:75], v[168:171], v[192:195], v[72:75]
v_add_u32 v24, -896, v32
v_add_u32 v25, -1920, v32
s_waitcnt lgkmcnt(15)
v_mfma_f32_16x16x32_bf16 v[76:79], v[172:175], v[192:195], v[76:79]
v_add_u32 v26, -2944, v32
v_add_u32 v27, -3968, v32
s_waitcnt lgkmcnt(13)
v_mfma_f32_16x16x32_bf16 v[80:83], v[176:179], v[192:195], v[80:83]
ds_read_b128 v[128:131], v33 offset:0
buffer_load_dwordx4 a[208:211], v56, s[12:15], s82 offen offset:2048 sc1
s_waitcnt lgkmcnt(12)
v_mfma_f32_16x16x32_bf16 v[84:87], v[180:183], v[192:195], v[84:87]
ds_read2_b32 v[96:97], v24 offset0:128 offset1:129
s_waitcnt lgkmcnt(11)
v_mfma_f32_16x16x32_bf16 v[88:91], v[184:187], v[192:195], v[88:91]
ds_read2_b32 v[98:99], v24 offset0:130 offset1:131
s_waitcnt lgkmcnt(10)
v_mfma_f32_16x16x32_bf16 v[92:95], v[188:191], v[192:195], v[92:95]
ds_read2_b32 v[100:101], v24 offset0:0 offset1:1
s_waitcnt lgkmcnt(10)
v_mfma_f32_16x16x32_bf16 v[68:71], v[160:163], v[196:199], v[68:71]
ds_read2_b32 v[102:103], v24 offset0:2 offset1:3
buffer_load_dwordx4 a[212:215], v56, s[12:15], s82 offen offset:3072 sc1
v_mfma_f32_16x16x32_bf16 v[72:75], v[164:167], v[196:199], v[72:75]
ds_read2_b32 v[104:105], v25 offset0:128 offset1:129
v_mfma_f32_16x16x32_bf16 v[76:79], v[168:171], v[196:199], v[76:79]
ds_read2_b32 v[106:107], v25 offset0:130 offset1:131
v_mfma_f32_16x16x32_bf16 v[80:83], v[172:175], v[196:199], v[80:83]
ds_read2_b32 v[108:109], v25 offset0:0 offset1:1
buffer_load_dwordx4 a[216:219], v57, s[12:15], s82 offen sc1
v_mfma_f32_16x16x32_bf16 v[84:87], v[176:179], v[196:199], v[84:87]
ds_read2_b32 v[110:111], v25 offset0:2 offset1:3
v_mfma_f32_16x16x32_bf16 v[88:91], v[180:183], v[196:199], v[88:91]
ds_read2_b32 v[112:113], v26 offset0:128 offset1:129
v_mfma_f32_16x16x32_bf16 v[92:95], v[184:187], v[196:199], v[92:95]
ds_read2_b32 v[114:115], v26 offset0:130 offset1:131
s_waitcnt lgkmcnt(15)
v_mfma_f32_16x16x32_bf16 v[72:75], v[160:163], v[200:203], v[72:75]
ds_read2_b32 v[116:117], v26 offset0:0 offset1:1
buffer_load_dwordx4 a[220:223], v56, s[12:15], s83 offen offset:0 sc1
v_mfma_f32_16x16x32_bf16 v[76:79], v[164:167], v[200:203], v[76:79]
ds_read2_b32 v[118:119], v26 offset0:2 offset1:3
v_mfma_f32_16x16x32_bf16 v[80:83], v[168:171], v[200:203], v[80:83]
ds_read2_b32 v[120:121], v27 offset0:128 offset1:129
v_mfma_f32_16x16x32_bf16 v[84:87], v[172:175], v[200:203], v[84:87]
ds_read2_b32 v[122:123], v27 offset0:130 offset1:131
buffer_load_dwordx4 a[224:227], v56, s[12:15], s83 offen offset:1024 sc1
v_mfma_f32_16x16x32_bf16 v[88:91], v[176:179], v[200:203], v[88:91]
ds_read2_b32 v[124:125], v27 offset0:0 offset1:1
v_mfma_f32_16x16x32_bf16 v[92:95], v[180:183], v[200:203], v[92:95]
ds_read2_b32 v[126:127], v27 offset0:2 offset1:3
v_mfma_f32_16x16x32_bf16 v[76:79], v[160:163], v[204:207], v[76:79]
ds_read_b128 v[132:135], v33 offset:512
v_mfma_f32_16x16x32_bf16 v[80:83], v[164:167], v[204:207], v[80:83]
ds_read_b128 v[136:139], v33 offset:1024
buffer_load_dwordx4 a[228:231], v56, s[12:15], s83 offen offset:2048 sc1
v_mfma_f32_16x16x32_bf16 v[92:95], v[176:179], v[204:207], v[92:95]
ds_read_b128 v[140:143], v33 offset:1536
v_mfma_f32_16x16x32_bf16 v[84:87], v[168:171], v[204:207], v[84:87]
ds_read_b128 v[144:147], v33 offset:2048
v_mfma_f32_16x16x32_bf16 v[88:91], v[172:175], v[204:207], v[88:91]
ds_read_b128 v[148:151], v33 offset:2560
s_waitcnt lgkmcnt(15)
v_mfma_f32_16x16x32_bf16 v[92:95], v[172:175], v[208:211], v[92:95]
ds_read_b128 v[152:155], v33 offset:3072
buffer_load_dwordx4 a[232:235], v56, s[12:15], s83 offen offset:3072 sc1
v_mfma_f32_16x16x32_bf16 v[80:83], v[160:163], v[208:211], v[80:83]
ds_read_b128 v[156:159], v33 offset:3584
v_mfma_f32_16x16x32_bf16 v[84:87], v[164:167], v[208:211], v[84:87]
v_mfma_f32_16x16x32_bf16 v[92:95], v[168:171], v[212:215], v[92:95]
buffer_load_dwordx4 a[236:239], v57, s[12:15], s83 offen sc1
v_mfma_f32_16x16x32_bf16 v[88:91], v[168:171], v[208:211], v[88:91]
v_mfma_f32_16x16x32_bf16 v[84:87], v[160:163], v[212:215], v[84:87]
v_mfma_f32_16x16x32_bf16 v[92:95], v[164:167], v[216:219], v[92:95]
v_mfma_f32_16x16x32_bf16 v[88:91], v[164:167], v[212:215], v[88:91]
buffer_load_dwordx4 a[240:243], v56, s[12:15], s84 offen offset:0 sc1
v_mfma_f32_16x16x32_bf16 v[88:91], v[160:163], v[216:219], v[88:91]
v_mfma_f32_16x16x32_bf16 v[92:95], v[160:163], v[220:223], v[92:95]
v_mfma_f32_16x16x32_bf16 v[64:67], v[96:99], v[128:131], v[64:67]
buffer_load_dwordx4 a[244:247], v56, s[12:15], s84 offen offset:1024 sc1
v_mfma_f32_16x16x32_bf16 v[68:71], v[100:103], v[128:131], v[68:71]
s_waitcnt lgkmcnt(7)
v_mfma_f32_16x16x32_bf16 v[92:95], v[124:127], v[128:131], v[92:95]
s_nop 3
ds_write_b128 v34, v[64:67] offset:0
s_waitcnt lgkmcnt(7)
v_mfma_f32_16x16x32_bf16 v[68:71], v[96:99], v[132:135], v[68:71]
v_mfma_f32_16x16x32_bf16 v[72:75], v[104:107], v[128:131], v[72:75]
buffer_load_dwordx4 a[248:251], v56, s[12:15], s84 offen offset:2048 sc1
v_mfma_f32_16x16x32_bf16 v[88:91], v[120:123], v[128:131], v[88:91]
s_nop 4
ds_write_b128 v34, v[68:71] offset:1024
v_mfma_f32_16x16x32_bf16 v[72:75], v[100:103], v[132:135], v[72:75]
v_mfma_f32_16x16x32_bf16 v[92:95], v[120:123], v[132:135], v[92:95]
s_waitcnt lgkmcnt(7)
v_mfma_f32_16x16x32_bf16 v[72:75], v[96:99], v[136:139], v[72:75]
buffer_load_dwordx4 a[252:255], v56, s[12:15], s84 offen offset:3072 sc1
v_mfma_f32_16x16x32_bf16 v[76:79], v[108:111], v[128:131], v[76:79]
v_mfma_f32_16x16x32_bf16 v[84:87], v[116:119], v[128:131], v[84:87]
s_nop 4
ds_write_b128 v34, v[72:75] offset:2048
v_mfma_f32_16x16x32_bf16 v[76:79], v[104:107], v[132:135], v[76:79]
s_lshr_b32 s100, s25, 1
s_lshl_b32 s100, s100, 11
s_add_u32 s100, s100, 16842752
v_lshl_add_u32 v13, v2, 7, s100
buffer_load_dwordx2 v[14:15], v13, s[12:15], 0 offen sc1
v_mfma_f32_16x16x32_bf16 v[88:91], v[116:119], v[132:135], v[88:91]
v_mfma_f32_16x16x32_bf16 v[76:79], v[100:103], v[136:139], v[76:79]
v_mfma_f32_16x16x32_bf16 v[92:95], v[116:119], v[136:139], v[92:95]
s_waitcnt lgkmcnt(7)
v_mfma_f32_16x16x32_bf16 v[76:79], v[96:99], v[140:143], v[76:79]
buffer_load_dwordx4 v[232:235], v57, s[12:15], s84 offen sc1
v_mfma_f32_16x16x32_bf16 v[80:83], v[112:115], v[128:131], v[80:83]
v_mfma_f32_16x16x32_bf16 v[84:87], v[112:115], v[132:135], v[84:87]
s_nop 4
ds_write_b128 v34, v[76:79] offset:3072
v_mfma_f32_16x16x32_bf16 v[80:83], v[108:111], v[132:135], v[80:83]
buffer_load_dwordx4 v[236:239], v56, s[12:15], s85 offen offset:0 sc1
v_mfma_f32_16x16x32_bf16 v[88:91], v[112:115], v[136:139], v[88:91]
v_mfma_f32_16x16x32_bf16 v[80:83], v[104:107], v[136:139], v[80:83]
v_mfma_f32_16x16x32_bf16 v[92:95], v[112:115], v[140:143], v[92:95]
v_mfma_f32_16x16x32_bf16 v[80:83], v[100:103], v[140:143], v[80:83]
buffer_load_dwordx4 v[240:243], v56, s[12:15], s85 offen offset:1024 sc1
v_mfma_f32_16x16x32_bf16 v[84:87], v[108:111], v[136:139], v[84:87]
s_waitcnt lgkmcnt(7)
v_mfma_f32_16x16x32_bf16 v[80:83], v[96:99], v[144:147], v[80:83]
v_mfma_f32_16x16x32_bf16 v[84:87], v[104:107], v[140:143], v[84:87]
v_mfma_f32_16x16x32_bf16 v[88:91], v[108:111], v[140:143], v[88:91]
s_nop 5
ds_write_b128 v34, v[80:83] offset:4096
buffer_load_dwordx4 v[244:247], v56, s[12:15], s85 offen offset:2048 sc1
v_mfma_f32_16x16x32_bf16 v[84:87], v[100:103], v[144:147], v[84:87]
v_mfma_f32_16x16x32_bf16 v[92:95], v[108:111], v[144:147], v[92:95]
s_waitcnt lgkmcnt(7)
v_mfma_f32_16x16x32_bf16 v[84:87], v[96:99], v[148:151], v[84:87]
buffer_load_dwordx4 v[248:251], v56, s[12:15], s85 offen offset:3072 sc1
v_mfma_f32_16x16x32_bf16 v[88:91], v[104:107], v[144:147], v[88:91]
v_mfma_f32_16x16x32_bf16 v[92:95], v[104:107], v[148:151], v[92:95]
s_nop 4
ds_write_b128 v34, v[84:87] offset:5120
v_mfma_f32_16x16x32_bf16 v[88:91], v[100:103], v[148:151], v[88:91]
s_waitcnt lgkmcnt(7)
v_mfma_f32_16x16x32_bf16 v[92:95], v[100:103], v[152:155], v[92:95]
buffer_load_dwordx4 v[252:255], v57, s[12:15], s85 offen sc1
v_mfma_f32_16x16x32_bf16 v[88:91], v[96:99], v[152:155], v[88:91]
s_waitcnt lgkmcnt(6)
v_mfma_f32_16x16x32_bf16 v[92:95], v[96:99], v[156:159], v[92:95]
s_waitcnt vmcnt(6)
v_cmp_ne_u64 vcc, v[14:15], s[20:21]
s_nop 3
s_mov_b64 s[46:47], vcc
s_cmp_eq_u64 s[46:47], 0
s_cselect_b32 s42, s86, 2146435072
s_cselect_b32 s43, s87, 2146435072
s_cselect_b32 s44, s88, 2146435072
s_cselect_b32 s45, s89, 2146435072
ds_write_b128 v34, v[88:91] offset:6144
ds_write_b128 v34, v[92:95] offset:7168
buffer_load_dwordx4 v[144:147], v58, s[12:15], s42 offen sc1
buffer_load_dwordx4 v[148:151], v59, s[12:15], s42 offen sc1
s_lshl_b32 s101, s3, 10
s_add_u32 s101, s101, 53248
buffer_load_dwordx4 v[152:155], v60, s[12:15], s42 offen sc1
v_and_b32 v25, 1, v1
v_bfe_u32 v26, v1, 1, 1
v_lshrrev_b32 v27, 2, v1
buffer_load_dwordx4 v[156:159], v61, s[12:15], s42 offen sc1
v_lshl_add_u32 v27, v25, 3, v27
v_and_b32 v27, 15, v27
v_mul_u32_u24 v26, 16448, v26
v_lshl_add_u32 v26, v25, 9, v26
v_lshl_add_u32 v26, v27, 4, v26
v_add_u32 v26, s101, v26
v_lshrrev_b32 v27, 2, v0
v_mul_u32_u24 v27, 20480, v27
v_and_b32 v25, 3, v0
v_lshl_add_u32 v27, v25, 4, v27
s_add_u32 s101, s24, 1
s_lshl_b32 s51, s101, 6
s_add_u32 s51, s51, 13631488
s_add_u32 s52, s51, 1310720
s_lshl_b32 s50, s101, 7
s_add_u32 s50, s50, 16973824
s_waitcnt lgkmcnt(0)
s_barrier
ds_read_b128 v[96:99], v26 offset:0
ds_read_b128 v[100:103], v26 offset:256
ds_read_b128 v[104:107], v26 offset:8192
ds_read_b128 v[108:111], v26 offset:8448
ds_read_b128 v[112:115], v26 offset:4096
ds_read_b128 v[116:119], v26 offset:4352
ds_read_b128 v[120:123], v26 offset:12288
ds_read_b128 v[124:127], v26 offset:12544
s_waitcnt lgkmcnt(4)
v_pk_add_f32 v[96:97], v[96:97], v[104:105]
v_pk_add_f32 v[98:99], v[98:99], v[106:107]
v_pk_add_f32 v[100:101], v[100:101], v[108:109]
v_pk_add_f32 v[102:103], v[102:103], v[110:111]
v_cvt_pk_bf16_f32 v128, v96, v97
v_cvt_pk_bf16_f32 v129, v98, v99
v_cvt_pk_bf16_f32 v130, v100, v101
v_cvt_pk_bf16_f32 v131, v102, v103
buffer_store_dwordx4 v[128:131], v27, s[12:15], s51 offen sc1
s_waitcnt lgkmcnt(0)
v_pk_add_f32 v[112:113], v[112:113], v[120:121]
v_pk_add_f32 v[114:115], v[114:115], v[122:123]
v_pk_add_f32 v[116:117], v[116:117], v[124:125]
v_pk_add_f32 v[118:119], v[118:119], v[126:127]
v_cvt_pk_bf16_f32 v132, v112, v113
v_cvt_pk_bf16_f32 v133, v114, v115
v_cvt_pk_bf16_f32 v134, v116, v117
v_cvt_pk_bf16_f32 v135, v118, v119
buffer_store_dwordx4 v[132:135], v27, s[12:15], s52 offen sc1
buffer_load_dwordx4 v[160:163], v58, s[12:15], s43 offen sc1
buffer_load_dwordx4 v[164:167], v59, s[12:15], s43 offen sc1
buffer_load_dwordx4 v[168:171], v60, s[12:15], s43 offen sc1
buffer_load_dwordx4 v[172:175], v61, s[12:15], s43 offen sc1
buffer_load_dwordx4 v[176:179], v58, s[12:15], s44 offen sc1
buffer_load_dwordx4 v[180:183], v59, s[12:15], s44 offen sc1
buffer_load_dwordx4 v[184:187], v60, s[12:15], s44 offen sc1
buffer_load_dwordx4 v[188:191], v61, s[12:15], s44 offen sc1
buffer_load_dwordx4 v[192:195], v58, s[12:15], s45 offen sc1
buffer_load_dwordx4 v[196:199], v59, s[12:15], s45 offen sc1
buffer_load_dwordx4 v[200:203], v60, s[12:15], s45 offen sc1
buffer_load_dwordx4 v[204:207], v61, s[12:15], s45 offen sc1
s_cmp_lg_u64 s[46:47], 0
s_cbranch_scc1 slow26
back27:
v_lshlrev_b32 v36, 16, v46
v_and_b32 v37, 0xffff0000, v46
v_lshlrev_b32 v38, 16, v47
v_and_b32 v39, 0xffff0000, v47
v_lshlrev_b32 v40, 16, v48
v_and_b32 v41, 0xffff0000, v48
v_lshlrev_b32 v42, 16, v49
v_and_b32 v43, 0xffff0000, v49
v_lshlrev_b32 v44, 16, v50
v_and_b32 v45, 0xffff0000, v50
v_lshlrev_b32 v46, 16, v51
v_and_b32 v47, 0xffff0000, v51
v_lshlrev_b32 v48, 16, v52
v_and_b32 v49, 0xffff0000, v52
v_lshlrev_b32 v50, 16, v53
v_and_b32 v51, 0xffff0000, v53
v_lshlrev_b32 v52, 16, v54
v_and_b32 v53, 0xffff0000, v54
v_lshlrev_b32 v54, 16, v55
v_and_b32 v55, 0xffff0000, v55
s_mov_b32 s16, s66
s_mov_b32 s17, s67
s_mov_b32 s18, 2621440
s_mov_b32 s19, 0x20000
s_mov_b32 s101, 192
v_cmp_ne_u32 vcc, s101, v0
v_mov_b32 v15, 2146435072
s_nop 0
v_cndmask_b32 v15, 0, v15, vcc
s_waitcnt vmcnt(14)
v_mfma_f32_16x16x32_bf16 v[64:67], a[0:3], v[144:147], v[36:39]
v_mfma_f32_16x16x32_bf16 v[68:71], a[4:7], v[144:147], v[40:43]
buffer_load_dwordx4 v[208:211], v58, s[12:15], s90 offen sc1
v_mfma_f32_16x16x32_bf16 v[72:75], a[8:11], v[144:147], v[44:47]
v_mfma_f32_16x16x32_bf16 v[76:79], a[12:15], v[144:147], v[48:51]
v_mfma_f32_16x16x32_bf16 v[80:83], a[16:19], v[144:147], v[52:55]
v_mfma_f32_16x16x32_bf16 v[84:87], a[0:3], v[148:151], 0
v_mfma_f32_16x16x32_bf16 v[88:91], a[4:7], v[148:151], 0
buffer_load_dwordx4 v[212:215], v59, s[12:15], s90 offen sc1
v_mfma_f32_16x16x32_bf16 v[92:95], a[8:11], v[148:151], 0
v_mfma_f32_16x16x32_bf16 v[96:99], a[12:15], v[148:151], 0
v_mfma_f32_16x16x32_bf16 v[100:103], a[16:19], v[148:151], 0
v_mfma_f32_16x16x32_bf16 v[104:107], a[0:3], v[152:155], 0
v_mfma_f32_16x16x32_bf16 v[108:111], a[4:7], v[152:155], 0
buffer_load_dwordx4 v[216:219], v60, s[12:15], s90 offen sc1
v_mfma_f32_16x16x32_bf16 v[112:115], a[8:11], v[152:155], 0
v_mfma_f32_16x16x32_bf16 v[116:119], a[12:15], v[152:155], 0
v_mfma_f32_16x16x32_bf16 v[120:123], a[16:19], v[152:155], 0
v_mfma_f32_16x16x32_bf16 v[124:127], a[0:3], v[156:159], 0
v_mfma_f32_16x16x32_bf16 v[128:131], a[4:7], v[156:159], 0
buffer_load_dwordx4 v[220:223], v61, s[12:15], s90 offen sc1
v_mfma_f32_16x16x32_bf16 v[132:135], a[8:11], v[156:159], 0
v_mfma_f32_16x16x32_bf16 v[136:139], a[12:15], v[156:159], 0
v_mfma_f32_16x16x32_bf16 v[140:143], a[16:19], v[156:159], 0
s_waitcnt vmcnt(12)
s_barrier
buffer_store_dwordx2 v[10:11], v15, s[12:15], s50 offen sc1
v_mfma_f32_16x16x32_bf16 v[64:67], a[20:23], v[160:163], v[64:67]
s_xor_b32 s101, s3, 1
s_mul_i32 s101, s101, 15360
v_mfma_f32_16x16x32_bf16 v[68:71], a[24:27], v[160:163], v[68:71]
s_add_u32 s101, s101, 86528
buffer_load_dwordx4 v[144:147], v58, s[12:15], s91 offen sc1
v_add_u32 v25, s101, v56
s_xor_b32 s101, s3, 2
v_mfma_f32_16x16x32_bf16 v[72:75], a[28:31], v[160:163], v[72:75]
s_mul_i32 s101, s101, 15360
v_mfma_f32_16x16x32_bf16 v[76:79], a[32:35], v[160:163], v[76:79]
s_add_u32 s101, s101, 91648
v_add_u32 v26, s101, v56
v_mfma_f32_16x16x32_bf16 v[80:83], a[36:39], v[160:163], v[80:83]
s_xor_b32 s101, s3, 3
v_mfma_f32_16x16x32_bf16 v[84:87], a[20:23], v[164:167], v[84:87]
s_mul_i32 s101, s101, 15360
v_mfma_f32_16x16x32_bf16 v[88:91], a[24:27], v[164:167], v[88:91]
s_add_u32 s101, s101, 96768
v_add_u32 v27, s101, v56
buffer_load_dwordx4 v[148:151], v59, s[12:15], s91 offen sc1
s_mul_i32 s101, s3, 15360
v_mfma_f32_16x16x32_bf16 v[92:95], a[28:31], v[164:167], v[92:95]
s_add_u32 s101, s101, 86528
v_add_u32 v24, s101, v56
v_mfma_f32_16x16x32_bf16 v[96:99], a[32:35], v[164:167], v[96:99]
s_mul_i32 s101, s3, 3072
v_mfma_f32_16x16x32_bf16 v[100:103], a[36:39], v[164:167], v[100:103]
s_add_u32 s101, s101, 147968
v_add_u32 v28, s101, v56
v_mfma_f32_16x16x32_bf16 v[104:107], a[20:23], v[168:171], v[104:107]
v_lshl_add_u32 v29, v1, 3, s101
v_mfma_f32_16x16x32_bf16 v[108:111], a[24:27], v[168:171], v[108:111]
v_mul_u32_u24 v30, 176, v2
v_lshl_add_u32 v30, v3, 3, v30
buffer_load_dwordx4 v[152:155], v60, s[12:15], s91 offen sc1
v_add_u32 v30, s101, v30
v_mfma_f32_16x16x32_bf16 v[112:115], a[28:31], v[168:171], v[112:115]
v_mfma_f32_16x16x32_bf16 v[116:119], a[32:35], v[168:171], v[116:119]
v_mfma_f32_16x16x32_bf16 v[120:123], a[36:39], v[168:171], v[120:123]
v_mfma_f32_16x16x32_bf16 v[124:127], a[20:23], v[172:175], v[124:127]
v_mfma_f32_16x16x32_bf16 v[128:131], a[24:27], v[172:175], v[128:131]
buffer_load_dwordx4 v[156:159], v61, s[12:15], s91 offen sc1
v_mfma_f32_16x16x32_bf16 v[132:135], a[28:31], v[172:175], v[132:135]
v_mfma_f32_16x16x32_bf16 v[136:139], a[32:35], v[172:175], v[136:139]
v_mfma_f32_16x16x32_bf16 v[140:143], a[36:39], v[172:175], v[140:143]
s_waitcnt vmcnt(13)
v_mfma_f32_16x16x32_bf16 v[64:67], a[40:43], v[176:179], v[64:67]
v_add_u32 v12, 0, v1
v_mul_u32_u24 v13, 6554, v12
v_mfma_f32_16x16x32_bf16 v[68:71], a[44:47], v[176:179], v[68:71]
v_lshrrev_b32 v13, 16, v13
v_mul_u32_u24 v14, 10, v13
buffer_load_dwordx4 v[160:163], v58, s[12:15], s92 offen sc1
v_sub_u32 v12, v12, v14
v_mfma_f32_16x16x32_bf16 v[72:75], a[48:51], v[176:179], v[72:75]
v_mul_u32_u24 v14, 176, v13
v_lshl_add_u32 v14, v12, 4, v14
v_mfma_f32_16x16x32_bf16 v[76:79], a[52:55], v[176:179], v[76:79]
v_add_u32 v16, s101, v14
v_mul_u32_u24 v14, 1280, v13
v_mfma_f32_16x16x32_bf16 v[80:83], a[56:59], v[176:179], v[80:83]
v_lshl_add_u32 v20, v12, 4, v14
v_add_u32 v12, 64, v1
v_mfma_f32_16x16x32_bf16 v[84:87], a[40:43], v[180:183], v[84:87]
v_mul_u32_u24 v13, 6554, v12
v_mfma_f32_16x16x32_bf16 v[88:91], a[44:47], v[180:183], v[88:91]
v_lshrrev_b32 v13, 16, v13
v_mul_u32_u24 v14, 10, v13
buffer_load_dwordx4 v[164:167], v59, s[12:15], s92 offen sc1
v_sub_u32 v12, v12, v14
v_mul_u32_u24 v14, 176, v13
v_mfma_f32_16x16x32_bf16 v[92:95], a[48:51], v[180:183], v[92:95]
v_lshl_add_u32 v14, v12, 4, v14
v_mfma_f32_16x16x32_bf16 v[96:99], a[52:55], v[180:183], v[96:99]
v_add_u32 v17, s101, v14
v_mul_u32_u24 v14, 1280, v13
v_mfma_f32_16x16x32_bf16 v[100:103], a[56:59], v[180:183], v[100:103]
v_lshl_add_u32 v21, v12, 4, v14
v_add_u32 v12, 128, v1
v_mfma_f32_16x16x32_bf16 v[104:107], a[40:43], v[184:187], v[104:107]
v_mul_u32_u24 v13, 6554, v12
v_mfma_f32_16x16x32_bf16 v[108:111], a[44:47], v[184:187], v[108:111]
v_lshrrev_b32 v13, 16, v13
v_mul_u32_u24 v14, 10, v13
buffer_load_dwordx4 v[168:171], v60, s[12:15], s92 offen sc1
v_sub_u32 v12, v12, v14
v_mul_u32_u24 v14, 176, v13
v_mfma_f32_16x16x32_bf16 v[112:115], a[48:51], v[184:187], v[112:115]
v_lshl_add_u32 v14, v12, 4, v14
v_mfma_f32_16x16x32_bf16 v[116:119], a[52:55], v[184:187], v[116:119]
v_add_u32 v18, s101, v14
v_mul_u32_u24 v14, 1280, v13
v_mfma_f32_16x16x32_bf16 v[120:123], a[56:59], v[184:187], v[120:123]
v_lshl_add_u32 v22, v12, 4, v14
v_mfma_f32_16x16x32_bf16 v[124:127], a[40:43], v[188:191], v[124:127]
v_cmp_gt_u32 vcc, 32, v1
v_mov_b32 v12, 2146435072
v_mfma_f32_16x16x32_bf16 v[128:131], a[44:47], v[188:191], v[128:131]
v_cndmask_b32 v22, v12, v22, vcc
buffer_load_dwordx4 v[172:175], v61, s[12:15], s92 offen sc1
v_mfma_f32_16x16x32_bf16 v[132:135], a[48:51], v[188:191], v[132:135]
v_mfma_f32_16x16x32_bf16 v[136:139], a[52:55], v[188:191], v[136:139]
v_mfma_f32_16x16x32_bf16 v[140:143], a[56:59], v[188:191], v[140:143]
s_waitcnt vmcnt(13)
v_mfma_f32_16x16x32_bf16 v[64:67], a[60:63], v[192:195], v[64:67]
v_mfma_f32_16x16x32_bf16 v[68:71], a[64:67], v[192:195], v[68:71]
buffer_load_dwordx4 v[176:179], v58, s[12:15], s93 offen sc1
v_mfma_f32_16x16x32_bf16 v[72:75], a[68:71], v[192:195], v[72:75]
v_mfma_f32_16x16x32_bf16 v[76:79], a[72:75], v[192:195], v[76:79]
v_mfma_f32_16x16x32_bf16 v[80:83], a[76:79], v[192:195], v[80:83]
v_mfma_f32_16x16x32_bf16 v[84:87], a[60:63], v[196:199], v[84:87]
v_mfma_f32_16x16x32_bf16 v[88:91], a[64:67], v[196:199], v[88:91]
buffer_load_dwordx4 v[180:183], v59, s[12:15], s93 offen sc1
v_mfma_f32_16x16x32_bf16 v[92:95], a[68:71], v[196:199], v[92:95]
v_mfma_f32_16x16x32_bf16 v[96:99], a[72:75], v[196:199], v[96:99]
v_mfma_f32_16x16x32_bf16 v[100:103], a[76:79], v[196:199], v[100:103]
v_mfma_f32_16x16x32_bf16 v[104:107], a[60:63], v[200:203], v[104:107]
v_mfma_f32_16x16x32_bf16 v[108:111], a[64:67], v[200:203], v[108:111]
buffer_load_dwordx4 v[184:187], v60, s[12:15], s93 offen sc1
v_mfma_f32_16x16x32_bf16 v[112:115], a[68:71], v[200:203], v[112:115]
v_mfma_f32_16x16x32_bf16 v[116:119], a[72:75], v[200:203], v[116:119]
v_mfma_f32_16x16x32_bf16 v[120:123], a[76:79], v[200:203], v[120:123]
v_mfma_f32_16x16x32_bf16 v[124:127], a[60:63], v[204:207], v[124:127]
v_mfma_f32_16x16x32_bf16 v[128:131], a[64:67], v[204:207], v[128:131]
buffer_load_dwordx4 v[188:191], v61, s[12:15], s93 offen sc1
v_mfma_f32_16x16x32_bf16 v[132:135], a[68:71], v[204:207], v[132:135]
v_mfma_f32_16x16x32_bf16 v[136:139], a[72:75], v[204:207], v[136:139]
v_mfma_f32_16x16x32_bf16 v[140:143], a[76:79], v[204:207], v[140:143]
s_waitcnt vmcnt(13)
v_mfma_f32_16x16x32_bf16 v[64:67], a[80:83], v[208:211], v[64:67]
v_mfma_f32_16x16x32_bf16 v[68:71], a[84:87], v[208:211], v[68:71]
buffer_load_dwordx4 v[192:195], v58, s[12:15], s94 offen sc1
v_mfma_f32_16x16x32_bf16 v[72:75], a[88:91], v[208:211], v[72:75]
v_mfma_f32_16x16x32_bf16 v[76:79], a[92:95], v[208:211], v[76:79]
v_mfma_f32_16x16x32_bf16 v[80:83], a[96:99], v[208:211], v[80:83]
v_mfma_f32_16x16x32_bf16 v[84:87], a[80:83], v[212:215], v[84:87]
v_mfma_f32_16x16x32_bf16 v[88:91], a[84:87], v[212:215], v[88:91]
buffer_load_dwordx4 v[196:199], v59, s[12:15], s94 offen sc1
v_mfma_f32_16x16x32_bf16 v[92:95], a[88:91], v[212:215], v[92:95]
v_mfma_f32_16x16x32_bf16 v[96:99], a[92:95], v[212:215], v[96:99]
v_mfma_f32_16x16x32_bf16 v[100:103], a[96:99], v[212:215], v[100:103]
v_mfma_f32_16x16x32_bf16 v[104:107], a[80:83], v[216:219], v[104:107]
v_mfma_f32_16x16x32_bf16 v[108:111], a[84:87], v[216:219], v[108:111]
buffer_load_dwordx4 v[200:203], v60, s[12:15], s94 offen sc1
v_mfma_f32_16x16x32_bf16 v[112:115], a[88:91], v[216:219], v[112:115]
v_mfma_f32_16x16x32_bf16 v[116:119], a[92:95], v[216:219], v[116:119]
v_mfma_f32_16x16x32_bf16 v[120:123], a[96:99], v[216:219], v[120:123]
v_mfma_f32_16x16x32_bf16 v[124:127], a[80:83], v[220:223], v[124:127]
v_mfma_f32_16x16x32_bf16 v[128:131], a[84:87], v[220:223], v[128:131]
buffer_load_dwordx4 v[204:207], v61, s[12:15], s94 offen sc1
v_mfma_f32_16x16x32_bf16 v[132:135], a[88:91], v[220:223], v[132:135]
v_mfma_f32_16x16x32_bf16 v[136:139], a[92:95], v[220:223], v[136:139]
v_mfma_f32_16x16x32_bf16 v[140:143], a[96:99], v[220:223], v[140:143]
s_waitcnt vmcnt(12)
v_mfma_f32_16x16x32_bf16 v[64:67], a[100:103], v[144:147], v[64:67]
v_mfma_f32_16x16x32_bf16 v[68:71], a[104:107], v[144:147], v[68:71]
buffer_load_dwordx4 v[208:211], v58, s[12:15], s95 offen sc1
v_mfma_f32_16x16x32_bf16 v[72:75], a[108:111], v[144:147], v[72:75]
v_mfma_f32_16x16x32_bf16 v[76:79], a[112:115], v[144:147], v[76:79]
v_mfma_f32_16x16x32_bf16 v[80:83], a[116:119], v[144:147], v[80:83]
v_mfma_f32_16x16x32_bf16 v[84:87], a[100:103], v[148:151], v[84:87]
v_mfma_f32_16x16x32_bf16 v[88:91], a[104:107], v[148:151], v[88:91]
buffer_load_dwordx4 v[212:215], v59, s[12:15], s95 offen sc1
v_mfma_f32_16x16x32_bf16 v[92:95], a[108:111], v[148:151], v[92:95]
v_mfma_f32_16x16x32_bf16 v[96:99], a[112:115], v[148:151], v[96:99]
v_mfma_f32_16x16x32_bf16 v[100:103], a[116:119], v[148:151], v[100:103]
v_mfma_f32_16x16x32_bf16 v[104:107], a[100:103], v[152:155], v[104:107]
v_mfma_f32_16x16x32_bf16 v[108:111], a[104:107], v[152:155], v[108:111]
buffer_load_dwordx4 v[216:219], v60, s[12:15], s95 offen sc1
v_mfma_f32_16x16x32_bf16 v[112:115], a[108:111], v[152:155], v[112:115]
v_mfma_f32_16x16x32_bf16 v[116:119], a[112:115], v[152:155], v[116:119]
v_mfma_f32_16x16x32_bf16 v[120:123], a[116:119], v[152:155], v[120:123]
v_mfma_f32_16x16x32_bf16 v[124:127], a[100:103], v[156:159], v[124:127]
v_mfma_f32_16x16x32_bf16 v[128:131], a[104:107], v[156:159], v[128:131]
buffer_load_dwordx4 v[220:223], v61, s[12:15], s95 offen sc1
v_mfma_f32_16x16x32_bf16 v[132:135], a[108:111], v[156:159], v[132:135]
v_mfma_f32_16x16x32_bf16 v[136:139], a[112:115], v[156:159], v[136:139]
v_mfma_f32_16x16x32_bf16 v[140:143], a[116:119], v[156:159], v[140:143]
s_waitcnt vmcnt(12)
v_mfma_f32_16x16x32_bf16 v[64:67], a[120:123], v[160:163], v[64:67]
v_mfma_f32_16x16x32_bf16 v[68:71], a[124:127], v[160:163], v[68:71]
buffer_load_dwordx4 v[144:147], v58, s[12:15], s96 offen sc1
v_mfma_f32_16x16x32_bf16 v[72:75], a[128:131], v[160:163], v[72:75]
v_mfma_f32_16x16x32_bf16 v[76:79], a[132:135], v[160:163], v[76:79]
v_mfma_f32_16x16x32_bf16 v[80:83], a[136:139], v[160:163], v[80:83]
v_mfma_f32_16x16x32_bf16 v[84:87], a[120:123], v[164:167], v[84:87]
v_mfma_f32_16x16x32_bf16 v[88:91], a[124:127], v[164:167], v[88:91]
buffer_load_dwordx4 v[148:151], v59, s[12:15], s96 offen sc1
v_mfma_f32_16x16x32_bf16 v[92:95], a[128:131], v[164:167], v[92:95]
v_mfma_f32_16x16x32_bf16 v[96:99], a[132:135], v[164:167], v[96:99]
v_mfma_f32_16x16x32_bf16 v[100:103], a[136:139], v[164:167], v[100:103]
v_mfma_f32_16x16x32_bf16 v[104:107], a[120:123], v[168:171], v[104:107]
v_mfma_f32_16x16x32_bf16 v[108:111], a[124:127], v[168:171], v[108:111]
buffer_load_dwordx4 v[152:155], v60, s[12:15], s96 offen sc1
v_mfma_f32_16x16x32_bf16 v[112:115], a[128:131], v[168:171], v[112:115]
v_mfma_f32_16x16x32_bf16 v[116:119], a[132:135], v[168:171], v[116:119]
v_mfma_f32_16x16x32_bf16 v[120:123], a[136:139], v[168:171], v[120:123]
v_mfma_f32_16x16x32_bf16 v[124:127], a[120:123], v[172:175], v[124:127]
v_mfma_f32_16x16x32_bf16 v[128:131], a[124:127], v[172:175], v[128:131]
buffer_load_dwordx4 v[156:159], v61, s[12:15], s96 offen sc1
v_mfma_f32_16x16x32_bf16 v[132:135], a[128:131], v[172:175], v[132:135]
v_mfma_f32_16x16x32_bf16 v[136:139], a[132:135], v[172:175], v[136:139]
v_mfma_f32_16x16x32_bf16 v[140:143], a[136:139], v[172:175], v[140:143]
s_waitcnt vmcnt(12)
v_mfma_f32_16x16x32_bf16 v[64:67], a[140:143], v[176:179], v[64:67]
v_mfma_f32_16x16x32_bf16 v[68:71], a[144:147], v[176:179], v[68:71]
buffer_load_dwordx4 v[160:163], v58, s[12:15], s97 offen sc1
v_mfma_f32_16x16x32_bf16 v[72:75], a[148:151], v[176:179], v[72:75]
v_mfma_f32_16x16x32_bf16 v[76:79], a[152:155], v[176:179], v[76:79]
v_mfma_f32_16x16x32_bf16 v[80:83], a[156:159], v[176:179], v[80:83]
v_mfma_f32_16x16x32_bf16 v[84:87], a[140:143], v[180:183], v[84:87]
v_mfma_f32_16x16x32_bf16 v[88:91], a[144:147], v[180:183], v[88:91]
buffer_load_dwordx4 v[164:167], v59, s[12:15], s97 offen sc1
v_mfma_f32_16x16x32_bf16 v[92:95], a[148:151], v[180:183], v[92:95]
v_mfma_f32_16x16x32_bf16 v[96:99], a[152:155], v[180:183], v[96:99]
v_mfma_f32_16x16x32_bf16 v[100:103], a[156:159], v[180:183], v[100:103]
v_mfma_f32_16x16x32_bf16 v[104:107], a[140:143], v[184:187], v[104:107]
v_mfma_f32_16x16x32_bf16 v[108:111], a[144:147], v[184:187], v[108:111]
buffer_load_dwordx4 v[168:171], v60, s[12:15], s97 offen sc1
v_mfma_f32_16x16x32_bf16 v[112:115], a[148:151], v[184:187], v[112:115]
v_mfma_f32_16x16x32_bf16 v[116:119], a[152:155], v[184:187], v[116:119]
v_mfma_f32_16x16x32_bf16 v[120:123], a[156:159], v[184:187], v[120:123]
v_mfma_f32_16x16x32_bf16 v[124:127], a[140:143], v[188:191], v[124:127]
v_mfma_f32_16x16x32_bf16 v[128:131], a[144:147], v[188:191], v[128:131]
buffer_load_dwordx4 v[172:175], v61, s[12:15], s97 offen sc1
v_mfma_f32_16x16x32_bf16 v[132:135], a[148:151], v[188:191], v[132:135]
v_mfma_f32_16x16x32_bf16 v[136:139], a[152:155], v[188:191], v[136:139]
v_mfma_f32_16x16x32_bf16 v[140:143], a[156:159], v[188:191], v[140:143]
s_waitcnt vmcnt(12)
v_mfma_f32_16x16x32_bf16 v[64:67], a[160:163], v[192:195], v[64:67]
v_mfma_f32_16x16x32_bf16 v[68:71], a[164:167], v[192:195], v[68:71]
buffer_load_dwordx4 v[176:179], v58, s[12:15], s98 offen sc1
v_mfma_f32_16x16x32_bf16 v[72:75], a[168:171], v[192:195], v[72:75]
v_mfma_f32_16x16x32_bf16 v[76:79], a[172:175], v[192:195], v[76:79]
v_mfma_f32_16x16x32_bf16 v[80:83], a[176:179], v[192:195], v[80:83]
v_mfma_f32_16x16x32_bf16 v[84:87], a[160:163], v[196:199], v[84:87]
v_mfma_f32_16x16x32_bf16 v[88:91], a[164:167], v[196:199], v[88:91]
buffer_load_dwordx4 v[180:183], v59, s[12:15], s98 offen sc1
v_mfma_f32_16x16x32_bf16 v[92:95], a[168:171], v[196:199], v[92:95]
v_mfma_f32_16x16x32_bf16 v[96:99], a[172:175], v[196:199], v[96:99]
v_mfma_f32_16x16x32_bf16 v[100:103], a[176:179], v[196:199], v[100:103]
v_mfma_f32_16x16x32_bf16 v[104:107], a[160:163], v[200:203], v[104:107]
s_mul_i32 s101, s26, 5120
s_add_u32 s101, s101, 16973824
v_min_u32 v13, 39, v1
v_lshl_add_u32 v13, v13, 7, s101
buffer_load_dwordx2 v[14:15], v13, s[12:15], 0 offen sc1
v_mfma_f32_16x16x32_bf16 v[108:111], a[164:167], v[200:203], v[108:111]
buffer_load_dwordx4 v[184:187], v60, s[12:15], s98 offen sc1
v_mfma_f32_16x16x32_bf16 v[112:115], a[168:171], v[200:203], v[112:115]
v_mfma_f32_16x16x32_bf16 v[116:119], a[172:175], v[200:203], v[116:119]
v_mfma_f32_16x16x32_bf16 v[120:123], a[176:179], v[200:203], v[120:123]
v_mfma_f32_16x16x32_bf16 v[124:127], a[160:163], v[204:207], v[124:127]
v_mfma_f32_16x16x32_bf16 v[128:131], a[164:167], v[204:207], v[128:131]
buffer_load_dwordx4 v[188:191], v61, s[12:15], s98 offen sc1
v_mfma_f32_16x16x32_bf16 v[132:135], a[168:171], v[204:207], v[132:135]
v_mfma_f32_16x16x32_bf16 v[136:139], a[172:175], v[204:207], v[136:139]
v_mfma_f32_16x16x32_bf16 v[140:143], a[176:179], v[204:207], v[140:143]
s_waitcnt vmcnt(13)
v_mfma_f32_16x16x32_bf16 v[64:67], a[180:183], v[208:211], v[64:67]
v_mfma_f32_16x16x32_bf16 v[68:71], a[184:187], v[208:211], v[68:71]
buffer_load_dwordx4 v[192:195], v58, s[12:15], s99 offen sc1
v_mfma_f32_16x16x32_bf16 v[72:75], a[188:191], v[208:211], v[72:75]
v_mfma_f32_16x16x32_bf16 v[76:79], a[192:195], v[208:211], v[76:79]
v_mfma_f32_16x16x32_bf16 v[80:83], a[196:199], v[208:211], v[80:83]
v_mfma_f32_16x16x32_bf16 v[84:87], a[180:183], v[212:215], v[84:87]
v_mfma_f32_16x16x32_bf16 v[88:91], a[184:187], v[212:215], v[88:91]
buffer_load_dwordx4 v[196:199], v59, s[12:15], s99 offen sc1
v_mfma_f32_16x16x32_bf16 v[92:95], a[188:191], v[212:215], v[92:95]
v_mfma_f32_16x16x32_bf16 v[96:99], a[192:195], v[212:215], v[96:99]
v_mfma_f32_16x16x32_bf16 v[100:103], a[196:199], v[212:215], v[100:103]
v_mfma_f32_16x16x32_bf16 v[104:107], a[180:183], v[216:219], v[104:107]
v_mfma_f32_16x16x32_bf16 v[108:111], a[184:187], v[216:219], v[108:111]
buffer_load_dwordx4 v[200:203], v60, s[12:15], s99 offen sc1
v_mfma_f32_16x16x32_bf16 v[112:115], a[188:191], v[216:219], v[112:115]
v_mfma_f32_16x16x32_bf16 v[116:119], a[192:195], v[216:219], v[116:119]
v_mfma_f32_16x16x32_bf16 v[120:123], a[196:199], v[216:219], v[120:123]
v_mfma_f32_16x16x32_bf16 v[124:127], a[180:183], v[220:223], v[124:127]
v_mfma_f32_16x16x32_bf16 v[128:131], a[184:187], v[220:223], v[128:131]
buffer_load_dwordx4 v[204:207], v61, s[12:15], s99 offen sc1
v_mfma_f32_16x16x32_bf16 v[132:135], a[188:191], v[220:223], v[132:135]
v_mfma_f32_16x16x32_bf16 v[136:139], a[192:195], v[220:223], v[136:139]
v_mfma_f32_16x16x32_bf16 v[140:143], a[196:199], v[220:223], v[140:143]
s_waitcnt vmcnt(13)
v_mfma_f32_16x16x32_bf16 v[64:67], a[200:203], v[144:147], v[64:67]
v_mfma_f32_16x16x32_bf16 v[68:71], a[204:207], v[144:147], v[68:71]
v_mfma_f32_16x16x32_bf16 v[72:75], a[208:211], v[144:147], v[72:75]
v_mfma_f32_16x16x32_bf16 v[76:79], a[212:215], v[144:147], v[76:79]
v_mfma_f32_16x16x32_bf16 v[80:83], a[216:219], v[144:147], v[80:83]
v_mfma_f32_16x16x32_bf16 v[84:87], a[200:203], v[148:151], v[84:87]
v_mfma_f32_16x16x32_bf16 v[88:91], a[204:207], v[148:151], v[88:91]
v_mfma_f32_16x16x32_bf16 v[92:95], a[208:211], v[148:151], v[92:95]
v_mfma_f32_16x16x32_bf16 v[96:99], a[212:215], v[148:151], v[96:99]
v_mfma_f32_16x16x32_bf16 v[100:103], a[216:219], v[148:151], v[100:103]
v_mfma_f32_16x16x32_bf16 v[104:107], a[200:203], v[152:155], v[104:107]
v_mfma_f32_16x16x32_bf16 v[108:111], a[204:207], v[152:155], v[108:111]
v_mfma_f32_16x16x32_bf16 v[112:115], a[208:211], v[152:155], v[112:115]
v_mfma_f32_16x16x32_bf16 v[116:119], a[212:215], v[152:155], v[116:119]
v_mfma_f32_16x16x32_bf16 v[120:123], a[216:219], v[152:155], v[120:123]
v_mfma_f32_16x16x32_bf16 v[124:127], a[200:203], v[156:159], v[124:127]
v_mfma_f32_16x16x32_bf16 v[128:131], a[204:207], v[156:159], v[128:131]
v_mfma_f32_16x16x32_bf16 v[132:135], a[208:211], v[156:159], v[132:135]
v_mfma_f32_16x16x32_bf16 v[136:139], a[212:215], v[156:159], v[136:139]
v_mfma_f32_16x16x32_bf16 v[140:143], a[216:219], v[156:159], v[140:143]
s_waitcnt vmcnt(9)
v_mfma_f32_16x16x32_bf16 v[84:87], a[220:223], v[164:167], v[84:87]
v_mfma_f32_16x16x32_bf16 v[88:91], a[224:227], v[164:167], v[88:91]
s_waitcnt vmcnt(6)
v_cmp_ne_u64 vcc, v[14:15], s[20:21]
v_mfma_f32_16x16x32_bf16 v[92:95], a[228:231], v[164:167], v[92:95]
s_cbranch_vccnz slow28
back29:
v_mfma_f32_16x16x32_bf16 v[96:99], a[232:235], v[164:167], v[96:99]
s_lshl_b32 s101, s25, 2
s_add_u32 s101, s101, s3
v_mfma_f32_16x16x32_bf16 v[100:103], a[236:239], v[164:167], v[100:103]
s_mul_i32 s51, s101, 20480
s_lshl_b32 s52, s101, 6
s_waitcnt vmcnt(4)
s_mul_i32 s101, s26, 2560
s_add_u32 s51, s51, s101
v_mfma_f32_16x16x32_bf16 v[84:87], a[240:243], v[180:183], v[84:87]
s_add_u32 s51, s51, 13631488
s_add_u32 s52, s52, 16777216
v_mfma_f32_16x16x32_bf16 v[88:91], a[244:247], v[180:183], v[88:91]
v_cmp_gt_u32 vcc, 32, v1
v_mov_b32 v12, 2146435072
v_mfma_f32_16x16x32_bf16 v[92:95], a[248:251], v[180:183], v[92:95]
v_lshlrev_b32 v13, 2, v2
v_cndmask_b32 v12, v12, v56, vcc
v_mfma_f32_16x16x32_bf16 v[96:99], a[252:255], v[180:183], v[96:99]
buffer_load_dwordx4 v[208:211], v56, s[12:15], s51 offen sc1
buffer_load_dwordx4 v[212:215], v56, s[12:15], s51 offen offset:1024 sc1
v_mfma_f32_16x16x32_bf16 v[100:103], v[232:235], v[180:183], v[100:103]
buffer_load_dwordx4 v[216:219], v12, s[12:15], s51 offen offset:2048 sc1
buffer_load_dword v62, v13, s[12:15], s52 offen sc1
s_waitcnt vmcnt(4)
s_lshl_b32 s101, s25, 2
s_add_u32 s101, s101, s3
v_mfma_f32_16x16x32_bf16 v[84:87], v[236:239], v[196:199], v[84:87]
s_mul_i32 s51, s101, 20480
s_mul_i32 s101, s26, 160
v_mfma_f32_16x16x32_bf16 v[88:91], v[240:243], v[196:199], v[88:91]
s_add_u32 s51, s51, s101
v_mfma_f32_16x16x32_bf16 v[92:95], v[244:247], v[196:199], v[92:95]
v_mfma_f32_16x16x32_bf16 v[96:99], v[248:251], v[196:199], v[96:99]
v_mfma_f32_16x16x32_bf16 v[100:103], v[252:255], v[196:199], v[100:103]
v_mfma_f32_16x16x32_bf16 v[104:107], a[220:223], v[168:171], v[104:107]
v_mfma_f32_16x16x32_bf16 v[108:111], a[224:227], v[168:171], v[108:111]
v_mfma_f32_16x16x32_bf16 v[112:115], a[228:231], v[168:171], v[112:115]
ds_write_b128 v25, v[84:87] offset:0
v_mfma_f32_16x16x32_bf16 v[116:119], a[232:235], v[168:171], v[116:119]
v_mfma_f32_16x16x32_bf16 v[120:123], a[236:239], v[168:171], v[120:123]
v_mfma_f32_16x16x32_bf16 v[104:107], a[240:243], v[184:187], v[104:107]
ds_write_b128 v25, v[88:91] offset:1024
v_mfma_f32_16x16x32_bf16 v[108:111], a[244:247], v[184:187], v[108:111]
v_mfma_f32_16x16x32_bf16 v[112:115], a[248:251], v[184:187], v[112:115]
v_mfma_f32_16x16x32_bf16 v[116:119], a[252:255], v[184:187], v[116:119]
ds_write_b128 v25, v[92:95] offset:2048
v_mfma_f32_16x16x32_bf16 v[120:123], v[232:235], v[184:187], v[120:123]
v_mfma_f32_16x16x32_bf16 v[104:107], v[236:239], v[200:203], v[104:107]
v_mfma_f32_16x16x32_bf16 v[108:111], v[240:243], v[200:203], v[108:111]
ds_write_b128 v25, v[96:99] offset:3072
v_mfma_f32_16x16x32_bf16 v[112:115], v[244:247], v[200:203], v[112:115]
v_mfma_f32_16x16x32_bf16 v[116:119], v[248:251], v[200:203], v[116:119]
v_mfma_f32_16x16x32_bf16 v[120:123], v[252:255], v[200:203], v[120:123]
ds_write_b128 v25, v[100:103] offset:4096
v_mfma_f32_16x16x32_bf16 v[124:127], a[220:223], v[172:175], v[124:127]
v_mfma_f32_16x16x32_bf16 v[128:131], a[224:227], v[172:175], v[128:131]
v_mfma_f32_16x16x32_bf16 v[132:135], a[228:231], v[172:175], v[132:135]
ds_write_b128 v26, v[104:107] offset:0
v_mfma_f32_16x16x32_bf16 v[136:139], a[232:235], v[172:175], v[136:139]
v_mfma_f32_16x16x32_bf16 v[140:143], a[236:239], v[172:175], v[140:143]
v_mfma_f32_16x16x32_bf16 v[124:127], a[240:243], v[188:191], v[124:127]
ds_write_b128 v26, v[108:111] offset:1024
v_mfma_f32_16x16x32_bf16 v[128:131], a[244:247], v[188:191], v[128:131]
v_mfma_f32_16x16x32_bf16 v[132:135], a[248:251], v[188:191], v[132:135]
v_mfma_f32_16x16x32_bf16 v[136:139], a[252:255], v[188:191], v[136:139]
ds_write_b128 v26, v[112:115] offset:2048
v_mfma_f32_16x16x32_bf16 v[140:143], v[232:235], v[188:191], v[140:143]
v_mfma_f32_16x16x32_bf16 v[124:127], v[236:239], v[204:207], v[124:127]
v_mfma_f32_16x16x32_bf16 v[128:131], v[240:243], v[204:207], v[128:131]
ds_write_b128 v26, v[116:119] offset:3072
v_mfma_f32_16x16x32_bf16 v[132:135], v[244:247], v[204:207], v[132:135]
v_mfma_f32_16x16x32_bf16 v[136:139], v[248:251], v[204:207], v[136:139]
v_mfma_f32_16x16x32_bf16 v[140:143], v[252:255], v[204:207], v[140:143]
ds_write_b128 v26, v[120:123] offset:4096
v_mfma_f32_16x16x32_bf16 v[64:67], a[220:223], v[160:163], v[64:67]
v_mfma_f32_16x16x32_bf16 v[68:71], a[224:227], v[160:163], v[68:71]
v_mfma_f32_16x16x32_bf16 v[72:75], a[228:231], v[160:163], v[72:75]
ds_write_b128 v27, v[124:127] offset:0
v_mfma_f32_16x16x32_bf16 v[76:79], a[232:235], v[160:163], v[76:79]
v_mfma_f32_16x16x32_bf16 v[80:83], a[236:239], v[160:163], v[80:83]
v_mfma_f32_16x16x32_bf16 v[64:67], a[240:243], v[176:179], v[64:67]
ds_write_b128 v27, v[128:131] offset:1024
v_mfma_f32_16x16x32_bf16 v[68:71], a[244:247], v[176:179], v[68:71]
v_mfma_f32_16x16x32_bf16 v[72:75], a[248:251], v[176:179], v[72:75]
v_mfma_f32_16x16x32_bf16 v[76:79], a[252:255], v[176:179], v[76:79]
ds_write_b128 v27, v[132:135] offset:2048
v_mfma_f32_16x16x32_bf16 v[80:83], v[232:235], v[176:179], v[80:83]
v_mfma_f32_16x16x32_bf16 v[64:67], v[236:239], v[192:195], v[64:67]
v_mfma_f32_16x16x32_bf16 v[68:71], v[240:243], v[192:195], v[68:71]
ds_write_b128 v27, v[136:139] offset:3072
v_mfma_f32_16x16x32_bf16 v[72:75], v[244:247], v[192:195], v[72:75]
v_mfma_f32_16x16x32_bf16 v[76:79], v[248:251], v[192:195], v[76:79]
v_mfma_f32_16x16x32_bf16 v[80:83], v[252:255], v[192:195], v[80:83]
ds_write_b128 v27, v[140:143] offset:4096
s_waitcnt vmcnt(0)
ds_write_b128 v28, v[208:211] offset:0
ds_write_b128 v28, v[212:215] offset:1024
ds_write_b128 v28, v[216:219] offset:2048
s_waitcnt lgkmcnt(0)
s_barrier
ds_read_b64_tr_b16 v[36:37], v29 offset:0
ds_read_b128 v[84:87], v24 offset:0
ds_read_b128 v[104:107], v24 offset:5120
ds_read_b128 v[124:127], v24 offset:10240
ds_read_b64_tr_b16 v[38:39], v29 offset:512
ds_read_b128 v[88:91], v24 offset:1024
ds_read_b128 v[108:111], v24 offset:6144
ds_read_b128 v[128:131], v24 offset:11264
ds_read_b64_tr_b16 v[40:41], v29 offset:1024
ds_read_b128 v[92:95], v24 offset:2048
ds_read_b128 v[112:115], v24 offset:7168
ds_read_b128 v[132:135], v24 offset:12288
ds_read_b64_tr_b16 v[42:43], v29 offset:1536
ds_read_b128 v[96:99], v24 offset:3072
ds_read_b128 v[116:119], v24 offset:8192
ds_read_b128 v[136:139], v24 offset:13312
ds_read_b64_tr_b16 v[44:45], v29 offset:2048
ds_read_b128 v[100:103], v24 offset:4096
ds_read_b128 v[120:123], v24 offset:9216
ds_read_b128 v[140:143], v24 offset:14336
s_waitcnt lgkmcnt(15)
v_pk_add_f32 v[64:65], v[64:65], v[84:85]
v_pk_add_f32 v[66:67], v[66:67], v[86:87]
v_pk_add_f32 v[64:65], v[64:65], v[104:105]
v_pk_add_f32 v[66:67], v[66:67], v[106:107]
v_pk_add_f32 v[64:65], v[64:65], v[124:125]
v_pk_add_f32 v[66:67], v[66:67], v[126:127]
v_lshlrev_b32 v48, 16, v36
v_and_b32 v49, 0xffff0000, v36
v_lshlrev_b32 v50, 16, v37
v_and_b32 v51, 0xffff0000, v37
v_pk_add_f32 v[48:49], v[48:49], v[64:65] neg_lo:[0,1] neg_hi:[0,1]
v_pk_add_f32 v[50:51], v[50:51], v[66:67] neg_lo:[0,1] neg_hi:[0,1]
v_pk_fma_f32 v[64:65], v[48:49], v[62:63], v[64:65] op_sel_hi:[1,0,1]
v_pk_fma_f32 v[66:67], v[50:51], v[62:63], v[66:67] op_sel_hi:[1,0,1]
v_cvt_pk_bf16_f32 v52, v64, v65
v_cvt_pk_bf16_f32 v53, v66, v67
ds_write_b64 v30, v[52:53] offset:0
s_waitcnt lgkmcnt(13)
v_pk_add_f32 v[68:69], v[68:69], v[88:89]
v_pk_add_f32 v[70:71], v[70:71], v[90:91]
v_pk_add_f32 v[68:69], v[68:69], v[108:109]
v_pk_add_f32 v[70:71], v[70:71], v[110:111]
v_pk_add_f32 v[68:69], v[68:69], v[128:129]
v_pk_add_f32 v[70:71], v[70:71], v[130:131]
v_lshlrev_b32 v48, 16, v38
v_and_b32 v49, 0xffff0000, v38
v_lshlrev_b32 v50, 16, v39
v_and_b32 v51, 0xffff0000, v39
v_pk_add_f32 v[48:49], v[48:49], v[68:69] neg_lo:[0,1] neg_hi:[0,1]
v_pk_add_f32 v[50:51], v[50:51], v[70:71] neg_lo:[0,1] neg_hi:[0,1]
v_pk_fma_f32 v[68:69], v[48:49], v[62:63], v[68:69] op_sel_hi:[1,0,1]
v_pk_fma_f32 v[70:71], v[50:51], v[62:63], v[70:71] op_sel_hi:[1,0,1]
v_cvt_pk_bf16_f32 v54, v68, v69
v_cvt_pk_bf16_f32 v55, v70, v71
ds_write_b64 v30, v[54:55] offset:32
s_waitcnt lgkmcnt(10)
v_pk_add_f32 v[72:73], v[72:73], v[92:93]
v_pk_add_f32 v[74:75], v[74:75], v[94:95]
v_pk_add_f32 v[72:73], v[72:73], v[112:113]
v_pk_add_f32 v[74:75], v[74:75], v[114:115]
v_pk_add_f32 v[72:73], v[72:73], v[132:133]
v_pk_add_f32 v[74:75], v[74:75], v[134:135]
v_lshlrev_b32 v48, 16, v40
v_and_b32 v49, 0xffff0000, v40
v_lshlrev_b32 v50, 16, v41
v_and_b32 v51, 0xffff0000, v41
v_pk_add_f32 v[48:49], v[48:49], v[72:73] neg_lo:[0,1] neg_hi:[0,1]
v_pk_add_f32 v[50:51], v[50:51], v[74:75] neg_lo:[0,1] neg_hi:[0,1]
v_pk_fma_f32 v[72:73], v[48:49], v[62:63], v[72:73] op_sel_hi:[1,0,1]
v_pk_fma_f32 v[74:75], v[50:51], v[62:63], v[74:75] op_sel_hi:[1,0,1]
v_cvt_pk_bf16_f32 v52, v72, v73
v_cvt_pk_bf16_f32 v53, v74, v75
ds_write_b64 v30, v[52:53] offset:64
s_waitcnt lgkmcnt(7)
v_pk_add_f32 v[76:77], v[76:77], v[96:97]
v_pk_add_f32 v[78:79], v[78:79], v[98:99]
v_pk_add_f32 v[76:77], v[76:77], v[116:117]
v_pk_add_f32 v[78:79], v[78:79], v[118:119]
v_pk_add_f32 v[76:77], v[76:77], v[136:137]
v_pk_add_f32 v[78:79], v[78:79], v[138:139]
v_lshlrev_b32 v48, 16, v42
v_and_b32 v49, 0xffff0000, v42
v_lshlrev_b32 v50, 16, v43
v_and_b32 v51, 0xffff0000, v43
v_pk_add_f32 v[48:49], v[48:49], v[76:77] neg_lo:[0,1] neg_hi:[0,1]
v_pk_add_f32 v[50:51], v[50:51], v[78:79] neg_lo:[0,1] neg_hi:[0,1]
v_pk_fma_f32 v[76:77], v[48:49], v[62:63], v[76:77] op_sel_hi:[1,0,1]
v_pk_fma_f32 v[78:79], v[50:51], v[62:63], v[78:79] op_sel_hi:[1,0,1]
v_cvt_pk_bf16_f32 v54, v76, v77
v_cvt_pk_bf16_f32 v55, v78, v79
ds_write_b64 v30, v[54:55] offset:96
s_waitcnt lgkmcnt(4)
v_pk_add_f32 v[80:81], v[80:81], v[100:101]
v_pk_add_f32 v[82:83], v[82:83], v[102:103]
v_pk_add_f32 v[80:81], v[80:81], v[120:121]
v_pk_add_f32 v[82:83], v[82:83], v[122:123]
v_pk_add_f32 v[80:81], v[80:81], v[140:141]
v_pk_add_f32 v[82:83], v[82:83], v[142:143]
v_lshlrev_b32 v48, 16, v44
v_and_b32 v49, 0xffff0000, v44
v_lshlrev_b32 v50, 16, v45
v_and_b32 v51, 0xffff0000, v45
v_pk_add_f32 v[48:49], v[48:49], v[80:81] neg_lo:[0,1] neg_hi:[0,1]
v_pk_add_f32 v[50:51], v[50:51], v[82:83] neg_lo:[0,1] neg_hi:[0,1]
v_pk_fma_f32 v[80:81], v[48:49], v[62:63], v[80:81] op_sel_hi:[1,0,1]
v_pk_fma_f32 v[82:83], v[50:51], v[62:63], v[82:83] op_sel_hi:[1,0,1]
v_cvt_pk_bf16_f32 v52, v80, v81
v_cvt_pk_bf16_f32 v53, v82, v83
ds_write_b64 v30, v[52:53] offset:128
ds_read_b128 v[96:99], v16
ds_read_b128 v[100:103], v17
ds_read_b128 v[104:107], v18
s_waitcnt lgkmcnt(2)
buffer_store_dwordx4 v[96:99], v20, s[16:19], s51 offen
s_waitcnt lgkmcnt(1)
buffer_store_dwordx4 v[100:103], v21, s[16:19], s51 offen
s_waitcnt lgkmcnt(0)
buffer_store_dwordx4 v[104:107], v22, s[16:19], s51 offen
s_endpgm
slow18:
s_mov_b32 s100, 0
v_mov_b32 v13, 0
slow18l:
global_load_dwordx2 v[10:11], v13, s[68:69] sc1
s_add_u32 s100, s100, 1
s_waitcnt vmcnt(0)
v_readfirstlane_b32 s21, v11
v_readfirstlane_b32 s20, v10
s_cmp_ge_u32 s100, 0x8000
s_cbranch_scc1 slow18x
s_cmp_eq_u32 s21, 0
s_cbranch_scc1 slow18l
slow18x:
s_nop 4
s_branch back19
slow20:
s_mov_b32 s100, 0
slow20l:
buffer_load_dwordx2 v[14:15], v13, s[12:15], 0 offen sc1
s_add_u32 s100, s100, 1
s_cmp_ge_u32 s100, 0x8000
s_cbranch_scc1 slow20x
s_waitcnt vmcnt(0)
v_cmp_ne_u64 vcc, v[14:15], s[20:21]
s_cbranch_vccnz slow20l
slow20x:
s_waitcnt vmcnt(0)
s_branch back21
slow22:
s_mov_b32 s100, 0
slow22l:
buffer_load_dwordx2 v[226:227], v12, s[12:15], 0 offen sc1
s_add_u32 s100, s100, 1
s_cmp_ge_u32 s100, 0x8000
s_cbranch_scc1 slow22x
s_waitcnt vmcnt(0)
v_cmp_ne_u64 vcc, v[226:227], s[20:21]
s_cbranch_vccnz slow22l
slow22x:
s_waitcnt vmcnt(0)
s_branch back23
slow26:
s_mov_b32 s100, 0
slow26l:
buffer_load_dwordx2 v[14:15], v13, s[12:15], 0 offen sc1
s_add_u32 s100, s100, 1
s_cmp_ge_u32 s100, 0x8000
s_cbranch_scc1 slow26x
s_waitcnt vmcnt(0)
v_cmp_ne_u64 vcc, v[14:15], s[20:21]
s_cbranch_vccnz slow26l
slow26x:
s_waitcnt vmcnt(0)
buffer_load_dwordx4 v[144:147], v58, s[12:15], s86 offen sc1
buffer_load_dwordx4 v[148:151], v59, s[12:15], s86 offen sc1
buffer_load_dwordx4 v[152:155], v60, s[12:15], s86 offen sc1
buffer_load_dwordx4 v[156:159], v61, s[12:15], s86 offen sc1
buffer_load_dwordx4 v[160:163], v58, s[12:15], s87 offen sc1
buffer_load_dwordx4 v[164:167], v59, s[12:15], s87 offen sc1
buffer_load_dwordx4 v[168:171], v60, s[12:15], s87 offen sc1
buffer_load_dwordx4 v[172:175], v61, s[12:15], s87 offen sc1
buffer_load_dwordx4 v[176:179], v58, s[12:15], s88 offen sc1
buffer_load_dwordx4 v[180:183], v59, s[12:15], s88 offen sc1
buffer_load_dwordx4 v[184:187], v60, s[12:15], s88 offen sc1
buffer_load_dwordx4 v[188:191], v61, s[12:15], s88 offen sc1
buffer_load_dwordx4 v[192:195], v58, s[12:15], s89 offen sc1
buffer_load_dwordx4 v[196:199], v59, s[12:15], s89 offen sc1
buffer_load_dwordx4 v[200:203], v60, s[12:15], s89 offen sc1
buffer_load_dwordx4 v[204:207], v61, s[12:15], s89 offen sc1
v_mov_b32 v12, 2146435072
buffer_load_dword v229, v12, s[12:15], 0 offen
buffer_load_dword v229, v12, s[12:15], 0 offen
s_branch back27
slow28:
s_mov_b32 s100, 0
slow28l:
buffer_load_dwordx2 v[14:15], v13, s[12:15], 0 offen sc1
s_add_u32 s100, s100, 1
s_cmp_ge_u32 s100, 0x8000
s_cbranch_scc1 slow28x
s_waitcnt vmcnt(0)
v_cmp_ne_u64 vcc, v[14:15], s[20:21]
s_cbranch_vccnz slow28l
slow28x:
s_waitcnt vmcnt(0)
s_branch back29
L_B_end:
L_C:
s_getpc_b64 s[20:21]
pc30:
v_lshlrev_b32 v4, 7, v0
v_min_u32 v4, L_C_end-pc30-4, v4
global_load_dword v229, v4, s[20:21]
s_lshl_b32 s23, s30, 1
s_add_u32 s23, s23, s31
s_sub_u32 s23, s23, 30
s_lshl_b32 s24, s23, 1
s_mov_b32 s22, s23
s_add_u32 s24, s24, 288
s_lshl_b32 s101, s24, 9
v_lshlrev_b32 v5, 1, v0
v_add_u32 v12, s101, v5
s_lshl_b32 s101, s24, 2
s_waitcnt lgkmcnt(0)
global_load_ushort v36, v12, s[38:39]
global_load_ushort v37, v12, s[40:41]
global_load_ushort v38, v12, s[42:43]
global_load_ushort v39, v12, s[44:45]
global_load_ushort v40, v12, s[46:47]
global_load_ushort v41, v12, s[48:49]
global_load_ushort v4, v12, s[38:39] offset:512
global_load_ushort v5, v12, s[40:41] offset:512
global_load_ushort v6, v12, s[42:43] offset:512
global_load_ushort v7, v12, s[44:45] offset:512
global_load_ushort v8, v12, s[46:47] offset:512
global_load_ushort v9, v12, s[48:49] offset:512
s_add_u32 s50, s50, s101
s_addc_u32 s51, s51, 0
s_add_u32 s52, s52, s101
s_addc_u32 s53, s53, 0
s_load_dwordx2 s[0:1], s[50:51], 0
s_load_dwordx2 s[54:55], s[52:53], 0
s_mov_b32 s12, s70
s_mov_b32 s13, s71
s_mov_b32 s14, 33554432
s_mov_b32 s15, 0x20000
s_mov_b32 s4, s36
s_mov_b32 s5, s37
s_mov_b32 s6, 2621440
s_mov_b32 s7, 0x20000
s_mov_b32 s16, s64
s_mov_b32 s17, s65
s_mov_b32 s18, 1280
s_mov_b32 s19, 0x20000
s_mov_b32 s28, 0
s_lshl_b32 s47, s3, 15
s_add_u32 s47, s47, 32768
s_lshl_b32 s101, s22, 2
s_add_u32 s101, s101, s3
s_mul_i32 s101, s101, 40960
v_lshrrev_b32 v64, 3, v1
v_and_b32 v65, 7, v1
v_xor_b32 v66, v64, v65
v_mul_u32_u24 v67, 1280, v64
v_lshl_add_u32 v67, v66, 4, v67
v_add_u32 v16, s101, v67
v_add_u32 v17, 9216, v16
v_add_u32 v18, 18432, v16
v_add_u32 v19, 27648, v16
s_and_b32 s101, s3, 1
s_lshl_b32 s101, s101, 10
s_add_u32 m0, s101, 30720
v_lshlrev_b32 v65, 4, v1
buffer_load_dwordx4 v65, s[16:19], s101 offen lds
s_mov_b32 s37, s31
s_add_u32 m0, s47, 0
s_nop 0
buffer_load_dwordx4 v16, s[4:7], s28 offen offset:0 lds
buffer_load_dwordx4 v17, s[4:7], s28 offen offset:1024 lds
buffer_load_dwordx4 v18, s[4:7], s28 offen offset:2048 lds
buffer_load_dwordx4 v19, s[4:7], s28 offen offset:3072 lds
s_add_u32 s28, s28, 128
v_mov_b32 v13, 0
global_load_dwordx2 v[10:11], v13, s[68:69] sc1
v_cmp_eq_u32 vcc, 0, v0
v_mov_b32 v63, 2146435072
v_lshlrev_b32 v56, 4, v1
v_cndmask_b32 v63, v63, 0, vcc
v_add_u32 v57, 4096, v56
s_xor_b32 s101, s3, 0
s_lshl_b32 s101, s101, 10
v_add_u32 v58, s101, v56
s_xor_b32 s101, s3, 1
s_lshl_b32 s101, s101, 10
v_add_u32 v59, s101, v56
s_xor_b32 s101, s3, 2
s_lshl_b32 s101, s101, 10
v_add_u32 v60, s101, v56
s_xor_b32 s101, s3, 3
s_lshl_b32 s101, s101, 10
v_add_u32 v61, s101, v56
s_and_b32 s42, s37, 3
s_mul_i32 s42, s42, 3
s_lshr_b32 s43, s37, 2
s_mul_i32 s43, s43, 5
s_add_u32 s42, s42, s43
s_mul_i32 s43, s42, 5042
s_lshr_b32 s43, s43, 16
s_mul_i32 s43, s43, 13
s_sub_u32 s42, s42, s43
s_mul_i32 s43, s3, 14
s_cmp_eq_u32 s3, 3
s_cselect_b32 s44, 1, 0
s_sub_u32 s43, s43, s44
s_cmp_lt_u32 s3, 2
s_cselect_b32 s44, 14, 13
s_add_u32 s44, s44, s43
s_add_u32 s42, s42, s43
s_mul_i32 s45, s26, 276480
s_add_u32 s45, s45, 7340032
s_mul_i32 s46, s25, 221184
s_mul_i32 s72, s42, 5120
s_add_u32 s72, s72, s45
s_lshl_b32 s86, s42, 12
s_add_u32 s86, s86, s46
s_add_u32 s42, s42, 1
s_cmp_eq_u32 s42, s44
s_cselect_b32 s42, s43, s42
s_mul_i32 s73, s42, 5120
s_add_u32 s73, s73, s45
s_lshl_b32 s87, s42, 12
s_add_u32 s87, s87, s46
s_add_u32 s42, s42, 1
s_cmp_eq_u32 s42, s44
s_cselect_b32 s42, s43, s42
s_mul_i32 s74, s42, 5120
s_add_u32 s74, s74, s45
s_lshl_b32 s88, s42, 12
s_add_u32 s88, s88, s46
s_add_u32 s42, s42, 1
s_cmp_eq_u32 s42, s44
s_cselect_b32 s42, s43, s42
s_mul_i32 s75, s42, 5120
s_add_u32 s75, s75, s45
s_lshl_b32 s89, s42, 12
s_add_u32 s89, s89, s46
s_add_u32 s42, s42, 1
s_cmp_eq_u32 s42, s44
s_cselect_b32 s42, s43, s42
s_mul_i32 s76, s42, 5120
s_add_u32 s76, s76, s45
s_lshl_b32 s90, s42, 12
s_add_u32 s90, s90, s46
s_add_u32 s42, s42, 1
s_cmp_eq_u32 s42, s44
s_cselect_b32 s42, s43, s42
s_mul_i32 s77, s42, 5120
s_add_u32 s77, s77, s45
s_lshl_b32 s91, s42, 12
s_add_u32 s91, s91, s46
s_add_u32 s42, s42, 1
s_cmp_eq_u32 s42, s44
s_cselect_b32 s42, s43, s42
s_mul_i32 s78, s42, 5120
s_add_u32 s78, s78, s45
s_lshl_b32 s92, s42, 12
s_add_u32 s92, s92, s46
s_add_u32 s42, s42, 1
s_cmp_eq_u32 s42, s44
s_cselect_b32 s42, s43, s42
s_mul_i32 s79, s42, 5120
s_add_u32 s79, s79, s45
s_lshl_b32 s93, s42, 12
s_add_u32 s93, s93, s46
s_add_u32 s42, s42, 1
s_cmp_eq_u32 s42, s44
s_cselect_b32 s42, s43, s42
s_mul_i32 s80, s42, 5120
s_add_u32 s80, s80, s45
s_lshl_b32 s94, s42, 12
s_add_u32 s94, s94, s46
s_add_u32 s42, s42, 1
s_cmp_eq_u32 s42, s44
s_cselect_b32 s42, s43, s42
s_mul_i32 s81, s42, 5120
s_add_u32 s81, s81, s45
s_lshl_b32 s95, s42, 12
s_add_u32 s95, s95, s46
s_add_u32 s42, s42, 1
s_cmp_eq_u32 s42, s44
s_cselect_b32 s42, s43, s42
s_mul_i32 s82, s42, 5120
s_add_u32 s82, s82, s45
s_lshl_b32 s96, s42, 12
s_add_u32 s96, s96, s46
s_add_u32 s42, s42, 1
s_cmp_eq_u32 s42, s44
s_cselect_b32 s42, s43, s42
s_mul_i32 s83, s42, 5120
s_add_u32 s83, s83, s45
s_lshl_b32 s97, s42, 12
s_add_u32 s97, s97, s46
s_add_u32 s42, s42, 1
s_cmp_eq_u32 s42, s44
s_cselect_b32 s42, s43, s42
s_mul_i32 s84, s42, 5120
s_add_u32 s84, s84, s45
s_lshl_b32 s98, s42, 12
s_add_u32 s98, s98, s46
s_add_u32 s42, s42, 1
s_cmp_eq_u32 s42, s44
s_cselect_b32 s42, s43, s42
s_mul_i32 s85, s42, 5120
s_add_u32 s85, s85, s45
s_lshl_b32 s99, s42, 12
s_add_u32 s99, s99, s46
s_cmp_lt_u32 s3, 2
s_cselect_b32 s85, s85, 2146435072
s_cselect_b32 s99, s99, 2146435072
s_waitcnt lgkmcnt(0)
s_lshr_b32 s101, s3, 1
s_lshl_b32 s101, s101, 4
s_lshr_b32 s0, s0, s101
s_lshl_b32 s0, s0, 16
s_lshr_b32 s54, s54, s101
s_lshl_b32 s54, s54, 16
v_mov_b32 v122, 0x3fb8aa3b
v_mul_f32 v122, s0, v122
s_mul_i32 s101, s3, 4608
v_exp_f32 v122, v122
s_add_u32 s101, s101, 12288
v_lshl_add_u32 v188, v1, 2, s101
v_cvt_pk_bf16_f32 v122, v122, v122
v_mul_u32_u24 v189, 288, v2
v_lshlrev_b32 v122, 16, v122
v_lshl_add_u32 v189, v3, 4, v189
v_add_u32 v189, s101, v189
s_waitcnt vmcnt(12)
s_waitcnt vmcnt(6)
v_lshlrev_b32 v36, 16, v36
v_lshlrev_b32 v37, 16, v37
v_lshlrev_b32 v38, 16, v38
v_lshlrev_b32 v39, 16, v39
v_lshlrev_b32 v40, 16, v40
v_lshlrev_b32 v41, 16, v41
v_mul_f32 v120, v122, v36
s_add_u32 m0, s47, 4096
s_nop 0
buffer_load_dwordx4 v16, s[4:7], s28 offen offset:0 lds
v_mul_f32 v121, v122, v37
v_mul_f32 v120, 0x3fb8aa3b, v120
v_mul_f32 v121, 0x3e22f983, v121
v_mul_f32 v123, 0x41000000, v120
v_mul_f32 v124, 0xc1000000, v121
v_exp_f32 v123, v123
v_fract_f32 v124, v124
v_mul_f32 v38, v122, v38
v_cos_f32 v116, v124
buffer_load_dwordx4 v17, s[4:7], s28 offen offset:1024 lds
v_sin_f32 v117, v124
v_mul_f32 v39, v122, v39
v_pk_mul_f32 v[116:117], v[116:117], v[122:123] op_sel:[0,1] op_sel_hi:[1,1]
v_mul_f32 v112, v40, v38
v_mul_f32 v113, v40, v39
v_fma_f32 v112, -v41, v39, v112
v_fma_f32 v113, -v41, v38, -v113
v_cvt_pk_bf16_f32 v128, v112, v113
v_pk_mul_f32 v[114:115], v[112:113], v[116:117] op_sel:[0,0] op_sel_hi:[0,1]
buffer_load_dwordx4 v18, s[4:7], s28 offen offset:2048 lds
v_pk_fma_f32 v[114:115], v[112:113], v[116:117], v[114:115] op_sel:[1,1,0] op_sel_hi:[1,0,1] neg_lo:[1,0,0]
v_cvt_pk_bf16_f32 v129, v114, v115
ds_write_b32 v188, v128 offset:0
v_pk_mul_f32 v[112:113], v[114:115], v[116:117] op_sel:[0,0] op_sel_hi:[0,1]
v_pk_fma_f32 v[112:113], v[114:115], v[116:117], v[112:113] op_sel:[1,1,0] op_sel_hi:[1,0,1] neg_lo:[1,0,0]
v_cvt_pk_bf16_f32 v130, v112, v113
ds_write_b32 v188, v129 offset:288
v_pk_mul_f32 v[114:115], v[112:113], v[116:117] op_sel:[0,0] op_sel_hi:[0,1]
v_pk_fma_f32 v[114:115], v[112:113], v[116:117], v[114:115] op_sel:[1,1,0] op_sel_hi:[1,0,1] neg_lo:[1,0,0]
v_cvt_pk_bf16_f32 v131, v114, v115
ds_write_b32 v188, v130 offset:576
buffer_load_dwordx4 v19, s[4:7], s28 offen offset:3072 lds
s_add_u32 s28, s28, 128
v_pk_mul_f32 v[112:113], v[114:115], v[116:117] op_sel:[0,0] op_sel_hi:[0,1]
v_pk_fma_f32 v[112:113], v[114:115], v[116:117], v[112:113] op_sel:[1,1,0] op_sel_hi:[1,0,1] neg_lo:[1,0,0]
v_cvt_pk_bf16_f32 v132, v112, v113
ds_write_b32 v188, v131 offset:864
v_pk_mul_f32 v[114:115], v[112:113], v[116:117] op_sel:[0,0] op_sel_hi:[0,1]
v_pk_fma_f32 v[114:115], v[112:113], v[116:117], v[114:115] op_sel:[1,1,0] op_sel_hi:[1,0,1] neg_lo:[1,0,0]
v_cvt_pk_bf16_f32 v133, v114, v115
ds_write_b32 v188, v132 offset:1152
v_pk_mul_f32 v[112:113], v[114:115], v[116:117] op_sel:[0,0] op_sel_hi:[0,1]
v_pk_fma_f32 v[112:113], v[114:115], v[116:117], v[112:113] op_sel:[1,1,0] op_sel_hi:[1,0,1] neg_lo:[1,0,0]
s_add_u32 m0, s47, 8192
s_nop 0
buffer_load_dwordx4 v16, s[4:7], s28 offen offset:0 lds
v_cvt_pk_bf16_f32 v134, v112, v113
ds_write_b32 v188, v133 offset:1440
v_pk_mul_f32 v[114:115], v[112:113], v[116:117] op_sel:[0,0] op_sel_hi:[0,1]
v_pk_fma_f32 v[114:115], v[112:113], v[116:117], v[114:115] op_sel:[1,1,0] op_sel_hi:[1,0,1] neg_lo:[1,0,0]
v_cvt_pk_bf16_f32 v135, v114, v115
ds_write_b32 v188, v134 offset:1728
v_pk_mul_f32 v[112:113], v[114:115], v[116:117] op_sel:[0,0] op_sel_hi:[0,1]
v_pk_fma_f32 v[112:113], v[114:115], v[116:117], v[112:113] op_sel:[1,1,0] op_sel_hi:[1,0,1] neg_lo:[1,0,0]
v_cvt_pk_bf16_f32 v128, v112, v113
ds_write_b32 v188, v135 offset:2016
buffer_load_dwordx4 v17, s[4:7], s28 offen offset:1024 lds
v_pk_mul_f32 v[114:115], v[112:113], v[116:117] op_sel:[0,0] op_sel_hi:[0,1]
v_pk_fma_f32 v[114:115], v[112:113], v[116:117], v[114:115] op_sel:[1,1,0] op_sel_hi:[1,0,1] neg_lo:[1,0,0]
v_cvt_pk_bf16_f32 v129, v114, v115
ds_write_b32 v188, v128 offset:2304
v_pk_mul_f32 v[112:113], v[114:115], v[116:117] op_sel:[0,0] op_sel_hi:[0,1]
v_pk_fma_f32 v[112:113], v[114:115], v[116:117], v[112:113] op_sel:[1,1,0] op_sel_hi:[1,0,1] neg_lo:[1,0,0]
v_cvt_pk_bf16_f32 v130, v112, v113
ds_write_b32 v188, v129 offset:2592
v_pk_mul_f32 v[114:115], v[112:113], v[116:117] op_sel:[0,0] op_sel_hi:[0,1]
v_pk_fma_f32 v[114:115], v[112:113], v[116:117], v[114:115] op_sel:[1,1,0] op_sel_hi:[1,0,1] neg_lo:[1,0,0]
v_cvt_pk_bf16_f32 v131, v114, v115
buffer_load_dwordx4 v18, s[4:7], s28 offen offset:2048 lds
ds_write_b32 v188, v130 offset:2880
v_pk_mul_f32 v[112:113], v[114:115], v[116:117] op_sel:[0,0] op_sel_hi:[0,1]
v_pk_fma_f32 v[112:113], v[114:115], v[116:117], v[112:113] op_sel:[1,1,0] op_sel_hi:[1,0,1] neg_lo:[1,0,0]
v_cvt_pk_bf16_f32 v132, v112, v113
ds_write_b32 v188, v131 offset:3168
v_pk_mul_f32 v[114:115], v[112:113], v[116:117] op_sel:[0,0] op_sel_hi:[0,1]
v_pk_fma_f32 v[114:115], v[112:113], v[116:117], v[114:115] op_sel:[1,1,0] op_sel_hi:[1,0,1] neg_lo:[1,0,0]
v_cvt_pk_bf16_f32 v133, v114, v115
ds_write_b32 v188, v132 offset:3456
v_pk_mul_f32 v[112:113], v[114:115], v[116:117] op_sel:[0,0] op_sel_hi:[0,1]
v_pk_fma_f32 v[112:113], v[114:115], v[116:117], v[112:113] op_sel:[1,1,0] op_sel_hi:[1,0,1] neg_lo:[1,0,0]
buffer_load_dwordx4 v19, s[4:7], s28 offen offset:3072 lds
s_add_u32 s28, s28, 128
v_cvt_pk_bf16_f32 v134, v112, v113
ds_write_b32 v188, v133 offset:3744
v_pk_mul_f32 v[114:115], v[112:113], v[116:117] op_sel:[0,0] op_sel_hi:[0,1]
v_pk_fma_f32 v[114:115], v[112:113], v[116:117], v[114:115] op_sel:[1,1,0] op_sel_hi:[1,0,1] neg_lo:[1,0,0]
v_cvt_pk_bf16_f32 v135, v114, v115
ds_write_b32 v188, v134 offset:4032
ds_write_b32 v188, v135 offset:4320
ds_read_b128 v[144:147], v189 offset:0
ds_read_b128 v[148:151], v189 offset:64
ds_read_b128 v[152:155], v189 offset:128
s_add_u32 m0, s47, 12288
s_nop 0
buffer_load_dwordx4 v16, s[4:7], s28 offen offset:0 lds
ds_read_b128 v[156:159], v189 offset:192
v_mul_f32 v125, 1.0, v120
v_mul_f32 v126, 1.0, v121
v_exp_f32 v125, v125
v_fract_f32 v126, v126
v_cos_f32 v64, v126
v_sin_f32 v65, v126
buffer_load_dwordx4 v17, s[4:7], s28 offen offset:1024 lds
s_nop 0
v_pk_mul_f32 v[64:65], v[64:65], v[124:125] op_sel:[0,1] op_sel_hi:[1,1]
v_mul_f32 v125, 0x43000000, v120
v_mul_f32 v126, 0x43000000, v121
v_exp_f32 v125, v125
v_fract_f32 v126, v126
v_cos_f32 v80, v126
v_sin_f32 v81, v126
buffer_load_dwordx4 v18, s[4:7], s28 offen offset:2048 lds
s_nop 0
v_pk_mul_f32 v[80:81], v[80:81], v[124:125] op_sel:[0,1] op_sel_hi:[1,1]
v_mov_b32 v135, 0x3f80
v_cvt_pk_bf16_f32 v128, v64, v65
v_cvt_pk_bf16_f32 v129, v80, v81
v_pk_mul_f32 v[66:67], v[64:65], v[64:65] op_sel:[0,0] op_sel_hi:[0,1]
ds_write_b32 v188, v135
v_pk_fma_f32 v[66:67], v[64:65], v[64:65], v[66:67] op_sel:[1,1,0] op_sel_hi:[1,0,1] neg_lo:[1,0,0]
ds_write_b32 v188, v128 offset:288
v_cvt_pk_bf16_f32 v130, v66, v67
ds_write_b32 v188, v129 offset:2304
buffer_load_dwordx4 v19, s[4:7], s28 offen offset:3072 lds
s_add_u32 s28, s28, 128
v_pk_mul_f32 v[68:69], v[66:67], v[64:65] op_sel:[0,0] op_sel_hi:[0,1]
v_pk_fma_f32 v[68:69], v[66:67], v[64:65], v[68:69] op_sel:[1,1,0] op_sel_hi:[1,0,1] neg_lo:[1,0,0]
v_cvt_pk_bf16_f32 v131, v68, v69
ds_write_b32 v188, v130 offset:576
v_pk_mul_f32 v[70:71], v[66:67], v[66:67] op_sel:[0,0] op_sel_hi:[0,1]
v_pk_fma_f32 v[70:71], v[66:67], v[66:67], v[70:71] op_sel:[1,1,0] op_sel_hi:[1,0,1] neg_lo:[1,0,0]
v_cvt_pk_bf16_f32 v132, v70, v71
ds_write_b32 v188, v131 offset:864
v_pk_mul_f32 v[72:73], v[70:71], v[64:65] op_sel:[0,0] op_sel_hi:[0,1]
v_pk_fma_f32 v[72:73], v[70:71], v[64:65], v[72:73] op_sel:[1,1,0] op_sel_hi:[1,0,1] neg_lo:[1,0,0]
s_add_u32 m0, s47, 16384
s_nop 0
buffer_load_dwordx4 v16, s[4:7], s28 offen offset:0 lds
v_cvt_pk_bf16_f32 v133, v72, v73
ds_write_b32 v188, v132 offset:1152
v_pk_mul_f32 v[74:75], v[70:71], v[66:67] op_sel:[0,0] op_sel_hi:[0,1]
v_pk_fma_f32 v[74:75], v[70:71], v[66:67], v[74:75] op_sel:[1,1,0] op_sel_hi:[1,0,1] neg_lo:[1,0,0]
v_cvt_pk_bf16_f32 v134, v74, v75
ds_write_b32 v188, v133 offset:1440
v_pk_mul_f32 v[76:77], v[70:71], v[68:69] op_sel:[0,0] op_sel_hi:[0,1]
v_pk_fma_f32 v[76:77], v[70:71], v[68:69], v[76:77] op_sel:[1,1,0] op_sel_hi:[1,0,1] neg_lo:[1,0,0]
v_cvt_pk_bf16_f32 v135, v76, v77
ds_write_b32 v188, v134 offset:1728
buffer_load_dwordx4 v17, s[4:7], s28 offen offset:1024 lds
v_pk_mul_f32 v[136:137], v[80:81], v[64:65] op_sel:[0,0] op_sel_hi:[0,1]
v_pk_fma_f32 v[136:137], v[80:81], v[64:65], v[136:137] op_sel:[1,1,0] op_sel_hi:[1,0,1] neg_lo:[1,0,0]
v_cvt_pk_bf16_f32 v128, v136, v137
ds_write_b32 v188, v135 offset:2016
v_pk_mul_f32 v[138:139], v[80:81], v[66:67] op_sel:[0,0] op_sel_hi:[0,1]
v_pk_fma_f32 v[138:139], v[80:81], v[66:67], v[138:139] op_sel:[1,1,0] op_sel_hi:[1,0,1] neg_lo:[1,0,0]
v_cvt_pk_bf16_f32 v129, v138, v139
ds_write_b32 v188, v128 offset:2592
v_pk_mul_f32 v[140:141], v[80:81], v[68:69] op_sel:[0,0] op_sel_hi:[0,1]
v_pk_fma_f32 v[140:141], v[80:81], v[68:69], v[140:141] op_sel:[1,1,0] op_sel_hi:[1,0,1] neg_lo:[1,0,0]
v_cvt_pk_bf16_f32 v130, v140, v141
buffer_load_dwordx4 v18, s[4:7], s28 offen offset:2048 lds
ds_write_b32 v188, v129 offset:2880
v_pk_mul_f32 v[142:143], v[80:81], v[70:71] op_sel:[0,0] op_sel_hi:[0,1]
v_pk_fma_f32 v[142:143], v[80:81], v[70:71], v[142:143] op_sel:[1,1,0] op_sel_hi:[1,0,1] neg_lo:[1,0,0]
v_cvt_pk_bf16_f32 v131, v142, v143
ds_write_b32 v188, v130 offset:3168
v_pk_mul_f32 v[136:137], v[80:81], v[72:73] op_sel:[0,0] op_sel_hi:[0,1]
v_pk_fma_f32 v[136:137], v[80:81], v[72:73], v[136:137] op_sel:[1,1,0] op_sel_hi:[1,0,1] neg_lo:[1,0,0]
v_cvt_pk_bf16_f32 v132, v136, v137
ds_write_b32 v188, v131 offset:3456
v_pk_mul_f32 v[138:139], v[80:81], v[74:75] op_sel:[0,0] op_sel_hi:[0,1]
v_pk_fma_f32 v[138:139], v[80:81], v[74:75], v[138:139] op_sel:[1,1,0] op_sel_hi:[1,0,1] neg_lo:[1,0,0]
buffer_load_dwordx4 v19, s[4:7], s28 offen offset:3072 lds
s_add_u32 s28, s28, 128
v_cvt_pk_bf16_f32 v133, v138, v139
ds_write_b32 v188, v132 offset:3744
v_pk_mul_f32 v[140:141], v[80:81], v[76:77] op_sel:[0,0] op_sel_hi:[0,1]
v_pk_fma_f32 v[140:141], v[80:81], v[76:77], v[140:141] op_sel:[1,1,0] op_sel_hi:[1,0,1] neg_lo:[1,0,0]
v_cvt_pk_bf16_f32 v134, v140, v141
ds_write_b32 v188, v133 offset:4032
ds_write_b32 v188, v134 offset:4320
ds_read_b128 v[160:163], v189 offset:0
ds_read_b128 v[164:167], v189 offset:64
ds_read_b128 v[168:171], v189 offset:128
s_add_u32 m0, s47, 20480
s_nop 0
buffer_load_dwordx4 v16, s[4:7], s28 offen offset:0 lds
ds_read_b128 v[172:175], v189 offset:192
v_pk_mul_f32 v[82:83], v[80:81], v[80:81] op_sel:[0,0] op_sel_hi:[0,1]
v_pk_fma_f32 v[82:83], v[80:81], v[80:81], v[82:83] op_sel:[1,1,0] op_sel_hi:[1,0,1] neg_lo:[1,0,0]
v_pk_mul_f32 v[84:85], v[82:83], v[80:81] op_sel:[0,0] op_sel_hi:[0,1]
v_pk_fma_f32 v[84:85], v[82:83], v[80:81], v[84:85] op_sel:[1,1,0] op_sel_hi:[1,0,1] neg_lo:[1,0,0]
v_pk_mul_f32 v[86:87], v[82:83], v[82:83] op_sel:[0,0] op_sel_hi:[0,1]
v_pk_fma_f32 v[86:87], v[82:83], v[82:83], v[86:87] op_sel:[1,1,0] op_sel_hi:[1,0,1] neg_lo:[1,0,0]
v_pk_mul_f32 v[88:89], v[86:87], v[80:81] op_sel:[0,0] op_sel_hi:[0,1]
v_pk_fma_f32 v[88:89], v[86:87], v[80:81], v[88:89] op_sel:[1,1,0] op_sel_hi:[1,0,1] neg_lo:[1,0,0]
v_pk_mul_f32 v[90:91], v[86:87], v[82:83] op_sel:[0,0] op_sel_hi:[0,1]
buffer_load_dwordx4 v17, s[4:7], s28 offen offset:1024 lds
v_pk_fma_f32 v[90:91], v[86:87], v[82:83], v[90:91] op_sel:[1,1,0] op_sel_hi:[1,0,1] neg_lo:[1,0,0]
v_pk_mul_f32 v[92:93], v[86:87], v[84:85] op_sel:[0,0] op_sel_hi:[0,1]
v_pk_fma_f32 v[92:93], v[86:87], v[84:85], v[92:93] op_sel:[1,1,0] op_sel_hi:[1,0,1] neg_lo:[1,0,0]
v_pk_mul_f32 v[94:95], v[86:87], v[86:87] op_sel:[0,0] op_sel_hi:[0,1]
v_pk_fma_f32 v[94:95], v[86:87], v[86:87], v[94:95] op_sel:[1,1,0] op_sel_hi:[1,0,1] neg_lo:[1,0,0]
s_waitcnt lgkmcnt(0)
v_mfma_f32_16x16x32_bf16 v[176:179], v[160:163], v[144:147], 0
v_mfma_f32_16x16x32_bf16 v[176:179], v[164:167], v[148:151], v[176:179]
v_mfma_f32_16x16x32_bf16 v[176:179], v[168:171], v[152:155], v[176:179]
buffer_load_dwordx4 v18, s[4:7], s28 offen offset:2048 lds
v_mfma_f32_16x16x32_bf16 v[176:179], v[172:175], v[156:159], v[176:179]
v_cvt_pk_bf16_f32 v135, v82, v83
v_pk_mul_f32 v[142:143], v[82:83], v[66:67] op_sel:[0,0] op_sel_hi:[0,1]
v_pk_fma_f32 v[142:143], v[82:83], v[66:67], v[142:143] op_sel:[1,1,0] op_sel_hi:[1,0,1] neg_lo:[1,0,0]
v_cvt_pk_bf16_f32 v128, v142, v143
ds_write_b32 v188, v135 offset:0
buffer_load_dwordx4 v19, s[4:7], s28 offen offset:3072 lds
s_add_u32 s28, s28, 128
v_pk_mul_f32 v[136:137], v[82:83], v[70:71] op_sel:[0,0] op_sel_hi:[0,1]
v_pk_fma_f32 v[136:137], v[82:83], v[70:71], v[136:137] op_sel:[1,1,0] op_sel_hi:[1,0,1] neg_lo:[1,0,0]
v_cvt_pk_bf16_f32 v129, v136, v137
ds_write_b32 v188, v128 offset:288
v_pk_mul_f32 v[138:139], v[82:83], v[74:75] op_sel:[0,0] op_sel_hi:[0,1]
v_pk_fma_f32 v[138:139], v[82:83], v[74:75], v[138:139] op_sel:[1,1,0] op_sel_hi:[1,0,1] neg_lo:[1,0,0]
v_cvt_pk_bf16_f32 v130, v138, v139
ds_write_b32 v188, v129 offset:576
v_cvt_pk_bf16_f32 v131, v84, v85
v_pk_mul_f32 v[140:141], v[84:85], v[66:67] op_sel:[0,0] op_sel_hi:[0,1]
s_add_u32 m0, s47, 24576
s_nop 0
buffer_load_dwordx4 v16, s[4:7], s28 offen offset:0 lds
v_pk_fma_f32 v[140:141], v[84:85], v[66:67], v[140:141] op_sel:[1,1,0] op_sel_hi:[1,0,1] neg_lo:[1,0,0]
ds_write_b32 v188, v130 offset:864
v_cvt_pk_bf16_f32 v132, v140, v141
ds_write_b32 v188, v131 offset:1152
v_pk_mul_f32 v[142:143], v[84:85], v[70:71] op_sel:[0,0] op_sel_hi:[0,1]
v_pk_fma_f32 v[142:143], v[84:85], v[70:71], v[142:143] op_sel:[1,1,0] op_sel_hi:[1,0,1] neg_lo:[1,0,0]
v_cvt_pk_bf16_f32 v133, v142, v143
ds_write_b32 v188, v132 offset:1440
v_pk_mul_f32 v[136:137], v[84:85], v[74:75] op_sel:[0,0] op_sel_hi:[0,1]
v_pk_fma_f32 v[136:137], v[84:85], v[74:75], v[136:137] op_sel:[1,1,0] op_sel_hi:[1,0,1] neg_lo:[1,0,0]
buffer_load_dwordx4 v17, s[4:7], s28 offen offset:1024 lds
v_cvt_pk_bf16_f32 v134, v136, v137
ds_write_b32 v188, v133 offset:1728
v_cvt_pk_bf16_f32 v135, v86, v87
v_pk_mul_f32 v[138:139], v[86:87], v[70:71] op_sel:[0,0] op_sel_hi:[0,1]
v_pk_fma_f32 v[138:139], v[86:87], v[70:71], v[138:139] op_sel:[1,1,0] op_sel_hi:[1,0,1] neg_lo:[1,0,0]
ds_write_b32 v188, v134 offset:2016
v_cvt_pk_bf16_f32 v128, v138, v139
ds_write_b32 v188, v135 offset:2304
v_cvt_pk_bf16_f32 v129, v88, v89
v_pk_mul_f32 v[140:141], v[88:89], v[70:71] op_sel:[0,0] op_sel_hi:[0,1]
v_pk_fma_f32 v[140:141], v[88:89], v[70:71], v[140:141] op_sel:[1,1,0] op_sel_hi:[1,0,1] neg_lo:[1,0,0]
buffer_load_dwordx4 v18, s[4:7], s28 offen offset:2048 lds
ds_write_b32 v188, v128 offset:2592
v_cvt_pk_bf16_f32 v130, v140, v141
ds_write_b32 v188, v129 offset:2880
v_cvt_pk_bf16_f32 v131, v90, v91
v_pk_mul_f32 v[142:143], v[90:91], v[70:71] op_sel:[0,0] op_sel_hi:[0,1]
v_pk_fma_f32 v[142:143], v[90:91], v[70:71], v[142:143] op_sel:[1,1,0] op_sel_hi:[1,0,1] neg_lo:[1,0,0]
ds_write_b32 v188, v130 offset:3168
v_cvt_pk_bf16_f32 v132, v142, v143
ds_write_b32 v188, v131 offset:3456
v_cvt_pk_bf16_f32 v133, v92, v93
v_pk_mul_f32 v[136:137], v[92:93], v[70:71] op_sel:[0,0] op_sel_hi:[0,1]
buffer_load_dwordx4 v19, s[4:7], s28 offen offset:3072 lds
s_add_u32 s28, s28, 128
v_pk_fma_f32 v[136:137], v[92:93], v[70:71], v[136:137] op_sel:[1,1,0] op_sel_hi:[1,0,1] neg_lo:[1,0,0]
ds_write_b32 v188, v132 offset:3744
v_cvt_pk_bf16_f32 v134, v136, v137
ds_write_b32 v188, v133 offset:4032
ds_write_b32 v188, v134 offset:4320
ds_read_b128 v[160:163], v189 offset:0
ds_read_b128 v[164:167], v189 offset:64
ds_read_b128 v[168:171], v189 offset:128
ds_read_b128 v[172:175], v189 offset:192
v_pk_mul_f32 v[96:97], v[94:95], v[80:81] op_sel:[0,0] op_sel_hi:[0,1]
s_add_u32 m0, s47, 28672
s_nop 0
buffer_load_dwordx4 v16, s[4:7], s28 offen offset:0 lds
v_pk_fma_f32 v[96:97], v[94:95], v[80:81], v[96:97] op_sel:[1,1,0] op_sel_hi:[1,0,1] neg_lo:[1,0,0]
v_pk_mul_f32 v[98:99], v[94:95], v[82:83] op_sel:[0,0] op_sel_hi:[0,1]
v_pk_fma_f32 v[98:99], v[94:95], v[82:83], v[98:99] op_sel:[1,1,0] op_sel_hi:[1,0,1] neg_lo:[1,0,0]
v_pk_mul_f32 v[100:101], v[94:95], v[84:85] op_sel:[0,0] op_sel_hi:[0,1]
v_pk_fma_f32 v[100:101], v[94:95], v[84:85], v[100:101] op_sel:[1,1,0] op_sel_hi:[1,0,1] neg_lo:[1,0,0]
v_pk_mul_f32 v[102:103], v[94:95], v[86:87] op_sel:[0,0] op_sel_hi:[0,1]
v_pk_fma_f32 v[102:103], v[94:95], v[86:87], v[102:103] op_sel:[1,1,0] op_sel_hi:[1,0,1] neg_lo:[1,0,0]
v_pk_mul_f32 v[104:105], v[94:95], v[88:89] op_sel:[0,0] op_sel_hi:[0,1]
v_pk_fma_f32 v[104:105], v[94:95], v[88:89], v[104:105] op_sel:[1,1,0] op_sel_hi:[1,0,1] neg_lo:[1,0,0]
v_pk_mul_f32 v[106:107], v[94:95], v[90:91] op_sel:[0,0] op_sel_hi:[0,1]
buffer_load_dwordx4 v17, s[4:7], s28 offen offset:1024 lds
v_pk_fma_f32 v[106:107], v[94:95], v[90:91], v[106:107] op_sel:[1,1,0] op_sel_hi:[1,0,1] neg_lo:[1,0,0]
v_pk_mul_f32 v[108:109], v[94:95], v[92:93] op_sel:[0,0] op_sel_hi:[0,1]
v_pk_fma_f32 v[108:109], v[94:95], v[92:93], v[108:109] op_sel:[1,1,0] op_sel_hi:[1,0,1] neg_lo:[1,0,0]
v_pk_mul_f32 v[110:111], v[94:95], v[94:95] op_sel:[0,0] op_sel_hi:[0,1]
v_pk_fma_f32 v[110:111], v[94:95], v[94:95], v[110:111] op_sel:[1,1,0] op_sel_hi:[1,0,1] neg_lo:[1,0,0]
s_waitcnt lgkmcnt(0)
v_mfma_f32_16x16x32_bf16 v[180:183], v[160:163], v[144:147], 0
v_mfma_f32_16x16x32_bf16 v[180:183], v[164:167], v[148:151], v[180:183]
v_mfma_f32_16x16x32_bf16 v[180:183], v[168:171], v[152:155], v[180:183]
buffer_load_dwordx4 v18, s[4:7], s28 offen offset:2048 lds
v_mfma_f32_16x16x32_bf16 v[180:183], v[172:175], v[156:159], v[180:183]
v_cvt_pk_bf16_f32 v135, v94, v95
v_cvt_pk_bf16_f32 v128, v96, v97
v_cvt_pk_bf16_f32 v129, v98, v99
v_cvt_pk_bf16_f32 v130, v100, v101
ds_write_b32 v188, v135 offset:0
buffer_load_dwordx4 v19, s[4:7], s28 offen offset:3072 lds
s_add_u32 s28, s28, 128
v_cvt_pk_bf16_f32 v131, v102, v103
ds_write_b32 v188, v128 offset:288
v_cvt_pk_bf16_f32 v132, v104, v105
ds_write_b32 v188, v129 offset:576
v_cvt_pk_bf16_f32 v133, v106, v107
ds_write_b32 v188, v130 offset:864
v_cvt_pk_bf16_f32 v134, v108, v109
ds_write_b32 v188, v131 offset:1152
v_cvt_pk_bf16_f32 v135, v110, v111
ds_write_b32 v188, v132 offset:1440
ds_write_b32 v188, v133 offset:1728
ds_write_b32 v188, v134 offset:2016
ds_write_b32 v188, v135 offset:2304
ds_read_b128 v[160:163], v189 offset:0
ds_read_b128 v[164:167], v189 offset:64
ds_read_b128 v[168:171], v189 offset:128
ds_read_b128 v[172:175], v189 offset:192
s_mul_i32 s101, s3, 3072
v_lshrrev_b32 v123, 1, v3
v_and_b32 v124, 1, v3
v_lshlrev_b32 v190, 9, v123
v_lshl_add_u32 v190, v2, 5, v190
v_lshl_add_u32 v190, v124, 4, v190
v_add_u32 v190, s101, v190
v_sub_u32 v124, 4, v123
v_lshlrev_b32 v191, v124, v2
v_lshl_add_u32 v225, v3, 8, s101
v_add_u32 v191, v191, v225
v_mul_u32_u24 v123, 120, v123
v_add3_u32 v224, v191, v123, 8
v_lshl_add_u32 v225, v2, 2, v225
s_waitcnt lgkmcnt(0)
v_mfma_f32_16x16x32_bf16 v[184:187], v[160:163], v[144:147], 0
v_mfma_f32_16x16x32_bf16 v[184:187], v[164:167], v[148:151], v[184:187]
v_mfma_f32_16x16x32_bf16 v[184:187], v[168:171], v[152:155], v[184:187]
v_mfma_f32_16x16x32_bf16 v[184:187], v[172:175], v[156:159], v[184:187]
ds_write_b128 v190, v[176:179]
ds_write_b64 v191, v[180:181] offset:1024
ds_write_b64 v224, v[182:183] offset:1024
s_nop 4
ds_write_b32 v225, v184 offset:2048
ds_write_b32 v225, v185 offset:2112
ds_write_b32 v225, v186 offset:2176
ds_write_b32 v225, v187 offset:2240
s_waitcnt vmcnt(33)
s_lshr_b32 s101, s3, 1
s_mul_i32 s100, s101, 6144
s_mul_i32 s101, s101, 8320
s_add_u32 s101, s101, 16368
v_lshlrev_b32 v65, 4, v1
v_sub_u32 v65, s101, v65
s_and_b32 s101, s3, 1
s_lshl_b32 s101, s101, 8
s_add_u32 s101, s101, s100
v_lshl_add_u32 v64, v1, 2, s101
s_waitcnt lgkmcnt(0)
s_barrier
ds_read_b32 v94, v64 offset:2048
ds_read_b32 v95, v64 offset:2052
ds_read_b32 v96, v64 offset:5120
ds_read_b32 v97, v64 offset:5124
s_bitcmp1_b32 s3, 0
s_cbranch_scc1 ex31
s_movk_i32 s30, 0x200
v_cmp_gt_u32 vcc, 32, v1
v_lshlrev_b32 v92, 5, v1
v_lshl_add_u32 v93, v1, 4, s30
v_cndmask_b32 v93, v93, v92, vcc
v_cmp_ge_u32 vcc, 32, v1
v_add_u32 v92, -4, v92
v_max_i32 v92, 0, v92
v_cndmask_b32 v92, v93, v92, vcc
v_add_u32 v93, s100, v93
v_add_u32 v92, s100, v92
ds_read_b128 v[68:71], v93
ds_read_b128 v[72:75], v93 offset:3072
ds_read_b128 v[76:79], v93 offset:16
ds_read_b128 v[80:83], v93 offset:3088
ds_read_b32 v66, v92
ds_read_b32 v67, v92 offset:3072
v_cmp_eq_u32 vcc, 0, v1
v_mov_b32 v92, s54
s_mov_b32 s30, 0
s_mov_b32 s31, -1
v_cndmask_b32 v92, 0, v92, vcc
s_waitcnt lgkmcnt(0)
v_pk_add_f32 v[68:69], v[68:69], v[72:73]
v_pk_add_f32 v[70:71], v[70:71], v[74:75]
v_pk_add_f32 v[76:77], v[76:77], v[80:81]
v_pk_add_f32 v[78:79], v[78:79], v[82:83]
v_add_f32 v66, v66, v67
v_cndmask_b32 v66, v66, 0, vcc
v_cndmask_b32 v72, v69, v68, s[30:31]
v_cndmask_b32 v73, v70, v69, s[30:31]
v_cndmask_b32 v74, v71, v70, s[30:31]
v_cndmask_b32 v75, v76, v70, s[30:31]
v_cndmask_b32 v80, v77, v70, s[30:31]
v_cndmask_b32 v81, v78, v71, s[30:31]
v_cndmask_b32 v82, v79, v76, s[30:31]
v_add_f32 v68, v68, v92
v_cvt_pk_bf16_f32 v84, v82, v81
v_cvt_pk_bf16_f32 v85, v80, v75
v_cvt_pk_bf16_f32 v86, v74, v73
v_cvt_pk_bf16_f32 v87, v72, v68
v_cvt_pk_bf16_f32 v88, v81, v80
v_cvt_pk_bf16_f32 v89, v75, v74
v_cvt_pk_bf16_f32 v90, v73, v72
v_cvt_pk_bf16_f32 v91, v68, v66
ds_write_b128 v65, v[84:87]
ds_write_b128 v65, v[88:91] offset:4160
v_add_u32 v65, -2048, v65
s_branch ex32
ex31:
v_lshl_add_u32 v92, v1, 3, s100
ds_read_b64 v[68:69], v92 offset:1536
ds_read_b64 v[72:73], v92 offset:4608
ds_read_b32 v70, v92 offset:1544
ds_read_b32 v74, v92 offset:4616
v_and_b32 v93, 1, v1
v_bfe_u32 v66, v1, 1, 1
v_mul_u32_u24 v93, 4160, v93
s_lshr_b32 s101, s3, 1
s_mul_i32 s101, s101, 8320
s_add_u32 s101, s101, 12288
v_lshl_add_u32 v93, v66, 4, v93
v_mov_b32 v76, 0
v_mov_b32 v77, 0
v_mov_b32 v78, 0
v_mov_b32 v79, 0
v_add_u32 v93, s101, v93
v_add_u32 v65, -1024, v65
ds_write_b128 v93, v[76:79] offset:4096
s_waitcnt lgkmcnt(0)
v_pk_add_f32 v[68:69], v[68:69], v[72:73]
v_add_f32 v70, v70, v74
v_cvt_pk_bf16_f32 v84, v70, v70
v_cvt_pk_bf16_f32 v85, v69, v69
v_cvt_pk_bf16_f32 v86, v69, v68
v_cvt_pk_bf16_f32 v87, v68, v68
v_cvt_pk_bf16_f32 v88, v70, v69
v_cvt_pk_bf16_f32 v89, v69, v69
v_cvt_pk_bf16_f32 v90, v68, v68
v_cvt_pk_bf16_f32 v91, v68, v68
ds_write_b128 v65, v[84:87]
ds_write_b128 v65, v[88:91] offset:4160
v_add_u32 v65, -2048, v65
ex32:
v_and_b32 v66, 1, v1
v_add_f32 v94, v94, v96
v_cmp_eq_u32 vcc, 1, v66
v_add_f32 v95, v95, v97
s_nop 0
v_cndmask_b32 v96, v94, v95, vcc
v_cvt_pk_bf16_f32 v98, v95, v95
v_cvt_pk_bf16_f32 v99, v95, v96
v_cvt_pk_bf16_f32 v100, v94, v94
v_cvt_pk_bf16_f32 v101, v94, v94
v_cvt_pk_bf16_f32 v102, v95, v95
v_cvt_pk_bf16_f32 v103, v96, v94
v_cvt_pk_bf16_f32 v104, v94, v94
v_cvt_pk_bf16_f32 v105, v94, v94
ds_write_b128 v65, v[98:101]
ds_write_b128 v65, v[102:105] offset:4160
s_waitcnt vmcnt(28)
v_readfirstlane_b32 s21, v11
v_readfirstlane_b32 s20, v10
s_cmp_eq_u32 s21, 0
s_cbranch_scc1 slow33
back34:
v_and_b32 v64, 7, v2
v_xor_b32 v64, v64, v3
v_lshl_add_u32 v65, v2, 7, s47
v_lshl_add_u32 v24, v64, 4, v65
v_xor_b32 v25, 64, v24
v_lshlrev_b32 v26, 4, v3
ds_read_b128 v[64:67], v26 offset:30720
ds_read_b128 v[68:71], v24 offset:0
ds_read_b128 v[72:75], v24 offset:2048
ds_read_b128 v[76:79], v26 offset:30784
ds_read_b128 v[80:83], v25 offset:0
ds_read_b128 v[84:87], v25 offset:2048
s_waitcnt vmcnt(24)
ds_read_b128 v[88:91], v26 offset:30848
ds_read_b128 v[92:95], v24 offset:4096
ds_read_b128 v[96:99], v24 offset:6144
ds_read_b128 v[100:103], v26 offset:30912
ds_read_b128 v[104:107], v25 offset:4096
ds_read_b128 v[108:111], v25 offset:6144
s_waitcnt lgkmcnt(6)
s_add_u32 m0, s47, 0
s_nop 0
buffer_load_dwordx4 v16, s[4:7], s28 offen offset:0 lds
buffer_load_dwordx4 v17, s[4:7], s28 offen offset:1024 lds
buffer_load_dwordx4 v18, s[4:7], s28 offen offset:2048 lds
buffer_load_dwordx4 v19, s[4:7], s28 offen offset:3072 lds
s_add_u32 s28, s28, 128
v_mfma_f32_16x16x32_bf16 v[208:211], v[64:67], v[68:71], 0
v_mfma_f32_16x16x32_bf16 v[212:215], v[64:67], v[72:75], 0
v_mfma_f32_16x16x32_bf16 v[216:219], v[76:79], v[80:83], 0
v_mfma_f32_16x16x32_bf16 v[220:223], v[76:79], v[84:87], 0
s_waitcnt vmcnt(24)
ds_read_b128 v[64:67], v26 offset:30976
ds_read_b128 v[68:71], v24 offset:8192
ds_read_b128 v[72:75], v24 offset:10240
ds_read_b128 v[76:79], v26 offset:31040
ds_read_b128 v[80:83], v25 offset:8192
ds_read_b128 v[84:87], v25 offset:10240
s_waitcnt lgkmcnt(6)
s_add_u32 m0, s47, 4096
s_nop 0
buffer_load_dwordx4 v16, s[4:7], s28 offen offset:0 lds
buffer_load_dwordx4 v17, s[4:7], s28 offen offset:1024 lds
buffer_load_dwordx4 v18, s[4:7], s28 offen offset:2048 lds
buffer_load_dwordx4 v19, s[4:7], s28 offen offset:3072 lds
s_add_u32 s28, s28, 128
v_mfma_f32_16x16x32_bf16 v[208:211], v[88:91], v[92:95], v[208:211]
v_mfma_f32_16x16x32_bf16 v[212:215], v[88:91], v[96:99], v[212:215]
v_mfma_f32_16x16x32_bf16 v[216:219], v[100:103], v[104:107], v[216:219]
v_mfma_f32_16x16x32_bf16 v[220:223], v[100:103], v[108:111], v[220:223]
s_waitcnt vmcnt(24)
ds_read_b128 v[88:91], v26 offset:31104
ds_read_b128 v[92:95], v24 offset:12288
ds_read_b128 v[96:99], v24 offset:14336
ds_read_b128 v[100:103], v26 offset:31168
ds_read_b128 v[104:107], v25 offset:12288
ds_read_b128 v[108:111], v25 offset:14336
s_waitcnt lgkmcnt(6)
v_mfma_f32_16x16x32_bf16 v[208:211], v[64:67], v[68:71], v[208:211]
v_mfma_f32_16x16x32_bf16 v[212:215], v[64:67], v[72:75], v[212:215]
v_mfma_f32_16x16x32_bf16 v[216:219], v[76:79], v[80:83], v[216:219]
v_mfma_f32_16x16x32_bf16 v[220:223], v[76:79], v[84:87], v[220:223]
s_waitcnt vmcnt(20)
ds_read_b128 v[64:67], v26 offset:31232
ds_read_b128 v[68:71], v24 offset:16384
ds_read_b128 v[72:75], v24 offset:18432
ds_read_b128 v[76:79], v26 offset:31296
ds_read_b128 v[80:83], v25 offset:16384
ds_read_b128 v[84:87], v25 offset:18432
s_waitcnt lgkmcnt(6)
v_mfma_f32_16x16x32_bf16 v[208:211], v[88:91], v[92:95], v[208:211]
v_mfma_f32_16x16x32_bf16 v[212:215], v[88:91], v[96:99], v[212:215]
v_mfma_f32_16x16x32_bf16 v[216:219], v[100:103], v[104:107], v[216:219]
v_mfma_f32_16x16x32_bf16 v[220:223], v[100:103], v[108:111], v[220:223]
s_waitcnt vmcnt(16)
ds_read_b128 v[88:91], v26 offset:31360
ds_read_b128 v[92:95], v24 offset:20480
ds_read_b128 v[96:99], v24 offset:22528
ds_read_b128 v[100:103], v26 offset:31424
ds_read_b128 v[104:107], v25 offset:20480
ds_read_b128 v[108:111], v25 offset:22528
s_waitcnt lgkmcnt(6)
v_mfma_f32_16x16x32_bf16 v[208:211], v[64:67], v[68:71], v[208:211]
v_mfma_f32_16x16x32_bf16 v[212:215], v[64:67], v[72:75], v[212:215]
v_mfma_f32_16x16x32_bf16 v[216:219], v[76:79], v[80:83], v[216:219]
v_mfma_f32_16x16x32_bf16 v[220:223], v[76:79], v[84:87], v[220:223]
s_waitcnt vmcnt(12)
ds_read_b128 v[64:67], v26 offset:31488
ds_read_b128 v[68:71], v24 offset:24576
ds_read_b128 v[72:75], v24 offset:26624
ds_read_b128 v[76:79], v26 offset:31552
ds_read_b128 v[80:83], v25 offset:24576
ds_read_b128 v[84:87], v25 offset:26624
s_waitcnt lgkmcnt(6)
v_mfma_f32_16x16x32_bf16 v[208:211], v[88:91], v[92:95], v[208:211]
v_mfma_f32_16x16x32_bf16 v[212:215], v[88:91], v[96:99], v[212:215]
v_mfma_f32_16x16x32_bf16 v[216:219], v[100:103], v[104:107], v[216:219]
v_mfma_f32_16x16x32_bf16 v[220:223], v[100:103], v[108:111], v[220:223]
s_waitcnt vmcnt(8)
ds_read_b128 v[88:91], v26 offset:31616
ds_read_b128 v[92:95], v24 offset:28672
ds_read_b128 v[96:99], v24 offset:30720
ds_read_b128 v[100:103], v26 offset:31680
ds_read_b128 v[104:107], v25 offset:28672
ds_read_b128 v[108:111], v25 offset:30720
s_waitcnt lgkmcnt(6)
v_mfma_f32_16x16x32_bf16 v[208:211], v[64:67], v[68:71], v[208:211]
v_mfma_f32_16x16x32_bf16 v[212:215], v[64:67], v[72:75], v[212:215]
v_mfma_f32_16x16x32_bf16 v[216:219], v[76:79], v[80:83], v[216:219]
v_mfma_f32_16x16x32_bf16 v[220:223], v[76:79], v[84:87], v[220:223]
s_waitcnt vmcnt(4)
ds_read_b128 v[64:67], v26 offset:31744
ds_read_b128 v[68:71], v24 offset:0
ds_read_b128 v[72:75], v24 offset:2048
ds_read_b128 v[76:79], v26 offset:31808
ds_read_b128 v[80:83], v25 offset:0
ds_read_b128 v[84:87], v25 offset:2048
s_waitcnt lgkmcnt(6)
v_mfma_f32_16x16x32_bf16 v[208:211], v[88:91], v[92:95], v[208:211]
v_mfma_f32_16x16x32_bf16 v[212:215], v[88:91], v[96:99], v[212:215]
v_mfma_f32_16x16x32_bf16 v[216:219], v[100:103], v[104:107], v[216:219]
v_mfma_f32_16x16x32_bf16 v[220:223], v[100:103], v[108:111], v[220:223]
s_waitcnt vmcnt(0)
ds_read_b128 v[88:91], v26 offset:31872
ds_read_b128 v[92:95], v24 offset:4096
ds_read_b128 v[96:99], v24 offset:6144
ds_read_b128 v[100:103], v26 offset:31936
ds_read_b128 v[104:107], v25 offset:4096
ds_read_b128 v[108:111], v25 offset:6144
s_waitcnt lgkmcnt(6)
v_mfma_f32_16x16x32_bf16 v[208:211], v[64:67], v[68:71], v[208:211]
v_mfma_f32_16x16x32_bf16 v[212:215], v[64:67], v[72:75], v[212:215]
v_mfma_f32_16x16x32_bf16 v[216:219], v[76:79], v[80:83], v[216:219]
v_mfma_f32_16x16x32_bf16 v[220:223], v[76:79], v[84:87], v[220:223]
s_waitcnt lgkmcnt(0)
v_mfma_f32_16x16x32_bf16 v[208:211], v[88:91], v[92:95], v[208:211]
v_mfma_f32_16x16x32_bf16 v[212:215], v[88:91], v[96:99], v[212:215]
v_mfma_f32_16x16x32_bf16 v[216:219], v[100:103], v[104:107], v[216:219]
v_mfma_f32_16x16x32_bf16 v[220:223], v[100:103], v[108:111], v[220:223]
s_lshl_b32 s51, s22, 2
s_add_u32 s51, s51, s3
s_lshl_b32 s51, s51, 7
s_add_u32 s51, s51, 16777216
v_and_b32 v64, 31, v1
v_cmp_eq_u32 vcc, 0, v3
v_lshlrev_b32 v64, 2, v64
v_add_f32 v208, v208, v216
v_add_f32 v212, v212, v220
v_cndmask_b32 v208, v212, v208, vcc
v_cmp_gt_u32 vcc, 32, v1
v_mov_b32 v65, 2146435072
v_cvt_pk_bf16_f32 v208, v208, v208
v_cndmask_b32 v64, v65, v64, vcc
v_lshlrev_b32 v208, 16, v208
v_mul_f32 v208, 0xbfb8aa3b, v208
v_exp_f32 v208, v208
s_nop 0
v_add_f32 v208, 1.0, v208
v_rcp_f32 v208, v208
s_nop 0
v_cvt_pk_bf16_f32 v208, v208, v208
v_lshlrev_b32 v208, 16, v208
buffer_store_dword v208, v64, s[12:15], s51 offen sc1
s_barrier
s_lshr_b32 s101, s3, 1
s_lshl_b32 s101, s101, 4
s_lshr_b32 s1, s1, s101
s_lshl_b32 s1, s1, 16
s_lshr_b32 s55, s55, s101
s_lshl_b32 s55, s55, 16
v_mov_b32 v122, 0x3fb8aa3b
v_mul_f32 v122, s1, v122
s_mul_i32 s101, s3, 4608
v_exp_f32 v122, v122
s_add_u32 s101, s101, 51456
v_lshl_add_u32 v188, v1, 2, s101
s_mov_b32 m0, s101
v_cvt_pk_bf16_f32 v122, v122, v122
v_mul_u32_u24 v189, 288, v2
v_lshlrev_b32 v122, 16, v122
v_lshl_add_u32 v189, v3, 4, v189
v_add_u32 v189, s101, v189
v_lshlrev_b32 v4, 16, v4
v_lshlrev_b32 v5, 16, v5
v_lshlrev_b32 v6, 16, v6
v_lshlrev_b32 v7, 16, v7
v_lshlrev_b32 v8, 16, v8
v_lshlrev_b32 v9, 16, v9
v_mul_f32 v120, v122, v4
v_mul_f32 v121, v122, v5
v_mul_f32 v120, 0x3fb8aa3b, v120
v_mul_f32 v121, 0x3e22f983, v121
v_mul_f32 v123, 0x41000000, v120
v_mul_f32 v124, 0xc1000000, v121
v_exp_f32 v123, v123
v_fract_f32 v124, v124
v_mul_f32 v6, v122, v6
v_cos_f32 v116, v124
v_sin_f32 v117, v124
v_mul_f32 v7, v122, v7
v_pk_mul_f32 v[116:117], v[116:117], v[122:123] op_sel:[0,1] op_sel_hi:[1,1]
v_mul_f32 v112, v8, v6
v_mul_f32 v113, v8, v7
v_fma_f32 v112, -v9, v7, v112
v_fma_f32 v113, -v9, v6, -v113
v_cvt_pk_bf16_f32 v128, v112, v113
v_pk_mul_f32 v[114:115], v[112:113], v[116:117] op_sel:[0,0] op_sel_hi:[0,1]
v_pk_fma_f32 v[114:115], v[112:113], v[116:117], v[114:115] op_sel:[1,1,0] op_sel_hi:[1,0,1] neg_lo:[1,0,0]
v_cvt_pk_bf16_f32 v129, v114, v115
ds_write_addtid_b32 v128 offset:0
v_pk_mul_f32 v[112:113], v[114:115], v[116:117] op_sel:[0,0] op_sel_hi:[0,1]
v_pk_fma_f32 v[112:113], v[114:115], v[116:117], v[112:113] op_sel:[1,1,0] op_sel_hi:[1,0,1] neg_lo:[1,0,0]
v_cvt_pk_bf16_f32 v130, v112, v113
ds_write_addtid_b32 v129 offset:288
v_pk_mul_f32 v[114:115], v[112:113], v[116:117] op_sel:[0,0] op_sel_hi:[0,1]
v_pk_fma_f32 v[114:115], v[112:113], v[116:117], v[114:115] op_sel:[1,1,0] op_sel_hi:[1,0,1] neg_lo:[1,0,0]
v_cvt_pk_bf16_f32 v131, v114, v115
ds_write_addtid_b32 v130 offset:576
v_pk_mul_f32 v[112:113], v[114:115], v[116:117] op_sel:[0,0] op_sel_hi:[0,1]
v_pk_fma_f32 v[112:113], v[114:115], v[116:117], v[112:113] op_sel:[1,1,0] op_sel_hi:[1,0,1] neg_lo:[1,0,0]
v_cvt_pk_bf16_f32 v132, v112, v113
ds_write_addtid_b32 v131 offset:864
v_pk_mul_f32 v[114:115], v[112:113], v[116:117] op_sel:[0,0] op_sel_hi:[0,1]
v_pk_fma_f32 v[114:115], v[112:113], v[116:117], v[114:115] op_sel:[1,1,0] op_sel_hi:[1,0,1] neg_lo:[1,0,0]
v_cvt_pk_bf16_f32 v133, v114, v115
ds_write_addtid_b32 v132 offset:1152
v_pk_mul_f32 v[112:113], v[114:115], v[116:117] op_sel:[0,0] op_sel_hi:[0,1]
v_pk_fma_f32 v[112:113], v[114:115], v[116:117], v[112:113] op_sel:[1,1,0] op_sel_hi:[1,0,1] neg_lo:[1,0,0]
v_cvt_pk_bf16_f32 v134, v112, v113
ds_write_addtid_b32 v133 offset:1440
v_pk_mul_f32 v[114:115], v[112:113], v[116:117] op_sel:[0,0] op_sel_hi:[0,1]
v_pk_fma_f32 v[114:115], v[112:113], v[116:117], v[114:115] op_sel:[1,1,0] op_sel_hi:[1,0,1] neg_lo:[1,0,0]
v_cvt_pk_bf16_f32 v135, v114, v115
ds_write_addtid_b32 v134 offset:1728
v_pk_mul_f32 v[112:113], v[114:115], v[116:117] op_sel:[0,0] op_sel_hi:[0,1]
v_pk_fma_f32 v[112:113], v[114:115], v[116:117], v[112:113] op_sel:[1,1,0] op_sel_hi:[1,0,1] neg_lo:[1,0,0]
v_cvt_pk_bf16_f32 v128, v112, v113
ds_write_addtid_b32 v135 offset:2016
v_pk_mul_f32 v[114:115], v[112:113], v[116:117] op_sel:[0,0] op_sel_hi:[0,1]
v_pk_fma_f32 v[114:115], v[112:113], v[116:117], v[114:115] op_sel:[1,1,0] op_sel_hi:[1,0,1] neg_lo:[1,0,0]
v_cvt_pk_bf16_f32 v129, v114, v115
ds_write_addtid_b32 v128 offset:2304
v_pk_mul_f32 v[112:113], v[114:115], v[116:117] op_sel:[0,0] op_sel_hi:[0,1]
v_pk_fma_f32 v[112:113], v[114:115], v[116:117], v[112:113] op_sel:[1,1,0] op_sel_hi:[1,0,1] neg_lo:[1,0,0]
v_cvt_pk_bf16_f32 v130, v112, v113
ds_write_addtid_b32 v129 offset:2592
v_pk_mul_f32 v[114:115], v[112:113], v[116:117] op_sel:[0,0] op_sel_hi:[0,1]
v_pk_fma_f32 v[114:115], v[112:113], v[116:117], v[114:115] op_sel:[1,1,0] op_sel_hi:[1,0,1] neg_lo:[1,0,0]
v_cvt_pk_bf16_f32 v131, v114, v115
ds_write_addtid_b32 v130 offset:2880
v_pk_mul_f32 v[112:113], v[114:115], v[116:117] op_sel:[0,0] op_sel_hi:[0,1]
v_pk_fma_f32 v[112:113], v[114:115], v[116:117], v[112:113] op_sel:[1,1,0] op_sel_hi:[1,0,1] neg_lo:[1,0,0]
v_cvt_pk_bf16_f32 v132, v112, v113
ds_write_addtid_b32 v131 offset:3168
v_pk_mul_f32 v[114:115], v[112:113], v[116:117] op_sel:[0,0] op_sel_hi:[0,1]
v_pk_fma_f32 v[114:115], v[112:113], v[116:117], v[114:115] op_sel:[1,1,0] op_sel_hi:[1,0,1] neg_lo:[1,0,0]
v_cvt_pk_bf16_f32 v133, v114, v115
ds_write_addtid_b32 v132 offset:3456
v_pk_mul_f32 v[112:113], v[114:115], v[116:117] op_sel:[0,0] op_sel_hi:[0,1]
v_pk_fma_f32 v[112:113], v[114:115], v[116:117], v[112:113] op_sel:[1,1,0] op_sel_hi:[1,0,1] neg_lo:[1,0,0]
v_cvt_pk_bf16_f32 v134, v112, v113
ds_write_addtid_b32 v133 offset:3744
v_pk_mul_f32 v[114:115], v[112:113], v[116:117] op_sel:[0,0] op_sel_hi:[0,1]
v_pk_fma_f32 v[114:115], v[112:113], v[116:117], v[114:115] op_sel:[1,1,0] op_sel_hi:[1,0,1] neg_lo:[1,0,0]
v_cvt_pk_bf16_f32 v135, v114, v115
ds_write_addtid_b32 v134 offset:4032
ds_write_addtid_b32 v135 offset:4320
ds_read_b128 v[144:147], v189 offset:0
ds_read_b128 v[148:151], v189 offset:64
ds_read_b128 v[152:155], v189 offset:128
ds_read_b128 v[156:159], v189 offset:192
v_mul_f32 v125, 1.0, v120
v_mul_f32 v126, 1.0, v121
v_exp_f32 v125, v125
v_fract_f32 v126, v126
v_cos_f32 v64, v126
v_sin_f32 v65, v126
s_nop 0
v_pk_mul_f32 v[64:65], v[64:65], v[124:125] op_sel:[0,1] op_sel_hi:[1,1]
v_mul_f32 v125, 0x43000000, v120
v_mul_f32 v126, 0x43000000, v121
v_exp_f32 v125, v125
v_fract_f32 v126, v126
v_cos_f32 v80, v126
v_sin_f32 v81, v126
s_nop 0
v_pk_mul_f32 v[80:81], v[80:81], v[124:125] op_sel:[0,1] op_sel_hi:[1,1]
v_mov_b32 v135, 0x3f80
v_cvt_pk_bf16_f32 v128, v64, v65
v_cvt_pk_bf16_f32 v129, v80, v81
v_pk_mul_f32 v[66:67], v[64:65], v[64:65] op_sel:[0,0] op_sel_hi:[0,1]
ds_write_b32 v188, v135
v_pk_fma_f32 v[66:67], v[64:65], v[64:65], v[66:67] op_sel:[1,1,0] op_sel_hi:[1,0,1] neg_lo:[1,0,0]
ds_write_addtid_b32 v128 offset:288
v_cvt_pk_bf16_f32 v130, v66, v67
ds_write_addtid_b32 v129 offset:2304
v_pk_mul_f32 v[68:69], v[66:67], v[64:65] op_sel:[0,0] op_sel_hi:[0,1]
v_pk_fma_f32 v[68:69], v[66:67], v[64:65], v[68:69] op_sel:[1,1,0] op_sel_hi:[1,0,1] neg_lo:[1,0,0]
v_cvt_pk_bf16_f32 v131, v68, v69
ds_write_addtid_b32 v130 offset:576
v_pk_mul_f32 v[70:71], v[66:67], v[66:67] op_sel:[0,0] op_sel_hi:[0,1]
v_pk_fma_f32 v[70:71], v[66:67], v[66:67], v[70:71] op_sel:[1,1,0] op_sel_hi:[1,0,1] neg_lo:[1,0,0]
v_cvt_pk_bf16_f32 v132, v70, v71
ds_write_addtid_b32 v131 offset:864
v_pk_mul_f32 v[72:73], v[70:71], v[64:65] op_sel:[0,0] op_sel_hi:[0,1]
v_pk_fma_f32 v[72:73], v[70:71], v[64:65], v[72:73] op_sel:[1,1,0] op_sel_hi:[1,0,1] neg_lo:[1,0,0]
v_cvt_pk_bf16_f32 v133, v72, v73
s_lshr_b32 s101, s24, 5
s_lshl_b32 s101, s101, 11
s_add_u32 s101, s101, 16875520
v_lshl_add_u32 v13, v2, 7, s101
buffer_load_dwordx2 v[14:15], v13, s[12:15], 0 offen sc1
ds_write_addtid_b32 v132 offset:1152
v_pk_mul_f32 v[74:75], v[70:71], v[66:67] op_sel:[0,0] op_sel_hi:[0,1]
v_pk_fma_f32 v[74:75], v[70:71], v[66:67], v[74:75] op_sel:[1,1,0] op_sel_hi:[1,0,1] neg_lo:[1,0,0]
v_cvt_pk_bf16_f32 v134, v74, v75
ds_write_addtid_b32 v133 offset:1440
v_pk_mul_f32 v[76:77], v[70:71], v[68:69] op_sel:[0,0] op_sel_hi:[0,1]
v_pk_fma_f32 v[76:77], v[70:71], v[68:69], v[76:77] op_sel:[1,1,0] op_sel_hi:[1,0,1] neg_lo:[1,0,0]
v_cvt_pk_bf16_f32 v135, v76, v77
ds_write_addtid_b32 v134 offset:1728
v_pk_mul_f32 v[136:137], v[80:81], v[64:65] op_sel:[0,0] op_sel_hi:[0,1]
v_pk_fma_f32 v[136:137], v[80:81], v[64:65], v[136:137] op_sel:[1,1,0] op_sel_hi:[1,0,1] neg_lo:[1,0,0]
s_mul_i32 s101, s3, 14
s_cmp_eq_u32 s3, 3
s_subb_u32 s101, s101, 0
s_lshr_b32 s100, s3, 1
s_sub_u32 s100, 13, s100
v_min_u32 v12, s100, v1
s_lshl_b32 s100, s26, 6
s_add_u32 s101, s101, s100
s_lshl_b32 s101, s101, 7
s_add_u32 s101, s101, 16908288
v_lshl_add_u32 v12, v12, 7, s101
buffer_load_dwordx2 v[226:227], v12, s[12:15], 0 offen sc1
v_cvt_pk_bf16_f32 v128, v136, v137
ds_write_addtid_b32 v135 offset:2016
v_pk_mul_f32 v[138:139], v[80:81], v[66:67] op_sel:[0,0] op_sel_hi:[0,1]
v_pk_fma_f32 v[138:139], v[80:81], v[66:67], v[138:139] op_sel:[1,1,0] op_sel_hi:[1,0,1] neg_lo:[1,0,0]
v_cvt_pk_bf16_f32 v129, v138, v139
ds_write_addtid_b32 v128 offset:2592
v_pk_mul_f32 v[140:141], v[80:81], v[68:69] op_sel:[0,0] op_sel_hi:[0,1]
v_pk_fma_f32 v[140:141], v[80:81], v[68:69], v[140:141] op_sel:[1,1,0] op_sel_hi:[1,0,1] neg_lo:[1,0,0]
v_cvt_pk_bf16_f32 v130, v140, v141
ds_write_addtid_b32 v129 offset:2880
v_pk_mul_f32 v[142:143], v[80:81], v[70:71] op_sel:[0,0] op_sel_hi:[0,1]
v_pk_fma_f32 v[142:143], v[80:81], v[70:71], v[142:143] op_sel:[1,1,0] op_sel_hi:[1,0,1] neg_lo:[1,0,0]
v_cvt_pk_bf16_f32 v131, v142, v143
ds_write_addtid_b32 v130 offset:3168
v_pk_mul_f32 v[136:137], v[80:81], v[72:73] op_sel:[0,0] op_sel_hi:[0,1]
v_pk_fma_f32 v[136:137], v[80:81], v[72:73], v[136:137] op_sel:[1,1,0] op_sel_hi:[1,0,1] neg_lo:[1,0,0]
v_cvt_pk_bf16_f32 v132, v136, v137
ds_write_addtid_b32 v131 offset:3456
v_pk_mul_f32 v[138:139], v[80:81], v[74:75] op_sel:[0,0] op_sel_hi:[0,1]
v_pk_fma_f32 v[138:139], v[80:81], v[74:75], v[138:139] op_sel:[1,1,0] op_sel_hi:[1,0,1] neg_lo:[1,0,0]
v_cvt_pk_bf16_f32 v133, v138, v139
ds_write_addtid_b32 v132 offset:3744
v_pk_mul_f32 v[140:141], v[80:81], v[76:77] op_sel:[0,0] op_sel_hi:[0,1]
v_pk_fma_f32 v[140:141], v[80:81], v[76:77], v[140:141] op_sel:[1,1,0] op_sel_hi:[1,0,1] neg_lo:[1,0,0]
v_cvt_pk_bf16_f32 v134, v140, v141
ds_write_addtid_b32 v133 offset:4032
ds_write_addtid_b32 v134 offset:4320
ds_read_b128 v[160:163], v189 offset:0
ds_read_b128 v[164:167], v189 offset:64
ds_read_b128 v[168:171], v189 offset:128
ds_read_b128 v[172:175], v189 offset:192
v_pk_mul_f32 v[82:83], v[80:81], v[80:81] op_sel:[0,0] op_sel_hi:[0,1]
v_pk_fma_f32 v[82:83], v[80:81], v[80:81], v[82:83] op_sel:[1,1,0] op_sel_hi:[1,0,1] neg_lo:[1,0,0]
v_pk_mul_f32 v[84:85], v[82:83], v[80:81] op_sel:[0,0] op_sel_hi:[0,1]
v_pk_fma_f32 v[84:85], v[82:83], v[80:81], v[84:85] op_sel:[1,1,0] op_sel_hi:[1,0,1] neg_lo:[1,0,0]
v_pk_mul_f32 v[86:87], v[82:83], v[82:83] op_sel:[0,0] op_sel_hi:[0,1]
v_pk_fma_f32 v[86:87], v[82:83], v[82:83], v[86:87] op_sel:[1,1,0] op_sel_hi:[1,0,1] neg_lo:[1,0,0]
v_pk_mul_f32 v[88:89], v[86:87], v[80:81] op_sel:[0,0] op_sel_hi:[0,1]
v_pk_fma_f32 v[88:89], v[86:87], v[80:81], v[88:89] op_sel:[1,1,0] op_sel_hi:[1,0,1] neg_lo:[1,0,0]
v_pk_mul_f32 v[90:91], v[86:87], v[82:83] op_sel:[0,0] op_sel_hi:[0,1]
v_pk_fma_f32 v[90:91], v[86:87], v[82:83], v[90:91] op_sel:[1,1,0] op_sel_hi:[1,0,1] neg_lo:[1,0,0]
v_pk_mul_f32 v[92:93], v[86:87], v[84:85] op_sel:[0,0] op_sel_hi:[0,1]
v_pk_fma_f32 v[92:93], v[86:87], v[84:85], v[92:93] op_sel:[1,1,0] op_sel_hi:[1,0,1] neg_lo:[1,0,0]
v_pk_mul_f32 v[94:95], v[86:87], v[86:87] op_sel:[0,0] op_sel_hi:[0,1]
v_pk_fma_f32 v[94:95], v[86:87], v[86:87], v[94:95] op_sel:[1,1,0] op_sel_hi:[1,0,1] neg_lo:[1,0,0]
s_waitcnt lgkmcnt(0)
v_mfma_f32_16x16x32_bf16 v[176:179], v[160:163], v[144:147], 0
v_mfma_f32_16x16x32_bf16 v[176:179], v[164:167], v[148:151], v[176:179]
v_mfma_f32_16x16x32_bf16 v[176:179], v[168:171], v[152:155], v[176:179]
v_mfma_f32_16x16x32_bf16 v[176:179], v[172:175], v[156:159], v[176:179]
v_cvt_pk_bf16_f32 v135, v82, v83
v_pk_mul_f32 v[142:143], v[82:83], v[66:67] op_sel:[0,0] op_sel_hi:[0,1]
v_pk_fma_f32 v[142:143], v[82:83], v[66:67], v[142:143] op_sel:[1,1,0] op_sel_hi:[1,0,1] neg_lo:[1,0,0]
v_cvt_pk_bf16_f32 v128, v142, v143
ds_write_addtid_b32 v135 offset:0
v_pk_mul_f32 v[136:137], v[82:83], v[70:71] op_sel:[0,0] op_sel_hi:[0,1]
v_pk_fma_f32 v[136:137], v[82:83], v[70:71], v[136:137] op_sel:[1,1,0] op_sel_hi:[1,0,1] neg_lo:[1,0,0]
v_cvt_pk_bf16_f32 v129, v136, v137
ds_write_addtid_b32 v128 offset:288
v_pk_mul_f32 v[138:139], v[82:83], v[74:75] op_sel:[0,0] op_sel_hi:[0,1]
v_pk_fma_f32 v[138:139], v[82:83], v[74:75], v[138:139] op_sel:[1,1,0] op_sel_hi:[1,0,1] neg_lo:[1,0,0]
v_cvt_pk_bf16_f32 v130, v138, v139
ds_write_addtid_b32 v129 offset:576
v_cvt_pk_bf16_f32 v131, v84, v85
v_pk_mul_f32 v[140:141], v[84:85], v[66:67] op_sel:[0,0] op_sel_hi:[0,1]
v_pk_fma_f32 v[140:141], v[84:85], v[66:67], v[140:141] op_sel:[1,1,0] op_sel_hi:[1,0,1] neg_lo:[1,0,0]
ds_write_addtid_b32 v130 offset:864
v_cvt_pk_bf16_f32 v132, v140, v141
ds_write_addtid_b32 v131 offset:1152
v_pk_mul_f32 v[142:143], v[84:85], v[70:71] op_sel:[0,0] op_sel_hi:[0,1]
v_pk_fma_f32 v[142:143], v[84:85], v[70:71], v[142:143] op_sel:[1,1,0] op_sel_hi:[1,0,1] neg_lo:[1,0,0]
v_cvt_pk_bf16_f32 v133, v142, v143
ds_write_addtid_b32 v132 offset:1440
v_pk_mul_f32 v[136:137], v[84:85], v[74:75] op_sel:[0,0] op_sel_hi:[0,1]
v_pk_fma_f32 v[136:137], v[84:85], v[74:75], v[136:137] op_sel:[1,1,0] op_sel_hi:[1,0,1] neg_lo:[1,0,0]
v_cvt_pk_bf16_f32 v134, v136, v137
ds_write_addtid_b32 v133 offset:1728
v_cvt_pk_bf16_f32 v135, v86, v87
v_pk_mul_f32 v[138:139], v[86:87], v[70:71] op_sel:[0,0] op_sel_hi:[0,1]
v_pk_fma_f32 v[138:139], v[86:87], v[70:71], v[138:139] op_sel:[1,1,0] op_sel_hi:[1,0,1] neg_lo:[1,0,0]
ds_write_addtid_b32 v134 offset:2016
v_cvt_pk_bf16_f32 v128, v138, v139
ds_write_addtid_b32 v135 offset:2304
v_cvt_pk_bf16_f32 v129, v88, v89
v_pk_mul_f32 v[140:141], v[88:89], v[70:71] op_sel:[0,0] op_sel_hi:[0,1]
v_pk_fma_f32 v[140:141], v[88:89], v[70:71], v[140:141] op_sel:[1,1,0] op_sel_hi:[1,0,1] neg_lo:[1,0,0]
ds_write_addtid_b32 v128 offset:2592
v_cvt_pk_bf16_f32 v130, v140, v141
ds_write_addtid_b32 v129 offset:2880
v_cvt_pk_bf16_f32 v131, v90, v91
v_pk_mul_f32 v[142:143], v[90:91], v[70:71] op_sel:[0,0] op_sel_hi:[0,1]
v_pk_fma_f32 v[142:143], v[90:91], v[70:71], v[142:143] op_sel:[1,1,0] op_sel_hi:[1,0,1] neg_lo:[1,0,0]
s_waitcnt vmcnt(1)
v_cmp_ne_u64 vcc, v[14:15], s[20:21]
s_cbranch_vccnz slow35
back36:
s_lshr_b32 s51, s24, 1
s_lshl_b32 s51, s51, 14
s_add_u32 s51, s51, 10485760
v_lshlrev_b32 v13, 4, v0
buffer_load_dwordx4 v[36:39], v13, s[12:15], s51 offen sc1
ds_write_addtid_b32 v130 offset:3168
v_cvt_pk_bf16_f32 v132, v142, v143
ds_write_addtid_b32 v131 offset:3456
v_cvt_pk_bf16_f32 v133, v92, v93
v_pk_mul_f32 v[136:137], v[92:93], v[70:71] op_sel:[0,0] op_sel_hi:[0,1]
v_pk_fma_f32 v[136:137], v[92:93], v[70:71], v[136:137] op_sel:[1,1,0] op_sel_hi:[1,0,1] neg_lo:[1,0,0]
ds_write_addtid_b32 v132 offset:3744
v_cvt_pk_bf16_f32 v134, v136, v137
ds_write_addtid_b32 v133 offset:4032
s_add_u32 s51, s51, 4096
buffer_load_dwordx4 v[40:43], v13, s[12:15], s51 offen sc1
ds_write_addtid_b32 v134 offset:4320
ds_read_b128 v[160:163], v189 offset:0
ds_read_b128 v[164:167], v189 offset:64
ds_read_b128 v[168:171], v189 offset:128
ds_read_b128 v[172:175], v189 offset:192
v_pk_mul_f32 v[96:97], v[94:95], v[80:81] op_sel:[0,0] op_sel_hi:[0,1]
v_pk_fma_f32 v[96:97], v[94:95], v[80:81], v[96:97] op_sel:[1,1,0] op_sel_hi:[1,0,1] neg_lo:[1,0,0]
v_pk_mul_f32 v[98:99], v[94:95], v[82:83] op_sel:[0,0] op_sel_hi:[0,1]
v_pk_fma_f32 v[98:99], v[94:95], v[82:83], v[98:99] op_sel:[1,1,0] op_sel_hi:[1,0,1] neg_lo:[1,0,0]
v_pk_mul_f32 v[100:101], v[94:95], v[84:85] op_sel:[0,0] op_sel_hi:[0,1]
v_pk_fma_f32 v[100:101], v[94:95], v[84:85], v[100:101] op_sel:[1,1,0] op_sel_hi:[1,0,1] neg_lo:[1,0,0]
v_pk_mul_f32 v[102:103], v[94:95], v[86:87] op_sel:[0,0] op_sel_hi:[0,1]
v_pk_fma_f32 v[102:103], v[94:95], v[86:87], v[102:103] op_sel:[1,1,0] op_sel_hi:[1,0,1] neg_lo:[1,0,0]
v_pk_mul_f32 v[104:105], v[94:95], v[88:89] op_sel:[0,0] op_sel_hi:[0,1]
s_add_u32 s51, s51, 4096
buffer_load_dwordx4 v[44:47], v13, s[12:15], s51 offen sc1
v_pk_fma_f32 v[104:105], v[94:95], v[88:89], v[104:105] op_sel:[1,1,0] op_sel_hi:[1,0,1] neg_lo:[1,0,0]
v_pk_mul_f32 v[106:107], v[94:95], v[90:91] op_sel:[0,0] op_sel_hi:[0,1]
v_pk_fma_f32 v[106:107], v[94:95], v[90:91], v[106:107] op_sel:[1,1,0] op_sel_hi:[1,0,1] neg_lo:[1,0,0]
v_pk_mul_f32 v[108:109], v[94:95], v[92:93] op_sel:[0,0] op_sel_hi:[0,1]
v_pk_fma_f32 v[108:109], v[94:95], v[92:93], v[108:109] op_sel:[1,1,0] op_sel_hi:[1,0,1] neg_lo:[1,0,0]
v_pk_mul_f32 v[110:111], v[94:95], v[94:95] op_sel:[0,0] op_sel_hi:[0,1]
v_pk_fma_f32 v[110:111], v[94:95], v[94:95], v[110:111] op_sel:[1,1,0] op_sel_hi:[1,0,1] neg_lo:[1,0,0]
s_waitcnt lgkmcnt(0)
v_mfma_f32_16x16x32_bf16 v[180:183], v[160:163], v[144:147], 0
v_mfma_f32_16x16x32_bf16 v[180:183], v[164:167], v[148:151], v[180:183]
v_mfma_f32_16x16x32_bf16 v[180:183], v[168:171], v[152:155], v[180:183]
s_add_u32 s51, s51, 4096
buffer_load_dwordx4 v[48:51], v13, s[12:15], s51 offen sc1
v_mfma_f32_16x16x32_bf16 v[180:183], v[172:175], v[156:159], v[180:183]
v_cvt_pk_bf16_f32 v135, v94, v95
v_cvt_pk_bf16_f32 v128, v96, v97
v_cvt_pk_bf16_f32 v129, v98, v99
v_cvt_pk_bf16_f32 v130, v100, v101
ds_write_addtid_b32 v135 offset:0
v_cvt_pk_bf16_f32 v131, v102, v103
ds_write_addtid_b32 v128 offset:288
v_cvt_pk_bf16_f32 v132, v104, v105
ds_write_addtid_b32 v129 offset:576
v_cvt_pk_bf16_f32 v133, v106, v107
s_waitcnt vmcnt(4)
v_cmp_ne_u64 vcc, v[226:227], s[20:21]
s_cbranch_vccnz slow37
back38:
ds_write_addtid_b32 v130 offset:864
v_cvt_pk_bf16_f32 v134, v108, v109
ds_write_addtid_b32 v131 offset:1152
v_cvt_pk_bf16_f32 v135, v110, v111
ds_write_addtid_b32 v132 offset:1440
ds_write_addtid_b32 v133 offset:1728
ds_write_addtid_b32 v134 offset:2016
ds_write_addtid_b32 v135 offset:2304
ds_read_b128 v[160:163], v189 offset:0
ds_read_b128 v[164:167], v189 offset:64
ds_read_b128 v[168:171], v189 offset:128
ds_read_b128 v[172:175], v189 offset:192
s_mul_i32 s101, s3, 3072
v_lshrrev_b32 v123, 1, v3
v_and_b32 v124, 1, v3
v_lshlrev_b32 v190, 9, v123
v_lshl_add_u32 v190, v2, 5, v190
v_lshl_add_u32 v190, v124, 4, v190
v_add_u32 v190, s101, v190
v_sub_u32 v124, 4, v123
v_lshlrev_b32 v191, v124, v2
v_lshl_add_u32 v225, v3, 8, s101
v_add_u32 v191, v191, v225
v_mul_u32_u24 v123, 120, v123
v_add3_u32 v224, v191, v123, 8
v_lshl_add_u32 v225, v2, 2, v225
s_waitcnt lgkmcnt(0)
v_mfma_f32_16x16x32_bf16 v[184:187], v[160:163], v[144:147], 0
v_mfma_f32_16x16x32_bf16 v[184:187], v[164:167], v[148:151], v[184:187]
v_mfma_f32_16x16x32_bf16 v[184:187], v[168:171], v[152:155], v[184:187]
v_mfma_f32_16x16x32_bf16 v[184:187], v[172:175], v[156:159], v[184:187]
ds_write_b128 v190, v[176:179]
ds_write_b64 v191, v[180:181] offset:1024
ds_write_b64 v224, v[182:183] offset:1024
s_nop 4
ds_write_b32 v225, v184 offset:2048
ds_write_b32 v225, v185 offset:2112
ds_write_b32 v225, v186 offset:2176
ds_write_b32 v225, v187 offset:2240
s_lshl_b32 s51, s22, 11
s_lshl_b32 s101, s23, 7
s_add_u32 s51, s51, s101
s_add_u32 s51, s51, 16844288
s_lshl_b32 s51, s22, 11
s_add_u32 s51, s51, 16844672
s_lshr_b32 s101, s3, 1
s_mul_i32 s100, s101, 6144
s_mul_i32 s101, s101, 8320
s_add_u32 s101, s101, 135152
v_lshlrev_b32 v65, 4, v1
v_sub_u32 v65, s101, v65
s_and_b32 s101, s3, 1
s_lshl_b32 s101, s101, 8
s_add_u32 s101, s101, s100
v_lshl_add_u32 v64, v1, 2, s101
s_waitcnt lgkmcnt(0)
s_barrier
buffer_store_dwordx2 v[10:11], v63, s[12:15], s51 offen sc1
ds_read_b32 v94, v64 offset:2048
ds_read_b32 v95, v64 offset:2052
ds_read_b32 v96, v64 offset:5120
ds_read_b32 v97, v64 offset:5124
s_bitcmp1_b32 s3, 0
s_cbranch_scc1 ex39
s_movk_i32 s30, 0x200
v_cmp_gt_u32 vcc, 32, v1
v_lshlrev_b32 v92, 5, v1
v_lshl_add_u32 v93, v1, 4, s30
v_cndmask_b32 v93, v93, v92, vcc
v_cmp_ge_u32 vcc, 32, v1
v_add_u32 v92, -4, v92
v_max_i32 v92, 0, v92
v_cndmask_b32 v92, v93, v92, vcc
v_add_u32 v93, s100, v93
v_add_u32 v92, s100, v92
ds_read_b128 v[68:71], v93
ds_read_b128 v[72:75], v93 offset:3072
ds_read_b128 v[76:79], v93 offset:16
ds_read_b128 v[80:83], v93 offset:3088
ds_read_b32 v66, v92
ds_read_b32 v67, v92 offset:3072
v_cmp_eq_u32 vcc, 0, v1
v_mov_b32 v92, s55
s_mov_b32 s30, 0
s_mov_b32 s31, -1
v_cndmask_b32 v92, 0, v92, vcc
s_waitcnt lgkmcnt(0)
v_pk_add_f32 v[68:69], v[68:69], v[72:73]
v_pk_add_f32 v[70:71], v[70:71], v[74:75]
v_pk_add_f32 v[76:77], v[76:77], v[80:81]
v_pk_add_f32 v[78:79], v[78:79], v[82:83]
v_add_f32 v66, v66, v67
v_cndmask_b32 v66, v66, 0, vcc
v_cndmask_b32 v72, v69, v68, s[30:31]
v_cndmask_b32 v73, v70, v69, s[30:31]
v_cndmask_b32 v74, v71, v70, s[30:31]
v_cndmask_b32 v75, v76, v70, s[30:31]
v_cndmask_b32 v80, v77, v70, s[30:31]
v_cndmask_b32 v81, v78, v71, s[30:31]
v_cndmask_b32 v82, v79, v76, s[30:31]
v_add_f32 v68, v68, v92
v_cvt_pk_bf16_f32 v84, v82, v81
v_cvt_pk_bf16_f32 v85, v80, v75
v_cvt_pk_bf16_f32 v86, v74, v73
v_cvt_pk_bf16_f32 v87, v72, v68
v_cvt_pk_bf16_f32 v88, v81, v80
v_cvt_pk_bf16_f32 v89, v75, v74
v_cvt_pk_bf16_f32 v90, v73, v72
v_cvt_pk_bf16_f32 v91, v68, v66
ds_write_b128 v65, v[84:87]
ds_write_b128 v65, v[88:91] offset:4160
v_add_u32 v65, -2048, v65
s_branch ex40
ex39:
v_lshl_add_u32 v92, v1, 3, s100
ds_read_b64 v[68:69], v92 offset:1536
ds_read_b64 v[72:73], v92 offset:4608
ds_read_b32 v70, v92 offset:1544
ds_read_b32 v74, v92 offset:4616
v_and_b32 v93, 1, v1
v_bfe_u32 v66, v1, 1, 1
v_mul_u32_u24 v93, 4160, v93
s_lshr_b32 s101, s3, 1
s_mul_i32 s101, s101, 8320
s_add_u32 s101, s101, 131072
v_lshl_add_u32 v93, v66, 4, v93
v_mov_b32 v76, 0
v_mov_b32 v77, 0
v_mov_b32 v78, 0
v_mov_b32 v79, 0
v_add_u32 v93, s101, v93
v_add_u32 v65, -1024, v65
ds_write_b128 v93, v[76:79] offset:4096
s_waitcnt lgkmcnt(0)
v_pk_add_f32 v[68:69], v[68:69], v[72:73]
v_add_f32 v70, v70, v74
v_cvt_pk_bf16_f32 v84, v70, v70
v_cvt_pk_bf16_f32 v85, v69, v69
v_cvt_pk_bf16_f32 v86, v69, v68
v_cvt_pk_bf16_f32 v87, v68, v68
v_cvt_pk_bf16_f32 v88, v70, v69
v_cvt_pk_bf16_f32 v89, v69, v69
v_cvt_pk_bf16_f32 v90, v68, v68
v_cvt_pk_bf16_f32 v91, v68, v68
ds_write_b128 v65, v[84:87]
ds_write_b128 v65, v[88:91] offset:4160
v_add_u32 v65, -2048, v65
ex40:
v_and_b32 v66, 1, v1
v_add_f32 v94, v94, v96
v_cmp_eq_u32 vcc, 1, v66
v_add_f32 v95, v95, v97
s_nop 0
v_cndmask_b32 v96, v94, v95, vcc
v_cvt_pk_bf16_f32 v98, v95, v95
v_cvt_pk_bf16_f32 v99, v95, v96
v_cvt_pk_bf16_f32 v100, v94, v94
v_cvt_pk_bf16_f32 v101, v94, v94
v_cvt_pk_bf16_f32 v102, v95, v95
v_cvt_pk_bf16_f32 v103, v96, v94
v_cvt_pk_bf16_f32 v104, v94, v94
v_cvt_pk_bf16_f32 v105, v94, v94
ds_write_b128 v65, v[98:101]
ds_write_b128 v65, v[102:105] offset:4160
s_lshr_b32 s44, s3, 1
s_mul_i32 s42, s44, 8320
s_add_u32 s44, s44, 0
s_mul_i32 s43, s44, 4672
s_and_b32 s44, s3, 1
s_lshl_b32 s44, s44, 6
s_sub_u32 s42, s42, s44
s_sub_u32 s43, s43, s44
s_add_u32 s42, s42, 16350
s_add_u32 s43, s43, 32864
v_and_b32 v35, 1, v2
v_xor_b32 v35, 1, v35
v_mul_u32_u24 v35, 4158, v35
v_lshl_add_u32 v35, v3, 4, v35
v_lshlrev_b32 v32, 1, v2
v_sub_u32 v35, v35, v32
v_add_u32 v32, s42, v35
v_lshl_add_u32 v35, v2, 5, s43
v_lshl_add_u32 v33, v3, 4, v35
s_lshr_b32 s44, s3, 1
s_mul_i32 s42, s44, 16448
s_and_b32 s44, s3, 1
s_lshl_b32 s44, s44, 13
s_add_u32 s42, s42, s44
s_add_u32 s42, s42, 53248
v_lshrrev_b32 v35, 1, v3
v_lshl_add_u32 v35, v35, 3, v2
v_and_b32 v35, 15, v35
v_lshl_add_u32 v34, v3, 8, s42
v_lshl_add_u32 v34, v35, 4, v34
v_add_u32 v28, -512, v32
v_add_u32 v29, -1536, v32
v_add_u32 v30, -2560, v32
v_add_u32 v31, -3584, v32
ds_read2_b32 v[160:161], v28 offset0:128 offset1:129
ds_read2_b32 v[162:163], v28 offset0:130 offset1:131
ds_read2_b32 v[164:165], v28 offset0:0 offset1:1
ds_read2_b32 v[166:167], v28 offset0:2 offset1:3
ds_read2_b32 v[168:169], v29 offset0:128 offset1:129
ds_read2_b32 v[170:171], v29 offset0:130 offset1:131
ds_read2_b32 v[172:173], v29 offset0:0 offset1:1
ds_read2_b32 v[174:175], v29 offset0:2 offset1:3
ds_read2_b32 v[176:177], v30 offset0:128 offset1:129
ds_read2_b32 v[178:179], v30 offset0:130 offset1:131
ds_read2_b32 v[180:181], v30 offset0:0 offset1:1
ds_read2_b32 v[182:183], v30 offset0:2 offset1:3
ds_read2_b32 v[184:185], v31 offset0:128 offset1:129
ds_read2_b32 v[186:187], v31 offset0:130 offset1:131
ds_read2_b32 v[188:189], v31 offset0:0 offset1:1
ds_read2_b32 v[190:191], v31 offset0:2 offset1:3
v_bfe_u32 v13, v0, 5, 2
v_and_b32 v14, 31, v0
v_mul_u32_u24 v13, 4672, v13
v_mov_b32 v16, 0
v_mov_b32 v17, 0
v_mov_b32 v18, 0
v_mov_b32 v19, 0
v_lshl_add_u32 v13, v14, 4, v13
v_and_b32 v14, 3, v0
v_mul_u32_u24 v14, 4672, v14
ds_write_b128 v13, v[16:19] offset:32768
v_lshrrev_b32 v13, 2, v0
v_lshl_add_u32 v13, v13, 4, v14
s_waitcnt vmcnt(1)
ds_write_b128 v13, v[36:39] offset:33280
ds_write_b128 v13, v[40:43] offset:34304
ds_write_b128 v13, v[44:47] offset:35328
ds_write_b128 v13, v[48:51] offset:36352
s_waitcnt lgkmcnt(0)
s_barrier
ds_read_b128 v[192:195], v33 offset:384
ds_read_b128 v[196:199], v33 offset:896
ds_read_b128 v[200:203], v33 offset:1408
ds_read_b128 v[204:207], v33 offset:1920
ds_read_b128 v[208:211], v33 offset:2432
ds_read_b128 v[212:215], v33 offset:2944
ds_read_b128 v[216:219], v33 offset:3456
ds_read_b128 v[220:223], v33 offset:3968
s_waitcnt lgkmcnt(7)
v_mfma_f32_16x16x32_bf16 v[64:67], v[160:163], v[192:195], 0
buffer_load_dwordx4 a[0:3], v56, s[12:15], s72 offen offset:0 sc1
v_mfma_f32_16x16x32_bf16 v[68:71], v[164:167], v[192:195], 0
v_mfma_f32_16x16x32_bf16 v[72:75], v[168:171], v[192:195], 0
v_mfma_f32_16x16x32_bf16 v[76:79], v[172:175], v[192:195], 0
v_mfma_f32_16x16x32_bf16 v[80:83], v[176:179], v[192:195], 0
buffer_load_dwordx4 a[4:7], v56, s[12:15], s72 offen offset:1024 sc1
v_mfma_f32_16x16x32_bf16 v[84:87], v[180:183], v[192:195], 0
v_mfma_f32_16x16x32_bf16 v[88:91], v[184:187], v[192:195], 0
v_add_u32 v24, -640, v32
v_add_u32 v25, -1664, v32
v_mfma_f32_16x16x32_bf16 v[92:95], v[188:191], v[192:195], 0
v_add_u32 v26, -2688, v32
v_add_u32 v27, -3712, v32
s_waitcnt lgkmcnt(6)
v_mfma_f32_16x16x32_bf16 v[68:71], v[160:163], v[196:199], v[68:71]
ds_read_b128 v[128:131], v33 offset:256
buffer_load_dwordx4 a[8:11], v56, s[12:15], s72 offen offset:2048 sc1
v_mfma_f32_16x16x32_bf16 v[72:75], v[164:167], v[196:199], v[72:75]
ds_read2_b32 v[96:97], v24 offset0:128 offset1:129
v_mfma_f32_16x16x32_bf16 v[76:79], v[168:171], v[196:199], v[76:79]
ds_read2_b32 v[98:99], v24 offset0:130 offset1:131
v_mfma_f32_16x16x32_bf16 v[80:83], v[172:175], v[196:199], v[80:83]
ds_read2_b32 v[100:101], v24 offset0:0 offset1:1
v_mfma_f32_16x16x32_bf16 v[84:87], v[176:179], v[196:199], v[84:87]
ds_read2_b32 v[102:103], v24 offset0:2 offset1:3
buffer_load_dwordx4 a[12:15], v56, s[12:15], s72 offen offset:3072 sc1
v_mfma_f32_16x16x32_bf16 v[88:91], v[180:183], v[196:199], v[88:91]
ds_read2_b32 v[104:105], v25 offset0:128 offset1:129
v_mfma_f32_16x16x32_bf16 v[92:95], v[184:187], v[196:199], v[92:95]
ds_read2_b32 v[106:107], v25 offset0:130 offset1:131
s_waitcnt lgkmcnt(12)
v_mfma_f32_16x16x32_bf16 v[72:75], v[160:163], v[200:203], v[72:75]
ds_read2_b32 v[108:109], v25 offset0:0 offset1:1
v_mfma_f32_16x16x32_bf16 v[76:79], v[164:167], v[200:203], v[76:79]
ds_read2_b32 v[110:111], v25 offset0:2 offset1:3
buffer_load_dwordx4 a[16:19], v57, s[12:15], s72 offen sc1
v_mfma_f32_16x16x32_bf16 v[80:83], v[168:171], v[200:203], v[80:83]
ds_read2_b32 v[112:113], v26 offset0:128 offset1:129
v_mfma_f32_16x16x32_bf16 v[84:87], v[172:175], v[200:203], v[84:87]
ds_read2_b32 v[114:115], v26 offset0:130 offset1:131
v_mfma_f32_16x16x32_bf16 v[88:91], v[176:179], v[200:203], v[88:91]
ds_read2_b32 v[116:117], v26 offset0:0 offset1:1
v_mfma_f32_16x16x32_bf16 v[92:95], v[180:183], v[200:203], v[92:95]
ds_read2_b32 v[118:119], v26 offset0:2 offset1:3
buffer_load_dwordx4 a[20:23], v56, s[12:15], s73 offen offset:0 sc1
s_waitcnt lgkmcnt(15)
v_mfma_f32_16x16x32_bf16 v[76:79], v[160:163], v[204:207], v[76:79]
ds_read2_b32 v[120:121], v27 offset0:128 offset1:129
v_mfma_f32_16x16x32_bf16 v[80:83], v[164:167], v[204:207], v[80:83]
ds_read2_b32 v[122:123], v27 offset0:130 offset1:131
v_mfma_f32_16x16x32_bf16 v[92:95], v[176:179], v[204:207], v[92:95]
ds_read2_b32 v[124:125], v27 offset0:0 offset1:1
v_mfma_f32_16x16x32_bf16 v[84:87], v[168:171], v[204:207], v[84:87]
ds_read2_b32 v[126:127], v27 offset0:2 offset1:3
buffer_load_dwordx4 a[24:27], v56, s[12:15], s73 offen offset:1024 sc1
v_mfma_f32_16x16x32_bf16 v[88:91], v[172:175], v[204:207], v[88:91]
ds_read_b128 v[132:135], v33 offset:768
v_mfma_f32_16x16x32_bf16 v[92:95], v[172:175], v[208:211], v[92:95]
ds_read_b128 v[136:139], v33 offset:1280
v_mfma_f32_16x16x32_bf16 v[80:83], v[160:163], v[208:211], v[80:83]
ds_read_b128 v[140:143], v33 offset:1792
v_mfma_f32_16x16x32_bf16 v[84:87], v[164:167], v[208:211], v[84:87]
ds_read_b128 v[144:147], v33 offset:2304
buffer_load_dwordx4 a[28:31], v56, s[12:15], s73 offen offset:2048 sc1
v_mfma_f32_16x16x32_bf16 v[92:95], v[168:171], v[212:215], v[92:95]
ds_read_b128 v[148:151], v33 offset:2816
v_mfma_f32_16x16x32_bf16 v[88:91], v[168:171], v[208:211], v[88:91]
ds_read_b128 v[152:155], v33 offset:3328
v_mfma_f32_16x16x32_bf16 v[84:87], v[160:163], v[212:215], v[84:87]
ds_read_b128 v[156:159], v33 offset:3840
s_waitcnt lgkmcnt(15)
v_mfma_f32_16x16x32_bf16 v[92:95], v[164:167], v[216:219], v[92:95]
buffer_load_dwordx4 a[32:35], v56, s[12:15], s73 offen offset:3072 sc1
v_mfma_f32_16x16x32_bf16 v[88:91], v[164:167], v[212:215], v[88:91]
v_mfma_f32_16x16x32_bf16 v[88:91], v[160:163], v[216:219], v[88:91]
v_mfma_f32_16x16x32_bf16 v[92:95], v[160:163], v[220:223], v[92:95]
v_mfma_f32_16x16x32_bf16 v[64:67], v[96:99], v[128:131], v[64:67]
buffer_load_dwordx4 a[36:39], v57, s[12:15], s73 offen sc1
v_mfma_f32_16x16x32_bf16 v[68:71], v[100:103], v[128:131], v[68:71]
v_mfma_f32_16x16x32_bf16 v[72:75], v[104:107], v[128:131], v[72:75]
v_add_u32 v28, -768, v32
v_add_u32 v29, -1792, v32
v_mfma_f32_16x16x32_bf16 v[76:79], v[108:111], v[128:131], v[76:79]
v_add_u32 v30, -2816, v32
v_add_u32 v31, -3840, v32
s_waitcnt lgkmcnt(13)
v_mfma_f32_16x16x32_bf16 v[80:83], v[112:115], v[128:131], v[80:83]
ds_read_b128 v[192:195], v33 offset:128
buffer_load_dwordx4 a[40:43], v56, s[12:15], s74 offen offset:0 sc1
s_waitcnt lgkmcnt(12)
v_mfma_f32_16x16x32_bf16 v[84:87], v[116:119], v[128:131], v[84:87]
ds_read2_b32 v[160:161], v28 offset0:128 offset1:129
s_waitcnt lgkmcnt(11)
v_mfma_f32_16x16x32_bf16 v[88:91], v[120:123], v[128:131], v[88:91]
ds_read2_b32 v[162:163], v28 offset0:130 offset1:131
s_waitcnt lgkmcnt(10)
v_mfma_f32_16x16x32_bf16 v[92:95], v[124:127], v[128:131], v[92:95]
ds_read2_b32 v[164:165], v28 offset0:0 offset1:1
s_waitcnt lgkmcnt(10)
v_mfma_f32_16x16x32_bf16 v[68:71], v[96:99], v[132:135], v[68:71]
ds_read2_b32 v[166:167], v28 offset0:2 offset1:3
buffer_load_dwordx4 a[44:47], v56, s[12:15], s74 offen offset:1024 sc1
v_mfma_f32_16x16x32_bf16 v[72:75], v[100:103], v[132:135], v[72:75]
ds_read2_b32 v[168:169], v29 offset0:128 offset1:129
v_mfma_f32_16x16x32_bf16 v[76:79], v[104:107], v[132:135], v[76:79]
ds_read2_b32 v[170:171], v29 offset0:130 offset1:131
v_mfma_f32_16x16x32_bf16 v[80:83], v[108:111], v[132:135], v[80:83]
ds_read2_b32 v[172:173], v29 offset0:0 offset1:1
v_mfma_f32_16x16x32_bf16 v[84:87], v[112:115], v[132:135], v[84:87]
ds_read2_b32 v[174:175], v29 offset0:2 offset1:3
buffer_load_dwordx4 a[48:51], v56, s[12:15], s74 offen offset:2048 sc1
v_mfma_f32_16x16x32_bf16 v[88:91], v[116:119], v[132:135], v[88:91]
ds_read2_b32 v[176:177], v30 offset0:128 offset1:129
v_mfma_f32_16x16x32_bf16 v[92:95], v[120:123], v[132:135], v[92:95]
ds_read2_b32 v[178:179], v30 offset0:130 offset1:131
s_waitcnt lgkmcnt(15)
v_mfma_f32_16x16x32_bf16 v[72:75], v[96:99], v[136:139], v[72:75]
ds_read2_b32 v[180:181], v30 offset0:0 offset1:1
v_mfma_f32_16x16x32_bf16 v[76:79], v[100:103], v[136:139], v[76:79]
ds_read2_b32 v[182:183], v30 offset0:2 offset1:3
buffer_load_dwordx4 a[52:55], v56, s[12:15], s74 offen offset:3072 sc1
v_mfma_f32_16x16x32_bf16 v[80:83], v[104:107], v[136:139], v[80:83]
ds_read2_b32 v[184:185], v31 offset0:128 offset1:129
v_mfma_f32_16x16x32_bf16 v[84:87], v[108:111], v[136:139], v[84:87]
ds_read2_b32 v[186:187], v31 offset0:130 offset1:131
v_mfma_f32_16x16x32_bf16 v[88:91], v[112:115], v[136:139], v[88:91]
ds_read2_b32 v[188:189], v31 offset0:0 offset1:1
v_mfma_f32_16x16x32_bf16 v[92:95], v[116:119], v[136:139], v[92:95]
ds_read2_b32 v[190:191], v31 offset0:2 offset1:3
buffer_load_dwordx4 a[56:59], v57, s[12:15], s74 offen sc1
v_mfma_f32_16x16x32_bf16 v[76:79], v[96:99], v[140:143], v[76:79]
ds_read_b128 v[196:199], v33 offset:640
v_mfma_f32_16x16x32_bf16 v[80:83], v[100:103], v[140:143], v[80:83]
ds_read_b128 v[200:203], v33 offset:1152
v_mfma_f32_16x16x32_bf16 v[92:95], v[112:115], v[140:143], v[92:95]
ds_read_b128 v[204:207], v33 offset:1664
v_mfma_f32_16x16x32_bf16 v[84:87], v[104:107], v[140:143], v[84:87]
ds_read_b128 v[208:211], v33 offset:2176
buffer_load_dwordx4 a[60:63], v56, s[12:15], s75 offen offset:0 sc1
v_mfma_f32_16x16x32_bf16 v[88:91], v[108:111], v[140:143], v[88:91]
ds_read_b128 v[212:215], v33 offset:2688
s_waitcnt lgkmcnt(15)
v_mfma_f32_16x16x32_bf16 v[92:95], v[108:111], v[144:147], v[92:95]
ds_read_b128 v[216:219], v33 offset:3200
v_mfma_f32_16x16x32_bf16 v[80:83], v[96:99], v[144:147], v[80:83]
ds_read_b128 v[220:223], v33 offset:3712
v_mfma_f32_16x16x32_bf16 v[84:87], v[100:103], v[144:147], v[84:87]
buffer_load_dwordx4 a[64:67], v56, s[12:15], s75 offen offset:1024 sc1
v_mfma_f32_16x16x32_bf16 v[92:95], v[104:107], v[148:151], v[92:95]
v_mfma_f32_16x16x32_bf16 v[88:91], v[104:107], v[144:147], v[88:91]
v_mfma_f32_16x16x32_bf16 v[84:87], v[96:99], v[148:151], v[84:87]
v_mfma_f32_16x16x32_bf16 v[92:95], v[100:103], v[152:155], v[92:95]
buffer_load_dwordx4 a[68:71], v56, s[12:15], s75 offen offset:2048 sc1
v_mfma_f32_16x16x32_bf16 v[88:91], v[100:103], v[148:151], v[88:91]
v_mfma_f32_16x16x32_bf16 v[88:91], v[96:99], v[152:155], v[88:91]
v_mfma_f32_16x16x32_bf16 v[92:95], v[96:99], v[156:159], v[92:95]
v_mfma_f32_16x16x32_bf16 v[64:67], v[160:163], v[192:195], v[64:67]
buffer_load_dwordx4 a[72:75], v56, s[12:15], s75 offen offset:3072 sc1
v_mfma_f32_16x16x32_bf16 v[68:71], v[164:167], v[192:195], v[68:71]
v_mfma_f32_16x16x32_bf16 v[72:75], v[168:171], v[192:195], v[72:75]
v_add_u32 v24, -896, v32
v_add_u32 v25, -1920, v32
s_waitcnt lgkmcnt(15)
v_mfma_f32_16x16x32_bf16 v[76:79], v[172:175], v[192:195], v[76:79]
v_add_u32 v26, -2944, v32
v_add_u32 v27, -3968, v32
s_waitcnt lgkmcnt(13)
v_mfma_f32_16x16x32_bf16 v[80:83], v[176:179], v[192:195], v[80:83]
ds_read_b128 v[128:131], v33 offset:0
buffer_load_dwordx4 a[76:79], v57, s[12:15], s75 offen sc1
s_waitcnt lgkmcnt(12)
v_mfma_f32_16x16x32_bf16 v[84:87], v[180:183], v[192:195], v[84:87]
ds_read2_b32 v[96:97], v24 offset0:128 offset1:129
s_waitcnt lgkmcnt(11)
v_mfma_f32_16x16x32_bf16 v[88:91], v[184:187], v[192:195], v[88:91]
ds_read2_b32 v[98:99], v24 offset0:130 offset1:131
s_waitcnt lgkmcnt(10)
v_mfma_f32_16x16x32_bf16 v[92:95], v[188:191], v[192:195], v[92:95]
ds_read2_b32 v[100:101], v24 offset0:0 offset1:1
s_waitcnt lgkmcnt(10)
v_mfma_f32_16x16x32_bf16 v[68:71], v[160:163], v[196:199], v[68:71]
ds_read2_b32 v[102:103], v24 offset0:2 offset1:3
buffer_load_dwordx4 a[80:83], v56, s[12:15], s76 offen offset:0 sc1
v_mfma_f32_16x16x32_bf16 v[72:75], v[164:167], v[196:199], v[72:75]
ds_read2_b32 v[104:105], v25 offset0:128 offset1:129
v_mfma_f32_16x16x32_bf16 v[76:79], v[168:171], v[196:199], v[76:79]
ds_read2_b32 v[106:107], v25 offset0:130 offset1:131
v_mfma_f32_16x16x32_bf16 v[80:83], v[172:175], v[196:199], v[80:83]
ds_read2_b32 v[108:109], v25 offset0:0 offset1:1
v_mfma_f32_16x16x32_bf16 v[84:87], v[176:179], v[196:199], v[84:87]
ds_read2_b32 v[110:111], v25 offset0:2 offset1:3
buffer_load_dwordx4 a[84:87], v56, s[12:15], s76 offen offset:1024 sc1
v_mfma_f32_16x16x32_bf16 v[88:91], v[180:183], v[196:199], v[88:91]
ds_read2_b32 v[112:113], v26 offset0:128 offset1:129
v_mfma_f32_16x16x32_bf16 v[92:95], v[184:187], v[196:199], v[92:95]
ds_read2_b32 v[114:115], v26 offset0:130 offset1:131
s_waitcnt lgkmcnt(15)
v_mfma_f32_16x16x32_bf16 v[72:75], v[160:163], v[200:203], v[72:75]
ds_read2_b32 v[116:117], v26 offset0:0 offset1:1
v_mfma_f32_16x16x32_bf16 v[76:79], v[164:167], v[200:203], v[76:79]
ds_read2_b32 v[118:119], v26 offset0:2 offset1:3
buffer_load_dwordx4 a[88:91], v56, s[12:15], s76 offen offset:2048 sc1
v_mfma_f32_16x16x32_bf16 v[80:83], v[168:171], v[200:203], v[80:83]
ds_read2_b32 v[120:121], v27 offset0:128 offset1:129
v_mfma_f32_16x16x32_bf16 v[84:87], v[172:175], v[200:203], v[84:87]
ds_read2_b32 v[122:123], v27 offset0:130 offset1:131
v_mfma_f32_16x16x32_bf16 v[88:91], v[176:179], v[200:203], v[88:91]
ds_read2_b32 v[124:125], v27 offset0:0 offset1:1
v_mfma_f32_16x16x32_bf16 v[92:95], v[180:183], v[200:203], v[92:95]
ds_read2_b32 v[126:127], v27 offset0:2 offset1:3
buffer_load_dwordx4 a[92:95], v56, s[12:15], s76 offen offset:3072 sc1
v_mfma_f32_16x16x32_bf16 v[76:79], v[160:163], v[204:207], v[76:79]
ds_read_b128 v[132:135], v33 offset:512
v_mfma_f32_16x16x32_bf16 v[80:83], v[164:167], v[204:207], v[80:83]
ds_read_b128 v[136:139], v33 offset:1024
v_mfma_f32_16x16x32_bf16 v[92:95], v[176:179], v[204:207], v[92:95]
ds_read_b128 v[140:143], v33 offset:1536
v_mfma_f32_16x16x32_bf16 v[84:87], v[168:171], v[204:207], v[84:87]
ds_read_b128 v[144:147], v33 offset:2048
buffer_load_dwordx4 a[96:99], v57, s[12:15], s76 offen sc1
v_mfma_f32_16x16x32_bf16 v[88:91], v[172:175], v[204:207], v[88:91]
ds_read_b128 v[148:151], v33 offset:2560
s_waitcnt lgkmcnt(15)
v_mfma_f32_16x16x32_bf16 v[92:95], v[172:175], v[208:211], v[92:95]
ds_read_b128 v[152:155], v33 offset:3072
v_mfma_f32_16x16x32_bf16 v[80:83], v[160:163], v[208:211], v[80:83]
ds_read_b128 v[156:159], v33 offset:3584
v_mfma_f32_16x16x32_bf16 v[84:87], v[164:167], v[208:211], v[84:87]
buffer_load_dwordx4 a[100:103], v56, s[12:15], s77 offen offset:0 sc1
v_mfma_f32_16x16x32_bf16 v[92:95], v[168:171], v[212:215], v[92:95]
v_mfma_f32_16x16x32_bf16 v[88:91], v[168:171], v[208:211], v[88:91]
v_mfma_f32_16x16x32_bf16 v[84:87], v[160:163], v[212:215], v[84:87]
v_mfma_f32_16x16x32_bf16 v[92:95], v[164:167], v[216:219], v[92:95]
buffer_load_dwordx4 a[104:107], v56, s[12:15], s77 offen offset:1024 sc1
v_mfma_f32_16x16x32_bf16 v[88:91], v[164:167], v[212:215], v[88:91]
v_mfma_f32_16x16x32_bf16 v[88:91], v[160:163], v[216:219], v[88:91]
v_mfma_f32_16x16x32_bf16 v[92:95], v[160:163], v[220:223], v[92:95]
v_mfma_f32_16x16x32_bf16 v[64:67], v[96:99], v[128:131], v[64:67]
buffer_load_dwordx4 a[108:111], v56, s[12:15], s77 offen offset:2048 sc1
v_mfma_f32_16x16x32_bf16 v[68:71], v[100:103], v[128:131], v[68:71]
s_waitcnt lgkmcnt(7)
v_mfma_f32_16x16x32_bf16 v[92:95], v[124:127], v[128:131], v[92:95]
s_lshr_b32 s44, s3, 1
s_mul_i32 s42, s44, 8320
s_add_u32 s44, s44, 2
s_nop 0
ds_write_b128 v34, v[64:67] offset:0
s_waitcnt lgkmcnt(7)
v_mfma_f32_16x16x32_bf16 v[68:71], v[96:99], v[132:135], v[68:71]
s_mul_i32 s43, s44, 4672
s_and_b32 s44, s3, 1
s_lshl_b32 s44, s44, 6
v_mfma_f32_16x16x32_bf16 v[72:75], v[104:107], v[128:131], v[72:75]
s_sub_u32 s42, s42, s44
s_sub_u32 s43, s43, s44
s_add_u32 s42, s42, 135134
buffer_load_dwordx4 a[112:115], v56, s[12:15], s77 offen offset:3072 sc1
v_mfma_f32_16x16x32_bf16 v[88:91], v[120:123], v[128:131], v[88:91]
s_add_u32 s43, s43, 32864
v_and_b32 v35, 1, v2
v_xor_b32 v35, 1, v35
ds_write_b128 v34, v[68:71] offset:1024
v_mfma_f32_16x16x32_bf16 v[72:75], v[100:103], v[132:135], v[72:75]
v_mul_u32_u24 v35, 4158, v35
v_lshl_add_u32 v35, v3, 4, v35
v_lshlrev_b32 v32, 1, v2
v_mfma_f32_16x16x32_bf16 v[92:95], v[120:123], v[132:135], v[92:95]
v_sub_u32 v35, v35, v32
v_add_u32 v32, s42, v35
v_lshl_add_u32 v35, v2, 5, s43
s_waitcnt lgkmcnt(7)
v_mfma_f32_16x16x32_bf16 v[72:75], v[96:99], v[136:139], v[72:75]
v_lshl_add_u32 v33, v3, 4, v35
buffer_load_dwordx4 a[116:119], v57, s[12:15], s77 offen sc1
v_mfma_f32_16x16x32_bf16 v[76:79], v[108:111], v[128:131], v[76:79]
v_add_u32 v28, -512, v32
v_add_u32 v29, -1536, v32
v_mfma_f32_16x16x32_bf16 v[84:87], v[116:119], v[128:131], v[84:87]
v_add_u32 v30, -2560, v32
v_add_u32 v31, -3584, v32
ds_write_b128 v34, v[72:75] offset:2048
v_mfma_f32_16x16x32_bf16 v[76:79], v[104:107], v[132:135], v[76:79]
ds_read_b128 v[192:195], v33 offset:384
v_mfma_f32_16x16x32_bf16 v[88:91], v[116:119], v[132:135], v[88:91]
ds_read2_b32 v[160:161], v28 offset0:128 offset1:129
buffer_load_dwordx4 a[120:123], v56, s[12:15], s78 offen offset:0 sc1
v_mfma_f32_16x16x32_bf16 v[76:79], v[100:103], v[136:139], v[76:79]
ds_read2_b32 v[162:163], v28 offset0:130 offset1:131
v_mfma_f32_16x16x32_bf16 v[92:95], v[116:119], v[136:139], v[92:95]
ds_read2_b32 v[164:165], v28 offset0:0 offset1:1
s_waitcnt lgkmcnt(11)
v_mfma_f32_16x16x32_bf16 v[76:79], v[96:99], v[140:143], v[76:79]
ds_read2_b32 v[166:167], v28 offset0:2 offset1:3
v_mfma_f32_16x16x32_bf16 v[80:83], v[112:115], v[128:131], v[80:83]
ds_read2_b32 v[168:169], v29 offset0:128 offset1:129
buffer_load_dwordx4 a[124:127], v56, s[12:15], s78 offen offset:1024 sc1
v_mfma_f32_16x16x32_bf16 v[84:87], v[112:115], v[132:135], v[84:87]
ds_read2_b32 v[170:171], v29 offset0:130 offset1:131
s_nop 1
ds_write_b128 v34, v[76:79] offset:3072
v_mfma_f32_16x16x32_bf16 v[80:83], v[108:111], v[132:135], v[80:83]
ds_read2_b32 v[172:173], v29 offset0:0 offset1:1
v_mfma_f32_16x16x32_bf16 v[88:91], v[112:115], v[136:139], v[88:91]
ds_read2_b32 v[174:175], v29 offset0:2 offset1:3
v_mfma_f32_16x16x32_bf16 v[80:83], v[104:107], v[136:139], v[80:83]
ds_read2_b32 v[176:177], v30 offset0:128 offset1:129
buffer_load_dwordx4 a[128:131], v56, s[12:15], s78 offen offset:2048 sc1
v_mfma_f32_16x16x32_bf16 v[92:95], v[112:115], v[140:143], v[92:95]
ds_read2_b32 v[178:179], v30 offset0:130 offset1:131
v_mfma_f32_16x16x32_bf16 v[80:83], v[100:103], v[140:143], v[80:83]
ds_read2_b32 v[180:181], v30 offset0:0 offset1:1
v_mfma_f32_16x16x32_bf16 v[84:87], v[108:111], v[136:139], v[84:87]
ds_read2_b32 v[182:183], v30 offset0:2 offset1:3
s_waitcnt lgkmcnt(15)
v_mfma_f32_16x16x32_bf16 v[80:83], v[96:99], v[144:147], v[80:83]
ds_read2_b32 v[184:185], v31 offset0:128 offset1:129
buffer_load_dwordx4 a[132:135], v56, s[12:15], s78 offen offset:3072 sc1
v_mfma_f32_16x16x32_bf16 v[84:87], v[104:107], v[140:143], v[84:87]
ds_read2_b32 v[186:187], v31 offset0:130 offset1:131
v_mfma_f32_16x16x32_bf16 v[88:91], v[108:111], v[140:143], v[88:91]
ds_read2_b32 v[188:189], v31 offset0:0 offset1:1
s_nop 1
ds_write_b128 v34, v[80:83] offset:4096
v_mfma_f32_16x16x32_bf16 v[84:87], v[100:103], v[144:147], v[84:87]
ds_read2_b32 v[190:191], v31 offset0:2 offset1:3
v_mfma_f32_16x16x32_bf16 v[92:95], v[108:111], v[144:147], v[92:95]
ds_read_b128 v[196:199], v33 offset:896
buffer_load_dwordx4 a[136:139], v57, s[12:15], s78 offen sc1
v_mfma_f32_16x16x32_bf16 v[84:87], v[96:99], v[148:151], v[84:87]
ds_read_b128 v[200:203], v33 offset:1408
v_mfma_f32_16x16x32_bf16 v[88:91], v[104:107], v[144:147], v[88:91]
ds_read_b128 v[204:207], v33 offset:1920
v_mfma_f32_16x16x32_bf16 v[92:95], v[104:107], v[148:151], v[92:95]
ds_read_b128 v[208:211], v33 offset:2432
s_nop 2
ds_write_b128 v34, v[84:87] offset:5120
v_mfma_f32_16x16x32_bf16 v[88:91], v[100:103], v[148:151], v[88:91]
ds_read_b128 v[212:215], v33 offset:2944
buffer_load_dwordx4 a[140:143], v56, s[12:15], s79 offen offset:0 sc1
v_mfma_f32_16x16x32_bf16 v[92:95], v[100:103], v[152:155], v[92:95]
ds_read_b128 v[216:219], v33 offset:3456
v_mfma_f32_16x16x32_bf16 v[88:91], v[96:99], v[152:155], v[88:91]
ds_read_b128 v[220:223], v33 offset:3968
v_mfma_f32_16x16x32_bf16 v[92:95], v[96:99], v[156:159], v[92:95]
s_nop 5
ds_write_b128 v34, v[88:91] offset:6144
s_nop 0
ds_write_b128 v34, v[92:95] offset:7168
buffer_load_dwordx4 a[144:147], v56, s[12:15], s79 offen offset:1024 sc1
buffer_load_dwordx4 a[148:151], v56, s[12:15], s79 offen offset:2048 sc1
s_lshl_b32 s101, s3, 10
s_add_u32 s101, s101, 53248
v_and_b32 v25, 1, v1
v_bfe_u32 v26, v1, 1, 1
v_lshrrev_b32 v27, 2, v1
v_lshl_add_u32 v27, v25, 3, v27
v_and_b32 v27, 15, v27
v_mul_u32_u24 v26, 16448, v26
v_lshl_add_u32 v26, v25, 9, v26
v_lshl_add_u32 v26, v27, 4, v26
v_add_u32 v26, s101, v26
v_lshrrev_b32 v27, 2, v0
v_mul_u32_u24 v27, 20480, v27
v_and_b32 v25, 3, v0
v_lshl_add_u32 v27, v25, 4, v27
s_add_u32 s101, s24, 0
s_lshl_b32 s51, s101, 6
s_add_u32 s51, s51, 13631488
s_add_u32 s52, s51, 1310720
s_lshl_b32 s50, s101, 7
s_add_u32 s50, s50, 16973824
s_waitcnt lgkmcnt(0)
s_barrier
ds_read_b128 v[96:99], v26 offset:0
ds_read_b128 v[100:103], v26 offset:256
ds_read_b128 v[104:107], v26 offset:8192
ds_read_b128 v[108:111], v26 offset:8448
ds_read_b128 v[112:115], v26 offset:4096
ds_read_b128 v[116:119], v26 offset:4352
ds_read_b128 v[120:123], v26 offset:12288
ds_read_b128 v[124:127], v26 offset:12544
s_waitcnt lgkmcnt(4)
v_pk_add_f32 v[96:97], v[96:97], v[104:105]
v_pk_add_f32 v[98:99], v[98:99], v[106:107]
v_pk_add_f32 v[100:101], v[100:101], v[108:109]
v_pk_add_f32 v[102:103], v[102:103], v[110:111]
v_cvt_pk_bf16_f32 v128, v96, v97
v_cvt_pk_bf16_f32 v129, v98, v99
v_cvt_pk_bf16_f32 v130, v100, v101
v_cvt_pk_bf16_f32 v131, v102, v103
buffer_store_dwordx4 v[128:131], v27, s[12:15], s51 offen sc1
s_waitcnt lgkmcnt(0)
v_pk_add_f32 v[112:113], v[112:113], v[120:121]
v_pk_add_f32 v[114:115], v[114:115], v[122:123]
v_pk_add_f32 v[116:117], v[116:117], v[124:125]
v_pk_add_f32 v[118:119], v[118:119], v[126:127]
v_cvt_pk_bf16_f32 v132, v112, v113
v_cvt_pk_bf16_f32 v133, v114, v115
v_cvt_pk_bf16_f32 v134, v116, v117
v_cvt_pk_bf16_f32 v135, v118, v119
buffer_store_dwordx4 v[132:135], v27, s[12:15], s52 offen sc1
v_mfma_f32_16x16x32_bf16 v[64:67], v[160:163], v[192:195], 0
s_mul_i32 s100, s26, 160
v_lshl_add_u32 v12, v3, 3, s100
v_mfma_f32_16x16x32_bf16 v[68:71], v[164:167], v[192:195], 0
v_mfma_f32_16x16x32_bf16 v[72:75], v[168:171], v[192:195], 0
v_mfma_f32_16x16x32_bf16 v[76:79], v[172:175], v[192:195], 0
v_mfma_f32_16x16x32_bf16 v[80:83], v[176:179], v[192:195], 0
global_load_dwordx2 v[46:47], v12, s[62:63] offset:0
v_mfma_f32_16x16x32_bf16 v[84:87], v[180:183], v[192:195], 0
v_mfma_f32_16x16x32_bf16 v[88:91], v[184:187], v[192:195], 0
v_add_u32 v24, -640, v32
v_add_u32 v25, -1664, v32
v_mfma_f32_16x16x32_bf16 v[92:95], v[188:191], v[192:195], 0
v_add_u32 v26, -2688, v32
v_add_u32 v27, -3712, v32
v_mfma_f32_16x16x32_bf16 v[68:71], v[160:163], v[196:199], v[68:71]
ds_read_b128 v[128:131], v33 offset:256
global_load_dwordx2 v[48:49], v12, s[62:63] offset:32
v_mfma_f32_16x16x32_bf16 v[72:75], v[164:167], v[196:199], v[72:75]
ds_read2_b32 v[96:97], v24 offset0:128 offset1:129
v_mfma_f32_16x16x32_bf16 v[76:79], v[168:171], v[196:199], v[76:79]
ds_read2_b32 v[98:99], v24 offset0:130 offset1:131
v_mfma_f32_16x16x32_bf16 v[80:83], v[172:175], v[196:199], v[80:83]
ds_read2_b32 v[100:101], v24 offset0:0 offset1:1
v_mfma_f32_16x16x32_bf16 v[84:87], v[176:179], v[196:199], v[84:87]
ds_read2_b32 v[102:103], v24 offset0:2 offset1:3
global_load_dwordx2 v[50:51], v12, s[62:63] offset:64
v_mfma_f32_16x16x32_bf16 v[88:91], v[180:183], v[196:199], v[88:91]
ds_read2_b32 v[104:105], v25 offset0:128 offset1:129
v_mfma_f32_16x16x32_bf16 v[92:95], v[184:187], v[196:199], v[92:95]
ds_read2_b32 v[106:107], v25 offset0:130 offset1:131
v_mfma_f32_16x16x32_bf16 v[72:75], v[160:163], v[200:203], v[72:75]
ds_read2_b32 v[108:109], v25 offset0:0 offset1:1
v_mfma_f32_16x16x32_bf16 v[76:79], v[164:167], v[200:203], v[76:79]
ds_read2_b32 v[110:111], v25 offset0:2 offset1:3
global_load_dwordx2 v[52:53], v12, s[62:63] offset:96
v_mfma_f32_16x16x32_bf16 v[80:83], v[168:171], v[200:203], v[80:83]
ds_read2_b32 v[112:113], v26 offset0:128 offset1:129
v_mfma_f32_16x16x32_bf16 v[84:87], v[172:175], v[200:203], v[84:87]
ds_read2_b32 v[114:115], v26 offset0:130 offset1:131
v_mfma_f32_16x16x32_bf16 v[88:91], v[176:179], v[200:203], v[88:91]
ds_read2_b32 v[116:117], v26 offset0:0 offset1:1
v_mfma_f32_16x16x32_bf16 v[92:95], v[180:183], v[200:203], v[92:95]
ds_read2_b32 v[118:119], v26 offset0:2 offset1:3
global_load_dwordx2 v[54:55], v12, s[62:63] offset:128
v_mfma_f32_16x16x32_bf16 v[76:79], v[160:163], v[204:207], v[76:79]
ds_read2_b32 v[120:121], v27 offset0:128 offset1:129
v_mfma_f32_16x16x32_bf16 v[80:83], v[164:167], v[204:207], v[80:83]
ds_read2_b32 v[122:123], v27 offset0:130 offset1:131
v_mfma_f32_16x16x32_bf16 v[92:95], v[176:179], v[204:207], v[92:95]
ds_read2_b32 v[124:125], v27 offset0:0 offset1:1
v_mfma_f32_16x16x32_bf16 v[84:87], v[168:171], v[204:207], v[84:87]
ds_read2_b32 v[126:127], v27 offset0:2 offset1:3
buffer_load_dwordx4 a[152:155], v56, s[12:15], s79 offen offset:3072 sc1
v_mfma_f32_16x16x32_bf16 v[88:91], v[172:175], v[204:207], v[88:91]
ds_read_b128 v[132:135], v33 offset:768
v_mfma_f32_16x16x32_bf16 v[92:95], v[172:175], v[208:211], v[92:95]
ds_read_b128 v[136:139], v33 offset:1280
v_mfma_f32_16x16x32_bf16 v[80:83], v[160:163], v[208:211], v[80:83]
ds_read_b128 v[140:143], v33 offset:1792
v_mfma_f32_16x16x32_bf16 v[84:87], v[164:167], v[208:211], v[84:87]
ds_read_b128 v[144:147], v33 offset:2304
buffer_load_dwordx4 a[156:159], v57, s[12:15], s79 offen sc1
v_mfma_f32_16x16x32_bf16 v[92:95], v[168:171], v[212:215], v[92:95]
ds_read_b128 v[148:151], v33 offset:2816
v_mfma_f32_16x16x32_bf16 v[88:91], v[168:171], v[208:211], v[88:91]
ds_read_b128 v[152:155], v33 offset:3328
v_mfma_f32_16x16x32_bf16 v[84:87], v[160:163], v[212:215], v[84:87]
ds_read_b128 v[156:159], v33 offset:3840
v_mfma_f32_16x16x32_bf16 v[92:95], v[164:167], v[216:219], v[92:95]
buffer_load_dwordx4 a[160:163], v56, s[12:15], s80 offen offset:0 sc1
v_mfma_f32_16x16x32_bf16 v[88:91], v[164:167], v[212:215], v[88:91]
v_mfma_f32_16x16x32_bf16 v[88:91], v[160:163], v[216:219], v[88:91]
v_mfma_f32_16x16x32_bf16 v[92:95], v[160:163], v[220:223], v[92:95]
s_waitcnt lgkmcnt(15)
v_mfma_f32_16x16x32_bf16 v[64:67], v[96:99], v[128:131], v[64:67]
buffer_load_dwordx4 a[164:167], v56, s[12:15], s80 offen offset:1024 sc1
v_mfma_f32_16x16x32_bf16 v[68:71], v[100:103], v[128:131], v[68:71]
v_mfma_f32_16x16x32_bf16 v[72:75], v[104:107], v[128:131], v[72:75]
v_add_u32 v28, -768, v32
v_add_u32 v29, -1792, v32
v_mfma_f32_16x16x32_bf16 v[76:79], v[108:111], v[128:131], v[76:79]
v_add_u32 v30, -2816, v32
v_add_u32 v31, -3840, v32
s_waitcnt lgkmcnt(13)
v_mfma_f32_16x16x32_bf16 v[80:83], v[112:115], v[128:131], v[80:83]
ds_read_b128 v[192:195], v33 offset:128
buffer_load_dwordx4 a[168:171], v56, s[12:15], s80 offen offset:2048 sc1
s_waitcnt lgkmcnt(12)
v_mfma_f32_16x16x32_bf16 v[84:87], v[116:119], v[128:131], v[84:87]
ds_read2_b32 v[160:161], v28 offset0:128 offset1:129
s_waitcnt lgkmcnt(11)
v_mfma_f32_16x16x32_bf16 v[88:91], v[120:123], v[128:131], v[88:91]
ds_read2_b32 v[162:163], v28 offset0:130 offset1:131
s_waitcnt lgkmcnt(10)
v_mfma_f32_16x16x32_bf16 v[92:95], v[124:127], v[128:131], v[92:95]
ds_read2_b32 v[164:165], v28 offset0:0 offset1:1
s_waitcnt lgkmcnt(10)
v_mfma_f32_16x16x32_bf16 v[68:71], v[96:99], v[132:135], v[68:71]
ds_read2_b32 v[166:167], v28 offset0:2 offset1:3
buffer_load_dwordx4 a[172:175], v56, s[12:15], s80 offen offset:3072 sc1
v_mfma_f32_16x16x32_bf16 v[72:75], v[100:103], v[132:135], v[72:75]
ds_read2_b32 v[168:169], v29 offset0:128 offset1:129
v_mfma_f32_16x16x32_bf16 v[76:79], v[104:107], v[132:135], v[76:79]
ds_read2_b32 v[170:171], v29 offset0:130 offset1:131
v_mfma_f32_16x16x32_bf16 v[80:83], v[108:111], v[132:135], v[80:83]
ds_read2_b32 v[172:173], v29 offset0:0 offset1:1
buffer_load_dwordx4 a[176:179], v57, s[12:15], s80 offen sc1
v_mfma_f32_16x16x32_bf16 v[84:87], v[112:115], v[132:135], v[84:87]
ds_read2_b32 v[174:175], v29 offset0:2 offset1:3
v_mfma_f32_16x16x32_bf16 v[88:91], v[116:119], v[132:135], v[88:91]
ds_read2_b32 v[176:177], v30 offset0:128 offset1:129
v_mfma_f32_16x16x32_bf16 v[92:95], v[120:123], v[132:135], v[92:95]
ds_read2_b32 v[178:179], v30 offset0:130 offset1:131
s_waitcnt lgkmcnt(15)
v_mfma_f32_16x16x32_bf16 v[72:75], v[96:99], v[136:139], v[72:75]
ds_read2_b32 v[180:181], v30 offset0:0 offset1:1
buffer_load_dwordx4 a[180:183], v56, s[12:15], s81 offen offset:0 sc1
v_mfma_f32_16x16x32_bf16 v[76:79], v[100:103], v[136:139], v[76:79]
ds_read2_b32 v[182:183], v30 offset0:2 offset1:3
v_mfma_f32_16x16x32_bf16 v[80:83], v[104:107], v[136:139], v[80:83]
ds_read2_b32 v[184:185], v31 offset0:128 offset1:129
v_mfma_f32_16x16x32_bf16 v[84:87], v[108:111], v[136:139], v[84:87]
ds_read2_b32 v[186:187], v31 offset0:130 offset1:131
buffer_load_dwordx4 a[184:187], v56, s[12:15], s81 offen offset:1024 sc1
v_mfma_f32_16x16x32_bf16 v[88:91], v[112:115], v[136:139], v[88:91]
ds_read2_b32 v[188:189], v31 offset0:0 offset1:1
v_mfma_f32_16x16x32_bf16 v[92:95], v[116:119], v[136:139], v[92:95]
ds_read2_b32 v[190:191], v31 offset0:2 offset1:3
v_mfma_f32_16x16x32_bf16 v[76:79], v[96:99], v[140:143], v[76:79]
ds_read_b128 v[196:199], v33 offset:640
v_mfma_f32_16x16x32_bf16 v[80:83], v[100:103], v[140:143], v[80:83]
ds_read_b128 v[200:203], v33 offset:1152
buffer_load_dwordx4 a[188:191], v56, s[12:15], s81 offen offset:2048 sc1
v_mfma_f32_16x16x32_bf16 v[92:95], v[112:115], v[140:143], v[92:95]
ds_read_b128 v[204:207], v33 offset:1664
v_mfma_f32_16x16x32_bf16 v[84:87], v[104:107], v[140:143], v[84:87]
ds_read_b128 v[208:211], v33 offset:2176
v_mfma_f32_16x16x32_bf16 v[88:91], v[108:111], v[140:143], v[88:91]
ds_read_b128 v[212:215], v33 offset:2688
s_waitcnt lgkmcnt(15)
v_mfma_f32_16x16x32_bf16 v[92:95], v[108:111], v[144:147], v[92:95]
ds_read_b128 v[216:219], v33 offset:3200
buffer_load_dwordx4 a[192:195], v56, s[12:15], s81 offen offset:3072 sc1
v_mfma_f32_16x16x32_bf16 v[80:83], v[96:99], v[144:147], v[80:83]
ds_read_b128 v[220:223], v33 offset:3712
v_mfma_f32_16x16x32_bf16 v[84:87], v[100:103], v[144:147], v[84:87]
v_mfma_f32_16x16x32_bf16 v[92:95], v[104:107], v[148:151], v[92:95]
buffer_load_dwordx4 a[196:199], v57, s[12:15], s81 offen sc1
v_mfma_f32_16x16x32_bf16 v[88:91], v[104:107], v[144:147], v[88:91]
v_mfma_f32_16x16x32_bf16 v[84:87], v[96:99], v[148:151], v[84:87]
v_mfma_f32_16x16x32_bf16 v[92:95], v[100:103], v[152:155], v[92:95]
v_mfma_f32_16x16x32_bf16 v[88:91], v[100:103], v[148:151], v[88:91]
buffer_load_dwordx4 a[200:203], v56, s[12:15], s82 offen offset:0 sc1
v_mfma_f32_16x16x32_bf16 v[88:91], v[96:99], v[152:155], v[88:91]
v_mfma_f32_16x16x32_bf16 v[92:95], v[96:99], v[156:159], v[92:95]
s_waitcnt vmcnt(18)
s_barrier
buffer_store_dwordx2 v[10:11], v63, s[12:15], s50 offen sc1
v_mfma_f32_16x16x32_bf16 v[64:67], v[160:163], v[192:195], v[64:67]
buffer_load_dwordx4 a[204:207], v56, s[12:15], s82 offen offset:1024 sc1
v_mfma_f32_16x16x32_bf16 v[68:71], v[164:167], v[192:195], v[68:71]
v_mfma_f32_16x16x32_bf16 v[72:75], v[168:171], v[192:195], v[72:75]
v_add_u32 v24, -896, v32
v_add_u32 v25, -1920, v32
s_waitcnt lgkmcnt(15)
v_mfma_f32_16x16x32_bf16 v[76:79], v[172:175], v[192:195], v[76:79]
v_add_u32 v26, -2944, v32
v_add_u32 v27, -3968, v32
s_waitcnt lgkmcnt(13)
v_mfma_f32_16x16x32_bf16 v[80:83], v[176:179], v[192:195], v[80:83]
ds_read_b128 v[128:131], v33 offset:0
buffer_load_dwordx4 a[208:211], v56, s[12:15], s82 offen offset:2048 sc1
s_waitcnt lgkmcnt(12)
v_mfma_f32_16x16x32_bf16 v[84:87], v[180:183], v[192:195], v[84:87]
ds_read2_b32 v[96:97], v24 offset0:128 offset1:129
s_waitcnt lgkmcnt(11)
v_mfma_f32_16x16x32_bf16 v[88:91], v[184:187], v[192:195], v[88:91]
ds_read2_b32 v[98:99], v24 offset0:130 offset1:131
s_waitcnt lgkmcnt(10)
v_mfma_f32_16x16x32_bf16 v[92:95], v[188:191], v[192:195], v[92:95]
ds_read2_b32 v[100:101], v24 offset0:0 offset1:1
s_waitcnt lgkmcnt(10)
v_mfma_f32_16x16x32_bf16 v[68:71], v[160:163], v[196:199], v[68:71]
ds_read2_b32 v[102:103], v24 offset0:2 offset1:3
buffer_load_dwordx4 a[212:215], v56, s[12:15], s82 offen offset:3072 sc1
v_mfma_f32_16x16x32_bf16 v[72:75], v[164:167], v[196:199], v[72:75]
ds_read2_b32 v[104:105], v25 offset0:128 offset1:129
v_mfma_f32_16x16x32_bf16 v[76:79], v[168:171], v[196:199], v[76:79]
ds_read2_b32 v[106:107], v25 offset0:130 offset1:131
v_mfma_f32_16x16x32_bf16 v[80:83], v[172:175], v[196:199], v[80:83]
ds_read2_b32 v[108:109], v25 offset0:0 offset1:1
buffer_load_dwordx4 a[216:219], v57, s[12:15], s82 offen sc1
v_mfma_f32_16x16x32_bf16 v[84:87], v[176:179], v[196:199], v[84:87]
ds_read2_b32 v[110:111], v25 offset0:2 offset1:3
v_mfma_f32_16x16x32_bf16 v[88:91], v[180:183], v[196:199], v[88:91]
ds_read2_b32 v[112:113], v26 offset0:128 offset1:129
v_mfma_f32_16x16x32_bf16 v[92:95], v[184:187], v[196:199], v[92:95]
ds_read2_b32 v[114:115], v26 offset0:130 offset1:131
s_waitcnt lgkmcnt(15)
v_mfma_f32_16x16x32_bf16 v[72:75], v[160:163], v[200:203], v[72:75]
ds_read2_b32 v[116:117], v26 offset0:0 offset1:1
buffer_load_dwordx4 a[220:223], v56, s[12:15], s83 offen offset:0 sc1
v_mfma_f32_16x16x32_bf16 v[76:79], v[164:167], v[200:203], v[76:79]
ds_read2_b32 v[118:119], v26 offset0:2 offset1:3
v_mfma_f32_16x16x32_bf16 v[80:83], v[168:171], v[200:203], v[80:83]
ds_read2_b32 v[120:121], v27 offset0:128 offset1:129
v_mfma_f32_16x16x32_bf16 v[84:87], v[172:175], v[200:203], v[84:87]
ds_read2_b32 v[122:123], v27 offset0:130 offset1:131
buffer_load_dwordx4 a[224:227], v56, s[12:15], s83 offen offset:1024 sc1
v_mfma_f32_16x16x32_bf16 v[88:91], v[176:179], v[200:203], v[88:91]
ds_read2_b32 v[124:125], v27 offset0:0 offset1:1
v_mfma_f32_16x16x32_bf16 v[92:95], v[180:183], v[200:203], v[92:95]
ds_read2_b32 v[126:127], v27 offset0:2 offset1:3
v_mfma_f32_16x16x32_bf16 v[76:79], v[160:163], v[204:207], v[76:79]
ds_read_b128 v[132:135], v33 offset:512
v_mfma_f32_16x16x32_bf16 v[80:83], v[164:167], v[204:207], v[80:83]
ds_read_b128 v[136:139], v33 offset:1024
buffer_load_dwordx4 a[228:231], v56, s[12:15], s83 offen offset:2048 sc1
v_mfma_f32_16x16x32_bf16 v[92:95], v[176:179], v[204:207], v[92:95]
ds_read_b128 v[140:143], v33 offset:1536
v_mfma_f32_16x16x32_bf16 v[84:87], v[168:171], v[204:207], v[84:87]
ds_read_b128 v[144:147], v33 offset:2048
v_mfma_f32_16x16x32_bf16 v[88:91], v[172:175], v[204:207], v[88:91]
ds_read_b128 v[148:151], v33 offset:2560
s_waitcnt lgkmcnt(15)
v_mfma_f32_16x16x32_bf16 v[92:95], v[172:175], v[208:211], v[92:95]
ds_read_b128 v[152:155], v33 offset:3072
buffer_load_dwordx4 a[232:235], v56, s[12:15], s83 offen offset:3072 sc1
v_mfma_f32_16x16x32_bf16 v[80:83], v[160:163], v[208:211], v[80:83]
ds_read_b128 v[156:159], v33 offset:3584
v_mfma_f32_16x16x32_bf16 v[84:87], v[164:167], v[208:211], v[84:87]
v_mfma_f32_16x16x32_bf16 v[92:95], v[168:171], v[212:215], v[92:95]
buffer_load_dwordx4 a[236:239], v57, s[12:15], s83 offen sc1
v_mfma_f32_16x16x32_bf16 v[88:91], v[168:171], v[208:211], v[88:91]
v_mfma_f32_16x16x32_bf16 v[84:87], v[160:163], v[212:215], v[84:87]
v_mfma_f32_16x16x32_bf16 v[92:95], v[164:167], v[216:219], v[92:95]
v_mfma_f32_16x16x32_bf16 v[88:91], v[164:167], v[212:215], v[88:91]
buffer_load_dwordx4 a[240:243], v56, s[12:15], s84 offen offset:0 sc1
v_mfma_f32_16x16x32_bf16 v[88:91], v[160:163], v[216:219], v[88:91]
v_mfma_f32_16x16x32_bf16 v[92:95], v[160:163], v[220:223], v[92:95]
v_mfma_f32_16x16x32_bf16 v[64:67], v[96:99], v[128:131], v[64:67]
buffer_load_dwordx4 a[244:247], v56, s[12:15], s84 offen offset:1024 sc1
v_mfma_f32_16x16x32_bf16 v[68:71], v[100:103], v[128:131], v[68:71]
s_waitcnt lgkmcnt(7)
v_mfma_f32_16x16x32_bf16 v[92:95], v[124:127], v[128:131], v[92:95]
s_nop 3
ds_write_b128 v34, v[64:67] offset:0
s_waitcnt lgkmcnt(7)
v_mfma_f32_16x16x32_bf16 v[68:71], v[96:99], v[132:135], v[68:71]
v_mfma_f32_16x16x32_bf16 v[72:75], v[104:107], v[128:131], v[72:75]
buffer_load_dwordx4 a[248:251], v56, s[12:15], s84 offen offset:2048 sc1
v_mfma_f32_16x16x32_bf16 v[88:91], v[120:123], v[128:131], v[88:91]
s_nop 4
ds_write_b128 v34, v[68:71] offset:1024
v_mfma_f32_16x16x32_bf16 v[72:75], v[100:103], v[132:135], v[72:75]
v_mfma_f32_16x16x32_bf16 v[92:95], v[120:123], v[132:135], v[92:95]
s_waitcnt lgkmcnt(7)
v_mfma_f32_16x16x32_bf16 v[72:75], v[96:99], v[136:139], v[72:75]
buffer_load_dwordx4 a[252:255], v56, s[12:15], s84 offen offset:3072 sc1
v_mfma_f32_16x16x32_bf16 v[76:79], v[108:111], v[128:131], v[76:79]
v_mfma_f32_16x16x32_bf16 v[84:87], v[116:119], v[128:131], v[84:87]
s_nop 4
ds_write_b128 v34, v[72:75] offset:2048
v_mfma_f32_16x16x32_bf16 v[76:79], v[104:107], v[132:135], v[76:79]
s_lshr_b32 s100, s25, 1
s_lshl_b32 s100, s100, 11
s_add_u32 s100, s100, 16842752
v_lshl_add_u32 v13, v2, 7, s100
buffer_load_dwordx2 v[14:15], v13, s[12:15], 0 offen sc1
v_mfma_f32_16x16x32_bf16 v[88:91], v[116:119], v[132:135], v[88:91]
v_mfma_f32_16x16x32_bf16 v[76:79], v[100:103], v[136:139], v[76:79]
v_mfma_f32_16x16x32_bf16 v[92:95], v[116:119], v[136:139], v[92:95]
s_waitcnt lgkmcnt(7)
v_mfma_f32_16x16x32_bf16 v[76:79], v[96:99], v[140:143], v[76:79]
buffer_load_dwordx4 v[232:235], v57, s[12:15], s84 offen sc1
v_mfma_f32_16x16x32_bf16 v[80:83], v[112:115], v[128:131], v[80:83]
v_mfma_f32_16x16x32_bf16 v[84:87], v[112:115], v[132:135], v[84:87]
s_nop 4
ds_write_b128 v34, v[76:79] offset:3072
v_mfma_f32_16x16x32_bf16 v[80:83], v[108:111], v[132:135], v[80:83]
buffer_load_dwordx4 v[236:239], v56, s[12:15], s85 offen offset:0 sc1
v_mfma_f32_16x16x32_bf16 v[88:91], v[112:115], v[136:139], v[88:91]
v_mfma_f32_16x16x32_bf16 v[80:83], v[104:107], v[136:139], v[80:83]
v_mfma_f32_16x16x32_bf16 v[92:95], v[112:115], v[140:143], v[92:95]
v_mfma_f32_16x16x32_bf16 v[80:83], v[100:103], v[140:143], v[80:83]
buffer_load_dwordx4 v[240:243], v56, s[12:15], s85 offen offset:1024 sc1
v_mfma_f32_16x16x32_bf16 v[84:87], v[108:111], v[136:139], v[84:87]
s_waitcnt lgkmcnt(7)
v_mfma_f32_16x16x32_bf16 v[80:83], v[96:99], v[144:147], v[80:83]
v_mfma_f32_16x16x32_bf16 v[84:87], v[104:107], v[140:143], v[84:87]
v_mfma_f32_16x16x32_bf16 v[88:91], v[108:111], v[140:143], v[88:91]
s_nop 5
ds_write_b128 v34, v[80:83] offset:4096
buffer_load_dwordx4 v[244:247], v56, s[12:15], s85 offen offset:2048 sc1
v_mfma_f32_16x16x32_bf16 v[84:87], v[100:103], v[144:147], v[84:87]
v_mfma_f32_16x16x32_bf16 v[92:95], v[108:111], v[144:147], v[92:95]
s_waitcnt lgkmcnt(7)
v_mfma_f32_16x16x32_bf16 v[84:87], v[96:99], v[148:151], v[84:87]
buffer_load_dwordx4 v[248:251], v56, s[12:15], s85 offen offset:3072 sc1
v_mfma_f32_16x16x32_bf16 v[88:91], v[104:107], v[144:147], v[88:91]
v_mfma_f32_16x16x32_bf16 v[92:95], v[104:107], v[148:151], v[92:95]
s_nop 4
ds_write_b128 v34, v[84:87] offset:5120
v_mfma_f32_16x16x32_bf16 v[88:91], v[100:103], v[148:151], v[88:91]
s_waitcnt lgkmcnt(7)
v_mfma_f32_16x16x32_bf16 v[92:95], v[100:103], v[152:155], v[92:95]
buffer_load_dwordx4 v[252:255], v57, s[12:15], s85 offen sc1
v_mfma_f32_16x16x32_bf16 v[88:91], v[96:99], v[152:155], v[88:91]
s_waitcnt lgkmcnt(6)
v_mfma_f32_16x16x32_bf16 v[92:95], v[96:99], v[156:159], v[92:95]
s_waitcnt vmcnt(6)
v_cmp_ne_u64 vcc, v[14:15], s[20:21]
s_nop 3
s_mov_b64 s[46:47], vcc
s_cmp_eq_u64 s[46:47], 0
s_cselect_b32 s42, s86, 2146435072
s_cselect_b32 s43, s87, 2146435072
s_cselect_b32 s44, s88, 2146435072
s_cselect_b32 s45, s89, 2146435072
ds_write_b128 v34, v[88:91] offset:6144
ds_write_b128 v34, v[92:95] offset:7168
buffer_load_dwordx4 v[144:147], v58, s[12:15], s42 offen sc1
buffer_load_dwordx4 v[148:151], v59, s[12:15], s42 offen sc1
s_lshl_b32 s101, s3, 10
s_add_u32 s101, s101, 53248
buffer_load_dwordx4 v[152:155], v60, s[12:15], s42 offen sc1
v_and_b32 v25, 1, v1
v_bfe_u32 v26, v1, 1, 1
v_lshrrev_b32 v27, 2, v1
buffer_load_dwordx4 v[156:159], v61, s[12:15], s42 offen sc1
v_lshl_add_u32 v27, v25, 3, v27
v_and_b32 v27, 15, v27
v_mul_u32_u24 v26, 16448, v26
v_lshl_add_u32 v26, v25, 9, v26
v_lshl_add_u32 v26, v27, 4, v26
v_add_u32 v26, s101, v26
v_lshrrev_b32 v27, 2, v0
v_mul_u32_u24 v27, 20480, v27
v_and_b32 v25, 3, v0
v_lshl_add_u32 v27, v25, 4, v27
s_add_u32 s101, s24, 1
s_lshl_b32 s51, s101, 6
s_add_u32 s51, s51, 13631488
s_add_u32 s52, s51, 1310720
s_lshl_b32 s50, s101, 7
s_add_u32 s50, s50, 16973824
s_waitcnt lgkmcnt(0)
s_barrier
ds_read_b128 v[96:99], v26 offset:0
ds_read_b128 v[100:103], v26 offset:256
ds_read_b128 v[104:107], v26 offset:8192
ds_read_b128 v[108:111], v26 offset:8448
ds_read_b128 v[112:115], v26 offset:4096
ds_read_b128 v[116:119], v26 offset:4352
ds_read_b128 v[120:123], v26 offset:12288
ds_read_b128 v[124:127], v26 offset:12544
s_waitcnt lgkmcnt(4)
v_pk_add_f32 v[96:97], v[96:97], v[104:105]
v_pk_add_f32 v[98:99], v[98:99], v[106:107]
v_pk_add_f32 v[100:101], v[100:101], v[108:109]
v_pk_add_f32 v[102:103], v[102:103], v[110:111]
v_cvt_pk_bf16_f32 v128, v96, v97
v_cvt_pk_bf16_f32 v129, v98, v99
v_cvt_pk_bf16_f32 v130, v100, v101
v_cvt_pk_bf16_f32 v131, v102, v103
buffer_store_dwordx4 v[128:131], v27, s[12:15], s51 offen sc1
s_waitcnt lgkmcnt(0)
v_pk_add_f32 v[112:113], v[112:113], v[120:121]
v_pk_add_f32 v[114:115], v[114:115], v[122:123]
v_pk_add_f32 v[116:117], v[116:117], v[124:125]
v_pk_add_f32 v[118:119], v[118:119], v[126:127]
v_cvt_pk_bf16_f32 v132, v112, v113
v_cvt_pk_bf16_f32 v133, v114, v115
v_cvt_pk_bf16_f32 v134, v116, v117
v_cvt_pk_bf16_f32 v135, v118, v119
buffer_store_dwordx4 v[132:135], v27, s[12:15], s52 offen sc1
buffer_load_dwordx4 v[160:163], v58, s[12:15], s43 offen sc1
buffer_load_dwordx4 v[164:167], v59, s[12:15], s43 offen sc1
buffer_load_dwordx4 v[168:171], v60, s[12:15], s43 offen sc1
buffer_load_dwordx4 v[172:175], v61, s[12:15], s43 offen sc1
buffer_load_dwordx4 v[176:179], v58, s[12:15], s44 offen sc1
buffer_load_dwordx4 v[180:183], v59, s[12:15], s44 offen sc1
buffer_load_dwordx4 v[184:187], v60, s[12:15], s44 offen sc1
buffer_load_dwordx4 v[188:191], v61, s[12:15], s44 offen sc1
buffer_load_dwordx4 v[192:195], v58, s[12:15], s45 offen sc1
buffer_load_dwordx4 v[196:199], v59, s[12:15], s45 offen sc1
buffer_load_dwordx4 v[200:203], v60, s[12:15], s45 offen sc1
buffer_load_dwordx4 v[204:207], v61, s[12:15], s45 offen sc1
s_cmp_lg_u64 s[46:47], 0
s_cbranch_scc1 slow41
back42:
v_lshlrev_b32 v36, 16, v46
v_and_b32 v37, 0xffff0000, v46
v_lshlrev_b32 v38, 16, v47
v_and_b32 v39, 0xffff0000, v47
v_lshlrev_b32 v40, 16, v48
v_and_b32 v41, 0xffff0000, v48
v_lshlrev_b32 v42, 16, v49
v_and_b32 v43, 0xffff0000, v49
v_lshlrev_b32 v44, 16, v50
v_and_b32 v45, 0xffff0000, v50
v_lshlrev_b32 v46, 16, v51
v_and_b32 v47, 0xffff0000, v51
v_lshlrev_b32 v48, 16, v52
v_and_b32 v49, 0xffff0000, v52
v_lshlrev_b32 v50, 16, v53
v_and_b32 v51, 0xffff0000, v53
v_lshlrev_b32 v52, 16, v54
v_and_b32 v53, 0xffff0000, v54
v_lshlrev_b32 v54, 16, v55
v_and_b32 v55, 0xffff0000, v55
s_mov_b32 s16, s66
s_mov_b32 s17, s67
s_mov_b32 s18, 2621440
s_mov_b32 s19, 0x20000
s_mov_b32 s101, 192
v_cmp_ne_u32 vcc, s101, v0
v_mov_b32 v15, 2146435072
s_nop 0
v_cndmask_b32 v15, 0, v15, vcc
s_waitcnt vmcnt(14)
v_mfma_f32_16x16x32_bf16 v[64:67], a[0:3], v[144:147], v[36:39]
v_mfma_f32_16x16x32_bf16 v[68:71], a[4:7], v[144:147], v[40:43]
buffer_load_dwordx4 v[208:211], v58, s[12:15], s90 offen sc1
v_mfma_f32_16x16x32_bf16 v[72:75], a[8:11], v[144:147], v[44:47]
v_mfma_f32_16x16x32_bf16 v[76:79], a[12:15], v[144:147], v[48:51]
v_mfma_f32_16x16x32_bf16 v[80:83], a[16:19], v[144:147], v[52:55]
v_mfma_f32_16x16x32_bf16 v[84:87], a[0:3], v[148:151], 0
v_mfma_f32_16x16x32_bf16 v[88:91], a[4:7], v[148:151], 0
buffer_load_dwordx4 v[212:215], v59, s[12:15], s90 offen sc1
v_mfma_f32_16x16x32_bf16 v[92:95], a[8:11], v[148:151], 0
v_mfma_f32_16x16x32_bf16 v[96:99], a[12:15], v[148:151], 0
v_mfma_f32_16x16x32_bf16 v[100:103], a[16:19], v[148:151], 0
v_mfma_f32_16x16x32_bf16 v[104:107], a[0:3], v[152:155], 0
v_mfma_f32_16x16x32_bf16 v[108:111], a[4:7], v[152:155], 0
buffer_load_dwordx4 v[216:219], v60, s[12:15], s90 offen sc1
v_mfma_f32_16x16x32_bf16 v[112:115], a[8:11], v[152:155], 0
v_mfma_f32_16x16x32_bf16 v[116:119], a[12:15], v[152:155], 0
v_mfma_f32_16x16x32_bf16 v[120:123], a[16:19], v[152:155], 0
v_mfma_f32_16x16x32_bf16 v[124:127], a[0:3], v[156:159], 0
v_mfma_f32_16x16x32_bf16 v[128:131], a[4:7], v[156:159], 0
buffer_load_dwordx4 v[220:223], v61, s[12:15], s90 offen sc1
v_mfma_f32_16x16x32_bf16 v[132:135], a[8:11], v[156:159], 0
v_mfma_f32_16x16x32_bf16 v[136:139], a[12:15], v[156:159], 0
v_mfma_f32_16x16x32_bf16 v[140:143], a[16:19], v[156:159], 0
s_waitcnt vmcnt(12)
s_barrier
buffer_store_dwordx2 v[10:11], v15, s[12:15], s50 offen sc1
v_mfma_f32_16x16x32_bf16 v[64:67], a[20:23], v[160:163], v[64:67]
s_xor_b32 s101, s3, 1
s_mul_i32 s101, s101, 15360
v_mfma_f32_16x16x32_bf16 v[68:71], a[24:27], v[160:163], v[68:71]
s_add_u32 s101, s101, 86528
buffer_load_dwordx4 v[144:147], v58, s[12:15], s91 offen sc1
v_add_u32 v25, s101, v56
s_xor_b32 s101, s3, 2
v_mfma_f32_16x16x32_bf16 v[72:75], a[28:31], v[160:163], v[72:75]
s_mul_i32 s101, s101, 15360
v_mfma_f32_16x16x32_bf16 v[76:79], a[32:35], v[160:163], v[76:79]
s_add_u32 s101, s101, 91648
v_add_u32 v26, s101, v56
v_mfma_f32_16x16x32_bf16 v[80:83], a[36:39], v[160:163], v[80:83]
s_xor_b32 s101, s3, 3
v_mfma_f32_16x16x32_bf16 v[84:87], a[20:23], v[164:167], v[84:87]
s_mul_i32 s101, s101, 15360
v_mfma_f32_16x16x32_bf16 v[88:91], a[24:27], v[164:167], v[88:91]
s_add_u32 s101, s101, 96768
v_add_u32 v27, s101, v56
buffer_load_dwordx4 v[148:151], v59, s[12:15], s91 offen sc1
s_mul_i32 s101, s3, 15360
v_mfma_f32_16x16x32_bf16 v[92:95], a[28:31], v[164:167], v[92:95]
s_add_u32 s101, s101, 86528
v_add_u32 v24, s101, v56
v_mfma_f32_16x16x32_bf16 v[96:99], a[32:35], v[164:167], v[96:99]
s_mul_i32 s101, s3, 3072
v_mfma_f32_16x16x32_bf16 v[100:103], a[36:39], v[164:167], v[100:103]
s_add_u32 s101, s101, 147968
v_add_u32 v28, s101, v56
v_mfma_f32_16x16x32_bf16 v[104:107], a[20:23], v[168:171], v[104:107]
v_lshl_add_u32 v29, v1, 3, s101
v_mfma_f32_16x16x32_bf16 v[108:111], a[24:27], v[168:171], v[108:111]
v_mul_u32_u24 v30, 176, v2
v_lshl_add_u32 v30, v3, 3, v30
buffer_load_dwordx4 v[152:155], v60, s[12:15], s91 offen sc1
v_add_u32 v30, s101, v30
v_mfma_f32_16x16x32_bf16 v[112:115], a[28:31], v[168:171], v[112:115]
v_mfma_f32_16x16x32_bf16 v[116:119], a[32:35], v[168:171], v[116:119]
v_mfma_f32_16x16x32_bf16 v[120:123], a[36:39], v[168:171], v[120:123]
v_mfma_f32_16x16x32_bf16 v[124:127], a[20:23], v[172:175], v[124:127]
v_mfma_f32_16x16x32_bf16 v[128:131], a[24:27], v[172:175], v[128:131]
buffer_load_dwordx4 v[156:159], v61, s[12:15], s91 offen sc1
v_mfma_f32_16x16x32_bf16 v[132:135], a[28:31], v[172:175], v[132:135]
v_mfma_f32_16x16x32_bf16 v[136:139], a[32:35], v[172:175], v[136:139]
v_mfma_f32_16x16x32_bf16 v[140:143], a[36:39], v[172:175], v[140:143]
s_waitcnt vmcnt(13)
v_mfma_f32_16x16x32_bf16 v[64:67], a[40:43], v[176:179], v[64:67]
v_add_u32 v12, 0, v1
v_mul_u32_u24 v13, 6554, v12
v_mfma_f32_16x16x32_bf16 v[68:71], a[44:47], v[176:179], v[68:71]
v_lshrrev_b32 v13, 16, v13
v_mul_u32_u24 v14, 10, v13
buffer_load_dwordx4 v[160:163], v58, s[12:15], s92 offen sc1
v_sub_u32 v12, v12, v14
v_mfma_f32_16x16x32_bf16 v[72:75], a[48:51], v[176:179], v[72:75]
v_mul_u32_u24 v14, 176, v13
v_lshl_add_u32 v14, v12, 4, v14
v_mfma_f32_16x16x32_bf16 v[76:79], a[52:55], v[176:179], v[76:79]
v_add_u32 v16, s101, v14
v_mul_u32_u24 v14, 1280, v13
v_mfma_f32_16x16x32_bf16 v[80:83], a[56:59], v[176:179], v[80:83]
v_lshl_add_u32 v20, v12, 4, v14
v_add_u32 v12, 64, v1
v_mfma_f32_16x16x32_bf16 v[84:87], a[40:43], v[180:183], v[84:87]
v_mul_u32_u24 v13, 6554, v12
v_mfma_f32_16x16x32_bf16 v[88:91], a[44:47], v[180:183], v[88:91]
v_lshrrev_b32 v13, 16, v13
v_mul_u32_u24 v14, 10, v13
buffer_load_dwordx4 v[164:167], v59, s[12:15], s92 offen sc1
v_sub_u32 v12, v12, v14
v_mul_u32_u24 v14, 176, v13
v_mfma_f32_16x16x32_bf16 v[92:95], a[48:51], v[180:183], v[92:95]
v_lshl_add_u32 v14, v12, 4, v14
v_mfma_f32_16x16x32_bf16 v[96:99], a[52:55], v[180:183], v[96:99]
v_add_u32 v17, s101, v14
v_mul_u32_u24 v14, 1280, v13
v_mfma_f32_16x16x32_bf16 v[100:103], a[56:59], v[180:183], v[100:103]
v_lshl_add_u32 v21, v12, 4, v14
v_add_u32 v12, 128, v1
v_mfma_f32_16x16x32_bf16 v[104:107], a[40:43], v[184:187], v[104:107]
v_mul_u32_u24 v13, 6554, v12
v_mfma_f32_16x16x32_bf16 v[108:111], a[44:47], v[184:187], v[108:111]
v_lshrrev_b32 v13, 16, v13
v_mul_u32_u24 v14, 10, v13
buffer_load_dwordx4 v[168:171], v60, s[12:15], s92 offen sc1
v_sub_u32 v12, v12, v14
v_mul_u32_u24 v14, 176, v13
v_mfma_f32_16x16x32_bf16 v[112:115], a[48:51], v[184:187], v[112:115]
v_lshl_add_u32 v14, v12, 4, v14
v_mfma_f32_16x16x32_bf16 v[116:119], a[52:55], v[184:187], v[116:119]
v_add_u32 v18, s101, v14
v_mul_u32_u24 v14, 1280, v13
v_mfma_f32_16x16x32_bf16 v[120:123], a[56:59], v[184:187], v[120:123]
v_lshl_add_u32 v22, v12, 4, v14
v_mfma_f32_16x16x32_bf16 v[124:127], a[40:43], v[188:191], v[124:127]
v_cmp_gt_u32 vcc, 32, v1
v_mov_b32 v12, 2146435072
v_mfma_f32_16x16x32_bf16 v[128:131], a[44:47], v[188:191], v[128:131]
v_cndmask_b32 v22, v12, v22, vcc
buffer_load_dwordx4 v[172:175], v61, s[12:15], s92 offen sc1
v_mfma_f32_16x16x32_bf16 v[132:135], a[48:51], v[188:191], v[132:135]
v_mfma_f32_16x16x32_bf16 v[136:139], a[52:55], v[188:191], v[136:139]
v_mfma_f32_16x16x32_bf16 v[140:143], a[56:59], v[188:191], v[140:143]
s_waitcnt vmcnt(13)
v_mfma_f32_16x16x32_bf16 v[64:67], a[60:63], v[192:195], v[64:67]
v_mfma_f32_16x16x32_bf16 v[68:71], a[64:67], v[192:195], v[68:71]
buffer_load_dwordx4 v[176:179], v58, s[12:15], s93 offen sc1
v_mfma_f32_16x16x32_bf16 v[72:75], a[68:71], v[192:195], v[72:75]
v_mfma_f32_16x16x32_bf16 v[76:79], a[72:75], v[192:195], v[76:79]
v_mfma_f32_16x16x32_bf16 v[80:83], a[76:79], v[192:195], v[80:83]
v_mfma_f32_16x16x32_bf16 v[84:87], a[60:63], v[196:199], v[84:87]
v_mfma_f32_16x16x32_bf16 v[88:91], a[64:67], v[196:199], v[88:91]
buffer_load_dwordx4 v[180:183], v59, s[12:15], s93 offen sc1
v_mfma_f32_16x16x32_bf16 v[92:95], a[68:71], v[196:199], v[92:95]
v_mfma_f32_16x16x32_bf16 v[96:99], a[72:75], v[196:199], v[96:99]
v_mfma_f32_16x16x32_bf16 v[100:103], a[76:79], v[196:199], v[100:103]
v_mfma_f32_16x16x32_bf16 v[104:107], a[60:63], v[200:203], v[104:107]
v_mfma_f32_16x16x32_bf16 v[108:111], a[64:67], v[200:203], v[108:111]
buffer_load_dwordx4 v[184:187], v60, s[12:15], s93 offen sc1
v_mfma_f32_16x16x32_bf16 v[112:115], a[68:71], v[200:203], v[112:115]
v_mfma_f32_16x16x32_bf16 v[116:119], a[72:75], v[200:203], v[116:119]
v_mfma_f32_16x16x32_bf16 v[120:123], a[76:79], v[200:203], v[120:123]
v_mfma_f32_16x16x32_bf16 v[124:127], a[60:63], v[204:207], v[124:127]
v_mfma_f32_16x16x32_bf16 v[128:131], a[64:67], v[204:207], v[128:131]
buffer_load_dwordx4 v[188:191], v61, s[12:15], s93 offen sc1
v_mfma_f32_16x16x32_bf16 v[132:135], a[68:71], v[204:207], v[132:135]
v_mfma_f32_16x16x32_bf16 v[136:139], a[72:75], v[204:207], v[136:139]
v_mfma_f32_16x16x32_bf16 v[140:143], a[76:79], v[204:207], v[140:143]
s_waitcnt vmcnt(13)
v_mfma_f32_16x16x32_bf16 v[64:67], a[80:83], v[208:211], v[64:67]
v_mfma_f32_16x16x32_bf16 v[68:71], a[84:87], v[208:211], v[68:71]
buffer_load_dwordx4 v[192:195], v58, s[12:15], s94 offen sc1
v_mfma_f32_16x16x32_bf16 v[72:75], a[88:91], v[208:211], v[72:75]
v_mfma_f32_16x16x32_bf16 v[76:79], a[92:95], v[208:211], v[76:79]
v_mfma_f32_16x16x32_bf16 v[80:83], a[96:99], v[208:211], v[80:83]
v_mfma_f32_16x16x32_bf16 v[84:87], a[80:83], v[212:215], v[84:87]
v_mfma_f32_16x16x32_bf16 v[88:91], a[84:87], v[212:215], v[88:91]
buffer_load_dwordx4 v[196:199], v59, s[12:15], s94 offen sc1
v_mfma_f32_16x16x32_bf16 v[92:95], a[88:91], v[212:215], v[92:95]
v_mfma_f32_16x16x32_bf16 v[96:99], a[92:95], v[212:215], v[96:99]
v_mfma_f32_16x16x32_bf16 v[100:103], a[96:99], v[212:215], v[100:103]
v_mfma_f32_16x16x32_bf16 v[104:107], a[80:83], v[216:219], v[104:107]
v_mfma_f32_16x16x32_bf16 v[108:111], a[84:87], v[216:219], v[108:111]
buffer_load_dwordx4 v[200:203], v60, s[12:15], s94 offen sc1
v_mfma_f32_16x16x32_bf16 v[112:115], a[88:91], v[216:219], v[112:115]
v_mfma_f32_16x16x32_bf16 v[116:119], a[92:95], v[216:219], v[116:119]
v_mfma_f32_16x16x32_bf16 v[120:123], a[96:99], v[216:219], v[120:123]
v_mfma_f32_16x16x32_bf16 v[124:127], a[80:83], v[220:223], v[124:127]
v_mfma_f32_16x16x32_bf16 v[128:131], a[84:87], v[220:223], v[128:131]
buffer_load_dwordx4 v[204:207], v61, s[12:15], s94 offen sc1
v_mfma_f32_16x16x32_bf16 v[132:135], a[88:91], v[220:223], v[132:135]
v_mfma_f32_16x16x32_bf16 v[136:139], a[92:95], v[220:223], v[136:139]
v_mfma_f32_16x16x32_bf16 v[140:143], a[96:99], v[220:223], v[140:143]
s_waitcnt vmcnt(12)
v_mfma_f32_16x16x32_bf16 v[64:67], a[100:103], v[144:147], v[64:67]
v_mfma_f32_16x16x32_bf16 v[68:71], a[104:107], v[144:147], v[68:71]
buffer_load_dwordx4 v[208:211], v58, s[12:15], s95 offen sc1
v_mfma_f32_16x16x32_bf16 v[72:75], a[108:111], v[144:147], v[72:75]
v_mfma_f32_16x16x32_bf16 v[76:79], a[112:115], v[144:147], v[76:79]
v_mfma_f32_16x16x32_bf16 v[80:83], a[116:119], v[144:147], v[80:83]
v_mfma_f32_16x16x32_bf16 v[84:87], a[100:103], v[148:151], v[84:87]
v_mfma_f32_16x16x32_bf16 v[88:91], a[104:107], v[148:151], v[88:91]
buffer_load_dwordx4 v[212:215], v59, s[12:15], s95 offen sc1
v_mfma_f32_16x16x32_bf16 v[92:95], a[108:111], v[148:151], v[92:95]
v_mfma_f32_16x16x32_bf16 v[96:99], a[112:115], v[148:151], v[96:99]
v_mfma_f32_16x16x32_bf16 v[100:103], a[116:119], v[148:151], v[100:103]
v_mfma_f32_16x16x32_bf16 v[104:107], a[100:103], v[152:155], v[104:107]
v_mfma_f32_16x16x32_bf16 v[108:111], a[104:107], v[152:155], v[108:111]
buffer_load_dwordx4 v[216:219], v60, s[12:15], s95 offen sc1
v_mfma_f32_16x16x32_bf16 v[112:115], a[108:111], v[152:155], v[112:115]
v_mfma_f32_16x16x32_bf16 v[116:119], a[112:115], v[152:155], v[116:119]
v_mfma_f32_16x16x32_bf16 v[120:123], a[116:119], v[152:155], v[120:123]
v_mfma_f32_16x16x32_bf16 v[124:127], a[100:103], v[156:159], v[124:127]
v_mfma_f32_16x16x32_bf16 v[128:131], a[104:107], v[156:159], v[128:131]
buffer_load_dwordx4 v[220:223], v61, s[12:15], s95 offen sc1
v_mfma_f32_16x16x32_bf16 v[132:135], a[108:111], v[156:159], v[132:135]
v_mfma_f32_16x16x32_bf16 v[136:139], a[112:115], v[156:159], v[136:139]
v_mfma_f32_16x16x32_bf16 v[140:143], a[116:119], v[156:159], v[140:143]
s_waitcnt vmcnt(12)
v_mfma_f32_16x16x32_bf16 v[64:67], a[120:123], v[160:163], v[64:67]
v_mfma_f32_16x16x32_bf16 v[68:71], a[124:127], v[160:163], v[68:71]
buffer_load_dwordx4 v[144:147], v58, s[12:15], s96 offen sc1
v_mfma_f32_16x16x32_bf16 v[72:75], a[128:131], v[160:163], v[72:75]
v_mfma_f32_16x16x32_bf16 v[76:79], a[132:135], v[160:163], v[76:79]
v_mfma_f32_16x16x32_bf16 v[80:83], a[136:139], v[160:163], v[80:83]
v_mfma_f32_16x16x32_bf16 v[84:87], a[120:123], v[164:167], v[84:87]
v_mfma_f32_16x16x32_bf16 v[88:91], a[124:127], v[164:167], v[88:91]
buffer_load_dwordx4 v[148:151], v59, s[12:15], s96 offen sc1
v_mfma_f32_16x16x32_bf16 v[92:95], a[128:131], v[164:167], v[92:95]
v_mfma_f32_16x16x32_bf16 v[96:99], a[132:135], v[164:167], v[96:99]
v_mfma_f32_16x16x32_bf16 v[100:103], a[136:139], v[164:167], v[100:103]
v_mfma_f32_16x16x32_bf16 v[104:107], a[120:123], v[168:171], v[104:107]
v_mfma_f32_16x16x32_bf16 v[108:111], a[124:127], v[168:171], v[108:111]
buffer_load_dwordx4 v[152:155], v60, s[12:15], s96 offen sc1
v_mfma_f32_16x16x32_bf16 v[112:115], a[128:131], v[168:171], v[112:115]
v_mfma_f32_16x16x32_bf16 v[116:119], a[132:135], v[168:171], v[116:119]
v_mfma_f32_16x16x32_bf16 v[120:123], a[136:139], v[168:171], v[120:123]
v_mfma_f32_16x16x32_bf16 v[124:127], a[120:123], v[172:175], v[124:127]
v_mfma_f32_16x16x32_bf16 v[128:131], a[124:127], v[172:175], v[128:131]
buffer_load_dwordx4 v[156:159], v61, s[12:15], s96 offen sc1
v_mfma_f32_16x16x32_bf16 v[132:135], a[128:131], v[172:175], v[132:135]
v_mfma_f32_16x16x32_bf16 v[136:139], a[132:135], v[172:175], v[136:139]
v_mfma_f32_16x16x32_bf16 v[140:143], a[136:139], v[172:175], v[140:143]
s_waitcnt vmcnt(12)
v_mfma_f32_16x16x32_bf16 v[64:67], a[140:143], v[176:179], v[64:67]
v_mfma_f32_16x16x32_bf16 v[68:71], a[144:147], v[176:179], v[68:71]
buffer_load_dwordx4 v[160:163], v58, s[12:15], s97 offen sc1
v_mfma_f32_16x16x32_bf16 v[72:75], a[148:151], v[176:179], v[72:75]
v_mfma_f32_16x16x32_bf16 v[76:79], a[152:155], v[176:179], v[76:79]
v_mfma_f32_16x16x32_bf16 v[80:83], a[156:159], v[176:179], v[80:83]
v_mfma_f32_16x16x32_bf16 v[84:87], a[140:143], v[180:183], v[84:87]
v_mfma_f32_16x16x32_bf16 v[88:91], a[144:147], v[180:183], v[88:91]
buffer_load_dwordx4 v[164:167], v59, s[12:15], s97 offen sc1
v_mfma_f32_16x16x32_bf16 v[92:95], a[148:151], v[180:183], v[92:95]
v_mfma_f32_16x16x32_bf16 v[96:99], a[152:155], v[180:183], v[96:99]
v_mfma_f32_16x16x32_bf16 v[100:103], a[156:159], v[180:183], v[100:103]
v_mfma_f32_16x16x32_bf16 v[104:107], a[140:143], v[184:187], v[104:107]
v_mfma_f32_16x16x32_bf16 v[108:111], a[144:147], v[184:187], v[108:111]
buffer_load_dwordx4 v[168:171], v60, s[12:15], s97 offen sc1
v_mfma_f32_16x16x32_bf16 v[112:115], a[148:151], v[184:187], v[112:115]
v_mfma_f32_16x16x32_bf16 v[116:119], a[152:155], v[184:187], v[116:119]
v_mfma_f32_16x16x32_bf16 v[120:123], a[156:159], v[184:187], v[120:123]
v_mfma_f32_16x16x32_bf16 v[124:127], a[140:143], v[188:191], v[124:127]
v_mfma_f32_16x16x32_bf16 v[128:131], a[144:147], v[188:191], v[128:131]
buffer_load_dwordx4 v[172:175], v61, s[12:15], s97 offen sc1
v_mfma_f32_16x16x32_bf16 v[132:135], a[148:151], v[188:191], v[132:135]
v_mfma_f32_16x16x32_bf16 v[136:139], a[152:155], v[188:191], v[136:139]
v_mfma_f32_16x16x32_bf16 v[140:143], a[156:159], v[188:191], v[140:143]
s_waitcnt vmcnt(12)
v_mfma_f32_16x16x32_bf16 v[64:67], a[160:163], v[192:195], v[64:67]
v_mfma_f32_16x16x32_bf16 v[68:71], a[164:167], v[192:195], v[68:71]
buffer_load_dwordx4 v[176:179], v58, s[12:15], s98 offen sc1
v_mfma_f32_16x16x32_bf16 v[72:75], a[168:171], v[192:195], v[72:75]
v_mfma_f32_16x16x32_bf16 v[76:79], a[172:175], v[192:195], v[76:79]
v_mfma_f32_16x16x32_bf16 v[80:83], a[176:179], v[192:195], v[80:83]
v_mfma_f32_16x16x32_bf16 v[84:87], a[160:163], v[196:199], v[84:87]
v_mfma_f32_16x16x32_bf16 v[88:91], a[164:167], v[196:199], v[88:91]
buffer_load_dwordx4 v[180:183], v59, s[12:15], s98 offen sc1
v_mfma_f32_16x16x32_bf16 v[92:95], a[168:171], v[196:199], v[92:95]
v_mfma_f32_16x16x32_bf16 v[96:99], a[172:175], v[196:199], v[96:99]
v_mfma_f32_16x16x32_bf16 v[100:103], a[176:179], v[196:199], v[100:103]
v_mfma_f32_16x16x32_bf16 v[104:107], a[160:163], v[200:203], v[104:107]
s_mul_i32 s101, s26, 5120
s_add_u32 s101, s101, 16973824
v_min_u32 v13, 39, v1
v_lshl_add_u32 v13, v13, 7, s101
buffer_load_dwordx2 v[14:15], v13, s[12:15], 0 offen sc1
v_mfma_f32_16x16x32_bf16 v[108:111], a[164:167], v[200:203], v[108:111]
buffer_load_dwordx4 v[184:187], v60, s[12:15], s98 offen sc1
v_mfma_f32_16x16x32_bf16 v[112:115], a[168:171], v[200:203], v[112:115]
v_mfma_f32_16x16x32_bf16 v[116:119], a[172:175], v[200:203], v[116:119]
v_mfma_f32_16x16x32_bf16 v[120:123], a[176:179], v[200:203], v[120:123]
v_mfma_f32_16x16x32_bf16 v[124:127], a[160:163], v[204:207], v[124:127]
v_mfma_f32_16x16x32_bf16 v[128:131], a[164:167], v[204:207], v[128:131]
buffer_load_dwordx4 v[188:191], v61, s[12:15], s98 offen sc1
v_mfma_f32_16x16x32_bf16 v[132:135], a[168:171], v[204:207], v[132:135]
v_mfma_f32_16x16x32_bf16 v[136:139], a[172:175], v[204:207], v[136:139]
v_mfma_f32_16x16x32_bf16 v[140:143], a[176:179], v[204:207], v[140:143]
s_waitcnt vmcnt(13)
v_mfma_f32_16x16x32_bf16 v[64:67], a[180:183], v[208:211], v[64:67]
v_mfma_f32_16x16x32_bf16 v[68:71], a[184:187], v[208:211], v[68:71]
buffer_load_dwordx4 v[192:195], v58, s[12:15], s99 offen sc1
v_mfma_f32_16x16x32_bf16 v[72:75], a[188:191], v[208:211], v[72:75]
v_mfma_f32_16x16x32_bf16 v[76:79], a[192:195], v[208:211], v[76:79]
v_mfma_f32_16x16x32_bf16 v[80:83], a[196:199], v[208:211], v[80:83]
v_mfma_f32_16x16x32_bf16 v[84:87], a[180:183], v[212:215], v[84:87]
v_mfma_f32_16x16x32_bf16 v[88:91], a[184:187], v[212:215], v[88:91]
buffer_load_dwordx4 v[196:199], v59, s[12:15], s99 offen sc1
v_mfma_f32_16x16x32_bf16 v[92:95], a[188:191], v[212:215], v[92:95]
v_mfma_f32_16x16x32_bf16 v[96:99], a[192:195], v[212:215], v[96:99]
v_mfma_f32_16x16x32_bf16 v[100:103], a[196:199], v[212:215], v[100:103]
v_mfma_f32_16x16x32_bf16 v[104:107], a[180:183], v[216:219], v[104:107]
v_mfma_f32_16x16x32_bf16 v[108:111], a[184:187], v[216:219], v[108:111]
buffer_load_dwordx4 v[200:203], v60, s[12:15], s99 offen sc1
v_mfma_f32_16x16x32_bf16 v[112:115], a[188:191], v[216:219], v[112:115]
v_mfma_f32_16x16x32_bf16 v[116:119], a[192:195], v[216:219], v[116:119]
v_mfma_f32_16x16x32_bf16 v[120:123], a[196:199], v[216:219], v[120:123]
v_mfma_f32_16x16x32_bf16 v[124:127], a[180:183], v[220:223], v[124:127]
v_mfma_f32_16x16x32_bf16 v[128:131], a[184:187], v[220:223], v[128:131]
buffer_load_dwordx4 v[204:207], v61, s[12:15], s99 offen sc1
v_mfma_f32_16x16x32_bf16 v[132:135], a[188:191], v[220:223], v[132:135]
v_mfma_f32_16x16x32_bf16 v[136:139], a[192:195], v[220:223], v[136:139]
v_mfma_f32_16x16x32_bf16 v[140:143], a[196:199], v[220:223], v[140:143]
s_waitcnt vmcnt(13)
v_mfma_f32_16x16x32_bf16 v[64:67], a[200:203], v[144:147], v[64:67]
v_mfma_f32_16x16x32_bf16 v[68:71], a[204:207], v[144:147], v[68:71]
v_mfma_f32_16x16x32_bf16 v[72:75], a[208:211], v[144:147], v[72:75]
v_mfma_f32_16x16x32_bf16 v[76:79], a[212:215], v[144:147], v[76:79]
v_mfma_f32_16x16x32_bf16 v[80:83], a[216:219], v[144:147], v[80:83]
v_mfma_f32_16x16x32_bf16 v[84:87], a[200:203], v[148:151], v[84:87]
v_mfma_f32_16x16x32_bf16 v[88:91], a[204:207], v[148:151], v[88:91]
v_mfma_f32_16x16x32_bf16 v[92:95], a[208:211], v[148:151], v[92:95]
v_mfma_f32_16x16x32_bf16 v[96:99], a[212:215], v[148:151], v[96:99]
v_mfma_f32_16x16x32_bf16 v[100:103], a[216:219], v[148:151], v[100:103]
v_mfma_f32_16x16x32_bf16 v[104:107], a[200:203], v[152:155], v[104:107]
v_mfma_f32_16x16x32_bf16 v[108:111], a[204:207], v[152:155], v[108:111]
v_mfma_f32_16x16x32_bf16 v[112:115], a[208:211], v[152:155], v[112:115]
v_mfma_f32_16x16x32_bf16 v[116:119], a[212:215], v[152:155], v[116:119]
v_mfma_f32_16x16x32_bf16 v[120:123], a[216:219], v[152:155], v[120:123]
v_mfma_f32_16x16x32_bf16 v[124:127], a[200:203], v[156:159], v[124:127]
v_mfma_f32_16x16x32_bf16 v[128:131], a[204:207], v[156:159], v[128:131]
v_mfma_f32_16x16x32_bf16 v[132:135], a[208:211], v[156:159], v[132:135]
v_mfma_f32_16x16x32_bf16 v[136:139], a[212:215], v[156:159], v[136:139]
v_mfma_f32_16x16x32_bf16 v[140:143], a[216:219], v[156:159], v[140:143]
s_waitcnt vmcnt(9)
v_mfma_f32_16x16x32_bf16 v[84:87], a[220:223], v[164:167], v[84:87]
v_mfma_f32_16x16x32_bf16 v[88:91], a[224:227], v[164:167], v[88:91]
s_waitcnt vmcnt(6)
v_cmp_ne_u64 vcc, v[14:15], s[20:21]
v_mfma_f32_16x16x32_bf16 v[92:95], a[228:231], v[164:167], v[92:95]
s_cbranch_vccnz slow43
back44:
v_mfma_f32_16x16x32_bf16 v[96:99], a[232:235], v[164:167], v[96:99]
s_lshl_b32 s101, s25, 2
s_add_u32 s101, s101, s3
v_mfma_f32_16x16x32_bf16 v[100:103], a[236:239], v[164:167], v[100:103]
s_mul_i32 s51, s101, 20480
s_lshl_b32 s52, s101, 6
s_waitcnt vmcnt(4)
s_mul_i32 s101, s26, 2560
s_add_u32 s51, s51, s101
v_mfma_f32_16x16x32_bf16 v[84:87], a[240:243], v[180:183], v[84:87]
s_add_u32 s51, s51, 13631488
s_add_u32 s52, s52, 16777216
v_mfma_f32_16x16x32_bf16 v[88:91], a[244:247], v[180:183], v[88:91]
v_cmp_gt_u32 vcc, 32, v1
v_mov_b32 v12, 2146435072
v_mfma_f32_16x16x32_bf16 v[92:95], a[248:251], v[180:183], v[92:95]
v_lshlrev_b32 v13, 2, v2
v_cndmask_b32 v12, v12, v56, vcc
v_mfma_f32_16x16x32_bf16 v[96:99], a[252:255], v[180:183], v[96:99]
buffer_load_dwordx4 v[208:211], v56, s[12:15], s51 offen sc1
buffer_load_dwordx4 v[212:215], v56, s[12:15], s51 offen offset:1024 sc1
v_mfma_f32_16x16x32_bf16 v[100:103], v[232:235], v[180:183], v[100:103]
buffer_load_dwordx4 v[216:219], v12, s[12:15], s51 offen offset:2048 sc1
buffer_load_dword v62, v13, s[12:15], s52 offen sc1
s_waitcnt vmcnt(4)
s_lshl_b32 s101, s25, 2
s_add_u32 s101, s101, s3
v_mfma_f32_16x16x32_bf16 v[84:87], v[236:239], v[196:199], v[84:87]
s_mul_i32 s51, s101, 20480
s_mul_i32 s101, s26, 160
v_mfma_f32_16x16x32_bf16 v[88:91], v[240:243], v[196:199], v[88:91]
s_add_u32 s51, s51, s101
v_mfma_f32_16x16x32_bf16 v[92:95], v[244:247], v[196:199], v[92:95]
v_mfma_f32_16x16x32_bf16 v[96:99], v[248:251], v[196:199], v[96:99]
v_mfma_f32_16x16x32_bf16 v[100:103], v[252:255], v[196:199], v[100:103]
v_mfma_f32_16x16x32_bf16 v[104:107], a[220:223], v[168:171], v[104:107]
v_mfma_f32_16x16x32_bf16 v[108:111], a[224:227], v[168:171], v[108:111]
v_mfma_f32_16x16x32_bf16 v[112:115], a[228:231], v[168:171], v[112:115]
ds_write_b128 v25, v[84:87] offset:0
v_mfma_f32_16x16x32_bf16 v[116:119], a[232:235], v[168:171], v[116:119]
v_mfma_f32_16x16x32_bf16 v[120:123], a[236:239], v[168:171], v[120:123]
v_mfma_f32_16x16x32_bf16 v[104:107], a[240:243], v[184:187], v[104:107]
ds_write_b128 v25, v[88:91] offset:1024
v_mfma_f32_16x16x32_bf16 v[108:111], a[244:247], v[184:187], v[108:111]
v_mfma_f32_16x16x32_bf16 v[112:115], a[248:251], v[184:187], v[112:115]
v_mfma_f32_16x16x32_bf16 v[116:119], a[252:255], v[184:187], v[116:119]
ds_write_b128 v25, v[92:95] offset:2048
v_mfma_f32_16x16x32_bf16 v[120:123], v[232:235], v[184:187], v[120:123]
v_mfma_f32_16x16x32_bf16 v[104:107], v[236:239], v[200:203], v[104:107]
v_mfma_f32_16x16x32_bf16 v[108:111], v[240:243], v[200:203], v[108:111]
ds_write_b128 v25, v[96:99] offset:3072
v_mfma_f32_16x16x32_bf16 v[112:115], v[244:247], v[200:203], v[112:115]
v_mfma_f32_16x16x32_bf16 v[116:119], v[248:251], v[200:203], v[116:119]
v_mfma_f32_16x16x32_bf16 v[120:123], v[252:255], v[200:203], v[120:123]
ds_write_b128 v25, v[100:103] offset:4096
v_mfma_f32_16x16x32_bf16 v[124:127], a[220:223], v[172:175], v[124:127]
v_mfma_f32_16x16x32_bf16 v[128:131], a[224:227], v[172:175], v[128:131]
v_mfma_f32_16x16x32_bf16 v[132:135], a[228:231], v[172:175], v[132:135]
ds_write_b128 v26, v[104:107] offset:0
v_mfma_f32_16x16x32_bf16 v[136:139], a[232:235], v[172:175], v[136:139]
v_mfma_f32_16x16x32_bf16 v[140:143], a[236:239], v[172:175], v[140:143]
v_mfma_f32_16x16x32_bf16 v[124:127], a[240:243], v[188:191], v[124:127]
ds_write_b128 v26, v[108:111] offset:1024
v_mfma_f32_16x16x32_bf16 v[128:131], a[244:247], v[188:191], v[128:131]
v_mfma_f32_16x16x32_bf16 v[132:135], a[248:251], v[188:191], v[132:135]
v_mfma_f32_16x16x32_bf16 v[136:139], a[252:255], v[188:191], v[136:139]
ds_write_b128 v26, v[112:115] offset:2048
v_mfma_f32_16x16x32_bf16 v[140:143], v[232:235], v[188:191], v[140:143]
v_mfma_f32_16x16x32_bf16 v[124:127], v[236:239], v[204:207], v[124:127]
v_mfma_f32_16x16x32_bf16 v[128:131], v[240:243], v[204:207], v[128:131]
ds_write_b128 v26, v[116:119] offset:3072
v_mfma_f32_16x16x32_bf16 v[132:135], v[244:247], v[204:207], v[132:135]
v_mfma_f32_16x16x32_bf16 v[136:139], v[248:251], v[204:207], v[136:139]
v_mfma_f32_16x16x32_bf16 v[140:143], v[252:255], v[204:207], v[140:143]
ds_write_b128 v26, v[120:123] offset:4096
v_mfma_f32_16x16x32_bf16 v[64:67], a[220:223], v[160:163], v[64:67]
v_mfma_f32_16x16x32_bf16 v[68:71], a[224:227], v[160:163], v[68:71]
v_mfma_f32_16x16x32_bf16 v[72:75], a[228:231], v[160:163], v[72:75]
ds_write_b128 v27, v[124:127] offset:0
v_mfma_f32_16x16x32_bf16 v[76:79], a[232:235], v[160:163], v[76:79]
v_mfma_f32_16x16x32_bf16 v[80:83], a[236:239], v[160:163], v[80:83]
v_mfma_f32_16x16x32_bf16 v[64:67], a[240:243], v[176:179], v[64:67]
ds_write_b128 v27, v[128:131] offset:1024
v_mfma_f32_16x16x32_bf16 v[68:71], a[244:247], v[176:179], v[68:71]
v_mfma_f32_16x16x32_bf16 v[72:75], a[248:251], v[176:179], v[72:75]
v_mfma_f32_16x16x32_bf16 v[76:79], a[252:255], v[176:179], v[76:79]
ds_write_b128 v27, v[132:135] offset:2048
v_mfma_f32_16x16x32_bf16 v[80:83], v[232:235], v[176:179], v[80:83]
v_mfma_f32_16x16x32_bf16 v[64:67], v[236:239], v[192:195], v[64:67]
v_mfma_f32_16x16x32_bf16 v[68:71], v[240:243], v[192:195], v[68:71]
ds_write_b128 v27, v[136:139] offset:3072
v_mfma_f32_16x16x32_bf16 v[72:75], v[244:247], v[192:195], v[72:75]
v_mfma_f32_16x16x32_bf16 v[76:79], v[248:251], v[192:195], v[76:79]
v_mfma_f32_16x16x32_bf16 v[80:83], v[252:255], v[192:195], v[80:83]
ds_write_b128 v27, v[140:143] offset:4096
s_waitcnt vmcnt(0)
ds_write_b128 v28, v[208:211] offset:0
ds_write_b128 v28, v[212:215] offset:1024
ds_write_b128 v28, v[216:219] offset:2048
s_waitcnt lgkmcnt(0)
s_barrier
ds_read_b64_tr_b16 v[36:37], v29 offset:0
ds_read_b128 v[84:87], v24 offset:0
ds_read_b128 v[104:107], v24 offset:5120
ds_read_b128 v[124:127], v24 offset:10240
ds_read_b64_tr_b16 v[38:39], v29 offset:512
ds_read_b128 v[88:91], v24 offset:1024
ds_read_b128 v[108:111], v24 offset:6144
ds_read_b128 v[128:131], v24 offset:11264
ds_read_b64_tr_b16 v[40:41], v29 offset:1024
ds_read_b128 v[92:95], v24 offset:2048
ds_read_b128 v[112:115], v24 offset:7168
ds_read_b128 v[132:135], v24 offset:12288
ds_read_b64_tr_b16 v[42:43], v29 offset:1536
ds_read_b128 v[96:99], v24 offset:3072
ds_read_b128 v[116:119], v24 offset:8192
ds_read_b128 v[136:139], v24 offset:13312
ds_read_b64_tr_b16 v[44:45], v29 offset:2048
ds_read_b128 v[100:103], v24 offset:4096
ds_read_b128 v[120:123], v24 offset:9216
ds_read_b128 v[140:143], v24 offset:14336
s_waitcnt lgkmcnt(15)
v_pk_add_f32 v[64:65], v[64:65], v[84:85]
v_pk_add_f32 v[66:67], v[66:67], v[86:87]
v_pk_add_f32 v[64:65], v[64:65], v[104:105]
v_pk_add_f32 v[66:67], v[66:67], v[106:107]
v_pk_add_f32 v[64:65], v[64:65], v[124:125]
v_pk_add_f32 v[66:67], v[66:67], v[126:127]
v_lshlrev_b32 v48, 16, v36
v_and_b32 v49, 0xffff0000, v36
v_lshlrev_b32 v50, 16, v37
v_and_b32 v51, 0xffff0000, v37
v_pk_add_f32 v[48:49], v[48:49], v[64:65] neg_lo:[0,1] neg_hi:[0,1]
v_pk_add_f32 v[50:51], v[50:51], v[66:67] neg_lo:[0,1] neg_hi:[0,1]
v_pk_fma_f32 v[64:65], v[48:49], v[62:63], v[64:65] op_sel_hi:[1,0,1]
v_pk_fma_f32 v[66:67], v[50:51], v[62:63], v[66:67] op_sel_hi:[1,0,1]
v_cvt_pk_bf16_f32 v52, v64, v65
v_cvt_pk_bf16_f32 v53, v66, v67
ds_write_b64 v30, v[52:53] offset:0
s_waitcnt lgkmcnt(13)
v_pk_add_f32 v[68:69], v[68:69], v[88:89]
v_pk_add_f32 v[70:71], v[70:71], v[90:91]
v_pk_add_f32 v[68:69], v[68:69], v[108:109]
v_pk_add_f32 v[70:71], v[70:71], v[110:111]
v_pk_add_f32 v[68:69], v[68:69], v[128:129]
v_pk_add_f32 v[70:71], v[70:71], v[130:131]
v_lshlrev_b32 v48, 16, v38
v_and_b32 v49, 0xffff0000, v38
v_lshlrev_b32 v50, 16, v39
v_and_b32 v51, 0xffff0000, v39
v_pk_add_f32 v[48:49], v[48:49], v[68:69] neg_lo:[0,1] neg_hi:[0,1]
v_pk_add_f32 v[50:51], v[50:51], v[70:71] neg_lo:[0,1] neg_hi:[0,1]
v_pk_fma_f32 v[68:69], v[48:49], v[62:63], v[68:69] op_sel_hi:[1,0,1]
v_pk_fma_f32 v[70:71], v[50:51], v[62:63], v[70:71] op_sel_hi:[1,0,1]
v_cvt_pk_bf16_f32 v54, v68, v69
v_cvt_pk_bf16_f32 v55, v70, v71
ds_write_b64 v30, v[54:55] offset:32
s_waitcnt lgkmcnt(10)
v_pk_add_f32 v[72:73], v[72:73], v[92:93]
v_pk_add_f32 v[74:75], v[74:75], v[94:95]
v_pk_add_f32 v[72:73], v[72:73], v[112:113]
v_pk_add_f32 v[74:75], v[74:75], v[114:115]
v_pk_add_f32 v[72:73], v[72:73], v[132:133]
v_pk_add_f32 v[74:75], v[74:75], v[134:135]
v_lshlrev_b32 v48, 16, v40
v_and_b32 v49, 0xffff0000, v40
v_lshlrev_b32 v50, 16, v41
v_and_b32 v51, 0xffff0000, v41
v_pk_add_f32 v[48:49], v[48:49], v[72:73] neg_lo:[0,1] neg_hi:[0,1]
v_pk_add_f32 v[50:51], v[50:51], v[74:75] neg_lo:[0,1] neg_hi:[0,1]
v_pk_fma_f32 v[72:73], v[48:49], v[62:63], v[72:73] op_sel_hi:[1,0,1]
v_pk_fma_f32 v[74:75], v[50:51], v[62:63], v[74:75] op_sel_hi:[1,0,1]
v_cvt_pk_bf16_f32 v52, v72, v73
v_cvt_pk_bf16_f32 v53, v74, v75
ds_write_b64 v30, v[52:53] offset:64
s_waitcnt lgkmcnt(7)
v_pk_add_f32 v[76:77], v[76:77], v[96:97]
v_pk_add_f32 v[78:79], v[78:79], v[98:99]
v_pk_add_f32 v[76:77], v[76:77], v[116:117]
v_pk_add_f32 v[78:79], v[78:79], v[118:119]
v_pk_add_f32 v[76:77], v[76:77], v[136:137]
v_pk_add_f32 v[78:79], v[78:79], v[138:139]
v_lshlrev_b32 v48, 16, v42
v_and_b32 v49, 0xffff0000, v42
v_lshlrev_b32 v50, 16, v43
v_and_b32 v51, 0xffff0000, v43
v_pk_add_f32 v[48:49], v[48:49], v[76:77] neg_lo:[0,1] neg_hi:[0,1]
v_pk_add_f32 v[50:51], v[50:51], v[78:79] neg_lo:[0,1] neg_hi:[0,1]
v_pk_fma_f32 v[76:77], v[48:49], v[62:63], v[76:77] op_sel_hi:[1,0,1]
v_pk_fma_f32 v[78:79], v[50:51], v[62:63], v[78:79] op_sel_hi:[1,0,1]
v_cvt_pk_bf16_f32 v54, v76, v77
v_cvt_pk_bf16_f32 v55, v78, v79
ds_write_b64 v30, v[54:55] offset:96
s_waitcnt lgkmcnt(4)
v_pk_add_f32 v[80:81], v[80:81], v[100:101]
v_pk_add_f32 v[82:83], v[82:83], v[102:103]
v_pk_add_f32 v[80:81], v[80:81], v[120:121]
v_pk_add_f32 v[82:83], v[82:83], v[122:123]
v_pk_add_f32 v[80:81], v[80:81], v[140:141]
v_pk_add_f32 v[82:83], v[82:83], v[142:143]
v_lshlrev_b32 v48, 16, v44
v_and_b32 v49, 0xffff0000, v44
v_lshlrev_b32 v50, 16, v45
v_and_b32 v51, 0xffff0000, v45
v_pk_add_f32 v[48:49], v[48:49], v[80:81] neg_lo:[0,1] neg_hi:[0,1]
v_pk_add_f32 v[50:51], v[50:51], v[82:83] neg_lo:[0,1] neg_hi:[0,1]
v_pk_fma_f32 v[80:81], v[48:49], v[62:63], v[80:81] op_sel_hi:[1,0,1]
v_pk_fma_f32 v[82:83], v[50:51], v[62:63], v[82:83] op_sel_hi:[1,0,1]
v_cvt_pk_bf16_f32 v52, v80, v81
v_cvt_pk_bf16_f32 v53, v82, v83
ds_write_b64 v30, v[52:53] offset:128
ds_read_b128 v[96:99], v16
ds_read_b128 v[100:103], v17
ds_read_b128 v[104:107], v18
s_waitcnt lgkmcnt(2)
buffer_store_dwordx4 v[96:99], v20, s[16:19], s51 offen
s_waitcnt lgkmcnt(1)
buffer_store_dwordx4 v[100:103], v21, s[16:19], s51 offen
s_waitcnt lgkmcnt(0)
buffer_store_dwordx4 v[104:107], v22, s[16:19], s51 offen
s_endpgm
slow33:
s_mov_b32 s100, 0
v_mov_b32 v13, 0
slow33l:
global_load_dwordx2 v[10:11], v13, s[68:69] sc1
s_add_u32 s100, s100, 1
s_waitcnt vmcnt(0)
v_readfirstlane_b32 s21, v11
v_readfirstlane_b32 s20, v10
s_cmp_ge_u32 s100, 0x8000
s_cbranch_scc1 slow33x
s_cmp_eq_u32 s21, 0
s_cbranch_scc1 slow33l
slow33x:
s_nop 4
s_branch back34
slow35:
s_mov_b32 s100, 0
slow35l:
buffer_load_dwordx2 v[14:15], v13, s[12:15], 0 offen sc1
s_add_u32 s100, s100, 1
s_cmp_ge_u32 s100, 0x8000
s_cbranch_scc1 slow35x
s_waitcnt vmcnt(0)
v_cmp_ne_u64 vcc, v[14:15], s[20:21]
s_cbranch_vccnz slow35l
slow35x:
s_waitcnt vmcnt(0)
s_branch back36
slow37:
s_mov_b32 s100, 0
slow37l:
buffer_load_dwordx2 v[226:227], v12, s[12:15], 0 offen sc1
s_add_u32 s100, s100, 1
s_cmp_ge_u32 s100, 0x8000
s_cbranch_scc1 slow37x
s_waitcnt vmcnt(0)
v_cmp_ne_u64 vcc, v[226:227], s[20:21]
s_cbranch_vccnz slow37l
slow37x:
s_waitcnt vmcnt(0)
s_branch back38
slow41:
s_mov_b32 s100, 0
slow41l:
buffer_load_dwordx2 v[14:15], v13, s[12:15], 0 offen sc1
s_add_u32 s100, s100, 1
s_cmp_ge_u32 s100, 0x8000
s_cbranch_scc1 slow41x
s_waitcnt vmcnt(0)
v_cmp_ne_u64 vcc, v[14:15], s[20:21]
s_cbranch_vccnz slow41l
slow41x:
s_waitcnt vmcnt(0)
buffer_load_dwordx4 v[144:147], v58, s[12:15], s86 offen sc1
buffer_load_dwordx4 v[148:151], v59, s[12:15], s86 offen sc1
buffer_load_dwordx4 v[152:155], v60, s[12:15], s86 offen sc1
buffer_load_dwordx4 v[156:159], v61, s[12:15], s86 offen sc1
buffer_load_dwordx4 v[160:163], v58, s[12:15], s87 offen sc1
buffer_load_dwordx4 v[164:167], v59, s[12:15], s87 offen sc1
buffer_load_dwordx4 v[168:171], v60, s[12:15], s87 offen sc1
buffer_load_dwordx4 v[172:175], v61, s[12:15], s87 offen sc1
buffer_load_dwordx4 v[176:179], v58, s[12:15], s88 offen sc1
buffer_load_dwordx4 v[180:183], v59, s[12:15], s88 offen sc1
buffer_load_dwordx4 v[184:187], v60, s[12:15], s88 offen sc1
buffer_load_dwordx4 v[188:191], v61, s[12:15], s88 offen sc1
buffer_load_dwordx4 v[192:195], v58, s[12:15], s89 offen sc1
buffer_load_dwordx4 v[196:199], v59, s[12:15], s89 offen sc1
buffer_load_dwordx4 v[200:203], v60, s[12:15], s89 offen sc1
buffer_load_dwordx4 v[204:207], v61, s[12:15], s89 offen sc1
v_mov_b32 v12, 2146435072
buffer_load_dword v229, v12, s[12:15], 0 offen
buffer_load_dword v229, v12, s[12:15], 0 offen
s_branch back42
slow43:
s_mov_b32 s100, 0
slow43l:
buffer_load_dwordx2 v[14:15], v13, s[12:15], 0 offen sc1
s_add_u32 s100, s100, 1
s_cmp_ge_u32 s100, 0x8000
s_cbranch_scc1 slow43x
s_waitcnt vmcnt(0)
v_cmp_ne_u64 vcc, v[14:15], s[20:21]
s_cbranch_vccnz slow43l
slow43x:
s_waitcnt vmcnt(0)
s_branch back44
L_C_end:
L_end:
s_endpgm
.section .rodata,"a"
.p2align 6
.amdhsa_kernel gated_mix__ssm_conv_s4__dense_activation_gelu__prompt_kernel
  .amdhsa_next_free_vgpr 512
  .amdhsa_next_free_sgpr 102
  .amdhsa_accum_offset 256
  .amdhsa_group_segment_fixed_size 0
  .amdhsa_kernarg_size 144
  .amdhsa_user_sgpr_count 2
  .amdhsa_user_sgpr_kernarg_segment_ptr 1
  .amdhsa_system_sgpr_workgroup_id_x 1
.end_amdhsa_kernel
```
